```python
import torch

def _softmax(x, axis=-1):
    return torch.softmax(x, dim=axis)

def _gelu(x):
    return torch.nn.functional.gelu(x, approximate='tanh')

def _silu(x):
    return torch.nn.functional.silu(x)

def _sigmoid(x):
    return torch.sigmoid(x)

def _layernorm(x, axis=-1, eps=1e-05):
    m = x.mean(dim=axis, keepdim=True)
    v = x.var(dim=axis, keepdim=True, unbiased=False)
    return (x - m) / torch.sqrt(v + eps)

def _scatter_add(tgt, idx, src, axis=0):
    return tgt.clone().index_add_(axis, idx, src)

def _segment_sum(src, seg, n):
    out = torch.zeros((n,) + src.shape[1:], dtype=src.dtype)
    return out.index_add_(0, seg, src)

def _pad(x, pw):
    flat = tuple((v for pair in reversed(pw) for v in pair))
    return torch.nn.functional.pad(x, flat)
kernel_name = 'adaLN_cond__mha_block_cached__glu_gated_reglu__prompt'

def setup_inputs():

    _w = lambda a: (lambda t: t.to(torch.bfloat16) if t.is_floating_point() else t)(torch.as_tensor(a))

    def _A_setup():
        B, Sq, D = (1, 2048, 640)
        H, Sk, Dh = (32, 2048, 128)
        return {'x': _w((lambda *s: torch.randn(*s, dtype=torch.bfloat16) * 0.05)(B, Sq, D)), 'k_cache': _w((lambda *s: torch.randn(*s, dtype=torch.bfloat16) * 1.6)(B, H, Sk, Dh)), 'v_cache': _w((lambda *s: torch.randn(*s, dtype=torch.bfloat16) * 0.8)(B, H, Sk, Dh)), 'wq': _w((lambda *s: torch.randn(*s, dtype=torch.bfloat16) * 1.6)(D, H * Dh) * D ** (-0.5)), 'wo': _w((lambda *s: torch.randn(*s, dtype=torch.bfloat16) * 0.8)(H * Dh, D) * (H * Dh) ** (-0.5))}
    _A_in = _A_setup()

    def _B_setup():
        B, S, D, F = (1, 2048, 640, 1728)
        return {'x': _w((lambda *s: torch.randn(*s, dtype=torch.bfloat16) * 0.05)(B, S, D)), 'W_gate': _w((lambda *s: torch.randn(*s, dtype=torch.bfloat16) * 0.4)(D, F) * (2.0 / D) ** 0.5), 'W_up': _w((lambda *s: torch.randn(*s, dtype=torch.bfloat16) * 0.4)(D, F) * (2.0 / D) ** 0.5), 'W_down': _w((lambda *s: torch.randn(*s, dtype=torch.bfloat16) * 0.4)(F, D) * (1.0 / F) ** 0.5)}
    _B_in = _B_setup()
    return {'A_x': _A_in['x'], 'A_k_cache': _A_in['k_cache'], 'A_v_cache': _A_in['v_cache'], 'A_wq': _A_in['wq'], 'A_wo': _A_in['wo'], 'B_x': _B_in['x'], 'B_W_gate': _B_in['W_gate'], 'B_W_up': _B_in['W_up'], 'B_W_down': _B_in['W_down'], 'c': _w((lambda *s: torch.randn(*s, dtype=torch.bfloat16) * 0.2)(1, 640) * 8.0), 'w_mod': _w((lambda *s: torch.randn(*s, dtype=torch.bfloat16) * 0.2)(640, 6 * 640) * 640 ** (-0.5) * 8.0)}

def reference(A_x, A_k_cache, A_v_cache, A_wq, A_wo, B_x, B_W_gate, B_W_up, B_W_down, c, w_mod):

    def _A_ref(x, k_cache, v_cache, wq, wo):
        B, Sq, D = x.shape
        H, Dh = (32, 128)
        q = (lambda x, *d: x.permute(*d))((x @ wq).reshape(B, Sq, H, Dh), 0, 2, 1, 3)
        scores = torch.einsum('bhqd,bhkd->bhqk', q, k_cache) * Dh ** (-0.5)
        p = _softmax(scores, axis=-1)
        o = torch.einsum('bhqk,bhkd->bhqd', p, v_cache)
        return (lambda x, *d: x.permute(*d))(o, 0, 2, 1, 3).reshape(B, Sq, H * Dh) @ wo

    def _B_ref(x, W_gate, W_up, W_down):
        gate = torch.einsum('bsd,df->bsf', x, W_gate)
        up = torch.einsum('bsd,df->bsf', x, W_up)
        gate = gate * (lambda x, dt: x.to(dt))(gate > 0, gate.dtype)
        h = gate * up
        return torch.einsum('bsf,fd->bsd', h, W_down)
    x = A_x
    mod = (_silu(c) @ w_mod).reshape(c.shape[0], 6, 1, -1)
    sa, ca, ga, sb, cb, gb = (mod[:, 0].clone(), mod[:, 1].clone(), mod[:, 2].clone(), mod[:, 3].clone(), mod[:, 4].clone(), mod[:, 5].clone())
    h = _layernorm(x, axis=-1) * (1 + ca) + sa
    x = x + ga * _A_ref(h, A_k_cache, A_v_cache, A_wq, A_wo)
    h = _layernorm(x, axis=-1) * (1 + cb) + sb
    x = x + gb * _B_ref(h, B_W_gate, B_W_up, B_W_down)
    return x
```

```asm
; @launch grid=(256,1,1) block=(256,1,1) lds=163840
.amdgcn_target "amdgcn-amd-amdhsa--gfx950"
.text
.globl adaLN_cond__mha_block_cached__glu_gated_reglu__prompt_kernel
.p2align 8
.type adaLN_cond__mha_block_cached__glu_gated_reglu__prompt_kernel,@function
adaLN_cond__mha_block_cached__glu_gated_reglu__prompt_kernel:
    s_cmp_ge_u32 s2, 256
    s_cbranch_scc1 PK_end
    s_load_dwordx16 s[44:59], s[0:1], 0
    s_load_dwordx4 s[76:79], s[0:1], 72
    s_load_dwordx2 s[96:97], s[0:1], 104
    s_load_dwordx2 s[40:41], s[0:1], 64
    s_load_dwordx2 s[42:43], s[0:1], 88
    s_and_b32 s3, s2, 0xf8
    s_cmp_lg_u32 s3, 120
    s_cbranch_scc1 R_nopf
    s_getpc_b64 s[100:101]
    v_lshlrev_b32 v253, 7, v0
    global_load_dword a255, v253, s[100:101]
R_nopf:
    v_lshrrev_b32 v1, 6, v0
    v_and_b32 v2, 63, v0
    v_readfirstlane_b32 s22, v1
    v_lshrrev_b32 v3, 4, v2
    v_and_b32 v4, 15, v2
    s_cmp_ge_u32 s2, 128
    s_cbranch_scc1 R_lnld
    s_mov_b32 s30, s2
    v_lshrrev_b32 v14, 3, v0
    v_and_b32 v15, 7, v0
    s_and_b32 s98, s2, 1
    s_lshl_b32 s98, s98, 5
    v_add_u32 v14, s98, v14
    v_mul_u32_u24 v5, 20, v14
    s_mov_b32 s3, 76800
    v_mul_lo_u32 v6, s3, v14
    v_lshl_add_u32 v6, v15, 4, v6
    s_lshr_b32 s3, s2, 1
    s_lshl_b32 s3, s3, 7
    s_mov_b32 s99, 2883584
    s_waitcnt lgkmcnt(0)
    s_load_dword s39, s[96:97], s99
    s_mov_b32 s4, s76
    s_and_b32 s5, s77, 0xffff
    s_mov_b32 s6, 1280
    s_mov_b32 s7, 0x20000
    s_cmp_lt_u32 s2, 120
    s_cselect_b32 s98, 4915200, 0
    s_mov_b32 s8, s78
    s_and_b32 s9, s79, 0xffff
    s_mov_b32 s10, s98
    s_mov_b32 s11, 0x20000
    buffer_load_dwordx4 v[16:19], v5, s[4:7], 0 offen
    buffer_load_dword v20, v5, s[4:7], 0 offen offset:16
    buffer_load_dwordx4 v[32:35], v6, s[8:11], s3 offen
    s_add_u32 s3, s3, 7680
    buffer_load_dwordx4 v[36:39], v6, s[8:11], s3 offen
    s_add_u32 s3, s3, 7680
    buffer_load_dwordx4 v[40:43], v6, s[8:11], s3 offen
    s_add_u32 s3, s3, 7680
    buffer_load_dwordx4 v[44:47], v6, s[8:11], s3 offen
    s_add_u32 s3, s3, 7680
    buffer_load_dwordx4 v[48:51], v6, s[8:11], s3 offen
    s_add_u32 s3, s3, 7680
    buffer_load_dwordx4 v[52:55], v6, s[8:11], s3 offen
    s_add_u32 s3, s3, 7680
    buffer_load_dwordx4 v[56:59], v6, s[8:11], s3 offen
    s_add_u32 s3, s3, 7680
    buffer_load_dwordx4 v[60:63], v6, s[8:11], s3 offen
    s_add_u32 s3, s3, 7680
    buffer_load_dwordx4 v[64:67], v6, s[8:11], s3 offen
    s_add_u32 s3, s3, 7680
    buffer_load_dwordx4 v[68:71], v6, s[8:11], s3 offen
    s_branch R_ldone
R_lnld:
    s_sub_u32 s30, s2, 128
    v_lshrrev_b32 v5, 2, v2
    v_lshrrev_b32 v6, 3, v2
    v_xor_b32 v6, v6, v2
    v_and_b32 v6, 3, v6
    v_mul_u32_u24 v5, 1280, v5
    v_lshl_add_u32 v5, v6, 4, v5
    s_mul_i32 s98, s22, 5120
    s_mul_i32 s31, s30, 20480
    s_mul_i32 s3, s22, 320
    s_add_u32 s3, s3, s31
    s_waitcnt lgkmcnt(0)
    s_mov_b32 s4, s44
    s_and_b32 s5, s45, 0xffff
    s_mov_b32 s6, 2621440
    s_mov_b32 s7, 0x20000
    s_add_u32 m0, s98, 98304
    s_nop 0
    buffer_load_dwordx4 v5, s[4:7], s3 offen offset:0 lds
    s_add_u32 m0, s98, 99264
    s_nop 0
    buffer_load_dwordx4 v5, s[4:7], s3 offen offset:64 lds
    s_add_u32 m0, s98, 100224
    s_nop 0
    buffer_load_dwordx4 v5, s[4:7], s3 offen offset:128 lds
    s_add_u32 m0, s98, 101184
    s_nop 0
    buffer_load_dwordx4 v5, s[4:7], s3 offen offset:192 lds
    s_add_u32 m0, s98, 102144
    s_nop 0
    buffer_load_dwordx4 v5, s[4:7], s3 offen offset:256 lds
    v_mov_b32 v14, 2883584
    global_load_dword v14, v14, s[96:97]
R_ldone:
    s_mov_b32 s16, s96
    s_and_b32 s17, s97, 0xffff
    s_mov_b32 s18, 67108864
    s_mov_b32 s19, 0x20000
    s_cmp_ge_u32 s2, 128
    s_cbranch_scc1 R_ln
    s_cmp_ge_u32 s30, 120
    s_cbranch_scc1 R_idle
    v_mov_b32 v72, 0
    v_mov_b32 v73, 0
    v_mov_b32 v74, 0
    v_mov_b32 v75, 0
    v_mov_b32 v76, 0
    v_mov_b32 v77, 0
    v_mov_b32 v78, 0
    v_mov_b32 v79, 0
    s_waitcnt vmcnt(10)
    v_lshlrev_b32 v22, 16, v16
    v_and_b32 v23, 0xffff0000, v16
    v_lshlrev_b32 v24, 16, v17
    v_and_b32 v25, 0xffff0000, v17
    v_lshlrev_b32 v26, 16, v18
    v_and_b32 v27, 0xffff0000, v18
    v_lshlrev_b32 v28, 16, v19
    v_and_b32 v29, 0xffff0000, v19
    v_lshlrev_b32 v30, 16, v20
    v_and_b32 v31, 0xffff0000, v20
    v_mul_f32 v80, 0xbfb8aa3b, v22
    v_mul_f32 v81, 0xbfb8aa3b, v23
    v_mul_f32 v82, 0xbfb8aa3b, v24
    v_mul_f32 v83, 0xbfb8aa3b, v25
    v_mul_f32 v84, 0xbfb8aa3b, v26
    v_mul_f32 v85, 0xbfb8aa3b, v27
    v_mul_f32 v86, 0xbfb8aa3b, v28
    v_mul_f32 v87, 0xbfb8aa3b, v29
    v_mul_f32 v88, 0xbfb8aa3b, v30
    v_mul_f32 v89, 0xbfb8aa3b, v31
    v_exp_f32 v80, v80
    v_exp_f32 v81, v81
    v_exp_f32 v82, v82
    v_exp_f32 v83, v83
    v_exp_f32 v84, v84
    v_exp_f32 v85, v85
    v_exp_f32 v86, v86
    v_exp_f32 v87, v87
    v_exp_f32 v88, v88
    v_exp_f32 v89, v89
    v_add_f32 v80, 1.0, v80
    v_add_f32 v81, 1.0, v81
    v_add_f32 v82, 1.0, v82
    v_add_f32 v83, 1.0, v83
    v_add_f32 v84, 1.0, v84
    v_add_f32 v85, 1.0, v85
    v_add_f32 v86, 1.0, v86
    v_add_f32 v87, 1.0, v87
    v_add_f32 v88, 1.0, v88
    v_add_f32 v89, 1.0, v89
    v_rcp_f32 v80, v80
    v_rcp_f32 v81, v81
    v_rcp_f32 v82, v82
    v_rcp_f32 v83, v83
    v_rcp_f32 v84, v84
    v_rcp_f32 v85, v85
    v_rcp_f32 v86, v86
    v_rcp_f32 v87, v87
    v_rcp_f32 v88, v88
    v_rcp_f32 v89, v89
    v_pk_mul_f32 v[22:23], v[22:23], v[80:81]
    v_pk_mul_f32 v[24:25], v[24:25], v[82:83]
    v_pk_mul_f32 v[26:27], v[26:27], v[84:85]
    v_pk_mul_f32 v[28:29], v[28:29], v[86:87]
    v_pk_mul_f32 v[30:31], v[30:31], v[88:89]
    v_cvt_pk_bf16_f32 v80, v22, v23
    v_cvt_pk_bf16_f32 v82, v24, v25
    v_cvt_pk_bf16_f32 v84, v26, v27
    v_cvt_pk_bf16_f32 v86, v28, v29
    v_cvt_pk_bf16_f32 v88, v30, v31
    v_lshlrev_b32 v22, 16, v80
    v_and_b32 v23, 0xffff0000, v80
    v_lshlrev_b32 v24, 16, v82
    v_and_b32 v25, 0xffff0000, v82
    v_lshlrev_b32 v26, 16, v84
    v_and_b32 v27, 0xffff0000, v84
    v_lshlrev_b32 v28, 16, v86
    v_and_b32 v29, 0xffff0000, v86
    v_lshlrev_b32 v30, 16, v88
    v_and_b32 v31, 0xffff0000, v88
    s_waitcnt vmcnt(9)
    v_lshlrev_b32 v80, 16, v32
    v_and_b32 v81, 0xffff0000, v32
    v_lshlrev_b32 v82, 16, v33
    v_and_b32 v83, 0xffff0000, v33
    v_lshlrev_b32 v84, 16, v34
    v_and_b32 v85, 0xffff0000, v34
    v_lshlrev_b32 v86, 16, v35
    v_and_b32 v87, 0xffff0000, v35
    v_pk_fma_f32 v[72:73], v[80:81], v[22:23], v[72:73] op_sel_hi:[1,0,1]
    v_pk_fma_f32 v[74:75], v[82:83], v[22:23], v[74:75] op_sel_hi:[1,0,1]
    v_pk_fma_f32 v[76:77], v[84:85], v[22:23], v[76:77] op_sel_hi:[1,0,1]
    v_pk_fma_f32 v[78:79], v[86:87], v[22:23], v[78:79] op_sel_hi:[1,0,1]
    s_waitcnt vmcnt(8)
    v_lshlrev_b32 v80, 16, v36
    v_and_b32 v81, 0xffff0000, v36
    v_lshlrev_b32 v82, 16, v37
    v_and_b32 v83, 0xffff0000, v37
    v_lshlrev_b32 v84, 16, v38
    v_and_b32 v85, 0xffff0000, v38
    v_lshlrev_b32 v86, 16, v39
    v_and_b32 v87, 0xffff0000, v39
    v_pk_fma_f32 v[72:73], v[80:81], v[22:23], v[72:73] op_sel:[0,1,0]
    v_pk_fma_f32 v[74:75], v[82:83], v[22:23], v[74:75] op_sel:[0,1,0]
    v_pk_fma_f32 v[76:77], v[84:85], v[22:23], v[76:77] op_sel:[0,1,0]
    v_pk_fma_f32 v[78:79], v[86:87], v[22:23], v[78:79] op_sel:[0,1,0]
    s_waitcnt vmcnt(7)
    v_lshlrev_b32 v80, 16, v40
    v_and_b32 v81, 0xffff0000, v40
    v_lshlrev_b32 v82, 16, v41
    v_and_b32 v83, 0xffff0000, v41
    v_lshlrev_b32 v84, 16, v42
    v_and_b32 v85, 0xffff0000, v42
    v_lshlrev_b32 v86, 16, v43
    v_and_b32 v87, 0xffff0000, v43
    v_pk_fma_f32 v[72:73], v[80:81], v[24:25], v[72:73] op_sel_hi:[1,0,1]
    v_pk_fma_f32 v[74:75], v[82:83], v[24:25], v[74:75] op_sel_hi:[1,0,1]
    v_pk_fma_f32 v[76:77], v[84:85], v[24:25], v[76:77] op_sel_hi:[1,0,1]
    v_pk_fma_f32 v[78:79], v[86:87], v[24:25], v[78:79] op_sel_hi:[1,0,1]
    s_waitcnt vmcnt(6)
    v_lshlrev_b32 v80, 16, v44
    v_and_b32 v81, 0xffff0000, v44
    v_lshlrev_b32 v82, 16, v45
    v_and_b32 v83, 0xffff0000, v45
    v_lshlrev_b32 v84, 16, v46
    v_and_b32 v85, 0xffff0000, v46
    v_lshlrev_b32 v86, 16, v47
    v_and_b32 v87, 0xffff0000, v47
    v_pk_fma_f32 v[72:73], v[80:81], v[24:25], v[72:73] op_sel:[0,1,0]
    v_pk_fma_f32 v[74:75], v[82:83], v[24:25], v[74:75] op_sel:[0,1,0]
    v_pk_fma_f32 v[76:77], v[84:85], v[24:25], v[76:77] op_sel:[0,1,0]
    v_pk_fma_f32 v[78:79], v[86:87], v[24:25], v[78:79] op_sel:[0,1,0]
    s_waitcnt vmcnt(5)
    v_lshlrev_b32 v80, 16, v48
    v_and_b32 v81, 0xffff0000, v48
    v_lshlrev_b32 v82, 16, v49
    v_and_b32 v83, 0xffff0000, v49
    v_lshlrev_b32 v84, 16, v50
    v_and_b32 v85, 0xffff0000, v50
    v_lshlrev_b32 v86, 16, v51
    v_and_b32 v87, 0xffff0000, v51
    v_pk_fma_f32 v[72:73], v[80:81], v[26:27], v[72:73] op_sel_hi:[1,0,1]
    v_pk_fma_f32 v[74:75], v[82:83], v[26:27], v[74:75] op_sel_hi:[1,0,1]
    v_pk_fma_f32 v[76:77], v[84:85], v[26:27], v[76:77] op_sel_hi:[1,0,1]
    v_pk_fma_f32 v[78:79], v[86:87], v[26:27], v[78:79] op_sel_hi:[1,0,1]
    s_waitcnt vmcnt(4)
    v_lshlrev_b32 v80, 16, v52
    v_and_b32 v81, 0xffff0000, v52
    v_lshlrev_b32 v82, 16, v53
    v_and_b32 v83, 0xffff0000, v53
    v_lshlrev_b32 v84, 16, v54
    v_and_b32 v85, 0xffff0000, v54
    v_lshlrev_b32 v86, 16, v55
    v_and_b32 v87, 0xffff0000, v55
    v_pk_fma_f32 v[72:73], v[80:81], v[26:27], v[72:73] op_sel:[0,1,0]
    v_pk_fma_f32 v[74:75], v[82:83], v[26:27], v[74:75] op_sel:[0,1,0]
    v_pk_fma_f32 v[76:77], v[84:85], v[26:27], v[76:77] op_sel:[0,1,0]
    v_pk_fma_f32 v[78:79], v[86:87], v[26:27], v[78:79] op_sel:[0,1,0]
    s_waitcnt vmcnt(3)
    v_lshlrev_b32 v80, 16, v56
    v_and_b32 v81, 0xffff0000, v56
    v_lshlrev_b32 v82, 16, v57
    v_and_b32 v83, 0xffff0000, v57
    v_lshlrev_b32 v84, 16, v58
    v_and_b32 v85, 0xffff0000, v58
    v_lshlrev_b32 v86, 16, v59
    v_and_b32 v87, 0xffff0000, v59
    v_pk_fma_f32 v[72:73], v[80:81], v[28:29], v[72:73] op_sel_hi:[1,0,1]
    v_pk_fma_f32 v[74:75], v[82:83], v[28:29], v[74:75] op_sel_hi:[1,0,1]
    v_pk_fma_f32 v[76:77], v[84:85], v[28:29], v[76:77] op_sel_hi:[1,0,1]
    v_pk_fma_f32 v[78:79], v[86:87], v[28:29], v[78:79] op_sel_hi:[1,0,1]
    s_waitcnt vmcnt(2)
    v_lshlrev_b32 v80, 16, v60
    v_and_b32 v81, 0xffff0000, v60
    v_lshlrev_b32 v82, 16, v61
    v_and_b32 v83, 0xffff0000, v61
    v_lshlrev_b32 v84, 16, v62
    v_and_b32 v85, 0xffff0000, v62
    v_lshlrev_b32 v86, 16, v63
    v_and_b32 v87, 0xffff0000, v63
    v_pk_fma_f32 v[72:73], v[80:81], v[28:29], v[72:73] op_sel:[0,1,0]
    v_pk_fma_f32 v[74:75], v[82:83], v[28:29], v[74:75] op_sel:[0,1,0]
    v_pk_fma_f32 v[76:77], v[84:85], v[28:29], v[76:77] op_sel:[0,1,0]
    v_pk_fma_f32 v[78:79], v[86:87], v[28:29], v[78:79] op_sel:[0,1,0]
    s_waitcnt vmcnt(1)
    v_lshlrev_b32 v80, 16, v64
    v_and_b32 v81, 0xffff0000, v64
    v_lshlrev_b32 v82, 16, v65
    v_and_b32 v83, 0xffff0000, v65
    v_lshlrev_b32 v84, 16, v66
    v_and_b32 v85, 0xffff0000, v66
    v_lshlrev_b32 v86, 16, v67
    v_and_b32 v87, 0xffff0000, v67
    v_pk_fma_f32 v[72:73], v[80:81], v[30:31], v[72:73] op_sel_hi:[1,0,1]
    v_pk_fma_f32 v[74:75], v[82:83], v[30:31], v[74:75] op_sel_hi:[1,0,1]
    v_pk_fma_f32 v[76:77], v[84:85], v[30:31], v[76:77] op_sel_hi:[1,0,1]
    v_pk_fma_f32 v[78:79], v[86:87], v[30:31], v[78:79] op_sel_hi:[1,0,1]
    s_waitcnt vmcnt(0)
    v_lshlrev_b32 v80, 16, v68
    v_and_b32 v81, 0xffff0000, v68
    v_lshlrev_b32 v82, 16, v69
    v_and_b32 v83, 0xffff0000, v69
    v_lshlrev_b32 v84, 16, v70
    v_and_b32 v85, 0xffff0000, v70
    v_lshlrev_b32 v86, 16, v71
    v_and_b32 v87, 0xffff0000, v71
    v_pk_fma_f32 v[72:73], v[80:81], v[30:31], v[72:73] op_sel:[0,1,0]
    v_pk_fma_f32 v[74:75], v[82:83], v[30:31], v[74:75] op_sel:[0,1,0]
    v_pk_fma_f32 v[76:77], v[84:85], v[30:31], v[76:77] op_sel:[0,1,0]
    v_pk_fma_f32 v[78:79], v[86:87], v[30:31], v[78:79] op_sel:[0,1,0]
    v_lshrrev_b32 v5, 4, v0
    v_lshlrev_b32 v5, 8, v5
    v_add_f32_dpp v72, v72, v72 row_ror:8 row_mask:0xf bank_mask:0xf
    v_add_f32_dpp v73, v73, v73 row_ror:8 row_mask:0xf bank_mask:0xf
    v_add_f32_dpp v74, v74, v74 row_ror:8 row_mask:0xf bank_mask:0xf
    v_add_f32_dpp v75, v75, v75 row_ror:8 row_mask:0xf bank_mask:0xf
    v_add_f32_dpp v76, v76, v76 row_ror:8 row_mask:0xf bank_mask:0xf
    v_add_f32_dpp v77, v77, v77 row_ror:8 row_mask:0xf bank_mask:0xf
    v_add_f32_dpp v78, v78, v78 row_ror:8 row_mask:0xf bank_mask:0xf
    v_add_f32_dpp v79, v79, v79 row_ror:8 row_mask:0xf bank_mask:0xf
    v_lshl_add_u32 v5, v15, 5, v5
    v_add_u32 v5, 140288, v5
    ds_write_b128 v5, v[72:75]
    ds_write_b128 v5, v[76:79] offset:16
    s_cmp_lg_u32 s22, 0
    s_waitcnt lgkmcnt(0)
    s_barrier
    s_cbranch_scc1 R_modw
    s_mul_i32 s55, s39, 0x9e3779b1
    s_add_u32 s55, s55, 0x7f4a7c15
    v_lshlrev_b32 v5, 2, v0
    v_add_u32 v6, 140288, v5
    ds_read_b32 v32, v6 offset:0
    ds_read_b32 v33, v6 offset:256
    ds_read_b32 v34, v6 offset:512
    ds_read_b32 v35, v6 offset:768
    ds_read_b32 v36, v6 offset:1024
    ds_read_b32 v37, v6 offset:1280
    ds_read_b32 v38, v6 offset:1536
    ds_read_b32 v39, v6 offset:1792
    ds_read_b32 v40, v6 offset:2048
    ds_read_b32 v41, v6 offset:2304
    ds_read_b32 v42, v6 offset:2560
    ds_read_b32 v43, v6 offset:2816
    ds_read_b32 v44, v6 offset:3072
    ds_read_b32 v45, v6 offset:3328
    ds_read_b32 v46, v6 offset:3584
    ds_read_b32 v47, v6 offset:3840
    v_lshlrev_b32 v7, 3, v0
    s_and_b32 s3, s2, 1
    s_mul_i32 s3, s3, 30720
    s_lshr_b32 s98, s2, 1
    s_lshl_b32 s98, s98, 9
    s_add_u32 s3, s3, s98
    s_add_u32 s3, s3, 3407872
    s_add_u32 s98, s3, 0x10000
    s_cmp_lt_u32 s2, 40
    s_cselect_b32 s98, s98, 0x7f000000
    s_waitcnt lgkmcnt(0)
    v_pk_add_f32 v[32:33], v[32:33], v[40:41]
    v_pk_add_f32 v[34:35], v[34:35], v[42:43]
    v_pk_add_f32 v[36:37], v[36:37], v[44:45]
    v_pk_add_f32 v[38:39], v[38:39], v[46:47]
    v_pk_add_f32 v[32:33], v[32:33], v[36:37]
    v_pk_add_f32 v[34:35], v[34:35], v[38:39]
    v_pk_add_f32 v[32:33], v[32:33], v[34:35]
    v_add_f32 v32, v32, v33
    v_mov_b32 v33, s55
    buffer_store_dwordx2 v[32:33], v7, s[16:19], s3 offen sc1
    buffer_store_dwordx2 v[32:33], v7, s[16:19], s98 offen sc1
    s_add_u32 s98, s98, 0x10000
    buffer_store_dwordx2 v[32:33], v7, s[16:19], s98 offen sc1
    s_add_u32 s98, s98, 0x10000
    buffer_store_dwordx2 v[32:33], v7, s[16:19], s98 offen sc1
    s_add_u32 s98, s98, 0x10000
    buffer_store_dwordx2 v[32:33], v7, s[16:19], s98 offen sc1
    s_add_u32 s98, s98, 0x10000
    buffer_store_dwordx2 v[32:33], v7, s[16:19], s98 offen sc1
    s_add_u32 s98, s98, 0x10000
    buffer_store_dwordx2 v[32:33], v7, s[16:19], s98 offen sc1
    s_add_u32 s98, s98, 0x10000
    buffer_store_dwordx2 v[32:33], v7, s[16:19], s98 offen sc1
R_modw:
R_modx:
    s_and_b32 s3, s2, 7
    s_lshl_b32 s3, s3, 2
    s_bfe_u32 s34, s2, 0x20003
    s_add_u32 s20, s3, s34
    s_lshr_b32 s21, s2, 5
    s_lshl_b32 s37, s22, 12
    s_lshl_b32 s38, s22, 13
    s_lshl_b32 s35, s20, 19
    s_lshl_b32 s36, s20, 8
    s_lshl_b32 s3, s22, 18
    s_add_u32 s36, s36, s3
    s_lshl_b32 s3, s21, 2
    s_add_u32 s3, s3, s22
    s_mul_i32 s81, s3, 81920
    v_lshlrev_b32 v249, 4, v2
    v_lshlrev_b32 v5, 2, v3
    v_xor_b32 v5, v5, v4
    v_lshlrev_b32 v5, 4, v5
    v_lshl_add_u32 v242, v3, 13, v5
    s_mov_b32 s12, s50
    s_and_b32 s13, s51, 0xffff
    s_mov_b32 s14, 5242880
    s_mov_b32 s15, 0x20000
    v_and_b32 v240, 0x30, v249
    s_and_b32 s98, s2, 7
    s_lshl_b32 s98, s98, 5
    s_add_u32 s3, s3, s98
    s_lshl_b32 s3, s3, 6
    s_add_u32 s26, s3, 2920448
    s_lshl_b32 s3, s3, 2
    s_add_u32 s27, s3, 3342336
    v_bfe_u32 v6, v2, 2, 2
    v_and_b32 v7, 3, v2
    v_lshl_add_u32 v8, v3, 3, v6
    v_lshlrev_b32 v8, 8, v8
    v_lshl_add_u32 v8, v7, 4, v8
    v_xor_b32 v9, 0, v6
    v_lshl_add_u32 v244, v9, 6, v8
    v_xor_b32 v9, 1, v6
    v_lshl_add_u32 v245, v9, 6, v8
    v_xor_b32 v9, 2, v6
    v_lshl_add_u32 v246, v9, 6, v8
    v_xor_b32 v9, 3, v6
    v_lshl_add_u32 v247, v9, 6, v8
    s_cmp_lg_u32 s22, 0
    s_cbranch_scc1 R_hop3
R_mody:
    s_add_u32 m0, s38, 0
    s_add_u32 s34, s36, 0
    buffer_load_dwordx4 v242, s[12:15], s34 offen offset:0 lds
    s_add_u32 s34, s36, 31744
    buffer_load_dwordx4 v242, s[12:15], s34 offen offset:1024 lds
    s_add_u32 s34, s36, 63488
    buffer_load_dwordx4 v242, s[12:15], s34 offen offset:2048 lds
    s_add_u32 s34, s36, 95232
    buffer_load_dwordx4 v242, s[12:15], s34 offen offset:3072 lds
    s_add_u32 m0, s38, 4096
    s_add_u32 s34, s36, 131072
    buffer_load_dwordx4 v242, s[12:15], s34 offen offset:0 lds
    s_add_u32 s34, s36, 162816
    buffer_load_dwordx4 v242, s[12:15], s34 offen offset:1024 lds
    s_add_u32 s34, s36, 194560
    buffer_load_dwordx4 v242, s[12:15], s34 offen offset:2048 lds
    s_add_u32 s34, s36, 226304
    buffer_load_dwordx4 v242, s[12:15], s34 offen offset:3072 lds
    s_waitcnt lgkmcnt(0)
    s_mul_i32 s55, s39, 0x9e3779b1
    s_add_u32 s55, s55, 0x7f4a7c15
    s_mov_b32 s25, 0x7f000000
    s_cmp_eq_u32 s22, 0
    s_cselect_b32 s94, -1, 0
    s_branch R_wait
R_idle:
    s_cmp_ge_u32 s22, 2
    s_cbranch_scc1 R_idle2
    s_getpc_b64 s[100:101]
    v_lshlrev_b32 v253, 7, v0
    v_add_u32 v253, 0x7000, v253
    global_load_dword a255, v253, s[100:101]
    s_waitcnt vmcnt(0)
    s_branch R_modx
R_idle2:
    s_and_b32 s3, s2, 7
    s_lshl_b32 s98, s3, 11
    s_add_u32 s98, s98, 2920448
    s_lshl_b32 s3, s3, 13
    s_add_u32 s3, s3, 3342336
    s_cmp_eq_u32 s22, 2
    s_cselect_b32 s3, s3, s98
    s_cselect_b32 s98, 63, 15
    v_and_b32 v5, s98, v2
    v_lshlrev_b32 v5, 7, v5
    buffer_load_dword a255, v5, s[16:19], s3 offen sc1
    s_waitcnt vmcnt(1)
    s_branch R_modx
    .p2align 12
R_ln:
    s_and_b32 s3, s2, 7
    s_lshl_b32 s3, s3, 2
    s_bfe_u32 s34, s2, 0x20003
    s_add_u32 s20, s3, s34
    s_lshr_b32 s21, s2, 5
    s_lshl_b32 s37, s22, 12
    s_lshl_b32 s38, s22, 13
    s_lshl_b32 s35, s20, 19
    s_lshl_b32 s36, s20, 8
    s_lshl_b32 s3, s22, 18
    s_add_u32 s36, s36, s3
    s_lshl_b32 s3, s21, 2
    s_add_u32 s3, s3, s22
    s_mul_i32 s81, s3, 81920
    v_lshlrev_b32 v249, 4, v2
    v_lshlrev_b32 v5, 2, v3
    v_xor_b32 v5, v5, v4
    v_lshlrev_b32 v5, 4, v5
    v_lshl_add_u32 v242, v3, 13, v5
    s_mov_b32 s12, s50
    s_and_b32 s13, s51, 0xffff
    s_mov_b32 s14, 5242880
    s_mov_b32 s15, 0x20000
    v_and_b32 v240, 0x30, v249
    s_and_b32 s98, s2, 7
    s_lshl_b32 s98, s98, 5
    s_add_u32 s3, s3, s98
    s_lshl_b32 s3, s3, 6
    s_add_u32 s26, s3, 2920448
    s_lshl_b32 s3, s3, 2
    s_add_u32 s27, s3, 3342336
    v_bfe_u32 v6, v2, 2, 2
    v_and_b32 v7, 3, v2
    v_lshl_add_u32 v8, v3, 3, v6
    v_lshlrev_b32 v8, 8, v8
    v_lshl_add_u32 v8, v7, 4, v8
    v_xor_b32 v9, 0, v6
    v_lshl_add_u32 v244, v9, 6, v8
    v_xor_b32 v9, 1, v6
    v_lshl_add_u32 v245, v9, 6, v8
    v_xor_b32 v9, 2, v6
    v_lshl_add_u32 v246, v9, 6, v8
    v_xor_b32 v9, 3, v6
    v_lshl_add_u32 v247, v9, 6, v8
    v_lshrrev_b32 v5, 1, v4
    v_xor_b32 v5, v5, v3
    v_and_b32 v5, 3, v5
    v_lshlrev_b32 v5, 4, v5
    v_lshl_add_u32 v5, v4, 6, v5
    s_mul_i32 s3, s22, 5120
    s_add_u32 s3, s3, 0x18000
    v_add_u32 v5, s3, v5
    s_waitcnt vmcnt(1)
    ds_read_b128 v[16:19], v5 offset:0
    ds_read_b128 v[20:23], v5 offset:1024
    ds_read_b128 v[24:27], v5 offset:2048
    ds_read_b128 v[28:31], v5 offset:3072
    ds_read_b128 v[32:35], v5 offset:4096
    s_waitcnt lgkmcnt(4)
    v_lshlrev_b32 v40, 16, v16
    v_and_b32 v41, 0xffff0000, v16
    v_lshlrev_b32 v42, 16, v17
    v_and_b32 v43, 0xffff0000, v17
    v_lshlrev_b32 v44, 16, v18
    v_and_b32 v45, 0xffff0000, v18
    v_lshlrev_b32 v46, 16, v19
    v_and_b32 v47, 0xffff0000, v19
    v_pk_mul_f32 v[82:83], v[40:41], v[40:41]
    v_pk_add_f32 v[80:81], v[40:41], v[42:43]
    v_pk_fma_f32 v[82:83], v[42:43], v[42:43], v[82:83]
    v_pk_add_f32 v[80:81], v[80:81], v[44:45]
    v_pk_fma_f32 v[82:83], v[44:45], v[44:45], v[82:83]
    v_pk_add_f32 v[80:81], v[80:81], v[46:47]
    v_pk_fma_f32 v[82:83], v[46:47], v[46:47], v[82:83]
    s_waitcnt lgkmcnt(3)
    v_lshlrev_b32 v48, 16, v20
    v_and_b32 v49, 0xffff0000, v20
    v_lshlrev_b32 v50, 16, v21
    v_and_b32 v51, 0xffff0000, v21
    v_lshlrev_b32 v52, 16, v22
    v_and_b32 v53, 0xffff0000, v22
    v_lshlrev_b32 v54, 16, v23
    v_and_b32 v55, 0xffff0000, v23
    v_pk_add_f32 v[80:81], v[80:81], v[48:49]
    v_pk_fma_f32 v[82:83], v[48:49], v[48:49], v[82:83]
    v_pk_add_f32 v[80:81], v[80:81], v[50:51]
    v_pk_fma_f32 v[82:83], v[50:51], v[50:51], v[82:83]
    v_pk_add_f32 v[80:81], v[80:81], v[52:53]
    v_pk_fma_f32 v[82:83], v[52:53], v[52:53], v[82:83]
    v_pk_add_f32 v[80:81], v[80:81], v[54:55]
    v_pk_fma_f32 v[82:83], v[54:55], v[54:55], v[82:83]
    s_waitcnt lgkmcnt(2)
    v_lshlrev_b32 v56, 16, v24
    v_and_b32 v57, 0xffff0000, v24
    v_lshlrev_b32 v58, 16, v25
    v_and_b32 v59, 0xffff0000, v25
    v_lshlrev_b32 v60, 16, v26
    v_and_b32 v61, 0xffff0000, v26
    v_lshlrev_b32 v62, 16, v27
    v_and_b32 v63, 0xffff0000, v27
    v_pk_add_f32 v[80:81], v[80:81], v[56:57]
    v_pk_fma_f32 v[82:83], v[56:57], v[56:57], v[82:83]
    v_pk_add_f32 v[80:81], v[80:81], v[58:59]
    v_pk_fma_f32 v[82:83], v[58:59], v[58:59], v[82:83]
    v_pk_add_f32 v[80:81], v[80:81], v[60:61]
    v_pk_fma_f32 v[82:83], v[60:61], v[60:61], v[82:83]
    v_pk_add_f32 v[80:81], v[80:81], v[62:63]
    v_pk_fma_f32 v[82:83], v[62:63], v[62:63], v[82:83]
    s_waitcnt lgkmcnt(1)
    v_lshlrev_b32 v64, 16, v28
    v_and_b32 v65, 0xffff0000, v28
    v_lshlrev_b32 v66, 16, v29
    v_and_b32 v67, 0xffff0000, v29
    v_lshlrev_b32 v68, 16, v30
    v_and_b32 v69, 0xffff0000, v30
    v_lshlrev_b32 v70, 16, v31
    v_and_b32 v71, 0xffff0000, v31
    v_pk_add_f32 v[80:81], v[80:81], v[64:65]
    v_pk_fma_f32 v[82:83], v[64:65], v[64:65], v[82:83]
    v_pk_add_f32 v[80:81], v[80:81], v[66:67]
    v_pk_fma_f32 v[82:83], v[66:67], v[66:67], v[82:83]
    v_pk_add_f32 v[80:81], v[80:81], v[68:69]
    v_pk_fma_f32 v[82:83], v[68:69], v[68:69], v[82:83]
    v_pk_add_f32 v[80:81], v[80:81], v[70:71]
    v_pk_fma_f32 v[82:83], v[70:71], v[70:71], v[82:83]
    s_waitcnt lgkmcnt(0)
    v_lshlrev_b32 v72, 16, v32
    v_and_b32 v73, 0xffff0000, v32
    v_lshlrev_b32 v74, 16, v33
    v_and_b32 v75, 0xffff0000, v33
    v_lshlrev_b32 v76, 16, v34
    v_and_b32 v77, 0xffff0000, v34
    v_lshlrev_b32 v78, 16, v35
    v_and_b32 v79, 0xffff0000, v35
    v_pk_add_f32 v[80:81], v[80:81], v[72:73]
    v_pk_fma_f32 v[82:83], v[72:73], v[72:73], v[82:83]
    v_pk_add_f32 v[80:81], v[80:81], v[74:75]
    v_pk_fma_f32 v[82:83], v[74:75], v[74:75], v[82:83]
    v_pk_add_f32 v[80:81], v[80:81], v[76:77]
    v_pk_fma_f32 v[82:83], v[76:77], v[76:77], v[82:83]
    v_pk_add_f32 v[80:81], v[80:81], v[78:79]
    v_pk_fma_f32 v[82:83], v[78:79], v[78:79], v[82:83]
    v_add_f32 v80, v80, v81
    v_add_f32 v81, v82, v83
    v_lshlrev_b32 v5, 5, v2
    v_add_u32 v5, 140288, v5
    s_lshl_b32 s3, s22, 3
    v_add_u32 v6, s3, v5
    ds_write_b64 v6, v[80:81]
    s_add_u32 m0, s38, 0
    s_add_u32 s34, s36, 0
    buffer_load_dwordx4 v242, s[12:15], s34 offen offset:0 lds
    s_add_u32 s34, s36, 31744
    buffer_load_dwordx4 v242, s[12:15], s34 offen offset:1024 lds
    s_add_u32 s34, s36, 63488
    buffer_load_dwordx4 v242, s[12:15], s34 offen offset:2048 lds
    s_add_u32 s34, s36, 95232
    buffer_load_dwordx4 v242, s[12:15], s34 offen offset:3072 lds
    s_add_u32 m0, s38, 4096
    s_add_u32 s34, s36, 131072
    buffer_load_dwordx4 v242, s[12:15], s34 offen offset:0 lds
    s_add_u32 s34, s36, 162816
    buffer_load_dwordx4 v242, s[12:15], s34 offen offset:1024 lds
    s_add_u32 s34, s36, 194560
    buffer_load_dwordx4 v242, s[12:15], s34 offen offset:2048 lds
    s_add_u32 s34, s36, 226304
    buffer_load_dwordx4 v242, s[12:15], s34 offen offset:3072 lds
    s_mul_i32 s3, s22, 5120
    s_add_u32 s31, s31, s3
    s_add_u32 s32, s31, 4096
    s_waitcnt lgkmcnt(0)
    s_barrier
    ds_read_b128 v[80:83], v5
    ds_read_b128 v[84:87], v5 offset:16
    s_waitcnt lgkmcnt(0)
    v_pk_add_f32 v[80:81], v[80:81], v[84:85]
    v_pk_add_f32 v[82:83], v[82:83], v[86:87]
    v_add_f32 v80, v80, v82
    v_add_f32 v81, v81, v83
    v_mov_b32 v82, v80
    v_mov_b32 v83, v81
    s_nop 0
    v_permlane32_swap_b32 v82, v80
    v_permlane32_swap_b32 v83, v81
    v_add_f32 v80, v80, v82
    v_add_f32 v81, v81, v83
    v_mov_b32 v82, v80
    v_mov_b32 v83, v81
    s_nop 0
    v_permlane16_swap_b32 v82, v80
    v_permlane16_swap_b32 v83, v81
    v_add_f32 v80, v80, v82
    v_add_f32 v81, v81, v83
    v_mul_f32 v84, 0xbacccccd, v80
    v_mul_f32 v81, 0x3acccccd, v81
    v_mul_f32 v82, 0x33800000, v84
    v_fma_f32 v81, -v84, v84, v81
    v_mul_f32 v82, v82, v84
    v_max_f32 v81, v82, v81
    v_add_f32 v81, 0x3727c5ac, v81
    v_rsq_f32 v86, v81
    s_nop 0
    v_mul_f32 v84, v84, v86
    v_pk_fma_f32 v[40:41], v[40:41], v[86:87], v[84:85] op_sel_hi:[1,0,0]
    v_pk_fma_f32 v[42:43], v[42:43], v[86:87], v[84:85] op_sel_hi:[1,0,0]
    v_pk_fma_f32 v[44:45], v[44:45], v[86:87], v[84:85] op_sel_hi:[1,0,0]
    v_pk_fma_f32 v[46:47], v[46:47], v[86:87], v[84:85] op_sel_hi:[1,0,0]
    v_pk_fma_f32 v[48:49], v[48:49], v[86:87], v[84:85] op_sel_hi:[1,0,0]
    v_pk_fma_f32 v[50:51], v[50:51], v[86:87], v[84:85] op_sel_hi:[1,0,0]
    v_pk_fma_f32 v[52:53], v[52:53], v[86:87], v[84:85] op_sel_hi:[1,0,0]
    v_pk_fma_f32 v[54:55], v[54:55], v[86:87], v[84:85] op_sel_hi:[1,0,0]
    v_pk_fma_f32 v[56:57], v[56:57], v[86:87], v[84:85] op_sel_hi:[1,0,0]
    v_pk_fma_f32 v[58:59], v[58:59], v[86:87], v[84:85] op_sel_hi:[1,0,0]
    v_pk_fma_f32 v[60:61], v[60:61], v[86:87], v[84:85] op_sel_hi:[1,0,0]
    v_pk_fma_f32 v[62:63], v[62:63], v[86:87], v[84:85] op_sel_hi:[1,0,0]
    v_pk_fma_f32 v[64:65], v[64:65], v[86:87], v[84:85] op_sel_hi:[1,0,0]
    v_pk_fma_f32 v[66:67], v[66:67], v[86:87], v[84:85] op_sel_hi:[1,0,0]
    v_pk_fma_f32 v[68:69], v[68:69], v[86:87], v[84:85] op_sel_hi:[1,0,0]
    v_pk_fma_f32 v[70:71], v[70:71], v[86:87], v[84:85] op_sel_hi:[1,0,0]
    v_pk_fma_f32 v[72:73], v[72:73], v[86:87], v[84:85] op_sel_hi:[1,0,0]
    v_pk_fma_f32 v[74:75], v[74:75], v[86:87], v[84:85] op_sel_hi:[1,0,0]
    v_pk_fma_f32 v[76:77], v[76:77], v[86:87], v[84:85] op_sel_hi:[1,0,0]
    v_pk_fma_f32 v[78:79], v[78:79], v[86:87], v[84:85] op_sel_hi:[1,0,0]
    s_lshl_b32 s3, s30, 2
    s_add_u32 s3, s3, s22
    s_lshl_b32 s3, s3, 4
    s_add_u32 s25, s3, 3342336
    s_lshl_b32 s3, s30, 4
    s_add_u32 s3, s3, 2920448
    s_mov_b32 s94, -1
    s_cmp_lg_u32 s22, 0
    s_cbranch_scc1 R_hop3
    v_cvt_pk_f16_f32 v16, v40, v41
    v_cvt_pk_f16_f32 v17, v42, v43
    v_cvt_pk_f16_f32 v18, v44, v45
    v_cvt_pk_f16_f32 v19, v46, v47
    buffer_store_dwordx4 v[16:19], v249, s[16:19], s31 offen offset:0 sc1
    v_cvt_pk_f16_f32 v20, v48, v49
    v_cvt_pk_f16_f32 v21, v50, v51
    v_cvt_pk_f16_f32 v22, v52, v53
    v_cvt_pk_f16_f32 v23, v54, v55
    buffer_store_dwordx4 v[20:23], v249, s[16:19], s31 offen offset:1024 sc1
    v_cvt_pk_f16_f32 v24, v56, v57
    v_cvt_pk_f16_f32 v25, v58, v59
    v_cvt_pk_f16_f32 v26, v60, v61
    v_cvt_pk_f16_f32 v27, v62, v63
    buffer_store_dwordx4 v[24:27], v249, s[16:19], s31 offen offset:2048 sc1
    v_cvt_pk_f16_f32 v28, v64, v65
    v_cvt_pk_f16_f32 v29, v66, v67
    v_cvt_pk_f16_f32 v30, v68, v69
    v_cvt_pk_f16_f32 v31, v70, v71
    buffer_store_dwordx4 v[28:31], v249, s[16:19], s31 offen offset:3072 sc1
    v_cvt_pk_f16_f32 v32, v72, v73
    v_cvt_pk_f16_f32 v33, v74, v75
    v_cvt_pk_f16_f32 v34, v76, v77
    v_cvt_pk_f16_f32 v35, v78, v79
    buffer_store_dwordx4 v[32:35], v249, s[16:19], s32 offen offset:0 sc1
    s_mov_b32 s31, 0x7f000000
    s_mov_b32 s32, 0x7f000000
    v_lshlrev_b32 v5, 7, v249
    s_mov_b32 s98, 0x9e3779b1
    s_waitcnt vmcnt(5)
    v_mul_lo_u32 v6, v14, s98
    v_add_u32 v6, 0x7f4a7c15, v6
    s_mov_b64 exec, 0xff
    s_waitcnt vmcnt(0)
    buffer_store_dword v6, v5, s[16:19], s3 offen sc1
    s_mov_b64 exec, -1
    s_branch R_nox
R_hop3:
    s_mov_b64 exec, 0
    s_cmp_eq_u32 s22, 1
    s_cbranch_scc1 HOP0_0
    s_cmp_eq_u32 s22, 2
    s_cbranch_scc1 HOP0_1
    s_branch HOP0_2
HOPRET0:
    s_mov_b64 exec, -1
    s_cmp_lt_u32 s2, 128
    s_cbranch_scc1 R_mody
R_nox:
    s_waitcnt vmcnt(8)
    v_readfirstlane_b32 s39, v14
    s_nop 0
    s_mul_i32 s55, s39, 0x9e3779b1
    s_add_u32 s55, s55, 0x7f4a7c15
R_wait:
    v_bfe_u32 v5, v2, 1, 3
    v_lshlrev_b32 v5, 13, v5
    v_and_b32 v6, 1, v2
    v_lshl_add_u32 v5, v6, 7, v5
    s_lshl_b32 s3, s21, 2
    s_add_u32 s3, s3, s22
    s_add_u32 s3, s3, 16
    s_lshl_b32 s3, s3, 16
    s_lshl_b32 s34, s20, 8
    s_add_u32 s3, s3, s34
    buffer_load_dword a255, v5, s[12:15], s3 offen
    s_mov_b32 s4, s46
    s_and_b32 s5, s47, 0xffff
    s_mov_b32 s6, 16777216
    s_mov_b32 s7, 0x20000
    s_mov_b32 s8, s48
    s_and_b32 s9, s49, 0xffff
    s_mov_b32 s10, 16777216
    s_mov_b32 s11, 0x20000
    s_mov_b32 s23, s35
    s_mov_b32 s24, s35
    v_and_b32 v7, 3, v2
    v_lshl_add_u32 v9, v3, 1, 0
    v_xor_b32 v9, v9, v4
    v_lshlrev_b32 v9, 4, v9
    v_lshl_add_u32 v9, v3, 8, v9
    v_add_u32 v251, s37, v9
    v_lshl_add_u32 v9, v3, 1, 8
    v_xor_b32 v9, v9, v4
    v_lshlrev_b32 v9, 4, v9
    v_lshl_add_u32 v9, v3, 8, v9
    v_add_u32 v252, s37, v9
    v_and_b32 v10, 7, v4
    v_lshlrev_b32 v10, 1, v10
    v_xor_b32 v10, v10, v3
    v_xor_b32 v9, 0, v10
    v_lshlrev_b32 v9, 4, v9
    v_lshl_add_u32 v208, v4, 8, v9
    v_xor_b32 v9, 4, v10
    v_lshlrev_b32 v9, 4, v9
    v_lshl_add_u32 v209, v4, 8, v9
    v_xor_b32 v9, 8, v10
    v_lshlrev_b32 v9, 4, v9
    v_lshl_add_u32 v210, v4, 8, v9
    v_xor_b32 v9, 12, v10
    v_lshlrev_b32 v9, 4, v9
    v_lshl_add_u32 v211, v4, 8, v9
    v_lshrrev_b32 v12, 2, v2
    v_lshlrev_b32 v11, 8, v12
    v_lshl_add_u32 v11, v7, 3, v11
    v_add_u32 v11, 0x10000, v11
    v_and_b32 v10, 7, v12
    v_xor_b32 v9, 0, v10
    v_lshl_add_u32 v212, v9, 5, v11
    v_xor_b32 v9, 1, v10
    v_lshl_add_u32 v213, v9, 5, v11
    v_xor_b32 v9, 2, v10
    v_lshl_add_u32 v214, v9, 5, v11
    v_xor_b32 v9, 3, v10
    v_lshl_add_u32 v215, v9, 5, v11
    v_xor_b32 v9, 4, v10
    v_lshl_add_u32 v216, v9, 5, v11
    v_xor_b32 v9, 5, v10
    v_lshl_add_u32 v217, v9, 5, v11
    v_xor_b32 v9, 6, v10
    v_lshl_add_u32 v218, v9, 5, v11
    v_xor_b32 v9, 7, v10
    v_lshl_add_u32 v219, v9, 5, v11
    v_mov_b32 v10, 0x3f803f80
    v_cmp_eq_u32 vcc, 0, v7
    s_nop 1
    v_cndmask_b32 v9, 0, v10, vcc
    v_accvgpr_write_b32 a192, v9
    v_accvgpr_write_b32 a193, v9
    v_accvgpr_write_b32 a194, v9
    v_accvgpr_write_b32 a195, v9
    v_cmp_eq_u32 vcc, 1, v7
    s_nop 1
    v_cndmask_b32 v9, 0, v10, vcc
    v_accvgpr_write_b32 a196, v9
    v_accvgpr_write_b32 a197, v9
    v_accvgpr_write_b32 a198, v9
    v_accvgpr_write_b32 a199, v9
    v_cmp_eq_u32 vcc, 2, v7
    s_nop 1
    v_cndmask_b32 v9, 0, v10, vcc
    v_accvgpr_write_b32 a200, v9
    v_accvgpr_write_b32 a201, v9
    v_accvgpr_write_b32 a202, v9
    v_accvgpr_write_b32 a203, v9
    v_cmp_eq_u32 vcc, 3, v7
    s_nop 1
    v_cndmask_b32 v9, 0, v10, vcc
    v_accvgpr_write_b32 a204, v9
    v_accvgpr_write_b32 a205, v9
    v_accvgpr_write_b32 a206, v9
    v_accvgpr_write_b32 a207, v9
    v_mov_b32 v9, 0xff800000
    v_accvgpr_write_b32 a224, v9
    v_accvgpr_write_b32 a225, v9
    v_accvgpr_write_b32 a226, v9
    v_accvgpr_write_b32 a227, v9
    v_bfe_i32 v9, v2, 2, 1
    v_and_b32 v9, 0xaaaaaaaa, v9
    v_or_b32 v243, 0x44444444, v9
    s_mov_b32 s28, 0xc2000000
    s_mov_b32 s29, 0
    s_cmp_eq_u32 s22, 0
    s_cselect_b32 s39, 5, 3
    v_lshrrev_b32 v9, 1, v2
    v_mul_u32_u24 v253, 1280, v9
    v_and_b32 v9, 1, v2
    v_lshl_add_u32 v253, v9, 4, v253
    s_lshr_b32 s3, s37, 2
    s_add_u32 s3, s3, 136192
    v_lshl_add_u32 v254, v2, 3, s3
    s_lshl_b32 s3, s2, 2
    s_add_u32 s3, s3, s22
    s_and_b32 s98, s3, 511
    s_mul_i32 s99, s98, 6554
    s_lshr_b32 s99, s99, 16
    s_mul_i32 s48, s99, 39680
    s_lshl_b32 s98, s98, 7
    s_add_u32 s48, s48, s98
    s_cmp_ge_u32 s3, 512
    s_cselect_b32 s46, s58, s56
    s_cselect_b32 s47, s59, s57
    s_and_b32 s47, s47, 0xffff
    s_min_u32 s3, s3, 909
    s_mul_i32 s98, s3, 13108
    s_lshr_b32 s98, s98, 16
    s_mul_i32 s99, s98, 5
    s_sub_u32 s99, s3, s99
    s_lshl_b32 s101, s3, 13
    s_add_u32 s101, s101, 37747712
    s_and_b32 s3, s98, 127
    s_mul_i32 s100, s3, 40960
    s_lshl_b32 s99, s99, 8
    s_add_u32 s100, s100, s99
    s_cmp_ge_u32 s98, 128
    s_cselect_b32 s52, s40, s52
    s_cselect_b32 s53, s41, s53
    s_cselect_b32 s54, 54, 0x80
    s_mul_i32 s54, s54, 40960
    s_lshl_b32 s76, s20, 2
    s_mov_b32 s77, s21
    s_and_b32 s99, s77, 1
    s_mul_i32 s3, s77, 5
    s_add_u32 s98, s3, s99
    s_xor_b32 s99, s99, 1
    s_lshl_b32 s99, s99, 2
    s_add_u32 s99, s3, s99
    s_mul_i32 s3, s22, 40960
    s_add_u32 s3, s3, 37748736
    s_lshl_b32 s78, s98, 10
    s_add_u32 s78, s78, s3
    s_sub_u32 s79, s99, s98
    s_lshl_b32 s79, s79, 10
    s_add_u32 s83, s76, s22
    s_lshl_b32 s80, s76, 17
    s_lshr_b32 s3, s37, 2
    s_add_u32 s80, s80, s3
    s_mul_i32 s51, s22, 40960
    s_add_u32 s51, s51, s78
    s_add_u32 s51, s51, 5242880
    s_and_b32 s3, s2, 1
    s_mul_i32 s50, s3, 2621440
    s_add_u32 s78, s78, s50
    s_lshl_b32 s3, s3, 16
    s_add_u32 s80, s80, s3
    s_xor_b32 s50, s80, 2097152
    s_add_u32 s80, s80, 4194304
    s_add_u32 s50, s50, 4194304
    s_mul_i32 s3, s83, 20480
    s_lshl_b32 s84, s98, 5
    s_add_u32 s84, s84, s3
    s_lshl_b32 s85, s99, 5
    s_add_u32 s85, s85, s3
    s_lshl_b32 s86, s98, 6
    s_add_u32 s86, s86, 2642432
    s_lshl_b32 s87, s99, 6
    s_add_u32 s87, s87, 2642432
    s_add_u32 s3, s3, 20971520
    s_lshl_b32 s88, s77, 10
    s_add_u32 s88, s88, s3
    s_lshr_b32 s89, s77, 1
    s_add_u32 s89, s89, 16
    s_lshl_b32 s89, s89, 10
    s_add_u32 s89, s89, s3
    s_and_b32 s3, s99, 1
    s_lshl_b32 s3, s3, 3
    s_add_u32 s89, s89, s3
    s_mov_b32 s72, s44
    s_and_b32 s73, s45, 0xffff
    s_mov_b32 s74, 2621440
    s_mov_b32 s75, 0x20000
    s_add_u32 s3, s22, 0
    s_and_b32 s3, s3, 3
    s_lshl_b32 s3, s3, 17
    v_add_u32 v224, s3, v249
    s_add_u32 s3, s22, 1
    s_and_b32 s3, s3, 3
    s_lshl_b32 s3, s3, 17
    v_add_u32 v225, s3, v249
    s_add_u32 s3, s22, 2
    s_and_b32 s3, s3, 3
    s_lshl_b32 s3, s3, 17
    v_add_u32 v226, s3, v249
    s_add_u32 s3, s22, 3
    s_and_b32 s3, s3, 3
    s_lshl_b32 s3, s3, 17
    v_add_u32 v227, s3, v249
    v_lshrrev_b32 v9, 2, v2
    v_mul_u32_u24 v9, 1216, v9
    v_add_u32 v228, v9, v249
    v_lshlrev_b32 v229, 4, v3
    s_add_u32 s3, s22, 0
    s_and_b32 s3, s3, 3
    s_mul_i32 s3, s3, 15360
    s_add_u32 s3, s3, 32768
    v_add_u32 v230, s3, v249
    s_add_u32 s3, s22, 1
    s_and_b32 s3, s3, 3
    s_mul_i32 s3, s3, 15360
    s_add_u32 s3, s3, 32768
    v_add_u32 v231, s3, v249
    s_add_u32 s3, s22, 2
    s_and_b32 s3, s3, 3
    s_mul_i32 s3, s3, 15360
    s_add_u32 s3, s3, 37888
    v_add_u32 v232, s3, v249
    s_add_u32 s3, s22, 3
    s_and_b32 s3, s3, 3
    s_mul_i32 s3, s3, 15360
    s_add_u32 s3, s3, 43008
    v_add_u32 v233, s3, v249
    v_lshlrev_b32 v9, 4, v0
    v_add_u32 v9, 2646016, v9
    v_subrev_u32 v10, 160, v0
    v_lshlrev_b32 v11, 4, v10
    s_sub_u32 s3, s86, 7680
    v_add_u32 v13, s3, v11
    v_cmp_le_u32 vcc, 160, v0
    s_sub_u32 s3, s87, 7936
    v_add_u32 v11, s3, v11
    v_cndmask_b32 v9, v9, v13, vcc
    v_cmp_le_u32 vcc, 176, v0
    s_nop 1
    v_cndmask_b32 v9, v9, v11, vcc
    v_subrev_u32 v10, 180, v0
    v_lshlrev_b32 v11, 4, v10
    s_sub_u32 s3, s86, 2560
    v_add_u32 v13, s3, v11
    v_cmp_le_u32 vcc, 180, v0
    s_sub_u32 s3, s87, 2816
    v_add_u32 v11, s3, v11
    v_cndmask_b32 v9, v9, v13, vcc
    v_cmp_le_u32 vcc, 196, v0
    s_nop 1
    v_cndmask_b32 v9, v9, v11, vcc
    v_mov_b32 v248, v9
    s_bfe_u32 s3, s2, 0x20001
    s_mul_i32 s3, s3, 27
    s_lshr_b32 s98, s2, 3
    s_add_u32 s3, s3, s98
    s_lshr_b32 s90, s3, 2
    s_and_b32 s3, s3, 3
    s_and_b32 s98, s2, 1
    s_lshl_b32 s98, s98, 2
    s_add_u32 s91, s3, s98
    s_mul_i32 s98, s22, 5
    s_add_u32 s93, s98, 2
    s_mul_i32 s93, s93, 110592
    s_add_u32 s98, s98, 1
    s_lshr_b32 s98, s98, 1
    s_mul_i32 s92, s98, 110592
    s_lshl_b32 s3, s90, 7
    s_add_u32 s92, s92, s3
    s_add_u32 s93, s93, s3
    s_cmp_lt_u32 s2, 216
    s_cselect_b32 s98, 2211840, 0
    s_mov_b32 s64, s56
    s_and_b32 s65, s57, 0xffff
    s_mov_b32 s66, s98
    s_mov_b32 s67, 0x20000
    s_mov_b32 s68, s58
    s_and_b32 s69, s59, 0xffff
    s_mov_b32 s70, s98
    s_mov_b32 s71, 0x20000
    v_lshrrev_b32 v10, 3, v2
    v_and_b32 v11, 6, v10
    v_and_b32 v9, 7, v2
    v_xor_b32 v9, v9, v11
    v_mul_u32_u24 v10, 3456, v10
    v_lshl_add_u32 v250, v9, 4, v10
    s_mul_i32 s3, s22, 1280
    s_and_b32 s99, s2, 7
    s_lshl_b32 s99, s99, 16
    s_add_u32 s99, s99, s3
    s_add_u32 s99, s99, 3407872
    s_cmp_lg_u32 s94, 0
    s_cselect_b32 s99, s99, 0x7f000000
    s_mov_b32 s95, 0
    s_mov_b32 s82, 1.0
    s_mov_b32 s34, 0x3e0293ee
    s_and_b32 s98, s2, 0xf8
    s_add_u32 s98, s98, s22
    s_cmp_lg_u32 s98, 121
    s_cbranch_scc1 R_nofin
    s_and_b32 s98, s2, 3
    s_mul_i32 s99, s98, 1280
    s_bfe_u32 s98, s2, 0x10002
    s_add_u32 s98, s98, 1
    s_mul_i32 s98, s98, 10240
    s_add_u32 s99, s99, s98
    s_add_u32 s99, s99, 3407872
    s_bitcmp1_b32 s2, 2
    s_cselect_b32 s95, 1.0, 0
    s_mov_b32 s82, 0
    s_mov_b32 s34, 1.0
    s_mov_b32 s94, -1
R_nofin:
    s_add_u32 s33, s99, 30720
    s_add_u32 s3, s3, 144384
    v_add_u32 v7, 5120, v249
    v_and_b32 v12, 1, v3
    v_mul_u32_u24 v12, 640, v12
    v_lshl_add_u32 v13, v4, 1, v12
    v_lshlrev_b32 v8, 3, v13
    v_add_u32 v8, 1024, v8
    v_lshl_add_u32 v9, v2, 3, s3
    v_lshl_add_u32 v10, v4, 3, v12
    v_add_u32 v10, s3, v10
    v_add_u32 v10, 512, v10
    v_lshl_add_u32 v11, v3, 5, s3
    v_cmp_eq_u32 vcc, 0, v12
    v_mov_b32 v29, s95
    v_mov_b32 v30, s82
    v_cndmask_b32 v31, v30, v29, vcc
    s_mov_b32 s98, 262144
R_gr:
    buffer_load_dwordx4 v[16:19], v249, s[16:19], s99 offen sc1
    buffer_load_dwordx4 v[20:23], v7, s[16:19], s99 offen sc1
    buffer_load_dwordx4 v[24:27], v8, s[16:19], s99 offen sc1
    buffer_load_dwordx4 v[80:83], v249, s[16:19], s33 offen sc1
    buffer_load_dwordx4 v[84:87], v7, s[16:19], s33 offen sc1
    buffer_load_dwordx4 v[88:91], v8, s[16:19], s33 offen sc1
    buffer_load_dword v28, v240, s[16:19], s26 offen sc1
    s_sub_u32 s98, s98, 1
    s_waitcnt vmcnt(0)
    s_cbranch_scc1 R_grok
    v_xor_b32 v28, s55, v28
    v_xor_b32 v17, s55, v17
    v_xor_b32 v19, s55, v19
    v_xor_b32 v21, s55, v21
    v_xor_b32 v23, s55, v23
    v_xor_b32 v25, s55, v25
    v_xor_b32 v27, s55, v27
    v_xor_b32 v81, s55, v81
    v_xor_b32 v83, s55, v83
    v_xor_b32 v85, s55, v85
    v_xor_b32 v87, s55, v87
    v_xor_b32 v89, s55, v89
    v_xor_b32 v91, s55, v91
    v_or3_b32 v17, v17, v19, v21
    v_or3_b32 v23, v23, v25, v27
    v_or3_b32 v81, v81, v83, v85
    v_or3_b32 v87, v87, v89, v91
    v_or3_b32 v17, v17, v23, v81
    v_or_b32 v17, v17, v87
    v_and_or_b32 v17, v17, s94, v28
    v_cmp_ne_u32 vcc, 0, v17
    s_cbranch_vccnz R_gr
R_grok:
    v_add_f32 v16, v16, v80
    v_add_f32 v18, v18, v82
    v_add_f32 v20, v20, v84
    v_add_f32 v22, v22, v86
    v_add_f32 v24, v24, v88
    v_add_f32 v26, v26, v90
    v_cvt_pk_bf16_f32 v19, v16, v18
    v_cvt_pk_bf16_f32 v23, v20, v22
    v_cvt_pk_bf16_f32 v27, v24, v26
    v_lshlrev_b32 v16, 16, v19
    v_and_b32 v17, 0xffff0000, v19
    v_lshlrev_b32 v20, 16, v23
    v_and_b32 v21, 0xffff0000, v23
    v_lshlrev_b32 v24, 16, v27
    v_and_b32 v25, 0xffff0000, v27
    v_add_f32 v16, v16, v29
    v_add_f32 v17, v17, v29
    v_add_f32 v20, v20, v30
    v_add_f32 v21, v21, v30
    v_add_f32 v24, v24, v31
    v_add_f32 v25, v25, v31
    v_cvt_pk_bf16_f32 v19, v16, v17
    v_cvt_pk_bf16_f32 v23, v20, v21
    v_cvt_pk_bf16_f32 v27, v24, v25
    v_lshlrev_b32 v16, 16, v19
    v_and_b32 v17, 0xffff0000, v19
    v_lshlrev_b32 v20, 16, v23
    v_and_b32 v21, 0xffff0000, v23
    v_lshlrev_b32 v24, 16, v27
    v_and_b32 v25, 0xffff0000, v27
    v_mul_f32 v16, s34, v16
    v_mul_f32 v17, s34, v17
    v_mul_f32 v20, s34, v20
    v_mul_f32 v21, s34, v21
    v_mul_f32 v24, s34, v24
    v_mul_f32 v25, s34, v25
    ds_write_b64 v9, v[16:17]
    ds_write_b64 v9, v[20:21] offset:640
HOP0_0:
    s_cbranch_execz HOP0_3
    ds_write_b64 v10, v[24:25]
    s_cmp_eq_u32 s34, 1.0
    s_cbranch_scc1 R_fin
R_finret:
    s_mov_b32 s98, s31
    s_mov_b32 s99, s32
    s_cmp_lt_u32 s2, 128
    s_cbranch_scc1 R_x
    ds_read_b128 v[96:99], v11 offset:640
    ds_read_b128 v[100:103], v11 offset:656
    ds_read_b128 v[104:107], v11 offset:0
    ds_read_b128 v[108:111], v11 offset:16
    ds_read_b128 v[112:115], v11 offset:768
    ds_read_b128 v[116:119], v11 offset:784
    ds_read_b128 v[120:123], v11 offset:128
    ds_read_b128 v[124:127], v11 offset:144
    ds_read_b128 v[160:163], v11 offset:896
    ds_read_b128 v[164:167], v11 offset:912
    ds_read_b128 v[168:171], v11 offset:256
    ds_read_b128 v[172:175], v11 offset:272
    ds_read_b128 v[176:179], v11 offset:1024
    ds_read_b128 v[180:183], v11 offset:1040
    ds_read_b128 v[184:187], v11 offset:384
    ds_read_b128 v[188:191], v11 offset:400
    s_add_u32 s30, s81, 0
    s_add_u32 s31, s81, 20480
    s_add_u32 s32, s81, 40960
    s_add_u32 s33, s81, 61440
    buffer_load_dwordx4 v[128:131], v249, s[16:19], s30 offen offset:0 sc1
    buffer_load_dwordx4 v[132:135], v249, s[16:19], s31 offen offset:0 sc1
    buffer_load_dwordx4 v[136:139], v249, s[16:19], s32 offen offset:0 sc1
    buffer_load_dwordx4 v[140:143], v249, s[16:19], s33 offen offset:0 sc1
    buffer_load_dwordx4 v[144:147], v249, s[16:19], s30 offen offset:1024 sc1
    buffer_load_dwordx4 v[148:151], v249, s[16:19], s31 offen offset:1024 sc1
    buffer_load_dwordx4 v[152:155], v249, s[16:19], s32 offen offset:1024 sc1
    buffer_load_dwordx4 v[156:159], v249, s[16:19], s33 offen offset:1024 sc1
    s_waitcnt lgkmcnt(12)
    v_pk_fma_f32 v[40:41], v[40:41], v[96:97], v[104:105]
    v_pk_fma_f32 v[42:43], v[42:43], v[98:99], v[106:107]
    v_pk_fma_f32 v[44:45], v[44:45], v[100:101], v[108:109]
    v_pk_fma_f32 v[46:47], v[46:47], v[102:103], v[110:111]
    ds_read_b128 v[96:99], v11 offset:1152
    ds_read_b128 v[100:103], v11 offset:1168
    ds_read_b128 v[104:107], v11 offset:512
    ds_read_b128 v[108:111], v11 offset:528
    v_cvt_pk_bf16_f32 v16, v40, v41
    v_cvt_pk_bf16_f32 v17, v42, v43
    v_cvt_pk_bf16_f32 v18, v44, v45
    v_cvt_pk_bf16_f32 v19, v46, v47
    buffer_store_dwordx4 v[16:19], v249, s[16:19], s98 offen offset:0 sc1
    s_waitcnt lgkmcnt(12)
    v_pk_fma_f32 v[48:49], v[48:49], v[112:113], v[120:121]
    v_pk_fma_f32 v[50:51], v[50:51], v[114:115], v[122:123]
    v_pk_fma_f32 v[52:53], v[52:53], v[116:117], v[124:125]
    v_pk_fma_f32 v[54:55], v[54:55], v[118:119], v[126:127]
    v_cvt_pk_bf16_f32 v20, v48, v49
    v_cvt_pk_bf16_f32 v21, v50, v51
    v_cvt_pk_bf16_f32 v22, v52, v53
    v_cvt_pk_bf16_f32 v23, v54, v55
    buffer_store_dwordx4 v[20:23], v249, s[16:19], s98 offen offset:1024 sc1
    s_waitcnt lgkmcnt(8)
    v_pk_fma_f32 v[56:57], v[56:57], v[160:161], v[168:169]
    v_pk_fma_f32 v[58:59], v[58:59], v[162:163], v[170:171]
    v_pk_fma_f32 v[60:61], v[60:61], v[164:165], v[172:173]
    v_pk_fma_f32 v[62:63], v[62:63], v[166:167], v[174:175]
    v_cvt_pk_bf16_f32 v24, v56, v57
    v_cvt_pk_bf16_f32 v25, v58, v59
    v_cvt_pk_bf16_f32 v26, v60, v61
    v_cvt_pk_bf16_f32 v27, v62, v63
    buffer_store_dwordx4 v[24:27], v249, s[16:19], s98 offen offset:2048 sc1
    s_waitcnt lgkmcnt(4)
    v_pk_fma_f32 v[64:65], v[64:65], v[176:177], v[184:185]
    v_pk_fma_f32 v[66:67], v[66:67], v[178:179], v[186:187]
    v_pk_fma_f32 v[68:69], v[68:69], v[180:181], v[188:189]
    v_pk_fma_f32 v[70:71], v[70:71], v[182:183], v[190:191]
    v_cvt_pk_bf16_f32 v28, v64, v65
    v_cvt_pk_bf16_f32 v29, v66, v67
    v_cvt_pk_bf16_f32 v30, v68, v69
    v_cvt_pk_bf16_f32 v31, v70, v71
    buffer_store_dwordx4 v[28:31], v249, s[16:19], s98 offen offset:3072 sc1
    s_waitcnt lgkmcnt(0)
    v_pk_fma_f32 v[72:73], v[72:73], v[96:97], v[104:105]
    v_pk_fma_f32 v[74:75], v[74:75], v[98:99], v[106:107]
    v_pk_fma_f32 v[76:77], v[76:77], v[100:101], v[108:109]
    v_pk_fma_f32 v[78:79], v[78:79], v[102:103], v[110:111]
    v_cvt_pk_bf16_f32 v32, v72, v73
    v_cvt_pk_bf16_f32 v33, v74, v75
    v_cvt_pk_bf16_f32 v34, v76, v77
    v_cvt_pk_bf16_f32 v35, v78, v79
    buffer_store_dwordx4 v[32:35], v249, s[16:19], s99 offen offset:0 sc1
    s_waitcnt vmcnt(5)
    s_branch R_x2
R_x:
    s_add_u32 s30, s81, 0
    s_add_u32 s31, s81, 20480
    s_add_u32 s32, s81, 40960
    s_add_u32 s33, s81, 61440
    buffer_load_dwordx4 v[128:131], v249, s[16:19], s30 offen offset:0 sc1
    buffer_load_dwordx4 v[132:135], v249, s[16:19], s31 offen offset:0 sc1
    buffer_load_dwordx4 v[136:139], v249, s[16:19], s32 offen offset:0 sc1
    buffer_load_dwordx4 v[140:143], v249, s[16:19], s33 offen offset:0 sc1
    buffer_load_dwordx4 v[144:147], v249, s[16:19], s30 offen offset:1024 sc1
    buffer_load_dwordx4 v[148:151], v249, s[16:19], s31 offen offset:1024 sc1
    buffer_load_dwordx4 v[152:155], v249, s[16:19], s32 offen offset:1024 sc1
    buffer_load_dwordx4 v[156:159], v249, s[16:19], s33 offen offset:1024 sc1
    s_waitcnt vmcnt(0) lgkmcnt(0)
R_x2:
    s_barrier
    buffer_load_dwordx4 v[160:163], v249, s[16:19], s30 offen offset:2048 sc1
    buffer_load_dwordx4 v[164:167], v249, s[16:19], s31 offen offset:2048 sc1
    buffer_load_dwordx4 v[168:171], v249, s[16:19], s32 offen offset:2048 sc1
    buffer_load_dwordx4 v[172:175], v249, s[16:19], s33 offen offset:2048 sc1
    v_bfe_u32 v5, v2, 1, 3
    v_lshlrev_b32 v5, 13, v5
    v_and_b32 v6, 1, v2
    v_lshl_add_u32 v5, v6, 7, v5
    s_lshl_b32 s3, s21, 2
    s_add_u32 s3, s3, s22
    s_add_u32 s3, s3, 48
    s_lshl_b32 s3, s3, 16
    s_lshl_b32 s34, s20, 8
    s_add_u32 s3, s3, s34
    buffer_load_dword a255, v5, s[12:15], s3 offen
    v_lshlrev_b32 v241, 5, v3
    v_add_u32 v241, 144384, v241
    ds_read_b128 v[192:195], v241 offset:640
    ds_read_b128 v[200:203], v241 offset:0
    ds_read_b128 v[196:199], v241 offset:656
    ds_read_b128 v[204:207], v241 offset:16
    ds_read_b64_tr_b16 a[160:161], v244 offset:0
    ds_read_b64_tr_b16 a[162:163], v244 offset:1024
    ds_read_b64_tr_b16 a[164:165], v244 offset:8
    ds_read_b64_tr_b16 a[166:167], v244 offset:1032
    ds_read_b64_tr_b16 a[168:169], v245 offset:0
    ds_read_b64_tr_b16 a[170:171], v245 offset:1024
    ds_read_b64_tr_b16 a[172:173], v245 offset:8
    ds_read_b64_tr_b16 a[174:175], v245 offset:1032
    v_lshlrev_b32 v234, 9, v249
    v_mov_b32 v235, s55
    v_and_b32 v240, 0xf0, v249
    s_waitcnt lgkmcnt(8)
    ds_read_b64_tr_b16 a[176:177], v246 offset:0
    ds_read_b64_tr_b16 a[178:179], v246 offset:1024
    ds_read_b64_tr_b16 a[180:181], v246 offset:8
    ds_read_b64_tr_b16 a[182:183], v246 offset:1032
    ds_read_b64_tr_b16 a[184:185], v247 offset:0
    ds_read_b64_tr_b16 a[186:187], v247 offset:1024
    ds_read_b64_tr_b16 a[188:189], v247 offset:8
    ds_read_b64_tr_b16 a[190:191], v247 offset:1032
    v_fma_mix_f32 v220, v128, v192, v200 op_sel_hi:[1,0,0]
    v_fma_mix_f32 v221, v128, v193, v201 op_sel:[1,0,0] op_sel_hi:[1,0,0]
    v_fma_mix_f32 v222, v132, v192, v200 op_sel_hi:[1,0,0]
    v_cvt_pk_bf16_f32 v128, v220, v221
    v_fma_mix_f32 v223, v132, v193, v201 op_sel:[1,0,0] op_sel_hi:[1,0,0]
    v_fma_mix_f32 v220, v136, v192, v200 op_sel_hi:[1,0,0]
    v_cvt_pk_bf16_f32 v132, v222, v223
    v_fma_mix_f32 v221, v136, v193, v201 op_sel:[1,0,0] op_sel_hi:[1,0,0]
    v_fma_mix_f32 v222, v140, v192, v200 op_sel_hi:[1,0,0]
    v_cvt_pk_bf16_f32 v136, v220, v221
    v_fma_mix_f32 v223, v140, v193, v201 op_sel:[1,0,0] op_sel_hi:[1,0,0]
    v_fma_mix_f32 v220, v129, v194, v202 op_sel_hi:[1,0,0]
    v_cvt_pk_bf16_f32 v140, v222, v223
    v_fma_mix_f32 v221, v129, v195, v203 op_sel:[1,0,0] op_sel_hi:[1,0,0]
    v_fma_mix_f32 v222, v133, v194, v202 op_sel_hi:[1,0,0]
    v_cvt_pk_bf16_f32 v129, v220, v221
    v_fma_mix_f32 v223, v133, v195, v203 op_sel:[1,0,0] op_sel_hi:[1,0,0]
    v_fma_mix_f32 v220, v137, v194, v202 op_sel_hi:[1,0,0]
    v_cvt_pk_bf16_f32 v133, v222, v223
    v_fma_mix_f32 v221, v137, v195, v203 op_sel:[1,0,0] op_sel_hi:[1,0,0]
    v_fma_mix_f32 v222, v141, v194, v202 op_sel_hi:[1,0,0]
    v_cvt_pk_bf16_f32 v137, v220, v221
    v_fma_mix_f32 v223, v141, v195, v203 op_sel:[1,0,0] op_sel_hi:[1,0,0]
    v_cvt_pk_bf16_f32 v141, v222, v223
    ds_read_b128 v[192:195], v241 offset:768
    ds_read_b128 v[200:203], v241 offset:128
    v_fma_mix_f32 v220, v130, v196, v204 op_sel_hi:[1,0,0]
    v_fma_mix_f32 v221, v130, v197, v205 op_sel:[1,0,0] op_sel_hi:[1,0,0]
    v_fma_mix_f32 v222, v134, v196, v204 op_sel_hi:[1,0,0]
    v_cvt_pk_bf16_f32 v130, v220, v221
    v_fma_mix_f32 v223, v134, v197, v205 op_sel:[1,0,0] op_sel_hi:[1,0,0]
    v_fma_mix_f32 v220, v138, v196, v204 op_sel_hi:[1,0,0]
    v_cvt_pk_bf16_f32 v134, v222, v223
    v_fma_mix_f32 v221, v138, v197, v205 op_sel:[1,0,0] op_sel_hi:[1,0,0]
    v_fma_mix_f32 v222, v142, v196, v204 op_sel_hi:[1,0,0]
    v_cvt_pk_bf16_f32 v138, v220, v221
    v_fma_mix_f32 v223, v142, v197, v205 op_sel:[1,0,0] op_sel_hi:[1,0,0]
    v_fma_mix_f32 v220, v131, v198, v206 op_sel_hi:[1,0,0]
    v_cvt_pk_bf16_f32 v142, v222, v223
    v_fma_mix_f32 v221, v131, v199, v207 op_sel:[1,0,0] op_sel_hi:[1,0,0]
    v_fma_mix_f32 v222, v135, v198, v206 op_sel_hi:[1,0,0]
    v_cvt_pk_bf16_f32 v131, v220, v221
    v_fma_mix_f32 v223, v135, v199, v207 op_sel:[1,0,0] op_sel_hi:[1,0,0]
    v_fma_mix_f32 v220, v139, v198, v206 op_sel_hi:[1,0,0]
    v_cvt_pk_bf16_f32 v135, v222, v223
    v_fma_mix_f32 v221, v139, v199, v207 op_sel:[1,0,0] op_sel_hi:[1,0,0]
    v_fma_mix_f32 v222, v143, v198, v206 op_sel_hi:[1,0,0]
    v_cvt_pk_bf16_f32 v139, v220, v221
    v_fma_mix_f32 v223, v143, v199, v207 op_sel:[1,0,0] op_sel_hi:[1,0,0]
    v_cvt_pk_bf16_f32 v143, v222, v223
    s_waitcnt lgkmcnt(0)
    v_mfma_f32_16x16x32_bf16 v[0:3], a[160:163], v[128:131], 0
    ds_read_b128 v[196:199], v241 offset:784
    v_fma_mix_f32 v220, v144, v192, v200 op_sel_hi:[1,0,0]
    v_fma_mix_f32 v221, v144, v193, v201 op_sel:[1,0,0] op_sel_hi:[1,0,0]
    v_mfma_f32_16x16x32_bf16 v[32:35], a[160:163], v[132:135], 0
    ds_read_b128 v[204:207], v241 offset:144
    v_fma_mix_f32 v222, v148, v192, v200 op_sel_hi:[1,0,0]
    v_cvt_pk_bf16_f32 v144, v220, v221
    v_mfma_f32_16x16x32_bf16 v[64:67], a[160:163], v[136:139], 0
    ds_read_b64_tr_b16 a[128:129], v244 offset:8192
    v_fma_mix_f32 v223, v148, v193, v201 op_sel:[1,0,0] op_sel_hi:[1,0,0]
    v_fma_mix_f32 v220, v152, v192, v200 op_sel_hi:[1,0,0]
    v_mfma_f32_16x16x32_bf16 v[96:99], a[160:163], v[140:143], 0
    ds_read_b64_tr_b16 a[130:131], v244 offset:9216
    v_cvt_pk_bf16_f32 v148, v222, v223
    v_fma_mix_f32 v221, v152, v193, v201 op_sel:[1,0,0] op_sel_hi:[1,0,0]
    v_mfma_f32_16x16x32_bf16 v[100:103], a[164:167], v[140:143], 0
    buffer_load_dwordx4 v[176:179], v249, s[16:19], s30 offen offset:3072 sc1
    v_mfma_f32_16x16x32_bf16 v[68:71], a[164:167], v[136:139], 0
    ds_read_b64_tr_b16 a[132:133], v244 offset:8200
    v_fma_mix_f32 v222, v156, v192, v200 op_sel_hi:[1,0,0]
    v_cvt_pk_bf16_f32 v152, v220, v221
    v_mfma_f32_16x16x32_bf16 v[36:39], a[164:167], v[132:135], 0
    ds_read_b64_tr_b16 a[134:135], v244 offset:9224
    v_fma_mix_f32 v223, v156, v193, v201 op_sel:[1,0,0] op_sel_hi:[1,0,0]
    v_mfma_f32_16x16x32_bf16 v[4:7], a[164:167], v[128:131], 0
    buffer_load_dwordx4 v[180:183], v249, s[16:19], s31 offen offset:3072 sc1
    v_mfma_f32_16x16x32_bf16 v[8:11], a[168:171], v[128:131], 0
    s_waitcnt vmcnt(7)
    s_mov_b64 exec, 0xff
    buffer_store_dword v235, v234, s[16:19], s25 offen sc1
    s_mov_b64 exec, -1
    ds_read_b64_tr_b16 a[136:137], v245 offset:8192
    v_fma_mix_f32 v220, v145, v194, v202 op_sel_hi:[1,0,0]
    v_cvt_pk_bf16_f32 v156, v222, v223
    v_mfma_f32_16x16x32_bf16 v[40:43], a[168:171], v[132:135], 0
    ds_read_b64_tr_b16 a[138:139], v245 offset:9216
    v_fma_mix_f32 v221, v145, v195, v203 op_sel:[1,0,0] op_sel_hi:[1,0,0]
    v_fma_mix_f32 v222, v149, v194, v202 op_sel_hi:[1,0,0]
    v_mfma_f32_16x16x32_bf16 v[72:75], a[168:171], v[136:139], 0
    ds_read_b64_tr_b16 a[140:141], v245 offset:8200
    v_cvt_pk_bf16_f32 v145, v220, v221
    v_fma_mix_f32 v223, v149, v195, v203 op_sel:[1,0,0] op_sel_hi:[1,0,0]
    v_mfma_f32_16x16x32_bf16 v[104:107], a[168:171], v[140:143], 0
    buffer_load_dwordx4 v[184:187], v249, s[16:19], s32 offen offset:3072 sc1
    v_mfma_f32_16x16x32_bf16 v[108:111], a[172:175], v[140:143], 0
    ds_read_b64_tr_b16 a[142:143], v245 offset:9224
    v_fma_mix_f32 v220, v153, v194, v202 op_sel_hi:[1,0,0]
    v_cvt_pk_bf16_f32 v149, v222, v223
    v_mfma_f32_16x16x32_bf16 v[76:79], a[172:175], v[136:139], 0
    v_fma_mix_f32 v221, v153, v195, v203 op_sel:[1,0,0] op_sel_hi:[1,0,0]
    v_fma_mix_f32 v222, v157, v194, v202 op_sel_hi:[1,0,0]
    v_cvt_pk_bf16_f32 v153, v220, v221
    v_mfma_f32_16x16x32_bf16 v[44:47], a[172:175], v[132:135], 0
    v_fma_mix_f32 v223, v157, v195, v203 op_sel:[1,0,0] op_sel_hi:[1,0,0]
    v_cvt_pk_bf16_f32 v157, v222, v223
    v_mfma_f32_16x16x32_bf16 v[12:15], a[172:175], v[128:131], 0
    s_waitcnt lgkmcnt(8)
    buffer_load_dwordx4 v[188:191], v249, s[16:19], s33 offen offset:3072 sc1
    v_mfma_f32_16x16x32_bf16 v[16:19], a[176:179], v[128:131], 0
    ds_read_b128 v[192:195], v241 offset:896
    v_fma_mix_f32 v220, v146, v196, v204 op_sel_hi:[1,0,0]
    v_fma_mix_f32 v221, v146, v197, v205 op_sel:[1,0,0] op_sel_hi:[1,0,0]
    v_mfma_f32_16x16x32_bf16 v[48:51], a[176:179], v[132:135], 0
    s_add_u32 m0, s38, 32768
    ds_read_b128 v[200:203], v241 offset:256
    v_fma_mix_f32 v222, v150, v196, v204 op_sel_hi:[1,0,0]
    v_cvt_pk_bf16_f32 v146, v220, v221
    v_mfma_f32_16x16x32_bf16 v[80:83], a[176:179], v[136:139], 0
    s_add_u32 s34, s36, 1048576
    ds_read_b64_tr_b16 a[144:145], v246 offset:8192
    v_fma_mix_f32 v223, v150, v197, v205 op_sel:[1,0,0] op_sel_hi:[1,0,0]
    v_mfma_f32_16x16x32_bf16 v[112:115], a[176:179], v[140:143], 0
    buffer_load_dwordx4 v242, s[12:15], s34 offen offset:0 lds
    v_mfma_f32_16x16x32_bf16 v[116:119], a[180:183], v[140:143], 0
    ds_read_b64_tr_b16 a[146:147], v246 offset:9216
    v_fma_mix_f32 v220, v154, v196, v204 op_sel_hi:[1,0,0]
    v_cvt_pk_bf16_f32 v150, v222, v223
    v_mfma_f32_16x16x32_bf16 v[84:87], a[180:183], v[136:139], 0
    ds_read_b64_tr_b16 a[148:149], v246 offset:8200
    v_fma_mix_f32 v221, v154, v197, v205 op_sel:[1,0,0] op_sel_hi:[1,0,0]
    v_fma_mix_f32 v222, v158, v196, v204 op_sel_hi:[1,0,0]
    v_mfma_f32_16x16x32_bf16 v[52:55], a[180:183], v[132:135], 0
    s_add_u32 s34, s36, 1080320
    ds_read_b64_tr_b16 a[150:151], v246 offset:9224
    v_cvt_pk_bf16_f32 v154, v220, v221
    v_mfma_f32_16x16x32_bf16 v[20:23], a[180:183], v[128:131], 0
    buffer_load_dwordx4 v242, s[12:15], s34 offen offset:1024 lds
    v_mfma_f32_16x16x32_bf16 v[24:27], a[184:187], v[128:131], 0
    ds_read_b64_tr_b16 a[152:153], v247 offset:8192
    v_fma_mix_f32 v223, v158, v197, v205 op_sel:[1,0,0] op_sel_hi:[1,0,0]
    v_fma_mix_f32 v220, v147, v198, v206 op_sel_hi:[1,0,0]
    v_mfma_f32_16x16x32_bf16 v[56:59], a[184:187], v[132:135], 0
    ds_read_b64_tr_b16 a[154:155], v247 offset:9216
    v_cvt_pk_bf16_f32 v158, v222, v223
    v_mfma_f32_16x16x32_bf16 v[88:91], a[184:187], v[136:139], 0
    s_add_u32 s34, s36, 1112064
    ds_read_b64_tr_b16 a[156:157], v247 offset:8200
    v_fma_mix_f32 v221, v147, v199, v207 op_sel:[1,0,0] op_sel_hi:[1,0,0]
    v_fma_mix_f32 v222, v151, v198, v206 op_sel_hi:[1,0,0]
    v_mfma_f32_16x16x32_bf16 v[120:123], a[184:187], v[140:143], 0
    buffer_load_dwordx4 v242, s[12:15], s34 offen offset:2048 lds
    v_mfma_f32_16x16x32_bf16 v[124:127], a[188:191], v[140:143], 0
    ds_read_b64_tr_b16 a[158:159], v247 offset:9224
    v_cvt_pk_bf16_f32 v147, v220, v221
    v_fma_mix_f32 v223, v151, v199, v207 op_sel:[1,0,0] op_sel_hi:[1,0,0]
    v_mfma_f32_16x16x32_bf16 v[92:95], a[188:191], v[136:139], 0
    v_fma_mix_f32 v220, v155, v198, v206 op_sel_hi:[1,0,0]
    v_cvt_pk_bf16_f32 v151, v222, v223
    v_mfma_f32_16x16x32_bf16 v[60:63], a[188:191], v[132:135], 0
    v_fma_mix_f32 v221, v155, v199, v207 op_sel:[1,0,0] op_sel_hi:[1,0,0]
    v_fma_mix_f32 v222, v159, v198, v206 op_sel_hi:[1,0,0]
    v_cvt_pk_bf16_f32 v155, v220, v221
    v_mfma_f32_16x16x32_bf16 v[28:31], a[188:191], v[128:131], 0
    s_waitcnt vmcnt(9) lgkmcnt(0)
    v_fma_mix_f32 v223, v159, v199, v207 op_sel:[1,0,0] op_sel_hi:[1,0,0]
    v_cvt_pk_bf16_f32 v159, v222, v223
    v_mfma_f32_16x16x32_bf16 v[0:3], a[128:131], v[144:147], v[0:3]
    ds_read_b128 v[196:199], v241 offset:912
    v_fma_mix_f32 v220, v160, v192, v200 op_sel_hi:[1,0,0]
    v_fma_mix_f32 v221, v160, v193, v201 op_sel:[1,0,0] op_sel_hi:[1,0,0]
    v_mfma_f32_16x16x32_bf16 v[32:35], a[128:131], v[148:151], v[32:35]
    ds_read_b128 v[204:207], v241 offset:272
    v_fma_mix_f32 v222, v164, v192, v200 op_sel_hi:[1,0,0]
    v_cvt_pk_bf16_f32 v160, v220, v221
    v_mfma_f32_16x16x32_bf16 v[64:67], a[128:131], v[152:155], v[64:67]
    ds_read_b64_tr_b16 a[160:161], v244 offset:16384
    v_fma_mix_f32 v223, v164, v193, v201 op_sel:[1,0,0] op_sel_hi:[1,0,0]
    v_fma_mix_f32 v220, v168, v192, v200 op_sel_hi:[1,0,0]
    v_mfma_f32_16x16x32_bf16 v[96:99], a[128:131], v[156:159], v[96:99]
    s_add_u32 s34, s36, 1143808
    ds_read_b64_tr_b16 a[162:163], v244 offset:17408
    v_cvt_pk_bf16_f32 v164, v222, v223
    v_fma_mix_f32 v221, v168, v193, v201 op_sel:[1,0,0] op_sel_hi:[1,0,0]
    v_mfma_f32_16x16x32_bf16 v[100:103], a[132:135], v[156:159], v[100:103]
    buffer_load_dwordx4 v242, s[12:15], s34 offen offset:3072 lds
    v_mfma_f32_16x16x32_bf16 v[68:71], a[132:135], v[152:155], v[68:71]
    s_add_u32 m0, s38, 36864
    ds_read_b64_tr_b16 a[164:165], v244 offset:16392
    v_fma_mix_f32 v222, v172, v192, v200 op_sel_hi:[1,0,0]
    v_cvt_pk_bf16_f32 v168, v220, v221
    v_mfma_f32_16x16x32_bf16 v[36:39], a[132:135], v[148:151], v[36:39]
    s_add_u32 s34, s36, 1179648
    ds_read_b64_tr_b16 a[166:167], v244 offset:17416
    v_fma_mix_f32 v223, v172, v193, v201 op_sel:[1,0,0] op_sel_hi:[1,0,0]
    v_mfma_f32_16x16x32_bf16 v[4:7], a[132:135], v[144:147], v[4:7]
    buffer_load_dwordx4 v242, s[12:15], s34 offen offset:0 lds
    v_mfma_f32_16x16x32_bf16 v[8:11], a[136:139], v[144:147], v[8:11]
    ds_read_b64_tr_b16 a[168:169], v245 offset:16384
    v_fma_mix_f32 v220, v161, v194, v202 op_sel_hi:[1,0,0]
    v_cvt_pk_bf16_f32 v172, v222, v223
    v_mfma_f32_16x16x32_bf16 v[40:43], a[136:139], v[148:151], v[40:43]
    ds_read_b64_tr_b16 a[170:171], v245 offset:17408
    v_fma_mix_f32 v221, v161, v195, v203 op_sel:[1,0,0] op_sel_hi:[1,0,0]
    v_fma_mix_f32 v222, v165, v194, v202 op_sel_hi:[1,0,0]
    v_mfma_f32_16x16x32_bf16 v[72:75], a[136:139], v[152:155], v[72:75]
    s_add_u32 s34, s36, 1211392
    ds_read_b64_tr_b16 a[172:173], v245 offset:16392
    v_cvt_pk_bf16_f32 v161, v220, v221
    v_fma_mix_f32 v223, v165, v195, v203 op_sel:[1,0,0] op_sel_hi:[1,0,0]
    v_mfma_f32_16x16x32_bf16 v[104:107], a[136:139], v[156:159], v[104:107]
    buffer_load_dwordx4 v242, s[12:15], s34 offen offset:1024 lds
    v_mfma_f32_16x16x32_bf16 v[108:111], a[140:143], v[156:159], v[108:111]
    ds_read_b64_tr_b16 a[174:175], v245 offset:17416
    v_fma_mix_f32 v220, v169, v194, v202 op_sel_hi:[1,0,0]
    v_cvt_pk_bf16_f32 v165, v222, v223
    v_mfma_f32_16x16x32_bf16 v[76:79], a[140:143], v[152:155], v[76:79]
    v_fma_mix_f32 v221, v169, v195, v203 op_sel:[1,0,0] op_sel_hi:[1,0,0]
    v_fma_mix_f32 v222, v173, v194, v202 op_sel_hi:[1,0,0]
    v_cvt_pk_bf16_f32 v169, v220, v221
    v_mfma_f32_16x16x32_bf16 v[44:47], a[140:143], v[148:151], v[44:47]
    s_add_u32 s34, s36, 1243136
    v_fma_mix_f32 v223, v173, v195, v203 op_sel:[1,0,0] op_sel_hi:[1,0,0]
    v_cvt_pk_bf16_f32 v173, v222, v223
    v_mfma_f32_16x16x32_bf16 v[12:15], a[140:143], v[144:147], v[12:15]
    s_waitcnt lgkmcnt(8)
    buffer_load_dwordx4 v242, s[12:15], s34 offen offset:2048 lds
    v_mfma_f32_16x16x32_bf16 v[16:19], a[144:147], v[144:147], v[16:19]
    ds_read_b128 v[192:195], v241 offset:1024
    v_fma_mix_f32 v220, v162, v196, v204 op_sel_hi:[1,0,0]
    v_fma_mix_f32 v221, v162, v197, v205 op_sel:[1,0,0] op_sel_hi:[1,0,0]
    v_mfma_f32_16x16x32_bf16 v[48:51], a[144:147], v[148:151], v[48:51]
    ds_read_b128 v[200:203], v241 offset:384
    v_fma_mix_f32 v222, v166, v196, v204 op_sel_hi:[1,0,0]
    v_cvt_pk_bf16_f32 v162, v220, v221
    v_mfma_f32_16x16x32_bf16 v[80:83], a[144:147], v[152:155], v[80:83]
    s_add_u32 s34, s36, 1274880
    ds_read_b64_tr_b16 a[176:177], v246 offset:16384
    v_fma_mix_f32 v223, v166, v197, v205 op_sel:[1,0,0] op_sel_hi:[1,0,0]
    v_mfma_f32_16x16x32_bf16 v[112:115], a[144:147], v[156:159], v[112:115]
    buffer_load_dwordx4 v242, s[12:15], s34 offen offset:3072 lds
    v_mfma_f32_16x16x32_bf16 v[116:119], a[148:151], v[156:159], v[116:119]
    s_add_u32 s30, s81, 4096
    s_add_u32 s31, s81, 24576
    ds_read_b64_tr_b16 a[178:179], v246 offset:17408
    v_fma_mix_f32 v220, v170, v196, v204 op_sel_hi:[1,0,0]
    v_cvt_pk_bf16_f32 v166, v222, v223
    v_mfma_f32_16x16x32_bf16 v[84:87], a[148:151], v[152:155], v[84:87]
    s_add_u32 s32, s81, 45056
    ds_read_b64_tr_b16 a[180:181], v246 offset:16392
    v_fma_mix_f32 v221, v170, v197, v205 op_sel:[1,0,0] op_sel_hi:[1,0,0]
    v_fma_mix_f32 v222, v174, v196, v204 op_sel_hi:[1,0,0]
    v_mfma_f32_16x16x32_bf16 v[52:55], a[148:151], v[148:151], v[52:55]
    s_add_u32 s33, s81, 65536
    ds_read_b64_tr_b16 a[182:183], v246 offset:17416
    v_cvt_pk_bf16_f32 v170, v220, v221
    v_mfma_f32_16x16x32_bf16 v[20:23], a[148:151], v[144:147], v[20:23]
    buffer_load_dwordx4 v[128:131], v249, s[16:19], s30 offen offset:0 sc1
    v_mfma_f32_16x16x32_bf16 v[24:27], a[152:155], v[144:147], v[24:27]
    ds_read_b64_tr_b16 a[184:185], v247 offset:16384
    v_fma_mix_f32 v223, v174, v197, v205 op_sel:[1,0,0] op_sel_hi:[1,0,0]
    v_fma_mix_f32 v220, v163, v198, v206 op_sel_hi:[1,0,0]
    v_mfma_f32_16x16x32_bf16 v[56:59], a[152:155], v[148:151], v[56:59]
    ds_read_b64_tr_b16 a[186:187], v247 offset:17408
    v_cvt_pk_bf16_f32 v174, v222, v223
    v_mfma_f32_16x16x32_bf16 v[88:91], a[152:155], v[152:155], v[88:91]
    ds_read_b64_tr_b16 a[188:189], v247 offset:16392
    v_fma_mix_f32 v221, v163, v199, v207 op_sel:[1,0,0] op_sel_hi:[1,0,0]
    v_fma_mix_f32 v222, v167, v198, v206 op_sel_hi:[1,0,0]
    v_mfma_f32_16x16x32_bf16 v[120:123], a[152:155], v[156:159], v[120:123]
    buffer_load_dwordx4 v[132:135], v249, s[16:19], s31 offen offset:0 sc1
    v_mfma_f32_16x16x32_bf16 v[124:127], a[156:159], v[156:159], v[124:127]
    ds_read_b64_tr_b16 a[190:191], v247 offset:17416
    v_cvt_pk_bf16_f32 v163, v220, v221
    v_fma_mix_f32 v223, v167, v199, v207 op_sel:[1,0,0] op_sel_hi:[1,0,0]
    v_mfma_f32_16x16x32_bf16 v[92:95], a[156:159], v[152:155], v[92:95]
    v_fma_mix_f32 v220, v171, v198, v206 op_sel_hi:[1,0,0]
    v_cvt_pk_bf16_f32 v167, v222, v223
    v_mfma_f32_16x16x32_bf16 v[60:63], a[156:159], v[148:151], v[60:63]
    v_fma_mix_f32 v221, v171, v199, v207 op_sel:[1,0,0] op_sel_hi:[1,0,0]
    v_fma_mix_f32 v222, v175, v198, v206 op_sel_hi:[1,0,0]
    v_cvt_pk_bf16_f32 v171, v220, v221
    v_mfma_f32_16x16x32_bf16 v[28:31], a[156:159], v[144:147], v[28:31]
    s_waitcnt vmcnt(10) lgkmcnt(0)
    v_fma_mix_f32 v223, v175, v199, v207 op_sel:[1,0,0] op_sel_hi:[1,0,0]
    v_cvt_pk_bf16_f32 v175, v222, v223
    v_mfma_f32_16x16x32_bf16 v[0:3], a[160:163], v[160:163], v[0:3]
    ds_read_b128 v[196:199], v241 offset:1040
    v_fma_mix_f32 v220, v176, v192, v200 op_sel_hi:[1,0,0]
    v_fma_mix_f32 v221, v176, v193, v201 op_sel:[1,0,0] op_sel_hi:[1,0,0]
    v_mfma_f32_16x16x32_bf16 v[32:35], a[160:163], v[164:167], v[32:35]
    ds_read_b128 v[204:207], v241 offset:400
    v_fma_mix_f32 v222, v180, v192, v200 op_sel_hi:[1,0,0]
    v_cvt_pk_bf16_f32 v176, v220, v221
    v_mfma_f32_16x16x32_bf16 v[64:67], a[160:163], v[168:171], v[64:67]
    ds_read_b64_tr_b16 a[128:129], v244 offset:24576
    v_fma_mix_f32 v223, v180, v193, v201 op_sel:[1,0,0] op_sel_hi:[1,0,0]
    v_fma_mix_f32 v220, v184, v192, v200 op_sel_hi:[1,0,0]
    v_mfma_f32_16x16x32_bf16 v[96:99], a[160:163], v[172:175], v[96:99]
    ds_read_b64_tr_b16 a[130:131], v244 offset:25600
    v_cvt_pk_bf16_f32 v180, v222, v223
    v_fma_mix_f32 v221, v184, v193, v201 op_sel:[1,0,0] op_sel_hi:[1,0,0]
    v_mfma_f32_16x16x32_bf16 v[100:103], a[164:167], v[172:175], v[100:103]
    buffer_load_dword v236, v240, s[16:19], s27 offen sc1
    v_mfma_f32_16x16x32_bf16 v[68:71], a[164:167], v[168:171], v[68:71]
    ds_read_b64_tr_b16 a[132:133], v244 offset:24584
    v_fma_mix_f32 v222, v188, v192, v200 op_sel_hi:[1,0,0]
    v_cvt_pk_bf16_f32 v184, v220, v221
    v_mfma_f32_16x16x32_bf16 v[36:39], a[164:167], v[164:167], v[36:39]
    ds_read_b64_tr_b16 a[134:135], v244 offset:25608
    v_fma_mix_f32 v223, v188, v193, v201 op_sel:[1,0,0] op_sel_hi:[1,0,0]
    v_mfma_f32_16x16x32_bf16 v[4:7], a[164:167], v[160:163], v[4:7]
    buffer_load_dwordx4 v[136:139], v249, s[16:19], s32 offen offset:0 sc1
    v_mfma_f32_16x16x32_bf16 v[8:11], a[168:171], v[160:163], v[8:11]
    ds_read_b64_tr_b16 a[136:137], v245 offset:24576
    v_fma_mix_f32 v220, v177, v194, v202 op_sel_hi:[1,0,0]
    v_cvt_pk_bf16_f32 v188, v222, v223
    v_mfma_f32_16x16x32_bf16 v[40:43], a[168:171], v[164:167], v[40:43]
    ds_read_b64_tr_b16 a[138:139], v245 offset:25600
    v_fma_mix_f32 v221, v177, v195, v203 op_sel:[1,0,0] op_sel_hi:[1,0,0]
    v_fma_mix_f32 v222, v181, v194, v202 op_sel_hi:[1,0,0]
    v_mfma_f32_16x16x32_bf16 v[72:75], a[168:171], v[168:171], v[72:75]
    ds_read_b64_tr_b16 a[140:141], v245 offset:24584
    v_cvt_pk_bf16_f32 v177, v220, v221
    v_fma_mix_f32 v223, v181, v195, v203 op_sel:[1,0,0] op_sel_hi:[1,0,0]
    v_mfma_f32_16x16x32_bf16 v[104:107], a[168:171], v[172:175], v[104:107]
    buffer_load_dwordx4 v[140:143], v249, s[16:19], s33 offen offset:0 sc1
    v_mfma_f32_16x16x32_bf16 v[108:111], a[172:175], v[172:175], v[108:111]
    ds_read_b64_tr_b16 a[142:143], v245 offset:25608
    v_fma_mix_f32 v220, v185, v194, v202 op_sel_hi:[1,0,0]
    v_cvt_pk_bf16_f32 v181, v222, v223
    v_mfma_f32_16x16x32_bf16 v[76:79], a[172:175], v[168:171], v[76:79]
    s_add_u32 m0, s38, 65536
    v_fma_mix_f32 v221, v185, v195, v203 op_sel:[1,0,0] op_sel_hi:[1,0,0]
    v_fma_mix_f32 v222, v189, v194, v202 op_sel_hi:[1,0,0]
    v_cvt_pk_bf16_f32 v185, v220, v221
    v_mfma_f32_16x16x32_bf16 v[44:47], a[172:175], v[164:167], v[44:47]
    s_add_u32 s34, s36, 2097152
    v_fma_mix_f32 v223, v189, v195, v203 op_sel:[1,0,0] op_sel_hi:[1,0,0]
    v_cvt_pk_bf16_f32 v189, v222, v223
    v_mfma_f32_16x16x32_bf16 v[12:15], a[172:175], v[160:163], v[12:15]
    s_waitcnt lgkmcnt(8)
    buffer_load_dwordx4 v242, s[12:15], s34 offen offset:0 lds
    v_mfma_f32_16x16x32_bf16 v[16:19], a[176:179], v[160:163], v[16:19]
    ds_read_b128 v[192:195], v241 offset:1152
    v_fma_mix_f32 v220, v178, v196, v204 op_sel_hi:[1,0,0]
    v_fma_mix_f32 v221, v178, v197, v205 op_sel:[1,0,0] op_sel_hi:[1,0,0]
    v_mfma_f32_16x16x32_bf16 v[48:51], a[176:179], v[164:167], v[48:51]
    ds_read_b128 v[200:203], v241 offset:512
    v_fma_mix_f32 v222, v182, v196, v204 op_sel_hi:[1,0,0]
    v_cvt_pk_bf16_f32 v178, v220, v221
    v_mfma_f32_16x16x32_bf16 v[80:83], a[176:179], v[168:171], v[80:83]
    s_add_u32 s34, s36, 2128896
    ds_read_b64_tr_b16 a[144:145], v246 offset:24576
    v_fma_mix_f32 v223, v182, v197, v205 op_sel:[1,0,0] op_sel_hi:[1,0,0]
    v_mfma_f32_16x16x32_bf16 v[112:115], a[176:179], v[172:175], v[112:115]
    buffer_load_dwordx4 v242, s[12:15], s34 offen offset:1024 lds
    v_mfma_f32_16x16x32_bf16 v[116:119], a[180:183], v[172:175], v[116:119]
    ds_read_b64_tr_b16 a[146:147], v246 offset:25600
    v_fma_mix_f32 v220, v186, v196, v204 op_sel_hi:[1,0,0]
    v_cvt_pk_bf16_f32 v182, v222, v223
    v_mfma_f32_16x16x32_bf16 v[84:87], a[180:183], v[168:171], v[84:87]
    ds_read_b64_tr_b16 a[148:149], v246 offset:24584
    v_fma_mix_f32 v221, v186, v197, v205 op_sel:[1,0,0] op_sel_hi:[1,0,0]
    v_fma_mix_f32 v222, v190, v196, v204 op_sel_hi:[1,0,0]
    v_mfma_f32_16x16x32_bf16 v[52:55], a[180:183], v[164:167], v[52:55]
    s_add_u32 s34, s36, 2160640
    ds_read_b64_tr_b16 a[150:151], v246 offset:25608
    v_cvt_pk_bf16_f32 v186, v220, v221
    v_mfma_f32_16x16x32_bf16 v[20:23], a[180:183], v[160:163], v[20:23]
    buffer_load_dwordx4 v242, s[12:15], s34 offen offset:2048 lds
    v_mfma_f32_16x16x32_bf16 v[24:27], a[184:187], v[160:163], v[24:27]
    ds_read_b64_tr_b16 a[152:153], v247 offset:24576
    v_fma_mix_f32 v223, v190, v197, v205 op_sel:[1,0,0] op_sel_hi:[1,0,0]
    v_fma_mix_f32 v220, v179, v198, v206 op_sel_hi:[1,0,0]
    v_mfma_f32_16x16x32_bf16 v[56:59], a[184:187], v[164:167], v[56:59]
    ds_read_b64_tr_b16 a[154:155], v247 offset:25600
    v_cvt_pk_bf16_f32 v190, v222, v223
    v_mfma_f32_16x16x32_bf16 v[88:91], a[184:187], v[168:171], v[88:91]
    s_add_u32 s34, s36, 2192384
    ds_read_b64_tr_b16 a[156:157], v247 offset:24584
    v_fma_mix_f32 v221, v179, v199, v207 op_sel:[1,0,0] op_sel_hi:[1,0,0]
    v_fma_mix_f32 v222, v183, v198, v206 op_sel_hi:[1,0,0]
    v_mfma_f32_16x16x32_bf16 v[120:123], a[184:187], v[172:175], v[120:123]
HOP0_1:
    s_cbranch_execz HOP0_4
    buffer_load_dwordx4 v242, s[12:15], s34 offen offset:3072 lds
    v_mfma_f32_16x16x32_bf16 v[124:127], a[188:191], v[172:175], v[124:127]
    ds_read_b64_tr_b16 a[158:159], v247 offset:25608
    v_cvt_pk_bf16_f32 v179, v220, v221
    v_fma_mix_f32 v223, v183, v199, v207 op_sel:[1,0,0] op_sel_hi:[1,0,0]
    v_mfma_f32_16x16x32_bf16 v[92:95], a[188:191], v[168:171], v[92:95]
    v_fma_mix_f32 v220, v187, v198, v206 op_sel_hi:[1,0,0]
    v_cvt_pk_bf16_f32 v183, v222, v223
    v_mfma_f32_16x16x32_bf16 v[60:63], a[188:191], v[164:167], v[60:63]
    v_fma_mix_f32 v221, v187, v199, v207 op_sel:[1,0,0] op_sel_hi:[1,0,0]
    v_fma_mix_f32 v222, v191, v198, v206 op_sel_hi:[1,0,0]
    v_cvt_pk_bf16_f32 v187, v220, v221
    v_mfma_f32_16x16x32_bf16 v[28:31], a[188:191], v[160:163], v[28:31]
    s_waitcnt vmcnt(4) lgkmcnt(0)
    s_barrier
    v_fma_mix_f32 v223, v191, v199, v207 op_sel:[1,0,0] op_sel_hi:[1,0,0]
    v_cvt_pk_bf16_f32 v191, v222, v223
    v_cmp_ne_u32 vcc, s55, v236
    s_cbranch_vccnz S0_spin
S0_ok:
    v_mfma_f32_16x16x32_bf16 v[0:3], a[128:131], v[176:179], v[0:3]
    ds_read_b128 v[196:199], v241 offset:1168
    v_fma_mix_f32 v220, v128, v192, v200 op_sel_hi:[1,0,0]
    v_fma_mix_f32 v221, v128, v193, v201 op_sel:[1,0,0] op_sel_hi:[1,0,0]
    v_mfma_f32_16x16x32_bf16 v[32:35], a[128:131], v[180:183], v[32:35]
    ds_read_b128 v[204:207], v241 offset:528
    v_fma_mix_f32 v222, v132, v192, v200 op_sel_hi:[1,0,0]
    v_cvt_pk_bf16_f32 v128, v220, v221
    v_mfma_f32_16x16x32_bf16 v[64:67], a[128:131], v[184:187], v[64:67]
    ds_read_b64_tr_b16 a[160:161], v244 offset:32768
    v_fma_mix_f32 v223, v132, v193, v201 op_sel:[1,0,0] op_sel_hi:[1,0,0]
    v_fma_mix_f32 v220, v136, v192, v200 op_sel_hi:[1,0,0]
    v_mfma_f32_16x16x32_bf16 v[96:99], a[128:131], v[188:191], v[96:99]
    ds_read_b64_tr_b16 a[162:163], v244 offset:33792
    v_cvt_pk_bf16_f32 v132, v222, v223
    v_fma_mix_f32 v221, v136, v193, v201 op_sel:[1,0,0] op_sel_hi:[1,0,0]
    v_mfma_f32_16x16x32_bf16 v[100:103], a[132:135], v[188:191], v[100:103]
    buffer_load_dwordx4 a[0:3], v249, s[16:19], s30 offen offset:1024 sc1
    v_mfma_f32_16x16x32_bf16 v[68:71], a[132:135], v[184:187], v[68:71]
    ds_read_b64_tr_b16 a[164:165], v244 offset:32776
    v_fma_mix_f32 v222, v140, v192, v200 op_sel_hi:[1,0,0]
    v_cvt_pk_bf16_f32 v136, v220, v221
    v_mfma_f32_16x16x32_bf16 v[36:39], a[132:135], v[180:183], v[36:39]
    ds_read_b64_tr_b16 a[166:167], v244 offset:33800
    v_fma_mix_f32 v223, v140, v193, v201 op_sel:[1,0,0] op_sel_hi:[1,0,0]
    v_mfma_f32_16x16x32_bf16 v[4:7], a[132:135], v[176:179], v[4:7]
    buffer_load_dwordx4 a[4:7], v249, s[16:19], s31 offen offset:1024 sc1
    v_mfma_f32_16x16x32_bf16 v[8:11], a[136:139], v[176:179], v[8:11]
    ds_read_b64_tr_b16 a[168:169], v245 offset:32768
    v_fma_mix_f32 v220, v129, v194, v202 op_sel_hi:[1,0,0]
    v_cvt_pk_bf16_f32 v140, v222, v223
    v_mfma_f32_16x16x32_bf16 v[40:43], a[136:139], v[180:183], v[40:43]
    ds_read_b64_tr_b16 a[170:171], v245 offset:33792
    v_fma_mix_f32 v221, v129, v195, v203 op_sel:[1,0,0] op_sel_hi:[1,0,0]
    v_fma_mix_f32 v222, v133, v194, v202 op_sel_hi:[1,0,0]
    v_mfma_f32_16x16x32_bf16 v[72:75], a[136:139], v[184:187], v[72:75]
    ds_read_b64_tr_b16 a[172:173], v245 offset:32776
    v_cvt_pk_bf16_f32 v129, v220, v221
    v_fma_mix_f32 v223, v133, v195, v203 op_sel:[1,0,0] op_sel_hi:[1,0,0]
    v_mfma_f32_16x16x32_bf16 v[104:107], a[136:139], v[188:191], v[104:107]
    buffer_load_dwordx4 a[8:11], v249, s[16:19], s32 offen offset:1024 sc1
    v_mfma_f32_16x16x32_bf16 v[108:111], a[140:143], v[188:191], v[108:111]
    ds_read_b64_tr_b16 a[174:175], v245 offset:33800
    v_fma_mix_f32 v220, v137, v194, v202 op_sel_hi:[1,0,0]
    v_cvt_pk_bf16_f32 v133, v222, v223
    v_mfma_f32_16x16x32_bf16 v[76:79], a[140:143], v[184:187], v[76:79]
    v_fma_mix_f32 v221, v137, v195, v203 op_sel:[1,0,0] op_sel_hi:[1,0,0]
    v_fma_mix_f32 v222, v141, v194, v202 op_sel_hi:[1,0,0]
    v_cvt_pk_bf16_f32 v137, v220, v221
    v_mfma_f32_16x16x32_bf16 v[44:47], a[140:143], v[180:183], v[44:47]
    v_fma_mix_f32 v223, v141, v195, v203 op_sel:[1,0,0] op_sel_hi:[1,0,0]
    v_cvt_pk_bf16_f32 v141, v222, v223
    v_mfma_f32_16x16x32_bf16 v[12:15], a[140:143], v[176:179], v[12:15]
    s_waitcnt lgkmcnt(8)
    buffer_load_dwordx4 a[12:15], v249, s[16:19], s33 offen offset:1024 sc1
    v_mfma_f32_16x16x32_bf16 v[16:19], a[144:147], v[176:179], v[16:19]
    ds_read_b64_tr_b16 a[176:177], v246 offset:32768
    v_fma_mix_f32 v220, v130, v196, v204 op_sel_hi:[1,0,0]
    v_fma_mix_f32 v221, v130, v197, v205 op_sel:[1,0,0] op_sel_hi:[1,0,0]
    v_mfma_f32_16x16x32_bf16 v[48:51], a[144:147], v[180:183], v[48:51]
    ds_read_b64_tr_b16 a[178:179], v246 offset:33792
    v_fma_mix_f32 v222, v134, v196, v204 op_sel_hi:[1,0,0]
    v_mfma_f32_16x16x32_bf16 v[80:83], a[144:147], v[184:187], v[80:83]
    ds_read_b64_tr_b16 a[180:181], v246 offset:32776
    v_cvt_pk_bf16_f32 v130, v220, v221
    v_fma_mix_f32 v223, v134, v197, v205 op_sel:[1,0,0] op_sel_hi:[1,0,0]
    v_mfma_f32_16x16x32_bf16 v[112:115], a[144:147], v[188:191], v[112:115]
    buffer_load_dwordx4 a[16:19], v249, s[16:19], s30 offen offset:2048 sc1
    v_mfma_f32_16x16x32_bf16 v[116:119], a[148:151], v[188:191], v[116:119]
    ds_read_b64_tr_b16 a[182:183], v246 offset:33800
    v_fma_mix_f32 v220, v138, v196, v204 op_sel_hi:[1,0,0]
    v_mfma_f32_16x16x32_bf16 v[84:87], a[148:151], v[184:187], v[84:87]
    ds_read_b64_tr_b16 a[184:185], v247 offset:32768
    v_cvt_pk_bf16_f32 v134, v222, v223
    v_fma_mix_f32 v221, v138, v197, v205 op_sel:[1,0,0] op_sel_hi:[1,0,0]
    v_mfma_f32_16x16x32_bf16 v[52:55], a[148:151], v[180:183], v[52:55]
    ds_read_b64_tr_b16 a[186:187], v247 offset:33792
    v_fma_mix_f32 v222, v142, v196, v204 op_sel_hi:[1,0,0]
    v_mfma_f32_16x16x32_bf16 v[20:23], a[148:151], v[176:179], v[20:23]
    buffer_load_dwordx4 a[20:23], v249, s[16:19], s31 offen offset:2048 sc1
    v_mfma_f32_16x16x32_bf16 v[24:27], a[152:155], v[176:179], v[24:27]
    ds_read_b64_tr_b16 a[188:189], v247 offset:32776
    v_cvt_pk_bf16_f32 v138, v220, v221
    v_fma_mix_f32 v223, v142, v197, v205 op_sel:[1,0,0] op_sel_hi:[1,0,0]
    v_mfma_f32_16x16x32_bf16 v[56:59], a[152:155], v[180:183], v[56:59]
    ds_read_b64_tr_b16 a[190:191], v247 offset:33800
    v_fma_mix_f32 v220, v131, v198, v206 op_sel_hi:[1,0,0]
    v_mfma_f32_16x16x32_bf16 v[88:91], a[152:155], v[184:187], v[88:91]
    v_cvt_pk_bf16_f32 v142, v222, v223
    v_fma_mix_f32 v221, v131, v199, v207 op_sel:[1,0,0] op_sel_hi:[1,0,0]
    v_fma_mix_f32 v222, v135, v198, v206 op_sel_hi:[1,0,0]
    v_mfma_f32_16x16x32_bf16 v[120:123], a[152:155], v[188:191], v[120:123]
    buffer_load_dwordx4 a[24:27], v249, s[16:19], s32 offen offset:2048 sc1
    v_mfma_f32_16x16x32_bf16 v[124:127], a[156:159], v[188:191], v[124:127]
    v_cvt_pk_bf16_f32 v131, v220, v221
    v_fma_mix_f32 v223, v135, v199, v207 op_sel:[1,0,0] op_sel_hi:[1,0,0]
    v_mfma_f32_16x16x32_bf16 v[92:95], a[156:159], v[184:187], v[92:95]
    v_fma_mix_f32 v220, v139, v198, v206 op_sel_hi:[1,0,0]
    v_cvt_pk_bf16_f32 v135, v222, v223
    v_fma_mix_f32 v221, v139, v199, v207 op_sel:[1,0,0] op_sel_hi:[1,0,0]
    v_mfma_f32_16x16x32_bf16 v[60:63], a[156:159], v[180:183], v[60:63]
    v_fma_mix_f32 v222, v143, v198, v206 op_sel_hi:[1,0,0]
    v_cvt_pk_bf16_f32 v139, v220, v221
    v_mfma_f32_16x16x32_bf16 v[28:31], a[156:159], v[176:179], v[28:31]
    s_waitcnt lgkmcnt(0)
    v_fma_mix_f32 v223, v143, v199, v207 op_sel:[1,0,0] op_sel_hi:[1,0,0]
    v_cvt_pk_bf16_f32 v143, v222, v223
    v_mfma_f32_16x16x32_bf16 v[0:3], a[160:163], v[128:131], v[0:3]
    ds_read_b64_tr_b16 a[128:129], v244 offset:40960
    v_mfma_f32_16x16x32_bf16 v[32:35], a[160:163], v[132:135], v[32:35]
    ds_read_b64_tr_b16 a[130:131], v244 offset:41984
    v_mfma_f32_16x16x32_bf16 v[64:67], a[160:163], v[136:139], v[64:67]
    ds_read_b64_tr_b16 a[132:133], v244 offset:40968
    v_mfma_f32_16x16x32_bf16 v[96:99], a[160:163], v[140:143], v[96:99]
    ds_read_b64_tr_b16 a[134:135], v244 offset:41992
    v_mfma_f32_16x16x32_bf16 v[100:103], a[164:167], v[140:143], v[100:103]
    buffer_load_dwordx4 a[28:31], v249, s[16:19], s33 offen offset:2048 sc1
    v_mfma_f32_16x16x32_bf16 v[68:71], a[164:167], v[136:139], v[68:71]
    s_add_u32 m0, s38, 69632
    ds_read_b64_tr_b16 a[136:137], v245 offset:40960
    v_mfma_f32_16x16x32_bf16 v[36:39], a[164:167], v[132:135], v[36:39]
    s_add_u32 s34, s36, 2228224
    ds_read_b64_tr_b16 a[138:139], v245 offset:41984
    v_mfma_f32_16x16x32_bf16 v[4:7], a[164:167], v[128:131], v[4:7]
    buffer_load_dwordx4 v242, s[12:15], s34 offen offset:0 lds
    v_mfma_f32_16x16x32_bf16 v[8:11], a[168:171], v[128:131], v[8:11]
    ds_read_b64_tr_b16 a[140:141], v245 offset:40968
    v_mfma_f32_16x16x32_bf16 v[40:43], a[168:171], v[132:135], v[40:43]
    ds_read_b64_tr_b16 a[142:143], v245 offset:41992
    v_mfma_f32_16x16x32_bf16 v[72:75], a[168:171], v[136:139], v[72:75]
    s_add_u32 s34, s36, 2259968
    ds_read_b64_tr_b16 a[144:145], v246 offset:40960
    v_mfma_f32_16x16x32_bf16 v[104:107], a[168:171], v[140:143], v[104:107]
    buffer_load_dwordx4 v242, s[12:15], s34 offen offset:1024 lds
    v_mfma_f32_16x16x32_bf16 v[108:111], a[172:175], v[140:143], v[108:111]
    ds_read_b64_tr_b16 a[146:147], v246 offset:41984
    v_mfma_f32_16x16x32_bf16 v[76:79], a[172:175], v[136:139], v[76:79]
    ds_read_b64_tr_b16 a[148:149], v246 offset:40968
    v_mfma_f32_16x16x32_bf16 v[44:47], a[172:175], v[132:135], v[44:47]
    s_add_u32 s34, s36, 2291712
    ds_read_b64_tr_b16 a[150:151], v246 offset:41992
    v_mfma_f32_16x16x32_bf16 v[12:15], a[172:175], v[128:131], v[12:15]
    buffer_load_dwordx4 v242, s[12:15], s34 offen offset:2048 lds
    v_mfma_f32_16x16x32_bf16 v[16:19], a[176:179], v[128:131], v[16:19]
    ds_read_b64_tr_b16 a[152:153], v247 offset:40960
    v_mfma_f32_16x16x32_bf16 v[48:51], a[176:179], v[132:135], v[48:51]
    ds_read_b64_tr_b16 a[154:155], v247 offset:41984
    v_mfma_f32_16x16x32_bf16 v[80:83], a[176:179], v[136:139], v[80:83]
    s_add_u32 s34, s36, 2323456
    ds_read_b64_tr_b16 a[156:157], v247 offset:40968
    v_mfma_f32_16x16x32_bf16 v[112:115], a[176:179], v[140:143], v[112:115]
    buffer_load_dwordx4 v242, s[12:15], s34 offen offset:3072 lds
    v_mfma_f32_16x16x32_bf16 v[116:119], a[180:183], v[140:143], v[116:119]
    ds_read_b64_tr_b16 a[158:159], v247 offset:41992
    v_mfma_f32_16x16x32_bf16 v[84:87], a[180:183], v[136:139], v[84:87]
    v_mfma_f32_16x16x32_bf16 v[52:55], a[180:183], v[132:135], v[52:55]
    v_mfma_f32_16x16x32_bf16 v[20:23], a[180:183], v[128:131], v[20:23]
    buffer_load_dwordx4 a[32:35], v249, s[16:19], s30 offen offset:3072 sc1
    v_mfma_f32_16x16x32_bf16 v[24:27], a[184:187], v[128:131], v[24:27]
    v_mfma_f32_16x16x32_bf16 v[56:59], a[184:187], v[132:135], v[56:59]
    v_mfma_f32_16x16x32_bf16 v[88:91], a[184:187], v[136:139], v[88:91]
    v_mfma_f32_16x16x32_bf16 v[120:123], a[184:187], v[140:143], v[120:123]
    buffer_load_dwordx4 a[36:39], v249, s[16:19], s31 offen offset:3072 sc1
    v_mfma_f32_16x16x32_bf16 v[124:127], a[188:191], v[140:143], v[124:127]
    v_mfma_f32_16x16x32_bf16 v[92:95], a[188:191], v[136:139], v[92:95]
    v_mfma_f32_16x16x32_bf16 v[60:63], a[188:191], v[132:135], v[60:63]
    v_mfma_f32_16x16x32_bf16 v[28:31], a[188:191], v[128:131], v[28:31]
    s_waitcnt vmcnt(10) lgkmcnt(0)
    v_mfma_f32_16x16x32_bf16 v[0:3], a[128:131], a[0:3], v[0:3]
    ds_read_b64_tr_b16 a[160:161], v244 offset:49152
    v_mfma_f32_16x16x32_bf16 v[32:35], a[128:131], a[4:7], v[32:35]
    ds_read_b64_tr_b16 a[162:163], v244 offset:50176
    v_mfma_f32_16x16x32_bf16 v[64:67], a[128:131], a[8:11], v[64:67]
    ds_read_b64_tr_b16 a[164:165], v244 offset:49160
    v_mfma_f32_16x16x32_bf16 v[96:99], a[128:131], a[12:15], v[96:99]
    ds_read_b64_tr_b16 a[166:167], v244 offset:50184
    v_mfma_f32_16x16x32_bf16 v[100:103], a[132:135], a[12:15], v[100:103]
    buffer_load_dwordx4 a[40:43], v249, s[16:19], s32 offen offset:3072 sc1
    v_mfma_f32_16x16x32_bf16 v[68:71], a[132:135], a[8:11], v[68:71]
    ds_read_b64_tr_b16 a[168:169], v245 offset:49152
    v_mfma_f32_16x16x32_bf16 v[36:39], a[132:135], a[4:7], v[36:39]
    ds_read_b64_tr_b16 a[170:171], v245 offset:50176
    v_mfma_f32_16x16x32_bf16 v[4:7], a[132:135], a[0:3], v[4:7]
    buffer_load_dwordx4 a[44:47], v249, s[16:19], s33 offen offset:3072 sc1
    v_mfma_f32_16x16x32_bf16 v[8:11], a[136:139], a[0:3], v[8:11]
    s_add_u32 s30, s81, 8192
    s_add_u32 s31, s81, 28672
    ds_read_b64_tr_b16 a[172:173], v245 offset:49160
    v_mfma_f32_16x16x32_bf16 v[40:43], a[136:139], a[4:7], v[40:43]
    s_add_u32 s32, s81, 49152
    ds_read_b64_tr_b16 a[174:175], v245 offset:50184
    v_mfma_f32_16x16x32_bf16 v[72:75], a[136:139], a[8:11], v[72:75]
    s_add_u32 s33, s81, 69632
    ds_read_b64_tr_b16 a[176:177], v246 offset:49152
    v_mfma_f32_16x16x32_bf16 v[104:107], a[136:139], a[12:15], v[104:107]
    buffer_load_dwordx4 a[48:51], v249, s[16:19], s30 offen offset:0 sc1
    v_mfma_f32_16x16x32_bf16 v[108:111], a[140:143], a[12:15], v[108:111]
    ds_read_b64_tr_b16 a[178:179], v246 offset:50176
    v_mfma_f32_16x16x32_bf16 v[76:79], a[140:143], a[8:11], v[76:79]
    ds_read_b64_tr_b16 a[180:181], v246 offset:49160
    v_mfma_f32_16x16x32_bf16 v[44:47], a[140:143], a[4:7], v[44:47]
    ds_read_b64_tr_b16 a[182:183], v246 offset:50184
    v_mfma_f32_16x16x32_bf16 v[12:15], a[140:143], a[0:3], v[12:15]
    buffer_load_dwordx4 a[52:55], v249, s[16:19], s31 offen offset:0 sc1
    v_mfma_f32_16x16x32_bf16 v[16:19], a[144:147], a[0:3], v[16:19]
    ds_read_b64_tr_b16 a[184:185], v247 offset:49152
    v_mfma_f32_16x16x32_bf16 v[48:51], a[144:147], a[4:7], v[48:51]
    ds_read_b64_tr_b16 a[186:187], v247 offset:50176
    v_mfma_f32_16x16x32_bf16 v[80:83], a[144:147], a[8:11], v[80:83]
    ds_read_b64_tr_b16 a[188:189], v247 offset:49160
    v_mfma_f32_16x16x32_bf16 v[112:115], a[144:147], a[12:15], v[112:115]
    buffer_load_dwordx4 a[56:59], v249, s[16:19], s32 offen offset:0 sc1
    v_mfma_f32_16x16x32_bf16 v[116:119], a[148:151], a[12:15], v[116:119]
    ds_read_b64_tr_b16 a[190:191], v247 offset:50184
    v_mfma_f32_16x16x32_bf16 v[84:87], a[148:151], a[8:11], v[84:87]
    v_mfma_f32_16x16x32_bf16 v[52:55], a[148:151], a[4:7], v[52:55]
    v_mfma_f32_16x16x32_bf16 v[20:23], a[148:151], a[0:3], v[20:23]
    buffer_load_dwordx4 a[60:63], v249, s[16:19], s33 offen offset:0 sc1
    v_mfma_f32_16x16x32_bf16 v[24:27], a[152:155], a[0:3], v[24:27]
    v_mfma_f32_16x16x32_bf16 v[56:59], a[152:155], a[4:7], v[56:59]
    v_mfma_f32_16x16x32_bf16 v[88:91], a[152:155], a[8:11], v[88:91]
    v_mfma_f32_16x16x32_bf16 v[120:123], a[152:155], a[12:15], v[120:123]
    buffer_load_dwordx4 a[64:67], v249, s[16:19], s30 offen offset:1024 sc1
    v_mfma_f32_16x16x32_bf16 v[124:127], a[156:159], a[12:15], v[124:127]
    v_mfma_f32_16x16x32_bf16 v[92:95], a[156:159], a[8:11], v[92:95]
    v_mfma_f32_16x16x32_bf16 v[60:63], a[156:159], a[4:7], v[60:63]
    v_mfma_f32_16x16x32_bf16 v[28:31], a[156:159], a[0:3], v[28:31]
    s_waitcnt vmcnt(13) lgkmcnt(0)
    v_mfma_f32_16x16x32_bf16 v[0:3], a[160:163], a[16:19], v[0:3]
    ds_read_b64_tr_b16 a[128:129], v244 offset:57344
    v_mfma_f32_16x16x32_bf16 v[32:35], a[160:163], a[20:23], v[32:35]
    ds_read_b64_tr_b16 a[130:131], v244 offset:58368
    v_mfma_f32_16x16x32_bf16 v[64:67], a[160:163], a[24:27], v[64:67]
    ds_read_b64_tr_b16 a[132:133], v244 offset:57352
    v_mfma_f32_16x16x32_bf16 v[96:99], a[160:163], a[28:31], v[96:99]
    ds_read_b64_tr_b16 a[134:135], v244 offset:58376
    v_mfma_f32_16x16x32_bf16 v[100:103], a[164:167], a[28:31], v[100:103]
    buffer_load_dwordx4 a[68:71], v249, s[16:19], s31 offen offset:1024 sc1
    v_mfma_f32_16x16x32_bf16 v[68:71], a[164:167], a[24:27], v[68:71]
    ds_read_b64_tr_b16 a[136:137], v245 offset:57344
    v_mfma_f32_16x16x32_bf16 v[36:39], a[164:167], a[20:23], v[36:39]
    ds_read_b64_tr_b16 a[138:139], v245 offset:58368
    v_mfma_f32_16x16x32_bf16 v[4:7], a[164:167], a[16:19], v[4:7]
    buffer_load_dwordx4 a[72:75], v249, s[16:19], s32 offen offset:1024 sc1
    v_mfma_f32_16x16x32_bf16 v[8:11], a[168:171], a[16:19], v[8:11]
    ds_read_b64_tr_b16 a[140:141], v245 offset:57352
    v_mfma_f32_16x16x32_bf16 v[40:43], a[168:171], a[20:23], v[40:43]
    ds_read_b64_tr_b16 a[142:143], v245 offset:58376
    v_mfma_f32_16x16x32_bf16 v[72:75], a[168:171], a[24:27], v[72:75]
    ds_read_b64_tr_b16 a[144:145], v246 offset:57344
    v_mfma_f32_16x16x32_bf16 v[104:107], a[168:171], a[28:31], v[104:107]
    buffer_load_dwordx4 a[76:79], v249, s[16:19], s33 offen offset:1024 sc1
    v_mfma_f32_16x16x32_bf16 v[108:111], a[172:175], a[28:31], v[108:111]
    ds_read_b64_tr_b16 a[146:147], v246 offset:58368
    v_mfma_f32_16x16x32_bf16 v[76:79], a[172:175], a[24:27], v[76:79]
    ds_read_b64_tr_b16 a[148:149], v246 offset:57352
    v_mfma_f32_16x16x32_bf16 v[44:47], a[172:175], a[20:23], v[44:47]
    ds_read_b64_tr_b16 a[150:151], v246 offset:58376
    v_mfma_f32_16x16x32_bf16 v[12:15], a[172:175], a[16:19], v[12:15]
    buffer_load_dwordx4 a[80:83], v249, s[16:19], s30 offen offset:2048 sc1
    v_mfma_f32_16x16x32_bf16 v[16:19], a[176:179], a[16:19], v[16:19]
    ds_read_b64_tr_b16 a[152:153], v247 offset:57344
    v_mfma_f32_16x16x32_bf16 v[48:51], a[176:179], a[20:23], v[48:51]
    ds_read_b64_tr_b16 a[154:155], v247 offset:58368
    v_mfma_f32_16x16x32_bf16 v[80:83], a[176:179], a[24:27], v[80:83]
    ds_read_b64_tr_b16 a[156:157], v247 offset:57352
    v_mfma_f32_16x16x32_bf16 v[112:115], a[176:179], a[28:31], v[112:115]
    buffer_load_dwordx4 a[84:87], v249, s[16:19], s31 offen offset:2048 sc1
    v_mfma_f32_16x16x32_bf16 v[116:119], a[180:183], a[28:31], v[116:119]
    ds_read_b64_tr_b16 a[158:159], v247 offset:58376
    v_mfma_f32_16x16x32_bf16 v[84:87], a[180:183], a[24:27], v[84:87]
    v_mfma_f32_16x16x32_bf16 v[52:55], a[180:183], a[20:23], v[52:55]
    v_mfma_f32_16x16x32_bf16 v[20:23], a[180:183], a[16:19], v[20:23]
    buffer_load_dwordx4 a[88:91], v249, s[16:19], s32 offen offset:2048 sc1
    v_mfma_f32_16x16x32_bf16 v[24:27], a[184:187], a[16:19], v[24:27]
    v_mfma_f32_16x16x32_bf16 v[56:59], a[184:187], a[20:23], v[56:59]
    v_mfma_f32_16x16x32_bf16 v[88:91], a[184:187], a[24:27], v[88:91]
    v_xor_b32 v244, 0x10000, v244
    v_xor_b32 v245, 0x10000, v245
    v_mfma_f32_16x16x32_bf16 v[120:123], a[184:187], a[28:31], v[120:123]
    buffer_load_dwordx4 a[92:95], v249, s[16:19], s33 offen offset:2048 sc1
    v_mfma_f32_16x16x32_bf16 v[124:127], a[188:191], a[28:31], v[124:127]
    v_xor_b32 v246, 0x10000, v246
    v_xor_b32 v247, 0x10000, v247
    v_mfma_f32_16x16x32_bf16 v[92:95], a[188:191], a[24:27], v[92:95]
    v_mfma_f32_16x16x32_bf16 v[60:63], a[188:191], a[20:23], v[60:63]
    s_waitcnt vmcnt(12) lgkmcnt(0)
    v_mfma_f32_16x16x32_bf16 v[28:31], a[188:191], a[16:19], v[28:31]
    s_barrier
    v_mfma_f32_16x16x32_bf16 v[0:3], a[128:131], a[32:35], v[0:3]
    ds_read_b64_tr_b16 a[160:161], v244 offset:0
    v_mfma_f32_16x16x32_bf16 v[32:35], a[128:131], a[36:39], v[32:35]
    ds_read_b64_tr_b16 a[162:163], v244 offset:1024
    v_mfma_f32_16x16x32_bf16 v[64:67], a[128:131], a[40:43], v[64:67]
    ds_read_b64_tr_b16 a[164:165], v244 offset:8192
    v_mfma_f32_16x16x32_bf16 v[96:99], a[128:131], a[44:47], v[96:99]
    ds_read_b64_tr_b16 a[166:167], v244 offset:9216
    v_mfma_f32_16x16x32_bf16 v[100:103], a[132:135], a[44:47], v[100:103]
    buffer_load_dwordx4 a[96:99], v249, s[16:19], s30 offen offset:3072 sc1
    v_mfma_f32_16x16x32_bf16 v[68:71], a[132:135], a[40:43], v[68:71]
    ds_read_b64_tr_b16 a[168:169], v244 offset:8
    v_mfma_f32_16x16x32_bf16 v[36:39], a[132:135], a[36:39], v[36:39]
    ds_read_b64_tr_b16 a[170:171], v244 offset:1032
    v_mfma_f32_16x16x32_bf16 v[4:7], a[132:135], a[32:35], v[4:7]
    buffer_load_dwordx4 a[100:103], v249, s[16:19], s31 offen offset:3072 sc1
    v_mfma_f32_16x16x32_bf16 v[8:11], a[136:139], a[32:35], v[8:11]
    ds_read_b64_tr_b16 a[172:173], v244 offset:8200
    v_mfma_f32_16x16x32_bf16 v[40:43], a[136:139], a[36:39], v[40:43]
    ds_read_b64_tr_b16 a[174:175], v244 offset:9224
    v_mfma_f32_16x16x32_bf16 v[72:75], a[136:139], a[40:43], v[72:75]
    ds_read_b64_tr_b16 a[176:177], v245 offset:0
    v_mfma_f32_16x16x32_bf16 v[104:107], a[136:139], a[44:47], v[104:107]
    buffer_load_dwordx4 a[104:107], v249, s[16:19], s32 offen offset:3072 sc1
    v_mfma_f32_16x16x32_bf16 v[108:111], a[140:143], a[44:47], v[108:111]
    ds_read_b64_tr_b16 a[178:179], v245 offset:1024
    v_mfma_f32_16x16x32_bf16 v[76:79], a[140:143], a[40:43], v[76:79]
    ds_read_b64_tr_b16 a[180:181], v245 offset:8192
    v_mfma_f32_16x16x32_bf16 v[44:47], a[140:143], a[36:39], v[44:47]
    ds_read_b64_tr_b16 a[182:183], v245 offset:9216
    v_mfma_f32_16x16x32_bf16 v[12:15], a[140:143], a[32:35], v[12:15]
    buffer_load_dwordx4 a[108:111], v249, s[16:19], s33 offen offset:3072 sc1
    v_mfma_f32_16x16x32_bf16 v[16:19], a[144:147], a[32:35], v[16:19]
    ds_read_b64_tr_b16 a[184:185], v245 offset:8
    v_mfma_f32_16x16x32_bf16 v[48:51], a[144:147], a[36:39], v[48:51]
    s_add_u32 m0, s38, 98304
    ds_read_b64_tr_b16 a[186:187], v245 offset:1032
    v_mfma_f32_16x16x32_bf16 v[80:83], a[144:147], a[40:43], v[80:83]
    s_add_u32 s34, s36, 3145728
    ds_read_b64_tr_b16 a[188:189], v245 offset:8200
    v_mfma_f32_16x16x32_bf16 v[112:115], a[144:147], a[44:47], v[112:115]
    buffer_load_dwordx4 v242, s[12:15], s34 offen offset:0 lds
    v_mfma_f32_16x16x32_bf16 v[116:119], a[148:151], a[44:47], v[116:119]
    ds_read_b64_tr_b16 a[190:191], v245 offset:9224
    v_mfma_f32_16x16x32_bf16 v[84:87], a[148:151], a[40:43], v[84:87]
    v_mfma_f32_16x16x32_bf16 v[52:55], a[148:151], a[36:39], v[52:55]
    s_add_u32 s34, s36, 3177472
    v_mfma_f32_16x16x32_bf16 v[20:23], a[148:151], a[32:35], v[20:23]
    buffer_load_dwordx4 v242, s[12:15], s34 offen offset:1024 lds
    v_mfma_f32_16x16x32_bf16 v[24:27], a[152:155], a[32:35], v[24:27]
    v_mfma_f32_16x16x32_bf16 v[56:59], a[152:155], a[36:39], v[56:59]
    v_mfma_f32_16x16x32_bf16 v[88:91], a[152:155], a[40:43], v[88:91]
    s_add_u32 s34, s36, 3209216
    v_mfma_f32_16x16x32_bf16 v[120:123], a[152:155], a[44:47], v[120:123]
    buffer_load_dwordx4 v242, s[12:15], s34 offen offset:2048 lds
    v_mfma_f32_16x16x32_bf16 v[124:127], a[156:159], a[44:47], v[124:127]
    v_mfma_f32_16x16x32_bf16 v[92:95], a[156:159], a[40:43], v[92:95]
    v_mfma_f32_16x16x32_bf16 v[60:63], a[156:159], a[36:39], v[60:63]
    v_mfma_f32_16x16x32_bf16 v[28:31], a[156:159], a[32:35], v[28:31]
    s_waitcnt vmcnt(11) lgkmcnt(0)
    v_mfma_f32_16x16x32_bf16 v[0:3], a[160:163], a[48:51], v[0:3]
    ds_read_b64_tr_b16 a[128:129], v246 offset:0
    v_mfma_f32_16x16x32_bf16 v[0:3], a[164:167], a[64:67], v[0:3]
    ds_read_b64_tr_b16 a[130:131], v246 offset:1024
    v_mfma_f32_16x16x32_bf16 v[32:35], a[164:167], a[68:71], v[32:35]
    ds_read_b64_tr_b16 a[132:133], v246 offset:8192
    v_mfma_f32_16x16x32_bf16 v[32:35], a[160:163], a[52:55], v[32:35]
    s_add_u32 s34, s36, 3240960
    ds_read_b64_tr_b16 a[134:135], v246 offset:9216
    v_mfma_f32_16x16x32_bf16 v[64:67], a[160:163], a[56:59], v[64:67]
    buffer_load_dwordx4 v242, s[12:15], s34 offen offset:3072 lds
    v_mfma_f32_16x16x32_bf16 v[64:67], a[164:167], a[72:75], v[64:67]
    s_add_u32 m0, s38, 102400
    ds_read_b64_tr_b16 a[136:137], v246 offset:8
    v_mfma_f32_16x16x32_bf16 v[96:99], a[164:167], a[76:79], v[96:99]
    s_add_u32 s34, s36, 3276800
    ds_read_b64_tr_b16 a[138:139], v246 offset:1032
    v_mfma_f32_16x16x32_bf16 v[96:99], a[160:163], a[60:63], v[96:99]
    buffer_load_dwordx4 v242, s[12:15], s34 offen offset:0 lds
    v_mfma_f32_16x16x32_bf16 v[100:103], a[168:171], a[60:63], v[100:103]
    ds_read_b64_tr_b16 a[140:141], v246 offset:8200
    v_mfma_f32_16x16x32_bf16 v[100:103], a[172:175], a[76:79], v[100:103]
    ds_read_b64_tr_b16 a[142:143], v246 offset:9224
    v_mfma_f32_16x16x32_bf16 v[68:71], a[172:175], a[72:75], v[68:71]
    s_add_u32 s34, s36, 3308544
    ds_read_b64_tr_b16 a[144:145], v247 offset:0
    v_mfma_f32_16x16x32_bf16 v[68:71], a[168:171], a[56:59], v[68:71]
    buffer_load_dwordx4 v242, s[12:15], s34 offen offset:1024 lds
    v_mfma_f32_16x16x32_bf16 v[36:39], a[168:171], a[52:55], v[36:39]
    ds_read_b64_tr_b16 a[146:147], v247 offset:1024
    v_mfma_f32_16x16x32_bf16 v[36:39], a[172:175], a[68:71], v[36:39]
    ds_read_b64_tr_b16 a[148:149], v247 offset:8192
    v_mfma_f32_16x16x32_bf16 v[4:7], a[172:175], a[64:67], v[4:7]
    s_add_u32 s34, s36, 3340288
    ds_read_b64_tr_b16 a[150:151], v247 offset:9216
    v_mfma_f32_16x16x32_bf16 v[4:7], a[168:171], a[48:51], v[4:7]
    buffer_load_dwordx4 v242, s[12:15], s34 offen offset:2048 lds
    v_mfma_f32_16x16x32_bf16 v[8:11], a[176:179], a[48:51], v[8:11]
    ds_read_b64_tr_b16 a[152:153], v247 offset:8
    v_mfma_f32_16x16x32_bf16 v[8:11], a[180:183], a[64:67], v[8:11]
    ds_read_b64_tr_b16 a[154:155], v247 offset:1032
    v_mfma_f32_16x16x32_bf16 v[40:43], a[180:183], a[68:71], v[40:43]
    s_add_u32 s34, s36, 3372032
    ds_read_b64_tr_b16 a[156:157], v247 offset:8200
    v_mfma_f32_16x16x32_bf16 v[40:43], a[176:179], a[52:55], v[40:43]
    buffer_load_dwordx4 v242, s[12:15], s34 offen offset:3072 lds
    v_mfma_f32_16x16x32_bf16 v[72:75], a[176:179], a[56:59], v[72:75]
    s_add_u32 s30, s81, 12288
    s_add_u32 s31, s81, 32768
    ds_read_b64_tr_b16 a[158:159], v247 offset:9224
    v_mfma_f32_16x16x32_bf16 v[72:75], a[180:183], a[72:75], v[72:75]
    s_add_u32 s32, s81, 53248
    v_mfma_f32_16x16x32_bf16 v[104:107], a[180:183], a[76:79], v[104:107]
    s_add_u32 s33, s81, 73728
    v_mfma_f32_16x16x32_bf16 v[104:107], a[176:179], a[60:63], v[104:107]
    buffer_load_dwordx4 a[112:115], v249, s[16:19], s30 offen offset:0 sc1
    v_mfma_f32_16x16x32_bf16 v[108:111], a[184:187], a[60:63], v[108:111]
    v_mfma_f32_16x16x32_bf16 v[108:111], a[188:191], a[76:79], v[108:111]
    v_mfma_f32_16x16x32_bf16 v[76:79], a[188:191], a[72:75], v[76:79]
    v_mfma_f32_16x16x32_bf16 v[76:79], a[184:187], a[56:59], v[76:79]
    buffer_load_dwordx4 a[116:119], v249, s[16:19], s31 offen offset:0 sc1
    v_mfma_f32_16x16x32_bf16 v[44:47], a[184:187], a[52:55], v[44:47]
    v_mfma_f32_16x16x32_bf16 v[44:47], a[188:191], a[68:71], v[44:47]
    v_mfma_f32_16x16x32_bf16 v[12:15], a[188:191], a[64:67], v[12:15]
    v_mfma_f32_16x16x32_bf16 v[12:15], a[184:187], a[48:51], v[12:15]
    s_waitcnt lgkmcnt(0)
    v_mfma_f32_16x16x32_bf16 v[16:19], a[128:131], a[48:51], v[16:19]
    ds_read_b64_tr_b16 a[160:161], v244 offset:16384
    v_mfma_f32_16x16x32_bf16 v[16:19], a[132:135], a[64:67], v[16:19]
    ds_read_b64_tr_b16 a[162:163], v244 offset:17408
    v_mfma_f32_16x16x32_bf16 v[48:51], a[132:135], a[68:71], v[48:51]
    ds_read_b64_tr_b16 a[164:165], v244 offset:24576
    v_mfma_f32_16x16x32_bf16 v[48:51], a[128:131], a[52:55], v[48:51]
    ds_read_b64_tr_b16 a[166:167], v244 offset:25600
    v_mfma_f32_16x16x32_bf16 v[80:83], a[128:131], a[56:59], v[80:83]
    buffer_load_dwordx4 a[120:123], v249, s[16:19], s32 offen offset:0 sc1
    v_mfma_f32_16x16x32_bf16 v[80:83], a[132:135], a[72:75], v[80:83]
    ds_read_b64_tr_b16 a[168:169], v244 offset:16392
    v_mfma_f32_16x16x32_bf16 v[112:115], a[132:135], a[76:79], v[112:115]
    ds_read_b64_tr_b16 a[170:171], v244 offset:17416
    v_mfma_f32_16x16x32_bf16 v[112:115], a[128:131], a[60:63], v[112:115]
    buffer_load_dwordx4 a[124:127], v249, s[16:19], s33 offen offset:0 sc1
    v_mfma_f32_16x16x32_bf16 v[116:119], a[136:139], a[60:63], v[116:119]
    ds_read_b64_tr_b16 a[172:173], v244 offset:24584
    v_mfma_f32_16x16x32_bf16 v[116:119], a[140:143], a[76:79], v[116:119]
    ds_read_b64_tr_b16 a[174:175], v244 offset:25608
    v_mfma_f32_16x16x32_bf16 v[84:87], a[140:143], a[72:75], v[84:87]
    ds_read_b64_tr_b16 a[176:177], v245 offset:16384
    v_mfma_f32_16x16x32_bf16 v[84:87], a[136:139], a[56:59], v[84:87]
    buffer_load_dwordx4 v[144:147], v249, s[16:19], s30 offen offset:1024 sc1
    v_mfma_f32_16x16x32_bf16 v[52:55], a[136:139], a[52:55], v[52:55]
    ds_read_b64_tr_b16 a[178:179], v245 offset:17408
    v_mfma_f32_16x16x32_bf16 v[52:55], a[140:143], a[68:71], v[52:55]
    ds_read_b64_tr_b16 a[180:181], v245 offset:24576
    v_mfma_f32_16x16x32_bf16 v[20:23], a[140:143], a[64:67], v[20:23]
    ds_read_b64_tr_b16 a[182:183], v245 offset:25600
    v_mfma_f32_16x16x32_bf16 v[20:23], a[136:139], a[48:51], v[20:23]
    buffer_load_dwordx4 v[148:151], v249, s[16:19], s31 offen offset:1024 sc1
    v_mfma_f32_16x16x32_bf16 v[24:27], a[144:147], a[48:51], v[24:27]
    ds_read_b64_tr_b16 a[184:185], v245 offset:16392
    v_mfma_f32_16x16x32_bf16 v[24:27], a[148:151], a[64:67], v[24:27]
    ds_read_b64_tr_b16 a[186:187], v245 offset:17416
    v_mfma_f32_16x16x32_bf16 v[56:59], a[148:151], a[68:71], v[56:59]
    ds_read_b64_tr_b16 a[188:189], v245 offset:24584
    v_mfma_f32_16x16x32_bf16 v[56:59], a[144:147], a[52:55], v[56:59]
    buffer_load_dwordx4 v[152:155], v249, s[16:19], s32 offen offset:1024 sc1
    v_mfma_f32_16x16x32_bf16 v[88:91], a[144:147], a[56:59], v[88:91]
    ds_read_b64_tr_b16 a[190:191], v245 offset:25608
    v_mfma_f32_16x16x32_bf16 v[88:91], a[148:151], a[72:75], v[88:91]
    v_mfma_f32_16x16x32_bf16 v[120:123], a[148:151], a[76:79], v[120:123]
    v_mfma_f32_16x16x32_bf16 v[120:123], a[144:147], a[60:63], v[120:123]
    buffer_load_dwordx4 v[156:159], v249, s[16:19], s33 offen offset:1024 sc1
    v_mfma_f32_16x16x32_bf16 v[124:127], a[152:155], a[60:63], v[124:127]
    v_mfma_f32_16x16x32_bf16 v[124:127], a[156:159], a[76:79], v[124:127]
    v_mfma_f32_16x16x32_bf16 v[92:95], a[156:159], a[72:75], v[92:95]
    v_mfma_f32_16x16x32_bf16 v[92:95], a[152:155], a[56:59], v[92:95]
    buffer_load_dwordx4 v[160:163], v249, s[16:19], s30 offen offset:2048 sc1
    v_mfma_f32_16x16x32_bf16 v[60:63], a[152:155], a[52:55], v[60:63]
    v_mfma_f32_16x16x32_bf16 v[60:63], a[156:159], a[68:71], v[60:63]
    v_mfma_f32_16x16x32_bf16 v[28:31], a[156:159], a[64:67], v[28:31]
    v_mfma_f32_16x16x32_bf16 v[28:31], a[152:155], a[48:51], v[28:31]
    s_waitcnt vmcnt(17) lgkmcnt(0)
    v_mfma_f32_16x16x32_bf16 v[0:3], a[160:163], a[80:83], v[0:3]
    ds_read_b64_tr_b16 a[128:129], v246 offset:16384
    v_mfma_f32_16x16x32_bf16 v[0:3], a[164:167], a[96:99], v[0:3]
    ds_read_b64_tr_b16 a[130:131], v246 offset:17408
    v_mfma_f32_16x16x32_bf16 v[32:35], a[164:167], a[100:103], v[32:35]
    ds_read_b64_tr_b16 a[132:133], v246 offset:24576
    v_mfma_f32_16x16x32_bf16 v[32:35], a[160:163], a[84:87], v[32:35]
    ds_read_b64_tr_b16 a[134:135], v246 offset:25600
    v_mfma_f32_16x16x32_bf16 v[64:67], a[160:163], a[88:91], v[64:67]
    buffer_load_dwordx4 v[164:167], v249, s[16:19], s31 offen offset:2048 sc1
    v_mfma_f32_16x16x32_bf16 v[64:67], a[164:167], a[104:107], v[64:67]
    ds_read_b64_tr_b16 a[136:137], v246 offset:16392
    v_mfma_f32_16x16x32_bf16 v[96:99], a[164:167], a[108:111], v[96:99]
    ds_read_b64_tr_b16 a[138:139], v246 offset:17416
    v_mfma_f32_16x16x32_bf16 v[96:99], a[160:163], a[92:95], v[96:99]
    buffer_load_dwordx4 v[168:171], v249, s[16:19], s32 offen offset:2048 sc1
    v_mfma_f32_16x16x32_bf16 v[100:103], a[168:171], a[92:95], v[100:103]
    ds_read_b64_tr_b16 a[140:141], v246 offset:24584
    v_mfma_f32_16x16x32_bf16 v[100:103], a[172:175], a[108:111], v[100:103]
    ds_read_b64_tr_b16 a[142:143], v246 offset:25608
    v_mfma_f32_16x16x32_bf16 v[68:71], a[172:175], a[104:107], v[68:71]
    ds_read_b64_tr_b16 a[144:145], v247 offset:16384
    v_mfma_f32_16x16x32_bf16 v[68:71], a[168:171], a[88:91], v[68:71]
    buffer_load_dwordx4 v[172:175], v249, s[16:19], s33 offen offset:2048 sc1
    v_mfma_f32_16x16x32_bf16 v[36:39], a[168:171], a[84:87], v[36:39]
    ds_read_b64_tr_b16 a[146:147], v247 offset:17408
    v_mfma_f32_16x16x32_bf16 v[36:39], a[172:175], a[100:103], v[36:39]
HOP0_2:
    s_cbranch_execz HOP0_5
    ds_read_b64_tr_b16 a[148:149], v247 offset:24576
    v_mfma_f32_16x16x32_bf16 v[4:7], a[172:175], a[96:99], v[4:7]
    ds_read_b64_tr_b16 a[150:151], v247 offset:25600
    v_mfma_f32_16x16x32_bf16 v[4:7], a[168:171], a[80:83], v[4:7]
    buffer_load_dwordx4 v[176:179], v249, s[16:19], s30 offen offset:3072 sc1
    v_mfma_f32_16x16x32_bf16 v[8:11], a[176:179], a[80:83], v[8:11]
    ds_read_b64_tr_b16 a[152:153], v247 offset:16392
    v_mfma_f32_16x16x32_bf16 v[8:11], a[180:183], a[96:99], v[8:11]
    ds_read_b64_tr_b16 a[154:155], v247 offset:17416
    v_mfma_f32_16x16x32_bf16 v[40:43], a[180:183], a[100:103], v[40:43]
    ds_read_b64_tr_b16 a[156:157], v247 offset:24584
    v_mfma_f32_16x16x32_bf16 v[40:43], a[176:179], a[84:87], v[40:43]
    buffer_load_dwordx4 v[180:183], v249, s[16:19], s31 offen offset:3072 sc1
    v_mfma_f32_16x16x32_bf16 v[72:75], a[176:179], a[88:91], v[72:75]
    ds_read_b64_tr_b16 a[158:159], v247 offset:25608
    v_mfma_f32_16x16x32_bf16 v[72:75], a[180:183], a[104:107], v[72:75]
    v_mfma_f32_16x16x32_bf16 v[104:107], a[180:183], a[108:111], v[104:107]
    v_mfma_f32_16x16x32_bf16 v[104:107], a[176:179], a[92:95], v[104:107]
    buffer_load_dwordx4 v[184:187], v249, s[16:19], s32 offen offset:3072 sc1
    v_mfma_f32_16x16x32_bf16 v[108:111], a[184:187], a[92:95], v[108:111]
    v_mfma_f32_16x16x32_bf16 v[108:111], a[188:191], a[108:111], v[108:111]
    v_mfma_f32_16x16x32_bf16 v[76:79], a[188:191], a[104:107], v[76:79]
    v_mfma_f32_16x16x32_bf16 v[76:79], a[184:187], a[88:91], v[76:79]
    buffer_load_dwordx4 v[188:191], v249, s[16:19], s33 offen offset:3072 sc1
    v_mfma_f32_16x16x32_bf16 v[44:47], a[184:187], a[84:87], v[44:47]
    v_mfma_f32_16x16x32_bf16 v[44:47], a[188:191], a[100:103], v[44:47]
    v_mfma_f32_16x16x32_bf16 v[12:15], a[188:191], a[96:99], v[12:15]
    s_waitcnt vmcnt(16) lgkmcnt(0)
    v_mfma_f32_16x16x32_bf16 v[12:15], a[184:187], a[80:83], v[12:15]
    s_barrier
    v_mfma_f32_16x16x32_bf16 v[16:19], a[128:131], a[80:83], v[16:19]
    ds_read_b64_tr_b16 a[160:161], v244 offset:32768
    v_mfma_f32_16x16x32_bf16 v[16:19], a[132:135], a[96:99], v[16:19]
    ds_read_b64_tr_b16 a[162:163], v244 offset:33792
    v_mfma_f32_16x16x32_bf16 v[48:51], a[132:135], a[100:103], v[48:51]
    s_add_u32 m0, s38, 0
    ds_read_b64_tr_b16 a[164:165], v244 offset:40960
    v_mfma_f32_16x16x32_bf16 v[48:51], a[128:131], a[84:87], v[48:51]
    s_add_u32 s34, s36, 4194304
    ds_read_b64_tr_b16 a[166:167], v244 offset:41984
    v_mfma_f32_16x16x32_bf16 v[80:83], a[128:131], a[88:91], v[80:83]
    buffer_load_dwordx4 v242, s[12:15], s34 offen offset:0 lds
    v_mfma_f32_16x16x32_bf16 v[80:83], a[132:135], a[104:107], v[80:83]
    ds_read_b64_tr_b16 a[168:169], v244 offset:49152
    v_mfma_f32_16x16x32_bf16 v[112:115], a[132:135], a[108:111], v[112:115]
    s_add_u32 s34, s36, 4226048
    ds_read_b64_tr_b16 a[170:171], v244 offset:50176
    v_mfma_f32_16x16x32_bf16 v[112:115], a[128:131], a[92:95], v[112:115]
    buffer_load_dwordx4 v242, s[12:15], s34 offen offset:1024 lds
    v_mfma_f32_16x16x32_bf16 v[116:119], a[136:139], a[92:95], v[116:119]
    ds_read_b64_tr_b16 a[172:173], v244 offset:57344
    v_mfma_f32_16x16x32_bf16 v[116:119], a[140:143], a[108:111], v[116:119]
    ds_read_b64_tr_b16 a[174:175], v244 offset:58368
    v_mfma_f32_16x16x32_bf16 v[84:87], a[140:143], a[104:107], v[84:87]
    s_add_u32 s34, s36, 4257792
    ds_read_b64_tr_b16 a[176:177], v244 offset:32776
    v_mfma_f32_16x16x32_bf16 v[84:87], a[136:139], a[88:91], v[84:87]
    buffer_load_dwordx4 v242, s[12:15], s34 offen offset:2048 lds
    v_mfma_f32_16x16x32_bf16 v[52:55], a[136:139], a[84:87], v[52:55]
    ds_read_b64_tr_b16 a[178:179], v244 offset:33800
    v_mfma_f32_16x16x32_bf16 v[52:55], a[140:143], a[100:103], v[52:55]
    ds_read_b64_tr_b16 a[180:181], v244 offset:40968
    v_mfma_f32_16x16x32_bf16 v[20:23], a[140:143], a[96:99], v[20:23]
    s_add_u32 s34, s36, 4289536
    ds_read_b64_tr_b16 a[182:183], v244 offset:41992
    v_mfma_f32_16x16x32_bf16 v[20:23], a[136:139], a[80:83], v[20:23]
    buffer_load_dwordx4 v242, s[12:15], s34 offen offset:3072 lds
    v_mfma_f32_16x16x32_bf16 v[24:27], a[144:147], a[80:83], v[24:27]
    ds_read_b64_tr_b16 a[184:185], v244 offset:49160
    v_mfma_f32_16x16x32_bf16 v[24:27], a[148:151], a[96:99], v[24:27]
    s_add_u32 m0, s38, 4096
    ds_read_b64_tr_b16 a[186:187], v244 offset:50184
    v_mfma_f32_16x16x32_bf16 v[56:59], a[148:151], a[100:103], v[56:59]
    s_add_u32 s34, s36, 4325376
    ds_read_b64_tr_b16 a[188:189], v244 offset:57352
    v_mfma_f32_16x16x32_bf16 v[56:59], a[144:147], a[84:87], v[56:59]
    buffer_load_dwordx4 v242, s[12:15], s34 offen offset:0 lds
    v_mfma_f32_16x16x32_bf16 v[88:91], a[144:147], a[88:91], v[88:91]
    ds_read_b64_tr_b16 a[190:191], v244 offset:58376
    v_mfma_f32_16x16x32_bf16 v[88:91], a[148:151], a[104:107], v[88:91]
    v_mfma_f32_16x16x32_bf16 v[120:123], a[148:151], a[108:111], v[120:123]
    s_add_u32 s34, s36, 4357120
    v_mfma_f32_16x16x32_bf16 v[120:123], a[144:147], a[92:95], v[120:123]
    buffer_load_dwordx4 v242, s[12:15], s34 offen offset:1024 lds
    v_mfma_f32_16x16x32_bf16 v[124:127], a[152:155], a[92:95], v[124:127]
    v_mfma_f32_16x16x32_bf16 v[124:127], a[156:159], a[108:111], v[124:127]
    v_mfma_f32_16x16x32_bf16 v[92:95], a[156:159], a[104:107], v[92:95]
    s_add_u32 s34, s36, 4388864
    v_mfma_f32_16x16x32_bf16 v[92:95], a[152:155], a[88:91], v[92:95]
    buffer_load_dwordx4 v242, s[12:15], s34 offen offset:2048 lds
    v_mfma_f32_16x16x32_bf16 v[60:63], a[152:155], a[84:87], v[60:63]
    v_mfma_f32_16x16x32_bf16 v[60:63], a[156:159], a[100:103], v[60:63]
    v_mfma_f32_16x16x32_bf16 v[28:31], a[156:159], a[96:99], v[28:31]
    v_mfma_f32_16x16x32_bf16 v[28:31], a[152:155], a[80:83], v[28:31]
    s_waitcnt vmcnt(7) lgkmcnt(0)
    v_mfma_f32_16x16x32_bf16 v[0:3], a[160:163], a[112:115], v[0:3]
    ds_read_b64_tr_b16 a[128:129], v245 offset:32768
    v_mfma_f32_16x16x32_bf16 v[0:3], a[164:167], v[144:147], v[0:3]
    ds_read_b64_tr_b16 a[130:131], v245 offset:33792
    v_mfma_f32_16x16x32_bf16 v[0:3], a[168:171], v[160:163], v[0:3]
    ds_read_b64_tr_b16 a[132:133], v245 offset:40960
    v_mfma_f32_16x16x32_bf16 v[0:3], a[172:175], v[176:179], v[0:3]
    s_add_u32 s34, s36, 4420608
    ds_read_b64_tr_b16 a[134:135], v245 offset:41984
    v_mfma_f32_16x16x32_bf16 v[32:35], a[172:175], v[180:183], v[32:35]
    buffer_load_dwordx4 v242, s[12:15], s34 offen offset:3072 lds
    v_mfma_f32_16x16x32_bf16 v[32:35], a[168:171], v[164:167], v[32:35]
    s_add_u32 s30, s81, 16384
    s_add_u32 s31, s81, 36864
    s_add_u32 s32, s81, 57344
    ds_read_b64_tr_b16 a[136:137], v245 offset:49152
    v_mfma_f32_16x16x32_bf16 v[32:35], a[164:167], v[148:151], v[32:35]
    s_add_u32 s33, s81, 77824
    ds_read_b64_tr_b16 a[138:139], v245 offset:50176
    v_mfma_f32_16x16x32_bf16 v[32:35], a[160:163], a[116:119], v[32:35]
    buffer_load_dwordx4 v[128:131], v249, s[16:19], s30 offen offset:0 sc1
    v_mfma_f32_16x16x32_bf16 v[64:67], a[160:163], a[120:123], v[64:67]
    ds_read_b64_tr_b16 a[140:141], v245 offset:57344
    v_mfma_f32_16x16x32_bf16 v[64:67], a[164:167], v[152:155], v[64:67]
    ds_read_b64_tr_b16 a[142:143], v245 offset:58368
    v_mfma_f32_16x16x32_bf16 v[64:67], a[168:171], v[168:171], v[64:67]
    ds_read_b64_tr_b16 a[144:145], v245 offset:32776
    v_mfma_f32_16x16x32_bf16 v[64:67], a[172:175], v[184:187], v[64:67]
    buffer_load_dwordx4 v[132:135], v249, s[16:19], s31 offen offset:0 sc1
    v_mfma_f32_16x16x32_bf16 v[96:99], a[172:175], v[188:191], v[96:99]
    ds_read_b64_tr_b16 a[146:147], v245 offset:33800
    v_mfma_f32_16x16x32_bf16 v[96:99], a[168:171], v[172:175], v[96:99]
    ds_read_b64_tr_b16 a[148:149], v245 offset:40968
    v_mfma_f32_16x16x32_bf16 v[96:99], a[164:167], v[156:159], v[96:99]
    ds_read_b64_tr_b16 a[150:151], v245 offset:41992
    v_mfma_f32_16x16x32_bf16 v[96:99], a[160:163], a[124:127], v[96:99]
    buffer_load_dwordx4 v[136:139], v249, s[16:19], s32 offen offset:0 sc1
    v_mfma_f32_16x16x32_bf16 v[100:103], a[176:179], a[124:127], v[100:103]
    ds_read_b64_tr_b16 a[152:153], v245 offset:49160
    v_mfma_f32_16x16x32_bf16 v[100:103], a[180:183], v[156:159], v[100:103]
    ds_read_b64_tr_b16 a[154:155], v245 offset:50184
    v_mfma_f32_16x16x32_bf16 v[100:103], a[184:187], v[172:175], v[100:103]
    ds_read_b64_tr_b16 a[156:157], v245 offset:57352
    v_mfma_f32_16x16x32_bf16 v[100:103], a[188:191], v[188:191], v[100:103]
    buffer_load_dwordx4 v[140:143], v249, s[16:19], s33 offen offset:0 sc1
    v_mfma_f32_16x16x32_bf16 v[68:71], a[188:191], v[184:187], v[68:71]
    ds_read_b64_tr_b16 a[158:159], v245 offset:58376
    v_mfma_f32_16x16x32_bf16 v[68:71], a[184:187], v[168:171], v[68:71]
    v_mfma_f32_16x16x32_bf16 v[68:71], a[180:183], v[152:155], v[68:71]
    v_mfma_f32_16x16x32_bf16 v[68:71], a[176:179], a[120:123], v[68:71]
    buffer_load_dwordx4 a[0:3], v249, s[16:19], s30 offen offset:1024 sc1
    v_mfma_f32_16x16x32_bf16 v[36:39], a[176:179], a[116:119], v[36:39]
    v_mfma_f32_16x16x32_bf16 v[36:39], a[180:183], v[148:151], v[36:39]
    v_mfma_f32_16x16x32_bf16 v[36:39], a[184:187], v[164:167], v[36:39]
    v_mfma_f32_16x16x32_bf16 v[36:39], a[188:191], v[180:183], v[36:39]
    buffer_load_dwordx4 a[4:7], v249, s[16:19], s31 offen offset:1024 sc1
    v_mfma_f32_16x16x32_bf16 v[4:7], a[188:191], v[176:179], v[4:7]
    v_mfma_f32_16x16x32_bf16 v[4:7], a[184:187], v[160:163], v[4:7]
    v_mfma_f32_16x16x32_bf16 v[4:7], a[180:183], v[144:147], v[4:7]
    v_mfma_f32_16x16x32_bf16 v[4:7], a[176:179], a[112:115], v[4:7]
    s_waitcnt lgkmcnt(0)
    v_mfma_f32_16x16x32_bf16 v[8:11], a[128:131], a[112:115], v[8:11]
    ds_read_b64_tr_b16 a[160:161], v246 offset:32768
    v_mfma_f32_16x16x32_bf16 v[8:11], a[132:135], v[144:147], v[8:11]
    ds_read_b64_tr_b16 a[162:163], v246 offset:33792
    v_mfma_f32_16x16x32_bf16 v[8:11], a[136:139], v[160:163], v[8:11]
    ds_read_b64_tr_b16 a[164:165], v246 offset:40960
    v_mfma_f32_16x16x32_bf16 v[8:11], a[140:143], v[176:179], v[8:11]
    ds_read_b64_tr_b16 a[166:167], v246 offset:41984
    v_mfma_f32_16x16x32_bf16 v[40:43], a[140:143], v[180:183], v[40:43]
    buffer_load_dwordx4 a[8:11], v249, s[16:19], s32 offen offset:1024 sc1
    v_mfma_f32_16x16x32_bf16 v[40:43], a[136:139], v[164:167], v[40:43]
    ds_read_b64_tr_b16 a[168:169], v246 offset:49152
    v_mfma_f32_16x16x32_bf16 v[40:43], a[132:135], v[148:151], v[40:43]
    ds_read_b64_tr_b16 a[170:171], v246 offset:50176
    v_mfma_f32_16x16x32_bf16 v[40:43], a[128:131], a[116:119], v[40:43]
    buffer_load_dwordx4 a[12:15], v249, s[16:19], s33 offen offset:1024 sc1
    v_mfma_f32_16x16x32_bf16 v[72:75], a[128:131], a[120:123], v[72:75]
    ds_read_b64_tr_b16 a[172:173], v246 offset:57344
    v_mfma_f32_16x16x32_bf16 v[72:75], a[132:135], v[152:155], v[72:75]
    ds_read_b64_tr_b16 a[174:175], v246 offset:58368
    v_mfma_f32_16x16x32_bf16 v[72:75], a[136:139], v[168:171], v[72:75]
    ds_read_b64_tr_b16 a[176:177], v246 offset:32776
    v_mfma_f32_16x16x32_bf16 v[72:75], a[140:143], v[184:187], v[72:75]
    buffer_load_dwordx4 a[16:19], v249, s[16:19], s30 offen offset:2048 sc1
    v_mfma_f32_16x16x32_bf16 v[104:107], a[140:143], v[188:191], v[104:107]
    ds_read_b64_tr_b16 a[178:179], v246 offset:33800
    v_mfma_f32_16x16x32_bf16 v[104:107], a[136:139], v[172:175], v[104:107]
    ds_read_b64_tr_b16 a[180:181], v246 offset:40968
    v_mfma_f32_16x16x32_bf16 v[104:107], a[132:135], v[156:159], v[104:107]
    ds_read_b64_tr_b16 a[182:183], v246 offset:41992
    v_mfma_f32_16x16x32_bf16 v[104:107], a[128:131], a[124:127], v[104:107]
    buffer_load_dwordx4 a[20:23], v249, s[16:19], s31 offen offset:2048 sc1
    v_mfma_f32_16x16x32_bf16 v[108:111], a[144:147], a[124:127], v[108:111]
    ds_read_b64_tr_b16 a[184:185], v246 offset:49160
    v_mfma_f32_16x16x32_bf16 v[108:111], a[148:151], v[156:159], v[108:111]
    ds_read_b64_tr_b16 a[186:187], v246 offset:50184
    v_mfma_f32_16x16x32_bf16 v[108:111], a[152:155], v[172:175], v[108:111]
    ds_read_b64_tr_b16 a[188:189], v246 offset:57352
    v_mfma_f32_16x16x32_bf16 v[108:111], a[156:159], v[188:191], v[108:111]
    buffer_load_dwordx4 a[24:27], v249, s[16:19], s32 offen offset:2048 sc1
    v_mfma_f32_16x16x32_bf16 v[76:79], a[156:159], v[184:187], v[76:79]
    ds_read_b64_tr_b16 a[190:191], v246 offset:58376
    v_mfma_f32_16x16x32_bf16 v[76:79], a[152:155], v[168:171], v[76:79]
    v_mfma_f32_16x16x32_bf16 v[76:79], a[148:151], v[152:155], v[76:79]
    v_mfma_f32_16x16x32_bf16 v[76:79], a[144:147], a[120:123], v[76:79]
    buffer_load_dwordx4 a[28:31], v249, s[16:19], s33 offen offset:2048 sc1
    v_mfma_f32_16x16x32_bf16 v[44:47], a[144:147], a[116:119], v[44:47]
    v_mfma_f32_16x16x32_bf16 v[44:47], a[148:151], v[148:151], v[44:47]
    v_mfma_f32_16x16x32_bf16 v[44:47], a[152:155], v[164:167], v[44:47]
    v_mfma_f32_16x16x32_bf16 v[44:47], a[156:159], v[180:183], v[44:47]
    buffer_load_dwordx4 a[32:35], v249, s[16:19], s30 offen offset:3072 sc1
    v_mfma_f32_16x16x32_bf16 v[12:15], a[156:159], v[176:179], v[12:15]
    v_mfma_f32_16x16x32_bf16 v[12:15], a[152:155], v[160:163], v[12:15]
    v_mfma_f32_16x16x32_bf16 v[12:15], a[148:151], v[144:147], v[12:15]
    v_mfma_f32_16x16x32_bf16 v[12:15], a[144:147], a[112:115], v[12:15]
    s_waitcnt lgkmcnt(0)
    v_mfma_f32_16x16x32_bf16 v[16:19], a[160:163], a[112:115], v[16:19]
    ds_read_b64_tr_b16 a[128:129], v247 offset:32768
    v_mfma_f32_16x16x32_bf16 v[16:19], a[164:167], v[144:147], v[16:19]
    ds_read_b64_tr_b16 a[130:131], v247 offset:33792
    v_mfma_f32_16x16x32_bf16 v[16:19], a[168:171], v[160:163], v[16:19]
    ds_read_b64_tr_b16 a[132:133], v247 offset:40960
    v_mfma_f32_16x16x32_bf16 v[16:19], a[172:175], v[176:179], v[16:19]
    ds_read_b64_tr_b16 a[134:135], v247 offset:41984
    v_mfma_f32_16x16x32_bf16 v[48:51], a[172:175], v[180:183], v[48:51]
    buffer_load_dwordx4 a[36:39], v249, s[16:19], s31 offen offset:3072 sc1
    v_mfma_f32_16x16x32_bf16 v[48:51], a[168:171], v[164:167], v[48:51]
    ds_read_b64_tr_b16 a[136:137], v247 offset:49152
    v_mfma_f32_16x16x32_bf16 v[48:51], a[164:167], v[148:151], v[48:51]
    ds_read_b64_tr_b16 a[138:139], v247 offset:50176
    v_mfma_f32_16x16x32_bf16 v[48:51], a[160:163], a[116:119], v[48:51]
    buffer_load_dwordx4 a[40:43], v249, s[16:19], s32 offen offset:3072 sc1
    v_mfma_f32_16x16x32_bf16 v[80:83], a[160:163], a[120:123], v[80:83]
    ds_read_b64_tr_b16 a[140:141], v247 offset:57344
    v_mfma_f32_16x16x32_bf16 v[80:83], a[164:167], v[152:155], v[80:83]
    ds_read_b64_tr_b16 a[142:143], v247 offset:58368
    v_mfma_f32_16x16x32_bf16 v[80:83], a[168:171], v[168:171], v[80:83]
    ds_read_b64_tr_b16 a[144:145], v247 offset:32776
    v_mfma_f32_16x16x32_bf16 v[80:83], a[172:175], v[184:187], v[80:83]
    buffer_load_dwordx4 a[44:47], v249, s[16:19], s33 offen offset:3072 sc1
    v_mfma_f32_16x16x32_bf16 v[112:115], a[172:175], v[188:191], v[112:115]
    ds_read_b64_tr_b16 a[146:147], v247 offset:33800
    v_mfma_f32_16x16x32_bf16 v[112:115], a[168:171], v[172:175], v[112:115]
    ds_read_b64_tr_b16 a[148:149], v247 offset:40968
    v_mfma_f32_16x16x32_bf16 v[112:115], a[164:167], v[156:159], v[112:115]
    s_add_u32 m0, s37, 32768
    ds_read_b64_tr_b16 a[150:151], v247 offset:41992
    v_mfma_f32_16x16x32_bf16 v[112:115], a[160:163], a[124:127], v[112:115]
    buffer_load_dwordx4 v251, s[4:7], s23 offen offset:0  lds
    v_mfma_f32_16x16x32_bf16 v[116:119], a[176:179], a[124:127], v[116:119]
    ds_read_b64_tr_b16 a[152:153], v247 offset:49160
    v_mfma_f32_16x16x32_bf16 v[116:119], a[180:183], v[156:159], v[116:119]
    ds_read_b64_tr_b16 a[154:155], v247 offset:50184
    v_mfma_f32_16x16x32_bf16 v[116:119], a[184:187], v[172:175], v[116:119]
    ds_read_b64_tr_b16 a[156:157], v247 offset:57352
    v_mfma_f32_16x16x32_bf16 v[116:119], a[188:191], v[188:191], v[116:119]
    buffer_load_dwordx4 v252, s[4:7], s23 offen offset:1024  lds
    v_mfma_f32_16x16x32_bf16 v[84:87], a[188:191], v[184:187], v[84:87]
    ds_read_b64_tr_b16 a[158:159], v247 offset:58376
    v_mfma_f32_16x16x32_bf16 v[84:87], a[184:187], v[168:171], v[84:87]
    v_mfma_f32_16x16x32_bf16 v[84:87], a[180:183], v[152:155], v[84:87]
    v_mfma_f32_16x16x32_bf16 v[84:87], a[176:179], a[120:123], v[84:87]
    buffer_load_dwordx4 v251, s[4:7], s23 offen offset:2048  lds
    v_mfma_f32_16x16x32_bf16 v[52:55], a[176:179], a[116:119], v[52:55]
    v_mfma_f32_16x16x32_bf16 v[52:55], a[180:183], v[148:151], v[52:55]
    v_mfma_f32_16x16x32_bf16 v[52:55], a[184:187], v[164:167], v[52:55]
    v_xor_b32 v244, 0x10000, v244
    v_xor_b32 v245, 0x10000, v245
    v_mfma_f32_16x16x32_bf16 v[52:55], a[188:191], v[180:183], v[52:55]
    buffer_load_dwordx4 v252, s[4:7], s23 offen offset:3072  lds
    v_mfma_f32_16x16x32_bf16 v[20:23], a[188:191], v[176:179], v[20:23]
    v_xor_b32 v246, 0x10000, v246
    v_xor_b32 v247, 0x10000, v247
    v_mfma_f32_16x16x32_bf16 v[20:23], a[184:187], v[160:163], v[20:23]
    v_mfma_f32_16x16x32_bf16 v[20:23], a[180:183], v[144:147], v[20:23]
    s_waitcnt vmcnt(20) lgkmcnt(0)
    v_mfma_f32_16x16x32_bf16 v[20:23], a[176:179], a[112:115], v[20:23]
    s_barrier
    v_mfma_f32_16x16x32_bf16 v[24:27], a[128:131], a[112:115], v[24:27]
    ds_read_b64_tr_b16 a[160:161], v244 offset:0
    v_mfma_f32_16x16x32_bf16 v[24:27], a[132:135], v[144:147], v[24:27]
    ds_read_b64_tr_b16 a[162:163], v244 offset:1024
    v_mfma_f32_16x16x32_bf16 v[24:27], a[136:139], v[160:163], v[24:27]
    s_add_u32 s23, s23, 0x4000
    ds_read_b64_tr_b16 a[164:165], v244 offset:8192
    v_mfma_f32_16x16x32_bf16 v[24:27], a[140:143], v[176:179], v[24:27]
    s_add_u32 m0, s37, 65536
    ds_read_b64_tr_b16 a[166:167], v244 offset:9216
    v_mfma_f32_16x16x32_bf16 v[56:59], a[140:143], v[180:183], v[56:59]
    buffer_load_dwordx4 v251, s[4:7], s23 offen offset:0  lds
    v_mfma_f32_16x16x32_bf16 v[56:59], a[136:139], v[164:167], v[56:59]
    ds_read_b64_tr_b16 a[168:169], v244 offset:16384
    v_mfma_f32_16x16x32_bf16 v[56:59], a[132:135], v[148:151], v[56:59]
    ds_read_b64_tr_b16 a[170:171], v244 offset:17408
    v_mfma_f32_16x16x32_bf16 v[56:59], a[128:131], a[116:119], v[56:59]
    buffer_load_dwordx4 v252, s[4:7], s23 offen offset:1024  lds
    v_mfma_f32_16x16x32_bf16 v[88:91], a[128:131], a[120:123], v[88:91]
    ds_read_b64_tr_b16 a[172:173], v244 offset:24576
    v_mfma_f32_16x16x32_bf16 v[88:91], a[132:135], v[152:155], v[88:91]
    ds_read_b64_tr_b16 a[174:175], v244 offset:25600
    v_mfma_f32_16x16x32_bf16 v[88:91], a[136:139], v[168:171], v[88:91]
    ds_read_b64_tr_b16 a[176:177], v244 offset:8
    v_mfma_f32_16x16x32_bf16 v[88:91], a[140:143], v[184:187], v[88:91]
    buffer_load_dwordx4 v251, s[4:7], s23 offen offset:2048  lds
    v_mfma_f32_16x16x32_bf16 v[120:123], a[140:143], v[188:191], v[120:123]
    ds_read_b64_tr_b16 a[178:179], v244 offset:1032
    v_mfma_f32_16x16x32_bf16 v[120:123], a[136:139], v[172:175], v[120:123]
    ds_read_b64_tr_b16 a[180:181], v244 offset:8200
    v_mfma_f32_16x16x32_bf16 v[120:123], a[132:135], v[156:159], v[120:123]
    ds_read_b64_tr_b16 a[182:183], v244 offset:9224
    v_mfma_f32_16x16x32_bf16 v[120:123], a[128:131], a[124:127], v[120:123]
    buffer_load_dwordx4 v252, s[4:7], s23 offen offset:3072  lds
    v_mfma_f32_16x16x32_bf16 v[124:127], a[144:147], a[124:127], v[124:127]
    ds_read_b64_tr_b16 a[184:185], v244 offset:16392
    v_mfma_f32_16x16x32_bf16 v[124:127], a[148:151], v[156:159], v[124:127]
    s_add_u32 s23, s23, 0x4000
    ds_read_b64_tr_b16 a[186:187], v244 offset:17416
    v_mfma_f32_16x16x32_bf16 v[124:127], a[152:155], v[172:175], v[124:127]
    s_add_u32 m0, s37, 98304
    ds_read_b64_tr_b16 a[188:189], v244 offset:24584
    v_mfma_f32_16x16x32_bf16 v[124:127], a[156:159], v[188:191], v[124:127]
    buffer_load_dwordx4 v251, s[4:7], s23 offen offset:0  lds
    v_mfma_f32_16x16x32_bf16 v[92:95], a[156:159], v[184:187], v[92:95]
    ds_read_b64_tr_b16 a[190:191], v244 offset:25608
    v_mfma_f32_16x16x32_bf16 v[92:95], a[152:155], v[168:171], v[92:95]
    v_mfma_f32_16x16x32_bf16 v[92:95], a[148:151], v[152:155], v[92:95]
    v_mfma_f32_16x16x32_bf16 v[92:95], a[144:147], a[120:123], v[92:95]
    buffer_load_dwordx4 v252, s[4:7], s23 offen offset:1024  lds
    v_mfma_f32_16x16x32_bf16 v[60:63], a[144:147], a[116:119], v[60:63]
    v_mfma_f32_16x16x32_bf16 v[60:63], a[148:151], v[148:151], v[60:63]
    v_mfma_f32_16x16x32_bf16 v[60:63], a[152:155], v[164:167], v[60:63]
    v_mfma_f32_16x16x32_bf16 v[60:63], a[156:159], v[180:183], v[60:63]
    buffer_load_dwordx4 v251, s[4:7], s23 offen offset:2048  lds
    v_mfma_f32_16x16x32_bf16 v[28:31], a[156:159], v[176:179], v[28:31]
    v_mfma_f32_16x16x32_bf16 v[28:31], a[152:155], v[160:163], v[28:31]
    v_mfma_f32_16x16x32_bf16 v[28:31], a[148:151], v[144:147], v[28:31]
    v_mfma_f32_16x16x32_bf16 v[28:31], a[144:147], a[112:115], v[28:31]
    s_waitcnt vmcnt(11) lgkmcnt(0)
    v_mfma_f32_16x16x32_bf16 v[0:3], a[160:163], v[128:131], v[0:3]
    ds_read_b64_tr_b16 a[128:129], v245 offset:0
    v_mfma_f32_16x16x32_bf16 v[0:3], a[164:167], a[0:3], v[0:3]
    ds_read_b64_tr_b16 a[130:131], v245 offset:1024
    v_mfma_f32_16x16x32_bf16 v[0:3], a[168:171], a[16:19], v[0:3]
    ds_read_b64_tr_b16 a[132:133], v245 offset:8192
    v_mfma_f32_16x16x32_bf16 v[0:3], a[172:175], a[32:35], v[0:3]
    ds_read_b64_tr_b16 a[134:135], v245 offset:9216
    v_mfma_f32_16x16x32_bf16 v[32:35], a[172:175], a[36:39], v[32:35]
    buffer_load_dwordx4 v252, s[4:7], s23 offen offset:3072  lds
    v_mfma_f32_16x16x32_bf16 v[32:35], a[168:171], a[20:23], v[32:35]
    ds_read_b64_tr_b16 a[136:137], v245 offset:16384
    v_mfma_f32_16x16x32_bf16 v[32:35], a[164:167], a[4:7], v[32:35]
    ds_read_b64_tr_b16 a[138:139], v245 offset:17408
    v_mfma_f32_16x16x32_bf16 v[32:35], a[160:163], v[132:135], v[32:35]
    s_add_u32 s23, s23, 0x4000
    ds_read_b64_tr_b16 a[140:141], v245 offset:24576
    v_mfma_f32_16x16x32_bf16 v[64:67], a[160:163], v[136:139], v[64:67]
    s_add_u32 m0, s37, 114688
    ds_read_b64_tr_b16 a[142:143], v245 offset:25600
    v_mfma_f32_16x16x32_bf16 v[64:67], a[164:167], a[8:11], v[64:67]
    buffer_load_dwordx4 v251, s[8:11], s24 offen offset:0  lds
    v_mfma_f32_16x16x32_bf16 v[64:67], a[168:171], a[24:27], v[64:67]
    ds_read_b64_tr_b16 a[144:145], v245 offset:8
    v_mfma_f32_16x16x32_bf16 v[64:67], a[172:175], a[40:43], v[64:67]
    ds_read_b64_tr_b16 a[146:147], v245 offset:1032
    v_mfma_f32_16x16x32_bf16 v[96:99], a[172:175], a[44:47], v[96:99]
    ds_read_b64_tr_b16 a[148:149], v245 offset:8200
    v_mfma_f32_16x16x32_bf16 v[96:99], a[168:171], a[28:31], v[96:99]
    ds_read_b64_tr_b16 a[150:151], v245 offset:9224
    v_mfma_f32_16x16x32_bf16 v[96:99], a[164:167], a[12:15], v[96:99]
    buffer_load_dwordx4 v252, s[8:11], s24 offen offset:1024  lds
    v_mfma_f32_16x16x32_bf16 v[96:99], a[160:163], v[140:143], v[96:99]
    ds_read_b64_tr_b16 a[152:153], v245 offset:16392
    v_mfma_f32_16x16x32_bf16 v[100:103], a[176:179], v[140:143], v[100:103]
    ds_read_b64_tr_b16 a[154:155], v245 offset:17416
    v_mfma_f32_16x16x32_bf16 v[100:103], a[180:183], a[12:15], v[100:103]
    ds_read_b64_tr_b16 a[156:157], v245 offset:24584
    v_mfma_f32_16x16x32_bf16 v[100:103], a[184:187], a[28:31], v[100:103]
    ds_read_b64_tr_b16 a[158:159], v245 offset:25608
    v_mfma_f32_16x16x32_bf16 v[100:103], a[188:191], a[44:47], v[100:103]
    v_mfma_f32_16x16x32_bf16 v[68:71], a[188:191], a[40:43], v[68:71]
    buffer_load_dwordx4 v251, s[8:11], s24 offen offset:2048  lds
    v_mfma_f32_16x16x32_bf16 v[68:71], a[184:187], a[24:27], v[68:71]
    v_mfma_f32_16x16x32_bf16 v[68:71], a[180:183], a[8:11], v[68:71]
    v_mfma_f32_16x16x32_bf16 v[68:71], a[176:179], v[136:139], v[68:71]
    v_mfma_f32_16x16x32_bf16 v[36:39], a[176:179], v[132:135], v[36:39]
    v_mfma_f32_16x16x32_bf16 v[36:39], a[180:183], a[4:7], v[36:39]
    buffer_load_dwordx4 v252, s[8:11], s24 offen offset:3072  lds
    v_mfma_f32_16x16x32_bf16 v[36:39], a[184:187], a[20:23], v[36:39]
    v_mfma_f32_16x16x32_bf16 v[36:39], a[188:191], a[36:39], v[36:39]
    v_mfma_f32_16x16x32_bf16 v[4:7], a[188:191], a[32:35], v[4:7]
    v_mfma_f32_16x16x32_bf16 v[4:7], a[184:187], a[16:19], v[4:7]
    v_mfma_f32_16x16x32_bf16 v[4:7], a[180:183], a[0:3], v[4:7]
    v_mfma_f32_16x16x32_bf16 v[4:7], a[176:179], v[128:131], v[4:7]
    s_waitcnt lgkmcnt(0)
    v_mfma_f32_16x16x32_bf16 v[8:11], a[128:131], v[128:131], v[8:11]
    ds_read_b64_tr_b16 a[160:161], v246 offset:0
    v_mfma_f32_16x16x32_bf16 v[8:11], a[132:135], a[0:3], v[8:11]
    ds_read_b64_tr_b16 a[162:163], v246 offset:1024
    v_mfma_f32_16x16x32_bf16 v[8:11], a[136:139], a[16:19], v[8:11]
    ds_read_b64_tr_b16 a[164:165], v246 offset:8192
    v_mfma_f32_16x16x32_bf16 v[8:11], a[140:143], a[32:35], v[8:11]
    ds_read_b64_tr_b16 a[166:167], v246 offset:9216
    v_mfma_f32_16x16x32_bf16 v[40:43], a[140:143], a[36:39], v[40:43]
    ds_read_b64_tr_b16 a[168:169], v246 offset:16384
    v_cvt_pk_bf16_f32 v0, v0, v1
    v_mfma_f32_16x16x32_bf16 v[40:43], a[136:139], a[20:23], v[40:43]
    ds_read_b64_tr_b16 a[170:171], v246 offset:17408
    v_cvt_pk_bf16_f32 v1, v2, v3
    v_mfma_f32_16x16x32_bf16 v[40:43], a[132:135], a[4:7], v[40:43]
    ds_read_b64_tr_b16 a[172:173], v246 offset:24576
    v_cvt_pk_bf16_f32 v2, v4, v5
    v_mfma_f32_16x16x32_bf16 v[40:43], a[128:131], v[132:135], v[40:43]
    ds_read_b64_tr_b16 a[174:175], v246 offset:25600
    v_cvt_pk_bf16_f32 v3, v6, v7
    v_mfma_f32_16x16x32_bf16 v[72:75], a[128:131], v[136:139], v[72:75]
    ds_read_b64_tr_b16 a[176:177], v246 offset:8
    v_cvt_pk_bf16_f32 v32, v32, v33
    v_mfma_f32_16x16x32_bf16 v[72:75], a[132:135], a[8:11], v[72:75]
    ds_read_b64_tr_b16 a[178:179], v246 offset:1032
    v_cvt_pk_bf16_f32 v33, v34, v35
    v_mfma_f32_16x16x32_bf16 v[72:75], a[136:139], a[24:27], v[72:75]
    ds_read_b64_tr_b16 a[180:181], v246 offset:8200
    v_cvt_pk_bf16_f32 v34, v36, v37
    v_mfma_f32_16x16x32_bf16 v[72:75], a[140:143], a[40:43], v[72:75]
    ds_read_b64_tr_b16 a[182:183], v246 offset:9224
    v_cvt_pk_bf16_f32 v35, v38, v39
    v_mfma_f32_16x16x32_bf16 v[104:107], a[140:143], a[44:47], v[104:107]
    ds_read_b64_tr_b16 a[184:185], v246 offset:16392
    v_cvt_pk_bf16_f32 v64, v64, v65
    v_mfma_f32_16x16x32_bf16 v[104:107], a[136:139], a[28:31], v[104:107]
    ds_read_b64_tr_b16 a[186:187], v246 offset:17416
    v_cvt_pk_bf16_f32 v65, v66, v67
    v_mfma_f32_16x16x32_bf16 v[104:107], a[132:135], a[12:15], v[104:107]
    ds_read_b64_tr_b16 a[188:189], v246 offset:24584
    v_cvt_pk_bf16_f32 v66, v68, v69
    v_mfma_f32_16x16x32_bf16 v[104:107], a[128:131], v[140:143], v[104:107]
    ds_read_b64_tr_b16 a[190:191], v246 offset:25608
    v_cvt_pk_bf16_f32 v67, v70, v71
    v_mfma_f32_16x16x32_bf16 v[108:111], a[144:147], v[140:143], v[108:111]
    v_cvt_pk_bf16_f32 v96, v96, v97
    v_cvt_pk_bf16_f32 v97, v98, v99
    v_mfma_f32_16x16x32_bf16 v[108:111], a[148:151], a[12:15], v[108:111]
    v_cvt_pk_bf16_f32 v98, v100, v101
    v_cvt_pk_bf16_f32 v99, v102, v103
    v_mfma_f32_16x16x32_bf16 v[108:111], a[152:155], a[28:31], v[108:111]
    v_mfma_f32_16x16x32_bf16 v[108:111], a[156:159], a[44:47], v[108:111]
    v_mfma_f32_16x16x32_bf16 v[76:79], a[156:159], a[40:43], v[76:79]
    v_mfma_f32_16x16x32_bf16 v[76:79], a[152:155], a[24:27], v[76:79]
    v_mfma_f32_16x16x32_bf16 v[76:79], a[148:151], a[8:11], v[76:79]
    v_mfma_f32_16x16x32_bf16 v[76:79], a[144:147], v[136:139], v[76:79]
    v_mfma_f32_16x16x32_bf16 v[44:47], a[144:147], v[132:135], v[44:47]
    v_mfma_f32_16x16x32_bf16 v[44:47], a[148:151], a[4:7], v[44:47]
    v_mfma_f32_16x16x32_bf16 v[44:47], a[152:155], a[20:23], v[44:47]
    v_mfma_f32_16x16x32_bf16 v[44:47], a[156:159], a[36:39], v[44:47]
    v_mfma_f32_16x16x32_bf16 v[12:15], a[156:159], a[32:35], v[12:15]
    v_mfma_f32_16x16x32_bf16 v[12:15], a[152:155], a[16:19], v[12:15]
    v_mfma_f32_16x16x32_bf16 v[12:15], a[148:151], a[0:3], v[12:15]
    v_mfma_f32_16x16x32_bf16 v[12:15], a[144:147], v[128:131], v[12:15]
    s_waitcnt lgkmcnt(0)
    v_mfma_f32_16x16x32_bf16 v[16:19], a[160:163], v[128:131], v[16:19]
    ds_read_b64_tr_b16 a[128:129], v247 offset:0
    v_mfma_f32_16x16x32_bf16 v[16:19], a[164:167], a[0:3], v[16:19]
    ds_read_b64_tr_b16 a[130:131], v247 offset:1024
    v_mfma_f32_16x16x32_bf16 v[16:19], a[168:171], a[16:19], v[16:19]
    ds_read_b64_tr_b16 a[132:133], v247 offset:8192
    v_mfma_f32_16x16x32_bf16 v[16:19], a[172:175], a[32:35], v[16:19]
    ds_read_b64_tr_b16 a[134:135], v247 offset:9216
    v_mfma_f32_16x16x32_bf16 v[48:51], a[172:175], a[36:39], v[48:51]
    ds_read_b64_tr_b16 a[136:137], v247 offset:16384
    v_cvt_pk_bf16_f32 v8, v8, v9
    v_mfma_f32_16x16x32_bf16 v[48:51], a[168:171], a[20:23], v[48:51]
    ds_read_b64_tr_b16 a[138:139], v247 offset:17408
    v_cvt_pk_bf16_f32 v9, v10, v11
    v_mfma_f32_16x16x32_bf16 v[48:51], a[164:167], a[4:7], v[48:51]
    ds_read_b64_tr_b16 a[140:141], v247 offset:24576
    v_cvt_pk_bf16_f32 v10, v12, v13
    v_mfma_f32_16x16x32_bf16 v[48:51], a[160:163], v[132:135], v[48:51]
    ds_read_b64_tr_b16 a[142:143], v247 offset:25600
    v_cvt_pk_bf16_f32 v11, v14, v15
    v_mfma_f32_16x16x32_bf16 v[80:83], a[160:163], v[136:139], v[80:83]
    ds_read_b64_tr_b16 a[144:145], v247 offset:8
    v_cvt_pk_bf16_f32 v40, v40, v41
    v_mfma_f32_16x16x32_bf16 v[80:83], a[164:167], a[8:11], v[80:83]
    ds_read_b64_tr_b16 a[146:147], v247 offset:1032
    v_cvt_pk_bf16_f32 v41, v42, v43
    v_mfma_f32_16x16x32_bf16 v[80:83], a[168:171], a[24:27], v[80:83]
    ds_read_b64_tr_b16 a[148:149], v247 offset:8200
    v_cvt_pk_bf16_f32 v42, v44, v45
    v_mfma_f32_16x16x32_bf16 v[80:83], a[172:175], a[40:43], v[80:83]
    ds_read_b64_tr_b16 a[150:151], v247 offset:9224
    v_cvt_pk_bf16_f32 v43, v46, v47
    v_mfma_f32_16x16x32_bf16 v[112:115], a[172:175], a[44:47], v[112:115]
    ds_read_b64_tr_b16 a[152:153], v247 offset:16392
    v_cvt_pk_bf16_f32 v72, v72, v73
    v_mfma_f32_16x16x32_bf16 v[112:115], a[168:171], a[28:31], v[112:115]
    ds_read_b64_tr_b16 a[154:155], v247 offset:17416
    v_cvt_pk_bf16_f32 v73, v74, v75
    v_mfma_f32_16x16x32_bf16 v[112:115], a[164:167], a[12:15], v[112:115]
    ds_read_b64_tr_b16 a[156:157], v247 offset:24584
    v_cvt_pk_bf16_f32 v74, v76, v77
    v_mfma_f32_16x16x32_bf16 v[112:115], a[160:163], v[140:143], v[112:115]
    ds_read_b64_tr_b16 a[158:159], v247 offset:25608
    v_cvt_pk_bf16_f32 v75, v78, v79
    v_mfma_f32_16x16x32_bf16 v[116:119], a[176:179], v[140:143], v[116:119]
    v_cvt_pk_bf16_f32 v104, v104, v105
    v_cvt_pk_bf16_f32 v105, v106, v107
    v_mfma_f32_16x16x32_bf16 v[116:119], a[180:183], a[12:15], v[116:119]
    v_cvt_pk_bf16_f32 v106, v108, v109
    v_cvt_pk_bf16_f32 v107, v110, v111
    v_mfma_f32_16x16x32_bf16 v[116:119], a[184:187], a[28:31], v[116:119]
    v_mfma_f32_16x16x32_bf16 v[116:119], a[188:191], a[44:47], v[116:119]
    v_mfma_f32_16x16x32_bf16 v[84:87], a[188:191], a[40:43], v[84:87]
    v_mfma_f32_16x16x32_bf16 v[84:87], a[184:187], a[24:27], v[84:87]
    v_mfma_f32_16x16x32_bf16 v[84:87], a[180:183], a[8:11], v[84:87]
    v_mfma_f32_16x16x32_bf16 v[84:87], a[176:179], v[136:139], v[84:87]
    v_mfma_f32_16x16x32_bf16 v[52:55], a[176:179], v[132:135], v[52:55]
    v_mfma_f32_16x16x32_bf16 v[52:55], a[180:183], a[4:7], v[52:55]
    v_mfma_f32_16x16x32_bf16 v[52:55], a[184:187], a[20:23], v[52:55]
    v_mfma_f32_16x16x32_bf16 v[52:55], a[188:191], a[36:39], v[52:55]
    v_mfma_f32_16x16x32_bf16 v[20:23], a[188:191], a[32:35], v[20:23]
    v_mfma_f32_16x16x32_bf16 v[20:23], a[184:187], a[16:19], v[20:23]
HOP0_3:
    s_cbranch_execz HOP0_6
    v_mfma_f32_16x16x32_bf16 v[20:23], a[180:183], a[0:3], v[20:23]
    s_waitcnt vmcnt(12) lgkmcnt(0)
    v_mfma_f32_16x16x32_bf16 v[20:23], a[176:179], v[128:131], v[20:23]
    s_barrier
    v_mfma_f32_16x16x32_bf16 v[120:123], a[128:131], v[140:143], v[120:123]
    s_add_u32 s24, s24, 0x4000
    ds_read_b128 a[160:163], v208 offset:32768
    v_mfma_f32_16x16x32_bf16 v[120:123], a[132:135], a[12:15], v[120:123]
    s_mov_b32 s12, s52
    ds_read_b128 a[164:167], v209 offset:32768
    v_mfma_f32_16x16x32_bf16 v[120:123], a[136:139], a[28:31], v[120:123]
    s_and_b32 s13, s53, 0xffff
    ds_read_b128 a[168:171], v210 offset:32768
    v_mfma_f32_16x16x32_bf16 v[120:123], a[140:143], a[44:47], v[120:123]
    s_mov_b32 s14, s54
    ds_read_b128 a[172:175], v211 offset:32768
    v_mfma_f32_16x16x32_bf16 v[88:91], a[140:143], a[40:43], v[88:91]
    s_mov_b32 s15, 0x20000
    ds_read_b128 a[176:179], v208 offset:36864
    v_cvt_pk_bf16_f32 v16, v16, v17
    v_mfma_f32_16x16x32_bf16 v[88:91], a[136:139], a[24:27], v[88:91]
    ds_read_b128 a[180:183], v209 offset:36864
    v_cvt_pk_bf16_f32 v17, v18, v19
    v_mfma_f32_16x16x32_bf16 v[88:91], a[132:135], a[8:11], v[88:91]
    ds_read_b128 a[184:187], v210 offset:36864
    v_cvt_pk_bf16_f32 v18, v20, v21
    v_mfma_f32_16x16x32_bf16 v[88:91], a[128:131], v[136:139], v[88:91]
    ds_read_b128 a[188:191], v211 offset:36864
    v_cvt_pk_bf16_f32 v19, v22, v23
    v_mfma_f32_16x16x32_bf16 v[56:59], a[128:131], v[132:135], v[56:59]
    v_cvt_pk_bf16_f32 v48, v48, v49
    v_cvt_pk_bf16_f32 v49, v50, v51
    v_mfma_f32_16x16x32_bf16 v[56:59], a[132:135], a[4:7], v[56:59]
    v_cvt_pk_bf16_f32 v50, v52, v53
    v_cvt_pk_bf16_f32 v51, v54, v55
    v_mfma_f32_16x16x32_bf16 v[56:59], a[136:139], a[20:23], v[56:59]
    v_cvt_pk_bf16_f32 v80, v80, v81
    v_cvt_pk_bf16_f32 v81, v82, v83
    v_mfma_f32_16x16x32_bf16 v[56:59], a[140:143], a[36:39], v[56:59]
    v_cvt_pk_bf16_f32 v82, v84, v85
    v_cvt_pk_bf16_f32 v83, v86, v87
    v_mfma_f32_16x16x32_bf16 v[24:27], a[140:143], a[32:35], v[24:27]
    v_cvt_pk_bf16_f32 v112, v112, v113
    v_cvt_pk_bf16_f32 v113, v114, v115
    v_mfma_f32_16x16x32_bf16 v[24:27], a[136:139], a[16:19], v[24:27]
    v_cvt_pk_bf16_f32 v114, v116, v117
    v_cvt_pk_bf16_f32 v115, v118, v119
    v_mfma_f32_16x16x32_bf16 v[24:27], a[132:135], a[0:3], v[24:27]
    v_mfma_f32_16x16x32_bf16 v[24:27], a[128:131], v[128:131], v[24:27]
    v_mfma_f32_16x16x32_bf16 v[28:31], a[144:147], v[128:131], v[28:31]
    v_mfma_f32_16x16x32_bf16 v[28:31], a[148:151], a[0:3], v[28:31]
    v_mfma_f32_16x16x32_bf16 v[28:31], a[152:155], a[16:19], v[28:31]
    v_mfma_f32_16x16x32_bf16 v[28:31], a[156:159], a[32:35], v[28:31]
    v_mfma_f32_16x16x32_bf16 v[60:63], a[156:159], a[36:39], v[60:63]
    v_mfma_f32_16x16x32_bf16 v[60:63], a[152:155], a[20:23], v[60:63]
    v_mfma_f32_16x16x32_bf16 v[60:63], a[148:151], a[4:7], v[60:63]
    v_mfma_f32_16x16x32_bf16 v[60:63], a[144:147], v[132:135], v[60:63]
    v_mfma_f32_16x16x32_bf16 v[92:95], a[144:147], v[136:139], v[92:95]
    v_mfma_f32_16x16x32_bf16 v[92:95], a[148:151], a[8:11], v[92:95]
    v_mfma_f32_16x16x32_bf16 v[92:95], a[152:155], a[24:27], v[92:95]
    v_mfma_f32_16x16x32_bf16 v[92:95], a[156:159], a[40:43], v[92:95]
    v_cvt_pk_bf16_f32 v24, v24, v25
    v_cvt_pk_bf16_f32 v25, v26, v27
    v_mfma_f32_16x16x32_bf16 v[124:127], a[156:159], a[44:47], v[124:127]
    v_cvt_pk_bf16_f32 v26, v28, v29
    v_cvt_pk_bf16_f32 v27, v30, v31
    v_mfma_f32_16x16x32_bf16 v[124:127], a[152:155], a[28:31], v[124:127]
    v_cvt_pk_bf16_f32 v56, v56, v57
    v_cvt_pk_bf16_f32 v57, v58, v59
    v_mfma_f32_16x16x32_bf16 v[124:127], a[148:151], a[12:15], v[124:127]
    v_cvt_pk_bf16_f32 v58, v60, v61
    v_cvt_pk_bf16_f32 v59, v62, v63
    v_mfma_f32_16x16x32_bf16 v[124:127], a[144:147], v[140:143], v[124:127]
    v_cvt_pk_bf16_f32 v88, v88, v89
    v_cvt_pk_bf16_f32 v89, v90, v91
    v_cvt_pk_bf16_f32 v90, v92, v93
    v_cvt_pk_bf16_f32 v91, v94, v95
    s_nop 3
    v_cvt_pk_bf16_f32 v120, v120, v121
    v_cvt_pk_bf16_f32 v121, v122, v123
    v_cvt_pk_bf16_f32 v122, v124, v125
    v_cvt_pk_bf16_f32 v123, v126, v127
K1_att0:
    ds_read_b128 a[128:131], v208 offset:40960
    ds_read_b128 a[132:135], v209 offset:40960
    ds_read_b128 a[136:139], v210 offset:40960
    ds_read_b128 a[140:143], v211 offset:40960
    ds_read_b128 a[144:147], v208 offset:45056
    ds_read_b128 a[148:151], v209 offset:45056
    ds_read_b128 a[152:155], v210 offset:45056
    ds_read_b128 a[156:159], v211 offset:45056
    s_add_u32 s25, s37, 0x10000
    s_mov_b32 s26, s37
    s_waitcnt lgkmcnt(8)
    v_mfma_f32_16x16x32_bf16 v[4:7], a[160:163], v[0:3], 0
    s_mov_b32 m0, s37
    v_accvgpr_read_b32 v220, a224
    v_accvgpr_read_b32 v221, a225
    v_mfma_f32_16x16x32_bf16 v[4:7], a[164:167], v[8:11], v[4:7]
    buffer_load_dwordx4 v251, s[4:7], s23 offen offset:0  lds
    v_mfma_f32_16x16x32_bf16 v[4:7], a[168:171], v[16:19], v[4:7]
    v_accvgpr_read_b32 v222, a226
    v_accvgpr_read_b32 v223, a227
    v_mfma_f32_16x16x32_bf16 v[4:7], a[172:175], v[24:27], v[4:7]
    buffer_load_dwordx4 v252, s[4:7], s23 offen offset:1024  lds
    v_mfma_f32_16x16x32_bf16 v[36:39], a[172:175], v[56:59], 0
    v_xor_b32 v208, 0x10000, v208
    v_xor_b32 v209, 0x10000, v209
    v_mfma_f32_16x16x32_bf16 v[36:39], a[168:171], v[48:51], v[36:39]
    v_xor_b32 v210, 0x10000, v210
    v_xor_b32 v211, 0x10000, v211
    v_mfma_f32_16x16x32_bf16 v[36:39], a[164:167], v[40:43], v[36:39]
    buffer_load_dwordx4 v251, s[4:7], s23 offen offset:2048  lds
    v_mfma_f32_16x16x32_bf16 v[36:39], a[160:163], v[32:35], v[36:39]
    v_accvgpr_write_b32 a208, 0
    v_accvgpr_write_b32 a209, 0
    v_mfma_f32_16x16x32_bf16 v[68:71], a[160:163], v[64:67], 0
    buffer_load_dwordx4 v252, s[4:7], s23 offen offset:3072  lds
    v_mfma_f32_16x16x32_bf16 v[68:71], a[164:167], v[72:75], v[68:71]
    s_add_u32 s23, s23, 0x4000
    v_accvgpr_write_b32 a210, 0
    v_accvgpr_write_b32 a211, 0
    v_mfma_f32_16x16x32_bf16 v[68:71], a[168:171], v[80:83], v[68:71]
    s_add_u32 m0, s37, 0x4000
    v_max3_f32 v220, v220, v4, v5
    v_max3_f32 v220, v220, v6, v7
    v_mfma_f32_16x16x32_bf16 v[68:71], a[172:175], v[88:91], v[68:71]
    buffer_load_dwordx4 v251, s[8:11], s24 offen offset:0  lds
    v_mfma_f32_16x16x32_bf16 v[100:103], a[172:175], v[120:123], 0
    v_max3_f32 v221, v221, v36, v37
    v_max3_f32 v221, v221, v38, v39
    v_mfma_f32_16x16x32_bf16 v[100:103], a[168:171], v[112:115], v[100:103]
    buffer_load_dwordx4 v252, s[8:11], s24 offen offset:1024  lds
    v_mfma_f32_16x16x32_bf16 v[100:103], a[164:167], v[104:107], v[100:103]
    v_mfma_f32_16x16x32_bf16 v[100:103], a[160:163], v[96:99], v[100:103]
    v_mfma_f32_16x16x32_bf16 v[12:15], a[176:179], v[0:3], 0
    v_max3_f32 v222, v222, v68, v69
    v_max3_f32 v222, v222, v70, v71
    v_mfma_f32_16x16x32_bf16 v[12:15], a[180:183], v[8:11], v[12:15]
    buffer_load_dwordx4 v251, s[8:11], s24 offen offset:2048  lds
    v_mfma_f32_16x16x32_bf16 v[12:15], a[184:187], v[16:19], v[12:15]
    v_mfma_f32_16x16x32_bf16 v[12:15], a[188:191], v[24:27], v[12:15]
    buffer_load_dwordx4 v252, s[8:11], s24 offen offset:3072  lds
    v_mfma_f32_16x16x32_bf16 v[44:47], a[188:191], v[56:59], 0
    s_add_u32 s24, s24, 0x4000
    v_max3_f32 v223, v223, v100, v101
    v_max3_f32 v223, v223, v102, v103
    v_mfma_f32_16x16x32_bf16 v[44:47], a[184:187], v[48:51], v[44:47]
    v_mov_b32 v236, v220
    v_mov_b32 v237, v221
    v_mfma_f32_16x16x32_bf16 v[44:47], a[180:183], v[40:43], v[44:47]
    v_mov_b32 v238, v222
    v_mov_b32 v239, v223
    v_mfma_f32_16x16x32_bf16 v[44:47], a[176:179], v[32:35], v[44:47]
    v_permlane32_swap_b32 v236, v220
    v_permlane32_swap_b32 v237, v221
    v_mfma_f32_16x16x32_bf16 v[76:79], a[176:179], v[64:67], 0
    v_permlane32_swap_b32 v238, v222
    v_permlane32_swap_b32 v239, v223
    v_mfma_f32_16x16x32_bf16 v[76:79], a[180:183], v[72:75], v[76:79]
    v_max_f32 v220, v220, v236
    v_max_f32 v221, v221, v237
    v_mfma_f32_16x16x32_bf16 v[76:79], a[184:187], v[80:83], v[76:79]
    v_max_f32 v222, v222, v238
    v_max_f32 v223, v223, v239
    v_mfma_f32_16x16x32_bf16 v[76:79], a[188:191], v[88:91], v[76:79]
    v_mov_b32 v236, v220
    v_mov_b32 v237, v221
    v_mfma_f32_16x16x32_bf16 v[108:111], a[188:191], v[120:123], 0
    v_mov_b32 v238, v222
    v_mov_b32 v239, v223
    v_mfma_f32_16x16x32_bf16 v[108:111], a[184:187], v[112:115], v[108:111]
    v_permlane16_swap_b32 v236, v220
    v_permlane16_swap_b32 v237, v221
    v_mfma_f32_16x16x32_bf16 v[108:111], a[180:183], v[104:107], v[108:111]
    v_permlane16_swap_b32 v238, v222
    v_permlane16_swap_b32 v239, v223
    v_mfma_f32_16x16x32_bf16 v[108:111], a[176:179], v[96:99], v[108:111]
    v_max_f32 v220, v220, v236
    v_max_f32 v221, v221, v237
    v_max_f32 v222, v222, v238
    v_max_f32 v223, v223, v239
    v_sub_f32 v192, s28, v220
    v_sub_f32 v193, s28, v220
    v_sub_f32 v196, s28, v221
    v_sub_f32 v197, s28, v221
    v_sub_f32 v200, s28, v222
    v_sub_f32 v201, s28, v222
    v_sub_f32 v204, s28, v223
    v_sub_f32 v205, s28, v223
    v_pk_add_f32 v[194:195], v[192:193], 0
    v_pk_add_f32 v[198:199], v[196:197], 0
    v_pk_add_f32 v[202:203], v[200:201], 0
    v_pk_add_f32 v[206:207], v[204:205], 0
    v_pk_add_f32 v[4:5], v[4:5], v[192:193]
    v_pk_add_f32 v[6:7], v[6:7], v[192:193]
    v_pk_add_f32 v[12:13], v[12:13], v[192:193]
    v_pk_add_f32 v[14:15], v[14:15], v[192:193]
    v_pk_add_f32 v[36:37], v[36:37], v[196:197]
    v_pk_add_f32 v[38:39], v[38:39], v[196:197]
    v_pk_add_f32 v[44:45], v[44:45], v[196:197]
    v_pk_add_f32 v[46:47], v[46:47], v[196:197]
    v_pk_add_f32 v[68:69], v[68:69], v[200:201]
    v_pk_add_f32 v[70:71], v[70:71], v[200:201]
    v_pk_add_f32 v[76:77], v[76:77], v[200:201]
    v_pk_add_f32 v[78:79], v[78:79], v[200:201]
    v_pk_add_f32 v[100:101], v[100:101], v[204:205]
    v_pk_add_f32 v[102:103], v[102:103], v[204:205]
    v_pk_add_f32 v[108:109], v[108:109], v[204:205]
    v_pk_add_f32 v[110:111], v[110:111], v[204:205]
    s_waitcnt vmcnt(16) lgkmcnt(0)
    s_barrier
    v_mfma_f32_16x16x32_bf16 v[20:23], a[128:131], v[0:3], v[192:195]
    ds_read_b128 a[160:163], v208 offset:0
    v_exp_f32 v4, v4
    v_mfma_f32_16x16x32_bf16 v[20:23], a[132:135], v[8:11], v[20:23]
    v_exp_f32 v5, v5
    v_mfma_f32_16x16x32_bf16 v[20:23], a[136:139], v[16:19], v[20:23]
    ds_read_b128 a[164:167], v209 offset:0
    v_exp_f32 v6, v6
    v_mfma_f32_16x16x32_bf16 v[20:23], a[140:143], v[24:27], v[20:23]
    v_exp_f32 v7, v7
    v_cvt_pk_bf16_f32 v128, v4, v5
    v_mfma_f32_16x16x32_bf16 v[52:55], a[140:143], v[56:59], v[196:199]
    ds_read_b128 a[168:171], v210 offset:0
    v_exp_f32 v12, v12
    v_mfma_f32_16x16x32_bf16 v[52:55], a[136:139], v[48:51], v[52:55]
    v_exp_f32 v13, v13
    v_cvt_pk_bf16_f32 v129, v6, v7
    v_mfma_f32_16x16x32_bf16 v[52:55], a[132:135], v[40:43], v[52:55]
    ds_read_b128 a[172:175], v211 offset:0
    v_exp_f32 v14, v14
    v_mfma_f32_16x16x32_bf16 v[52:55], a[128:131], v[32:35], v[52:55]
    v_exp_f32 v15, v15
    v_cvt_pk_bf16_f32 v130, v12, v13
    v_mfma_f32_16x16x32_bf16 v[84:87], a[128:131], v[64:67], v[200:203]
    ds_read_b128 a[176:179], v208 offset:4096
    v_exp_f32 v36, v36
    v_mfma_f32_16x16x32_bf16 v[84:87], a[132:135], v[72:75], v[84:87]
    v_exp_f32 v37, v37
    v_cvt_pk_bf16_f32 v131, v14, v15
    v_mfma_f32_16x16x32_bf16 v[84:87], a[136:139], v[80:83], v[84:87]
    ds_read_b128 a[180:183], v209 offset:4096
    v_exp_f32 v38, v38
    v_mfma_f32_16x16x32_bf16 v[84:87], a[140:143], v[88:91], v[84:87]
    v_exp_f32 v39, v39
    v_cvt_pk_bf16_f32 v136, v36, v37
    v_mfma_f32_16x16x32_bf16 v[116:119], a[140:143], v[120:123], v[204:207]
    ds_read_b128 a[184:187], v210 offset:4096
    v_exp_f32 v44, v44
    v_mfma_f32_16x16x32_bf16 v[116:119], a[136:139], v[112:115], v[116:119]
    v_exp_f32 v45, v45
    v_cvt_pk_bf16_f32 v137, v38, v39
    v_mfma_f32_16x16x32_bf16 v[116:119], a[132:135], v[104:107], v[116:119]
    ds_read_b128 a[188:191], v211 offset:4096
    v_exp_f32 v46, v46
    v_mfma_f32_16x16x32_bf16 v[116:119], a[128:131], v[96:99], v[116:119]
    v_exp_f32 v47, v47
    v_cvt_pk_bf16_f32 v138, v44, v45
    v_mfma_f32_16x16x32_bf16 v[28:31], a[144:147], v[0:3], v[192:195]
    s_add_u32 m0, s26, 32768
    v_exp_f32 v68, v68
    v_mfma_f32_16x16x32_bf16 v[28:31], a[148:151], v[8:11], v[28:31]
    v_exp_f32 v69, v69
    v_cvt_pk_bf16_f32 v139, v46, v47
    v_mfma_f32_16x16x32_bf16 v[28:31], a[152:155], v[16:19], v[28:31]
    buffer_load_dwordx4 v251, s[4:7], s23 offen offset:0  lds
    v_exp_f32 v70, v70
    v_mfma_f32_16x16x32_bf16 v[28:31], a[156:159], v[24:27], v[28:31]
    v_exp_f32 v71, v71
    v_cvt_pk_bf16_f32 v144, v68, v69
    v_mfma_f32_16x16x32_bf16 v[60:63], a[156:159], v[56:59], v[196:199]
    v_exp_f32 v76, v76
    v_mfma_f32_16x16x32_bf16 v[60:63], a[152:155], v[48:51], v[60:63]
    v_exp_f32 v77, v77
    v_cvt_pk_bf16_f32 v145, v70, v71
    v_mfma_f32_16x16x32_bf16 v[60:63], a[148:151], v[40:43], v[60:63]
    buffer_load_dwordx4 v252, s[4:7], s23 offen offset:1024  lds
    v_exp_f32 v78, v78
    v_mfma_f32_16x16x32_bf16 v[60:63], a[144:147], v[32:35], v[60:63]
    v_exp_f32 v79, v79
    v_cvt_pk_bf16_f32 v146, v76, v77
    v_mfma_f32_16x16x32_bf16 v[92:95], a[144:147], v[64:67], v[200:203]
    v_exp_f32 v100, v100
    v_mfma_f32_16x16x32_bf16 v[92:95], a[148:151], v[72:75], v[92:95]
    v_exp_f32 v101, v101
    v_cvt_pk_bf16_f32 v147, v78, v79
    v_mfma_f32_16x16x32_bf16 v[92:95], a[152:155], v[80:83], v[92:95]
    buffer_load_dwordx4 v251, s[4:7], s23 offen offset:2048  lds
    v_exp_f32 v102, v102
    v_mfma_f32_16x16x32_bf16 v[92:95], a[156:159], v[88:91], v[92:95]
    v_exp_f32 v103, v103
    v_cvt_pk_bf16_f32 v152, v100, v101
    v_mfma_f32_16x16x32_bf16 v[124:127], a[156:159], v[120:123], v[204:207]
    v_exp_f32 v108, v108
    v_mfma_f32_16x16x32_bf16 v[124:127], a[152:155], v[112:115], v[124:127]
    v_exp_f32 v109, v109
    v_cvt_pk_bf16_f32 v153, v102, v103
    v_mfma_f32_16x16x32_bf16 v[124:127], a[148:151], v[104:107], v[124:127]
    buffer_load_dwordx4 v252, s[4:7], s23 offen offset:3072  lds
    v_exp_f32 v110, v110
    v_mfma_f32_16x16x32_bf16 v[124:127], a[144:147], v[96:99], v[124:127]
    s_add_u32 s23, s23, 0x4000
    v_exp_f32 v111, v111
    v_cvt_pk_bf16_f32 v154, v108, v109
    s_waitcnt lgkmcnt(0)
    v_cvt_pk_bf16_f32 v155, v110, v111
    v_mfma_f32_16x16x32_bf16 v[4:7], a[160:163], v[0:3], v[192:195]
    ds_read_b128 a[128:131], v208 offset:8192
    v_exp_f32 v20, v20
    v_mfma_f32_16x16x32_bf16 v[4:7], a[164:167], v[8:11], v[4:7]
    v_exp_f32 v21, v21
    v_mfma_f32_16x16x32_bf16 v[4:7], a[168:171], v[16:19], v[4:7]
    ds_read_b128 a[132:135], v209 offset:8192
    v_exp_f32 v22, v22
    v_mfma_f32_16x16x32_bf16 v[4:7], a[172:175], v[24:27], v[4:7]
    v_exp_f32 v23, v23
    v_cvt_pk_bf16_f32 v132, v20, v21
    v_mfma_f32_16x16x32_bf16 v[36:39], a[172:175], v[56:59], v[196:199]
    ds_read_b128 a[136:139], v210 offset:8192
    v_exp_f32 v28, v28
    v_mfma_f32_16x16x32_bf16 v[36:39], a[168:171], v[48:51], v[36:39]
    v_exp_f32 v29, v29
    v_cvt_pk_bf16_f32 v133, v22, v23
    v_mfma_f32_16x16x32_bf16 v[36:39], a[164:167], v[40:43], v[36:39]
    ds_read_b128 a[140:143], v211 offset:8192
    v_exp_f32 v30, v30
    v_mfma_f32_16x16x32_bf16 v[36:39], a[160:163], v[32:35], v[36:39]
    v_exp_f32 v31, v31
    v_cvt_pk_bf16_f32 v134, v28, v29
    v_mfma_f32_16x16x32_bf16 v[68:71], a[160:163], v[64:67], v[200:203]
    ds_read_b128 a[144:147], v208 offset:12288
    v_exp_f32 v52, v52
    v_mfma_f32_16x16x32_bf16 v[68:71], a[164:167], v[72:75], v[68:71]
    v_exp_f32 v53, v53
    v_cvt_pk_bf16_f32 v135, v30, v31
    v_mfma_f32_16x16x32_bf16 v[68:71], a[168:171], v[80:83], v[68:71]
    ds_read_b128 a[148:151], v209 offset:12288
    v_exp_f32 v54, v54
    v_mfma_f32_16x16x32_bf16 v[68:71], a[172:175], v[88:91], v[68:71]
    v_exp_f32 v55, v55
    v_cvt_pk_bf16_f32 v140, v52, v53
    v_mfma_f32_16x16x32_bf16 v[100:103], a[172:175], v[120:123], v[204:207]
    ds_read_b128 a[152:155], v210 offset:12288
    v_exp_f32 v60, v60
    v_mfma_f32_16x16x32_bf16 v[100:103], a[168:171], v[112:115], v[100:103]
    v_exp_f32 v61, v61
    v_cvt_pk_bf16_f32 v141, v54, v55
    v_mfma_f32_16x16x32_bf16 v[100:103], a[164:167], v[104:107], v[100:103]
    ds_read_b128 a[156:159], v211 offset:12288
    v_exp_f32 v62, v62
    v_mfma_f32_16x16x32_bf16 v[100:103], a[160:163], v[96:99], v[100:103]
    v_exp_f32 v63, v63
    v_cvt_pk_bf16_f32 v142, v60, v61
    v_mfma_f32_16x16x32_bf16 v[12:15], a[176:179], v[0:3], v[192:195]
    s_add_u32 m0, s26, 49152
    v_exp_f32 v84, v84
    v_mfma_f32_16x16x32_bf16 v[12:15], a[180:183], v[8:11], v[12:15]
    v_exp_f32 v85, v85
    v_cvt_pk_bf16_f32 v143, v62, v63
    v_mfma_f32_16x16x32_bf16 v[12:15], a[184:187], v[16:19], v[12:15]
    buffer_load_dwordx4 v251, s[8:11], s24 offen offset:0  lds
    v_exp_f32 v86, v86
    v_mfma_f32_16x16x32_bf16 v[12:15], a[188:191], v[24:27], v[12:15]
    v_exp_f32 v87, v87
    v_cvt_pk_bf16_f32 v148, v84, v85
    v_mfma_f32_16x16x32_bf16 v[44:47], a[188:191], v[56:59], v[196:199]
    v_exp_f32 v92, v92
    v_mfma_f32_16x16x32_bf16 v[44:47], a[184:187], v[48:51], v[44:47]
    v_exp_f32 v93, v93
    v_cvt_pk_bf16_f32 v149, v86, v87
    v_mfma_f32_16x16x32_bf16 v[44:47], a[180:183], v[40:43], v[44:47]
    buffer_load_dwordx4 v252, s[8:11], s24 offen offset:1024  lds
    v_exp_f32 v94, v94
    v_mfma_f32_16x16x32_bf16 v[44:47], a[176:179], v[32:35], v[44:47]
    v_exp_f32 v95, v95
    v_cvt_pk_bf16_f32 v150, v92, v93
    v_mfma_f32_16x16x32_bf16 v[76:79], a[176:179], v[64:67], v[200:203]
    v_exp_f32 v116, v116
    v_mfma_f32_16x16x32_bf16 v[76:79], a[180:183], v[72:75], v[76:79]
    v_exp_f32 v117, v117
    v_cvt_pk_bf16_f32 v151, v94, v95
    v_mfma_f32_16x16x32_bf16 v[76:79], a[184:187], v[80:83], v[76:79]
    buffer_load_dwordx4 v251, s[8:11], s24 offen offset:2048  lds
    v_exp_f32 v118, v118
    v_mfma_f32_16x16x32_bf16 v[76:79], a[188:191], v[88:91], v[76:79]
    v_exp_f32 v119, v119
    v_cvt_pk_bf16_f32 v156, v116, v117
    v_mfma_f32_16x16x32_bf16 v[108:111], a[188:191], v[120:123], v[204:207]
    v_exp_f32 v124, v124
    v_mfma_f32_16x16x32_bf16 v[108:111], a[184:187], v[112:115], v[108:111]
    v_exp_f32 v125, v125
    v_cvt_pk_bf16_f32 v157, v118, v119
    v_mfma_f32_16x16x32_bf16 v[108:111], a[180:183], v[104:107], v[108:111]
    buffer_load_dwordx4 v252, s[8:11], s24 offen offset:3072  lds
    v_exp_f32 v126, v126
    v_mfma_f32_16x16x32_bf16 v[108:111], a[176:179], v[96:99], v[108:111]
    s_add_u32 s24, s24, 0x4000
    v_exp_f32 v127, v127
    v_cvt_pk_bf16_f32 v158, v124, v125
    s_waitcnt vmcnt(16) lgkmcnt(0)
    v_cvt_pk_bf16_f32 v159, v126, v127
    s_barrier
    v_mfma_f32_16x16x32_bf16 v[20:23], a[128:131], v[0:3], v[192:195]
    v_exp_f32 v4, v4
    v_mfma_f32_16x16x32_bf16 v[20:23], a[132:135], v[8:11], v[20:23]
    ds_read_b64_tr_b16 a[160:161], v212 offset:49152
    ds_read_b64_tr_b16 a[162:163], v212 offset:53248
    v_mfma_f32_16x16x32_bf16 v[20:23], a[136:139], v[16:19], v[20:23]
    v_exp_f32 v5, v5
    v_mfma_f32_16x16x32_bf16 v[20:23], a[140:143], v[24:27], v[20:23]
    ds_read_b64_tr_b16 a[164:165], v212 offset:57344
    ds_read_b64_tr_b16 a[166:167], v212 offset:61440
    v_mfma_f32_16x16x32_bf16 v[52:55], a[140:143], v[56:59], v[196:199]
    v_exp_f32 v6, v6
    v_mfma_f32_16x16x32_bf16 v[52:55], a[136:139], v[48:51], v[52:55]
    ds_read_b64_tr_b16 a[168:169], v213 offset:49152
    v_cvt_pk_bf16_f32 v160, v4, v5
    v_mfma_f32_16x16x32_bf16 v[52:55], a[132:135], v[40:43], v[52:55]
    v_exp_f32 v7, v7
    v_mfma_f32_16x16x32_bf16 v[52:55], a[128:131], v[32:35], v[52:55]
    ds_read_b64_tr_b16 a[170:171], v213 offset:53248
    ds_read_b64_tr_b16 a[172:173], v213 offset:57344
    v_mfma_f32_16x16x32_bf16 v[84:87], a[128:131], v[64:67], v[200:203]
    v_exp_f32 v12, v12
    v_mfma_f32_16x16x32_bf16 v[84:87], a[132:135], v[72:75], v[84:87]
    ds_read_b64_tr_b16 a[174:175], v213 offset:61440
    v_cvt_pk_bf16_f32 v161, v6, v7
    v_mfma_f32_16x16x32_bf16 v[84:87], a[136:139], v[80:83], v[84:87]
    v_exp_f32 v13, v13
    v_mfma_f32_16x16x32_bf16 v[84:87], a[140:143], v[88:91], v[84:87]
    ds_read_b64_tr_b16 a[176:177], v214 offset:49152
    ds_read_b64_tr_b16 a[178:179], v214 offset:53248
    v_mfma_f32_16x16x32_bf16 v[116:119], a[140:143], v[120:123], v[204:207]
    v_exp_f32 v14, v14
    v_mfma_f32_16x16x32_bf16 v[116:119], a[136:139], v[112:115], v[116:119]
    ds_read_b64_tr_b16 a[180:181], v214 offset:57344
    v_cvt_pk_bf16_f32 v162, v12, v13
    v_mfma_f32_16x16x32_bf16 v[116:119], a[132:135], v[104:107], v[116:119]
    v_exp_f32 v15, v15
    v_mfma_f32_16x16x32_bf16 v[116:119], a[128:131], v[96:99], v[116:119]
    ds_read_b64_tr_b16 a[182:183], v214 offset:61440
    ds_read_b64_tr_b16 a[184:185], v215 offset:49152
    v_mfma_f32_16x16x32_bf16 v[28:31], a[144:147], v[0:3], v[192:195]
    v_exp_f32 v36, v36
    v_mfma_f32_16x16x32_bf16 v[28:31], a[148:151], v[8:11], v[28:31]
    ds_read_b64_tr_b16 a[186:187], v215 offset:53248
    v_cvt_pk_bf16_f32 v163, v14, v15
    v_mfma_f32_16x16x32_bf16 v[28:31], a[152:155], v[16:19], v[28:31]
    v_exp_f32 v37, v37
    v_mfma_f32_16x16x32_bf16 v[28:31], a[156:159], v[24:27], v[28:31]
    ds_read_b64_tr_b16 a[188:189], v215 offset:57344
    ds_read_b64_tr_b16 a[190:191], v215 offset:61440
    v_mfma_f32_16x16x32_bf16 v[60:63], a[156:159], v[56:59], v[196:199]
    v_exp_f32 v38, v38
    v_mfma_f32_16x16x32_bf16 v[60:63], a[152:155], v[48:51], v[60:63]
    s_add_u32 m0, s25, 0
    v_cvt_pk_bf16_f32 v168, v36, v37
    v_mfma_f32_16x16x32_bf16 v[60:63], a[148:151], v[40:43], v[60:63]
    v_exp_f32 v39, v39
    v_mfma_f32_16x16x32_bf16 v[60:63], a[144:147], v[32:35], v[60:63]
    buffer_load_dwordx4 v251, s[4:7], s23 offen offset:0  lds
    v_mfma_f32_16x16x32_bf16 v[92:95], a[144:147], v[64:67], v[200:203]
    v_exp_f32 v44, v44
    v_mfma_f32_16x16x32_bf16 v[92:95], a[148:151], v[72:75], v[92:95]
    v_cvt_pk_bf16_f32 v169, v38, v39
    v_mfma_f32_16x16x32_bf16 v[92:95], a[152:155], v[80:83], v[92:95]
    v_exp_f32 v45, v45
    v_mfma_f32_16x16x32_bf16 v[92:95], a[156:159], v[88:91], v[92:95]
    buffer_load_dwordx4 v252, s[4:7], s23 offen offset:1024  lds
    v_mfma_f32_16x16x32_bf16 v[124:127], a[156:159], v[120:123], v[204:207]
    v_exp_f32 v46, v46
    v_mfma_f32_16x16x32_bf16 v[124:127], a[152:155], v[112:115], v[124:127]
    v_cvt_pk_bf16_f32 v170, v44, v45
    v_mfma_f32_16x16x32_bf16 v[124:127], a[148:151], v[104:107], v[124:127]
    v_exp_f32 v47, v47
    v_mfma_f32_16x16x32_bf16 v[124:127], a[144:147], v[96:99], v[124:127]
    s_waitcnt lgkmcnt(0)
    v_mfma_f32_16x16x32_bf16 a[0:3], a[160:163], v[128:131], 0
    v_exp_f32 v68, v68
    v_mfma_f32_16x16x32_bf16 a[0:3], a[164:167], v[132:135], a[0:3]
    ds_read_b128 a[128:131], v208 offset:32768
    v_cvt_pk_bf16_f32 v171, v46, v47
    v_mfma_f32_16x16x32_bf16 a[4:7], a[164:167], v[140:143], 0
    v_exp_f32 v69, v69
    v_mfma_f32_16x16x32_bf16 a[4:7], a[160:163], v[136:139], a[4:7]
    ds_read_b128 a[132:135], v209 offset:32768
    ds_read_b128 a[136:139], v210 offset:32768
    v_mfma_f32_16x16x32_bf16 a[8:11], a[160:163], v[144:147], 0
    v_exp_f32 v70, v70
    v_mfma_f32_16x16x32_bf16 a[8:11], a[164:167], v[148:151], a[8:11]
    ds_read_b128 a[140:143], v211 offset:32768
    v_cvt_pk_bf16_f32 v176, v68, v69
    v_mfma_f32_16x16x32_bf16 a[12:15], a[164:167], v[156:159], 0
    v_exp_f32 v71, v71
    v_mfma_f32_16x16x32_bf16 a[12:15], a[160:163], v[152:155], a[12:15]
    ds_read_b128 a[144:147], v208 offset:36864
    ds_read_b128 a[148:151], v209 offset:36864
    v_mfma_f32_16x16x32_bf16 a[28:31], a[168:171], v[152:155], 0
    v_exp_f32 v76, v76
    v_mfma_f32_16x16x32_bf16 a[28:31], a[172:175], v[156:159], a[28:31]
    ds_read_b128 a[152:155], v210 offset:36864
    v_cvt_pk_bf16_f32 v177, v70, v71
    v_mfma_f32_16x16x32_bf16 a[24:27], a[172:175], v[148:151], 0
    v_exp_f32 v77, v77
    v_mfma_f32_16x16x32_bf16 a[24:27], a[168:171], v[144:147], a[24:27]
    ds_read_b128 a[156:159], v211 offset:36864
    v_mfma_f32_16x16x32_bf16 a[20:23], a[168:171], v[136:139], 0
    v_exp_f32 v78, v78
    v_mfma_f32_16x16x32_bf16 a[20:23], a[172:175], v[140:143], a[20:23]
    v_cvt_pk_bf16_f32 v178, v76, v77
    v_mfma_f32_16x16x32_bf16 a[16:19], a[172:175], v[132:135], 0
    v_exp_f32 v79, v79
    v_mfma_f32_16x16x32_bf16 a[16:19], a[168:171], v[128:131], a[16:19]
    buffer_load_dwordx4 v251, s[4:7], s23 offen offset:2048  lds
    v_mfma_f32_16x16x32_bf16 a[32:35], a[176:179], v[128:131], 0
    v_exp_f32 v100, v100
    v_mfma_f32_16x16x32_bf16 a[32:35], a[180:183], v[132:135], a[32:35]
    v_cvt_pk_bf16_f32 v179, v78, v79
    v_mfma_f32_16x16x32_bf16 a[36:39], a[180:183], v[140:143], 0
    v_exp_f32 v101, v101
    v_mfma_f32_16x16x32_bf16 a[36:39], a[176:179], v[136:139], a[36:39]
    buffer_load_dwordx4 v252, s[4:7], s23 offen offset:3072  lds
    v_mfma_f32_16x16x32_bf16 a[40:43], a[176:179], v[144:147], 0
    v_exp_f32 v102, v102
    v_mfma_f32_16x16x32_bf16 a[40:43], a[180:183], v[148:151], a[40:43]
    s_add_u32 s23, s23, 0x4000
    v_cvt_pk_bf16_f32 v184, v100, v101
    v_mfma_f32_16x16x32_bf16 a[44:47], a[180:183], v[156:159], 0
    v_exp_f32 v103, v103
    v_mfma_f32_16x16x32_bf16 a[44:47], a[176:179], v[152:155], a[44:47]
    v_mfma_f32_16x16x32_bf16 a[60:63], a[184:187], v[152:155], 0
    v_exp_f32 v108, v108
    v_mfma_f32_16x16x32_bf16 a[60:63], a[188:191], v[156:159], a[60:63]
    v_cvt_pk_bf16_f32 v185, v102, v103
    v_mfma_f32_16x16x32_bf16 a[56:59], a[188:191], v[148:151], 0
    v_exp_f32 v109, v109
    v_mfma_f32_16x16x32_bf16 a[56:59], a[184:187], v[144:147], a[56:59]
    v_mfma_f32_16x16x32_bf16 a[52:55], a[184:187], v[136:139], 0
    v_exp_f32 v110, v110
    v_mfma_f32_16x16x32_bf16 a[52:55], a[188:191], v[140:143], a[52:55]
    v_cvt_pk_bf16_f32 v186, v108, v109
    v_mfma_f32_16x16x32_bf16 a[48:51], a[188:191], v[132:135], 0
    v_exp_f32 v111, v111
    v_mfma_f32_16x16x32_bf16 a[48:51], a[184:187], v[128:131], a[48:51]
    v_smfmac_f32_16x16x64_bf16 a[208:211], a[192:195], v[128:135], v243
    s_waitcnt lgkmcnt(0)
    v_cvt_pk_bf16_f32 v187, v110, v111
    v_smfmac_f32_16x16x64_bf16 a[208:211], a[196:199], v[136:143], v243
    v_mov_b32 v220, 0
    s_lshl_b32 s3, s22, 2
    s_add_u32 s3, s3, 140288
    v_mov_b32 v221, s3
    v_bfe_u32 v222, v249, 2, 4
    v_add_u32 v222, 140288, v222
    ds_write_b32 v221, v220
    v_mfma_f32_16x16x32_bf16 v[4:7], a[128:131], v[0:3], v[192:195]
    v_exp_f32 v20, v20
    v_mfma_f32_16x16x32_bf16 v[4:7], a[132:135], v[8:11], v[4:7]
    ds_read_b64_tr_b16 a[160:161], v216 offset:49152
    ds_read_b64_tr_b16 a[162:163], v216 offset:53248
    v_mfma_f32_16x16x32_bf16 v[4:7], a[136:139], v[16:19], v[4:7]
    v_exp_f32 v21, v21
    v_mfma_f32_16x16x32_bf16 v[4:7], a[140:143], v[24:27], v[4:7]
    ds_read_b64_tr_b16 a[164:165], v216 offset:57344
    ds_read_b64_tr_b16 a[166:167], v216 offset:61440
    v_mfma_f32_16x16x32_bf16 v[36:39], a[140:143], v[56:59], v[196:199]
    v_exp_f32 v22, v22
    v_mfma_f32_16x16x32_bf16 v[36:39], a[136:139], v[48:51], v[36:39]
    ds_read_b64_tr_b16 a[168:169], v217 offset:49152
    v_cvt_pk_bf16_f32 v164, v20, v21
    v_mfma_f32_16x16x32_bf16 v[36:39], a[132:135], v[40:43], v[36:39]
    v_exp_f32 v23, v23
    v_mfma_f32_16x16x32_bf16 v[36:39], a[128:131], v[32:35], v[36:39]
    ds_read_b64_tr_b16 a[170:171], v217 offset:53248
    ds_read_b64_tr_b16 a[172:173], v217 offset:57344
    v_mfma_f32_16x16x32_bf16 v[68:71], a[128:131], v[64:67], v[200:203]
    v_exp_f32 v28, v28
    v_mfma_f32_16x16x32_bf16 v[68:71], a[132:135], v[72:75], v[68:71]
    ds_read_b64_tr_b16 a[174:175], v217 offset:61440
    v_cvt_pk_bf16_f32 v165, v22, v23
    v_mfma_f32_16x16x32_bf16 v[68:71], a[136:139], v[80:83], v[68:71]
    v_exp_f32 v29, v29
    v_mfma_f32_16x16x32_bf16 v[68:71], a[140:143], v[88:91], v[68:71]
    ds_read_b64_tr_b16 a[176:177], v218 offset:49152
    ds_read_b64_tr_b16 a[178:179], v218 offset:53248
    v_mfma_f32_16x16x32_bf16 v[100:103], a[140:143], v[120:123], v[204:207]
    v_exp_f32 v30, v30
    v_mfma_f32_16x16x32_bf16 v[100:103], a[136:139], v[112:115], v[100:103]
HOP0_4:
    s_cbranch_execz HOP0_7
    ds_read_b64_tr_b16 a[180:181], v218 offset:57344
    v_cvt_pk_bf16_f32 v166, v28, v29
    v_mfma_f32_16x16x32_bf16 v[100:103], a[132:135], v[104:107], v[100:103]
    v_exp_f32 v31, v31
    v_mfma_f32_16x16x32_bf16 v[100:103], a[128:131], v[96:99], v[100:103]
    ds_read_b64_tr_b16 a[182:183], v218 offset:61440
    ds_read_b64_tr_b16 a[184:185], v219 offset:49152
    v_mfma_f32_16x16x32_bf16 v[12:15], a[144:147], v[0:3], v[192:195]
    v_exp_f32 v52, v52
    v_mfma_f32_16x16x32_bf16 v[12:15], a[148:151], v[8:11], v[12:15]
    ds_read_b64_tr_b16 a[186:187], v219 offset:53248
    v_cvt_pk_bf16_f32 v167, v30, v31
    v_mfma_f32_16x16x32_bf16 v[12:15], a[152:155], v[16:19], v[12:15]
    v_exp_f32 v53, v53
    v_mfma_f32_16x16x32_bf16 v[12:15], a[156:159], v[24:27], v[12:15]
    ds_read_b64_tr_b16 a[188:189], v219 offset:57344
    ds_read_b64_tr_b16 a[190:191], v219 offset:61440
    v_mfma_f32_16x16x32_bf16 v[44:47], a[156:159], v[56:59], v[196:199]
    v_exp_f32 v54, v54
    v_mfma_f32_16x16x32_bf16 v[44:47], a[152:155], v[48:51], v[44:47]
    s_add_u32 m0, s25, 16384
    v_cvt_pk_bf16_f32 v172, v52, v53
    v_mfma_f32_16x16x32_bf16 v[44:47], a[148:151], v[40:43], v[44:47]
    v_exp_f32 v55, v55
    v_mfma_f32_16x16x32_bf16 v[44:47], a[144:147], v[32:35], v[44:47]
    buffer_load_dwordx4 v251, s[8:11], s24 offen offset:0  lds
    v_mfma_f32_16x16x32_bf16 v[76:79], a[144:147], v[64:67], v[200:203]
    v_exp_f32 v60, v60
    v_mfma_f32_16x16x32_bf16 v[76:79], a[148:151], v[72:75], v[76:79]
    v_cvt_pk_bf16_f32 v173, v54, v55
    v_mfma_f32_16x16x32_bf16 v[76:79], a[152:155], v[80:83], v[76:79]
    v_exp_f32 v61, v61
    v_mfma_f32_16x16x32_bf16 v[76:79], a[156:159], v[88:91], v[76:79]
    buffer_load_dwordx4 v252, s[8:11], s24 offen offset:1024  lds
    v_mfma_f32_16x16x32_bf16 v[108:111], a[156:159], v[120:123], v[204:207]
    v_exp_f32 v62, v62
    v_mfma_f32_16x16x32_bf16 v[108:111], a[152:155], v[112:115], v[108:111]
    v_cvt_pk_bf16_f32 v174, v60, v61
    v_mfma_f32_16x16x32_bf16 v[108:111], a[148:151], v[104:107], v[108:111]
    v_exp_f32 v63, v63
    v_mfma_f32_16x16x32_bf16 v[108:111], a[144:147], v[96:99], v[108:111]
    s_waitcnt lgkmcnt(0)
    v_xor_b32 v212, 0x10000, v212
    v_xor_b32 v213, 0x10000, v213
    v_mfma_f32_16x16x32_bf16 a[64:67], a[160:163], v[128:131], 0
    v_exp_f32 v84, v84
    v_mfma_f32_16x16x32_bf16 a[64:67], a[164:167], v[132:135], a[64:67]
    ds_read_b128 a[128:131], v208 offset:40960
    v_cvt_pk_bf16_f32 v175, v62, v63
    v_mfma_f32_16x16x32_bf16 a[68:71], a[164:167], v[140:143], 0
    v_exp_f32 v85, v85
    v_mfma_f32_16x16x32_bf16 a[68:71], a[160:163], v[136:139], a[68:71]
    ds_read_b128 a[132:135], v209 offset:40960
    ds_read_b128 a[136:139], v210 offset:40960
    v_mfma_f32_16x16x32_bf16 a[72:75], a[160:163], v[144:147], 0
    v_exp_f32 v86, v86
    v_mfma_f32_16x16x32_bf16 a[72:75], a[164:167], v[148:151], a[72:75]
    ds_read_b128 a[140:143], v211 offset:40960
    v_cvt_pk_bf16_f32 v180, v84, v85
    v_mfma_f32_16x16x32_bf16 a[76:79], a[164:167], v[156:159], 0
    v_exp_f32 v87, v87
    v_mfma_f32_16x16x32_bf16 a[76:79], a[160:163], v[152:155], a[76:79]
    ds_read_b128 a[144:147], v208 offset:45056
    ds_read_b128 a[148:151], v209 offset:45056
    v_mfma_f32_16x16x32_bf16 a[92:95], a[168:171], v[152:155], 0
    v_exp_f32 v92, v92
    v_mfma_f32_16x16x32_bf16 a[92:95], a[172:175], v[156:159], a[92:95]
    ds_read_b128 a[152:155], v210 offset:45056
    v_cvt_pk_bf16_f32 v181, v86, v87
    v_mfma_f32_16x16x32_bf16 a[88:91], a[172:175], v[148:151], 0
    v_exp_f32 v93, v93
    v_mfma_f32_16x16x32_bf16 a[88:91], a[168:171], v[144:147], a[88:91]
    ds_read_b128 a[156:159], v211 offset:45056
    v_mfma_f32_16x16x32_bf16 a[84:87], a[168:171], v[136:139], 0
    v_exp_f32 v94, v94
    v_mfma_f32_16x16x32_bf16 a[84:87], a[172:175], v[140:143], a[84:87]
    v_cvt_pk_bf16_f32 v182, v92, v93
    v_xor_b32 v214, 0x10000, v214
    v_mfma_f32_16x16x32_bf16 a[80:83], a[172:175], v[132:135], 0
    v_exp_f32 v95, v95
    v_mfma_f32_16x16x32_bf16 a[80:83], a[168:171], v[128:131], a[80:83]
    buffer_load_dwordx4 v251, s[8:11], s24 offen offset:2048  lds
    v_mfma_f32_16x16x32_bf16 a[96:99], a[176:179], v[128:131], 0
    v_exp_f32 v116, v116
    v_mfma_f32_16x16x32_bf16 a[96:99], a[180:183], v[132:135], a[96:99]
    v_cvt_pk_bf16_f32 v183, v94, v95
    v_xor_b32 v215, 0x10000, v215
    v_mfma_f32_16x16x32_bf16 a[100:103], a[180:183], v[140:143], 0
    v_exp_f32 v117, v117
    v_mfma_f32_16x16x32_bf16 a[100:103], a[176:179], v[136:139], a[100:103]
    buffer_load_dwordx4 v252, s[8:11], s24 offen offset:3072  lds
    v_mfma_f32_16x16x32_bf16 a[104:107], a[176:179], v[144:147], 0
    v_exp_f32 v118, v118
    v_mfma_f32_16x16x32_bf16 a[104:107], a[180:183], v[148:151], a[104:107]
    s_add_u32 s24, s24, 0x4000
    v_cvt_pk_bf16_f32 v188, v116, v117
    v_xor_b32 v216, 0x10000, v216
    v_mfma_f32_16x16x32_bf16 a[108:111], a[180:183], v[156:159], 0
    v_exp_f32 v119, v119
    v_mfma_f32_16x16x32_bf16 a[108:111], a[176:179], v[152:155], a[108:111]
    v_xor_b32 v217, 0x10000, v217
    v_xor_b32 v218, 0x10000, v218
    v_mfma_f32_16x16x32_bf16 a[124:127], a[184:187], v[152:155], 0
    v_exp_f32 v124, v124
    v_mfma_f32_16x16x32_bf16 a[124:127], a[188:191], v[156:159], a[124:127]
    v_cvt_pk_bf16_f32 v189, v118, v119
    v_xor_b32 v219, 0x10000, v219
    v_mfma_f32_16x16x32_bf16 a[120:123], a[188:191], v[148:151], 0
    s_xor_b32 s25, s25, 0x10000
    v_exp_f32 v125, v125
    v_mfma_f32_16x16x32_bf16 a[120:123], a[184:187], v[144:147], a[120:123]
    s_xor_b32 s26, s26, 0x10000
    v_xor_b32 v208, 0x10000, v208
    v_xor_b32 v209, 0x10000, v209
    v_mfma_f32_16x16x32_bf16 a[116:119], a[184:187], v[136:139], 0
    v_exp_f32 v126, v126
    v_mfma_f32_16x16x32_bf16 a[116:119], a[188:191], v[140:143], a[116:119]
    v_cvt_pk_bf16_f32 v190, v124, v125
    v_xor_b32 v210, 0x10000, v210
    v_mfma_f32_16x16x32_bf16 a[112:115], a[188:191], v[132:135], 0
    s_mov_b32 s27, 14
    v_exp_f32 v127, v127
    v_mfma_f32_16x16x32_bf16 a[112:115], a[184:187], v[128:131], a[112:115]
    v_xor_b32 v211, 0x10000, v211
    v_smfmac_f32_16x16x64_bf16 a[208:211], a[200:203], v[144:151], v243
    s_waitcnt vmcnt(8) lgkmcnt(0)
    v_cvt_pk_bf16_f32 v191, v126, v127
    v_smfmac_f32_16x16x64_bf16 a[208:211], a[204:207], v[152:159], v243
    s_barrier
K1_loop:
    v_mfma_f32_16x16x32_bf16 v[20:23], a[128:131], v[0:3], v[192:195]
    v_exp_f32 v4, v4
    v_mfma_f32_16x16x32_bf16 v[20:23], a[132:135], v[8:11], v[20:23]
    ds_read_b64_tr_b16 v[244:245], v254 offset:0
    ds_read_b64_tr_b16 v[246:247], v254 offset:512
    v_mfma_f32_16x16x32_bf16 v[20:23], a[136:139], v[16:19], v[20:23]
    s_cmp_eq_u32 s27, 6
    v_exp_f32 v5, v5
    v_mfma_f32_16x16x32_bf16 v[20:23], a[140:143], v[24:27], v[20:23]
    s_cselect_b32 s12, s46, s12
    ds_read_b64_tr_b16 a[160:161], v212 offset:16384
    ds_read_b64_tr_b16 a[162:163], v212 offset:20480
    v_mfma_f32_16x16x32_bf16 v[52:55], a[140:143], v[56:59], v[196:199]
    s_cselect_b32 s13, s47, s13
    v_exp_f32 v6, v6
    v_mfma_f32_16x16x32_bf16 v[52:55], a[136:139], v[48:51], v[52:55]
    s_cselect_b32 s14, 2211840, s14
    ds_read_b64_tr_b16 a[164:165], v212 offset:24576
    v_cvt_pk_bf16_f32 v128, v4, v5
    v_mfma_f32_16x16x32_bf16 v[52:55], a[132:135], v[40:43], v[52:55]
    s_cselect_b32 s100, s48, s100
    v_exp_f32 v7, v7
    v_mfma_f32_16x16x32_bf16 v[52:55], a[128:131], v[32:35], v[52:55]
    s_cmp_lt_u32 s27, 6
    ds_read_b64_tr_b16 a[166:167], v212 offset:28672
    ds_read_b64_tr_b16 a[168:169], v213 offset:16384
    v_mfma_f32_16x16x32_bf16 v[84:87], a[128:131], v[64:67], v[200:203]
    s_cselect_b32 s14, 0, s14
    v_exp_f32 v12, v12
    v_mfma_f32_16x16x32_bf16 v[84:87], a[132:135], v[72:75], v[84:87]
    s_sub_u32 s49, s27, 6
    ds_read_b64_tr_b16 a[170:171], v213 offset:20480
    v_cvt_pk_bf16_f32 v129, v6, v7
    v_mfma_f32_16x16x32_bf16 v[84:87], a[136:139], v[80:83], v[84:87]
    s_cmp_lt_u32 s49, 8
    v_exp_f32 v13, v13
    v_mfma_f32_16x16x32_bf16 v[84:87], a[140:143], v[88:91], v[84:87]
    s_cselect_b32 s49, s101, 0x7f000000
    ds_read_b64_tr_b16 a[172:173], v213 offset:24576
    ds_read_b64_tr_b16 a[174:175], v213 offset:28672
    v_mfma_f32_16x16x32_bf16 v[116:119], a[140:143], v[120:123], v[204:207]
    s_add_u32 s101, s101, 1024
    v_exp_f32 v14, v14
    v_mfma_f32_16x16x32_bf16 v[116:119], a[136:139], v[112:115], v[116:119]
    s_lshr_b32 s3, s37, 2
    ds_read_b64_tr_b16 a[176:177], v214 offset:16384
    v_cvt_pk_bf16_f32 v130, v12, v13
    v_mfma_f32_16x16x32_bf16 v[116:119], a[132:135], v[104:107], v[116:119]
    s_add_u32 m0, s3, 136192
    v_exp_f32 v15, v15
    v_mfma_f32_16x16x32_bf16 v[116:119], a[128:131], v[96:99], v[116:119]
    ds_read_b64_tr_b16 a[178:179], v214 offset:20480
    ds_read_b64_tr_b16 a[180:181], v214 offset:24576
    v_mfma_f32_16x16x32_bf16 v[28:31], a[144:147], v[0:3], v[192:195]
    v_exp_f32 v36, v36
    v_mfma_f32_16x16x32_bf16 v[28:31], a[148:151], v[8:11], v[28:31]
    ds_read_b64_tr_b16 a[182:183], v214 offset:28672
    v_cvt_pk_bf16_f32 v131, v14, v15
    v_mfma_f32_16x16x32_bf16 v[28:31], a[152:155], v[16:19], v[28:31]
    v_exp_f32 v37, v37
    v_mfma_f32_16x16x32_bf16 v[28:31], a[156:159], v[24:27], v[28:31]
    ds_read_b64_tr_b16 a[184:185], v215 offset:16384
    ds_read_b64_tr_b16 a[186:187], v215 offset:20480
    v_mfma_f32_16x16x32_bf16 v[60:63], a[156:159], v[56:59], v[196:199]
    v_exp_f32 v38, v38
    v_mfma_f32_16x16x32_bf16 v[60:63], a[152:155], v[48:51], v[60:63]
    ds_read_b64_tr_b16 a[188:189], v215 offset:24576
    v_cvt_pk_bf16_f32 v136, v36, v37
    v_mfma_f32_16x16x32_bf16 v[60:63], a[148:151], v[40:43], v[60:63]
    s_waitcnt lgkmcnt(15)
    v_exp_f32 v39, v39
    v_mfma_f32_16x16x32_bf16 v[60:63], a[144:147], v[32:35], v[60:63]
    buffer_store_dwordx4 v[244:247], v249, s[16:19], s49 offen sc1
    v_mfma_f32_16x16x32_bf16 v[92:95], a[144:147], v[64:67], v[200:203]
    v_exp_f32 v44, v44
    v_mfma_f32_16x16x32_bf16 v[92:95], a[148:151], v[72:75], v[92:95]
    ds_read_b64_tr_b16 a[190:191], v215 offset:28672
    v_cvt_pk_bf16_f32 v137, v38, v39
    v_mfma_f32_16x16x32_bf16 v[92:95], a[152:155], v[80:83], v[92:95]
    v_exp_f32 v45, v45
    v_mfma_f32_16x16x32_bf16 v[92:95], a[156:159], v[88:91], v[92:95]
    buffer_load_dwordx4 v253, s[12:15], s100 offen lds
    v_mfma_f32_16x16x32_bf16 v[124:127], a[156:159], v[120:123], v[204:207]
    v_exp_f32 v46, v46
    v_mfma_f32_16x16x32_bf16 v[124:127], a[152:155], v[112:115], v[124:127]
    s_add_u32 s100, s100, 32
    v_cvt_pk_bf16_f32 v138, v44, v45
    v_mfma_f32_16x16x32_bf16 v[124:127], a[148:151], v[104:107], v[124:127]
    v_exp_f32 v47, v47
    v_mfma_f32_16x16x32_bf16 v[124:127], a[144:147], v[96:99], v[124:127]
    s_waitcnt lgkmcnt(0)
    ds_read_b32 v223, v222
    v_mfma_f32_16x16x32_bf16 a[0:3], a[160:163], v[160:163], a[0:3]
    v_exp_f32 v68, v68
    v_mfma_f32_16x16x32_bf16 a[0:3], a[164:167], v[164:167], a[0:3]
    ds_read_b128 a[128:131], v208 offset:0
    v_cvt_pk_bf16_f32 v139, v46, v47
    v_mfma_f32_16x16x32_bf16 a[4:7], a[164:167], v[172:175], a[4:7]
    v_exp_f32 v69, v69
    v_mfma_f32_16x16x32_bf16 a[4:7], a[160:163], v[168:171], a[4:7]
    ds_read_b128 a[132:135], v209 offset:0
    ds_read_b128 a[136:139], v210 offset:0
    v_mfma_f32_16x16x32_bf16 a[8:11], a[160:163], v[176:179], a[8:11]
    v_exp_f32 v70, v70
    v_mfma_f32_16x16x32_bf16 a[8:11], a[164:167], v[180:183], a[8:11]
    ds_read_b128 a[140:143], v211 offset:0
    v_cvt_pk_bf16_f32 v144, v68, v69
    v_mfma_f32_16x16x32_bf16 a[12:15], a[164:167], v[188:191], a[12:15]
    v_exp_f32 v71, v71
    v_mfma_f32_16x16x32_bf16 a[12:15], a[160:163], v[184:187], a[12:15]
    ds_read_b128 a[144:147], v208 offset:4096
    ds_read_b128 a[148:151], v209 offset:4096
    v_mfma_f32_16x16x32_bf16 a[28:31], a[168:171], v[184:187], a[28:31]
    v_exp_f32 v76, v76
    v_mfma_f32_16x16x32_bf16 a[28:31], a[172:175], v[188:191], a[28:31]
    ds_read_b128 a[152:155], v210 offset:4096
    v_cvt_pk_bf16_f32 v145, v70, v71
    v_mfma_f32_16x16x32_bf16 a[24:27], a[172:175], v[180:183], a[24:27]
    v_exp_f32 v77, v77
    v_mfma_f32_16x16x32_bf16 a[24:27], a[168:171], v[176:179], a[24:27]
    s_waitcnt lgkmcnt(7)
    ds_read_b128 a[156:159], v211 offset:4096
    v_cmp_gt_u32 vcc, v220, v223
    v_mfma_f32_16x16x32_bf16 a[20:23], a[168:171], v[168:171], a[20:23]
    v_exp_f32 v78, v78
    v_mfma_f32_16x16x32_bf16 a[20:23], a[172:175], v[172:175], a[20:23]
    s_add_u32 m0, s26, 32768
    v_cvt_pk_bf16_f32 v146, v76, v77
    v_mfma_f32_16x16x32_bf16 a[16:19], a[172:175], v[164:167], a[16:19]
    v_exp_f32 v79, v79
    v_mfma_f32_16x16x32_bf16 a[16:19], a[168:171], v[160:163], a[16:19]
    s_cbranch_vccnz K1_pg0
K1_pg0_ok:
    v_mfma_f32_16x16x32_bf16 a[32:35], a[176:179], v[160:163], a[32:35]
    v_exp_f32 v100, v100
    v_mfma_f32_16x16x32_bf16 a[32:35], a[180:183], v[164:167], a[32:35]
    v_cvt_pk_bf16_f32 v147, v78, v79
    v_mfma_f32_16x16x32_bf16 a[36:39], a[180:183], v[172:175], a[36:39]
    v_exp_f32 v101, v101
    v_mfma_f32_16x16x32_bf16 a[36:39], a[176:179], v[168:171], a[36:39]
    buffer_load_dwordx4 v251, s[4:7], s23 offen offset:0  lds
    v_mfma_f32_16x16x32_bf16 a[40:43], a[176:179], v[176:179], a[40:43]
    v_exp_f32 v102, v102
    v_mfma_f32_16x16x32_bf16 a[40:43], a[180:183], v[180:183], a[40:43]
    v_cvt_pk_bf16_f32 v152, v100, v101
    v_mfma_f32_16x16x32_bf16 a[44:47], a[180:183], v[188:191], a[44:47]
    v_exp_f32 v103, v103
    v_mfma_f32_16x16x32_bf16 a[44:47], a[176:179], v[184:187], a[44:47]
    buffer_load_dwordx4 v252, s[4:7], s23 offen offset:1024  lds
    v_mfma_f32_16x16x32_bf16 a[60:63], a[184:187], v[184:187], a[60:63]
    v_exp_f32 v108, v108
    v_mfma_f32_16x16x32_bf16 a[60:63], a[188:191], v[188:191], a[60:63]
    v_cvt_pk_bf16_f32 v153, v102, v103
    v_mfma_f32_16x16x32_bf16 a[56:59], a[188:191], v[180:183], a[56:59]
    v_exp_f32 v109, v109
    v_mfma_f32_16x16x32_bf16 a[56:59], a[184:187], v[176:179], a[56:59]
    buffer_load_dwordx4 v251, s[4:7], s23 offen offset:2048  lds
    v_mfma_f32_16x16x32_bf16 a[52:55], a[184:187], v[168:171], a[52:55]
    v_exp_f32 v110, v110
    v_mfma_f32_16x16x32_bf16 a[52:55], a[188:191], v[172:175], a[52:55]
    v_cvt_pk_bf16_f32 v154, v108, v109
    v_mfma_f32_16x16x32_bf16 a[48:51], a[188:191], v[164:167], a[48:51]
    v_exp_f32 v111, v111
    v_mfma_f32_16x16x32_bf16 a[48:51], a[184:187], v[160:163], a[48:51]
    buffer_load_dwordx4 v252, s[4:7], s23 offen offset:3072  lds
    v_smfmac_f32_16x16x64_bf16 a[208:211], a[192:195], v[160:167], v243
    s_waitcnt lgkmcnt(0)
    v_cvt_pk_bf16_f32 v155, v110, v111
    v_smfmac_f32_16x16x64_bf16 a[208:211], a[196:199], v[168:175], v243
    s_add_u32 s23, s23, 0x4000
    v_mfma_f32_16x16x32_bf16 v[4:7], a[128:131], v[0:3], v[192:195]
    v_exp_f32 v20, v20
    v_mfma_f32_16x16x32_bf16 v[4:7], a[132:135], v[8:11], v[4:7]
    ds_read_b64_tr_b16 a[160:161], v216 offset:16384
    ds_read_b64_tr_b16 a[162:163], v216 offset:20480
    v_mfma_f32_16x16x32_bf16 v[4:7], a[136:139], v[16:19], v[4:7]
    v_exp_f32 v21, v21
    v_mfma_f32_16x16x32_bf16 v[4:7], a[140:143], v[24:27], v[4:7]
    ds_read_b64_tr_b16 a[164:165], v216 offset:24576
    ds_read_b64_tr_b16 a[166:167], v216 offset:28672
    v_mfma_f32_16x16x32_bf16 v[36:39], a[140:143], v[56:59], v[196:199]
    v_exp_f32 v22, v22
    v_mfma_f32_16x16x32_bf16 v[36:39], a[136:139], v[48:51], v[36:39]
    ds_read_b64_tr_b16 a[168:169], v217 offset:16384
    v_cvt_pk_bf16_f32 v132, v20, v21
    v_mfma_f32_16x16x32_bf16 v[36:39], a[132:135], v[40:43], v[36:39]
    v_exp_f32 v23, v23
    v_mfma_f32_16x16x32_bf16 v[36:39], a[128:131], v[32:35], v[36:39]
    ds_read_b64_tr_b16 a[170:171], v217 offset:20480
    ds_read_b64_tr_b16 a[172:173], v217 offset:24576
    v_mfma_f32_16x16x32_bf16 v[68:71], a[128:131], v[64:67], v[200:203]
    v_exp_f32 v28, v28
    v_mfma_f32_16x16x32_bf16 v[68:71], a[132:135], v[72:75], v[68:71]
    ds_read_b64_tr_b16 a[174:175], v217 offset:28672
    v_cvt_pk_bf16_f32 v133, v22, v23
    v_mfma_f32_16x16x32_bf16 v[68:71], a[136:139], v[80:83], v[68:71]
    v_exp_f32 v29, v29
    v_mfma_f32_16x16x32_bf16 v[68:71], a[140:143], v[88:91], v[68:71]
    ds_read_b64_tr_b16 a[176:177], v218 offset:16384
    ds_read_b64_tr_b16 a[178:179], v218 offset:20480
    v_mfma_f32_16x16x32_bf16 v[100:103], a[140:143], v[120:123], v[204:207]
    v_exp_f32 v30, v30
    v_mfma_f32_16x16x32_bf16 v[100:103], a[136:139], v[112:115], v[100:103]
    ds_read_b64_tr_b16 a[180:181], v218 offset:24576
    v_cvt_pk_bf16_f32 v134, v28, v29
    v_mfma_f32_16x16x32_bf16 v[100:103], a[132:135], v[104:107], v[100:103]
    v_exp_f32 v31, v31
    v_mfma_f32_16x16x32_bf16 v[100:103], a[128:131], v[96:99], v[100:103]
    ds_read_b64_tr_b16 a[182:183], v218 offset:28672
    ds_read_b64_tr_b16 a[184:185], v219 offset:16384
    v_mfma_f32_16x16x32_bf16 v[12:15], a[144:147], v[0:3], v[192:195]
    v_exp_f32 v52, v52
    v_mfma_f32_16x16x32_bf16 v[12:15], a[148:151], v[8:11], v[12:15]
    ds_read_b64_tr_b16 a[186:187], v219 offset:20480
    v_cvt_pk_bf16_f32 v135, v30, v31
    v_mfma_f32_16x16x32_bf16 v[12:15], a[152:155], v[16:19], v[12:15]
    v_exp_f32 v53, v53
    v_mfma_f32_16x16x32_bf16 v[12:15], a[156:159], v[24:27], v[12:15]
    ds_read_b64_tr_b16 a[188:189], v219 offset:24576
    ds_read_b64_tr_b16 a[190:191], v219 offset:28672
    v_mfma_f32_16x16x32_bf16 v[44:47], a[156:159], v[56:59], v[196:199]
    v_exp_f32 v54, v54
    v_mfma_f32_16x16x32_bf16 v[44:47], a[152:155], v[48:51], v[44:47]
    s_add_u32 m0, s26, 49152
    v_add_u32 v220, 1, v220
    v_cvt_pk_bf16_f32 v140, v52, v53
    v_mfma_f32_16x16x32_bf16 v[44:47], a[148:151], v[40:43], v[44:47]
    v_exp_f32 v55, v55
    v_mfma_f32_16x16x32_bf16 v[44:47], a[144:147], v[32:35], v[44:47]
    buffer_load_dwordx4 v251, s[8:11], s24 offen offset:0  lds
    v_mfma_f32_16x16x32_bf16 v[76:79], a[144:147], v[64:67], v[200:203]
    v_exp_f32 v60, v60
    v_mfma_f32_16x16x32_bf16 v[76:79], a[148:151], v[72:75], v[76:79]
    v_cvt_pk_bf16_f32 v141, v54, v55
    v_mfma_f32_16x16x32_bf16 v[76:79], a[152:155], v[80:83], v[76:79]
    v_exp_f32 v61, v61
    v_mfma_f32_16x16x32_bf16 v[76:79], a[156:159], v[88:91], v[76:79]
    buffer_load_dwordx4 v252, s[8:11], s24 offen offset:1024  lds
    v_mfma_f32_16x16x32_bf16 v[108:111], a[156:159], v[120:123], v[204:207]
    v_exp_f32 v62, v62
    v_mfma_f32_16x16x32_bf16 v[108:111], a[152:155], v[112:115], v[108:111]
    v_cvt_pk_bf16_f32 v142, v60, v61
    v_mfma_f32_16x16x32_bf16 v[108:111], a[148:151], v[104:107], v[108:111]
    v_exp_f32 v63, v63
    v_mfma_f32_16x16x32_bf16 v[108:111], a[144:147], v[96:99], v[108:111]
    s_waitcnt lgkmcnt(0)
    buffer_load_dwordx4 v251, s[8:11], s24 offen offset:2048  lds
    v_mfma_f32_16x16x32_bf16 a[64:67], a[160:163], v[160:163], a[64:67]
    v_exp_f32 v84, v84
    v_mfma_f32_16x16x32_bf16 a[64:67], a[164:167], v[164:167], a[64:67]
    ds_read_b128 a[128:131], v208 offset:8192
    v_cvt_pk_bf16_f32 v143, v62, v63
    v_mfma_f32_16x16x32_bf16 a[68:71], a[164:167], v[172:175], a[68:71]
    v_exp_f32 v85, v85
    v_mfma_f32_16x16x32_bf16 a[68:71], a[160:163], v[168:171], a[68:71]
    ds_read_b128 a[132:135], v209 offset:8192
    ds_read_b128 a[136:139], v210 offset:8192
    v_mfma_f32_16x16x32_bf16 a[72:75], a[160:163], v[176:179], a[72:75]
    v_exp_f32 v86, v86
    v_mfma_f32_16x16x32_bf16 a[72:75], a[164:167], v[180:183], a[72:75]
    ds_read_b128 a[140:143], v211 offset:8192
    v_cvt_pk_bf16_f32 v148, v84, v85
    v_mfma_f32_16x16x32_bf16 a[76:79], a[164:167], v[188:191], a[76:79]
    v_exp_f32 v87, v87
    v_mfma_f32_16x16x32_bf16 a[76:79], a[160:163], v[184:187], a[76:79]
    ds_read_b128 a[144:147], v208 offset:12288
    ds_read_b128 a[148:151], v209 offset:12288
    v_mfma_f32_16x16x32_bf16 a[92:95], a[168:171], v[184:187], a[92:95]
    v_exp_f32 v92, v92
    v_mfma_f32_16x16x32_bf16 a[92:95], a[172:175], v[188:191], a[92:95]
    ds_read_b128 a[152:155], v210 offset:12288
    v_cvt_pk_bf16_f32 v149, v86, v87
    v_mfma_f32_16x16x32_bf16 a[88:91], a[172:175], v[180:183], a[88:91]
    v_exp_f32 v93, v93
    v_mfma_f32_16x16x32_bf16 a[88:91], a[168:171], v[176:179], a[88:91]
    ds_read_b128 a[156:159], v211 offset:12288
    v_mfma_f32_16x16x32_bf16 a[84:87], a[168:171], v[168:171], a[84:87]
    v_exp_f32 v94, v94
    v_mfma_f32_16x16x32_bf16 a[84:87], a[172:175], v[172:175], a[84:87]
    v_cvt_pk_bf16_f32 v150, v92, v93
    v_mfma_f32_16x16x32_bf16 a[80:83], a[172:175], v[164:167], a[80:83]
    v_exp_f32 v95, v95
    v_mfma_f32_16x16x32_bf16 a[80:83], a[168:171], v[160:163], a[80:83]
    buffer_load_dwordx4 v252, s[8:11], s24 offen offset:3072  lds
    v_mfma_f32_16x16x32_bf16 a[96:99], a[176:179], v[160:163], a[96:99]
    v_exp_f32 v116, v116
    v_mfma_f32_16x16x32_bf16 a[96:99], a[180:183], v[164:167], a[96:99]
    v_cvt_pk_bf16_f32 v151, v94, v95
    v_mfma_f32_16x16x32_bf16 a[100:103], a[180:183], v[172:175], a[100:103]
    v_exp_f32 v117, v117
    v_mfma_f32_16x16x32_bf16 a[100:103], a[176:179], v[168:171], a[100:103]
    v_mfma_f32_16x16x32_bf16 a[104:107], a[176:179], v[176:179], a[104:107]
    v_exp_f32 v118, v118
    v_mfma_f32_16x16x32_bf16 a[104:107], a[180:183], v[180:183], a[104:107]
    s_add_u32 s24, s24, 0x4000
    v_cvt_pk_bf16_f32 v156, v116, v117
    v_mfma_f32_16x16x32_bf16 a[108:111], a[180:183], v[188:191], a[108:111]
    v_exp_f32 v119, v119
    v_mfma_f32_16x16x32_bf16 a[108:111], a[176:179], v[184:187], a[108:111]
    s_waitcnt vmcnt(10) lgkmcnt(0)
    ds_write_b32 v221, v220
    v_mfma_f32_16x16x32_bf16 a[124:127], a[184:187], v[184:187], a[124:127]
    v_exp_f32 v124, v124
    v_mfma_f32_16x16x32_bf16 a[124:127], a[188:191], v[188:191], a[124:127]
    v_cvt_pk_bf16_f32 v157, v118, v119
    v_mfma_f32_16x16x32_bf16 a[120:123], a[188:191], v[180:183], a[120:123]
    v_exp_f32 v125, v125
    v_mfma_f32_16x16x32_bf16 a[120:123], a[184:187], v[176:179], a[120:123]
    v_mfma_f32_16x16x32_bf16 a[116:119], a[184:187], v[168:171], a[116:119]
    v_exp_f32 v126, v126
    v_mfma_f32_16x16x32_bf16 a[116:119], a[188:191], v[172:175], a[116:119]
    v_cvt_pk_bf16_f32 v158, v124, v125
    v_mfma_f32_16x16x32_bf16 a[112:115], a[188:191], v[164:167], a[112:115]
    s_cmp_le_u32 s27, s39
    v_exp_f32 v127, v127
    v_mfma_f32_16x16x32_bf16 a[112:115], a[184:187], v[160:163], a[112:115]
    v_cvt_pk_bf16_f32 v159, v126, v127
    v_smfmac_f32_16x16x64_bf16 a[208:211], a[200:203], v[176:183], v243
    v_smfmac_f32_16x16x64_bf16 a[208:211], a[204:207], v[184:191], v243
    s_cbranch_scc1 K1_dosig
K1_sigret:
    v_mfma_f32_16x16x32_bf16 v[20:23], a[128:131], v[0:3], v[192:195]
    v_exp_f32 v4, v4
    v_mfma_f32_16x16x32_bf16 v[20:23], a[132:135], v[8:11], v[20:23]
    ds_read_b64_tr_b16 a[160:161], v212 offset:49152
    ds_read_b64_tr_b16 a[162:163], v212 offset:53248
    v_mfma_f32_16x16x32_bf16 v[20:23], a[136:139], v[16:19], v[20:23]
    v_exp_f32 v5, v5
    v_mfma_f32_16x16x32_bf16 v[20:23], a[140:143], v[24:27], v[20:23]
    ds_read_b64_tr_b16 a[164:165], v212 offset:57344
    ds_read_b64_tr_b16 a[166:167], v212 offset:61440
    v_mfma_f32_16x16x32_bf16 v[52:55], a[140:143], v[56:59], v[196:199]
    v_exp_f32 v6, v6
    v_mfma_f32_16x16x32_bf16 v[52:55], a[136:139], v[48:51], v[52:55]
    ds_read_b64_tr_b16 a[168:169], v213 offset:49152
    v_cvt_pk_bf16_f32 v160, v4, v5
    v_mfma_f32_16x16x32_bf16 v[52:55], a[132:135], v[40:43], v[52:55]
    v_exp_f32 v7, v7
    v_mfma_f32_16x16x32_bf16 v[52:55], a[128:131], v[32:35], v[52:55]
    ds_read_b64_tr_b16 a[170:171], v213 offset:53248
    ds_read_b64_tr_b16 a[172:173], v213 offset:57344
    v_mfma_f32_16x16x32_bf16 v[84:87], a[128:131], v[64:67], v[200:203]
    v_exp_f32 v12, v12
    v_mfma_f32_16x16x32_bf16 v[84:87], a[132:135], v[72:75], v[84:87]
    ds_read_b64_tr_b16 a[174:175], v213 offset:61440
    v_cvt_pk_bf16_f32 v161, v6, v7
    v_mfma_f32_16x16x32_bf16 v[84:87], a[136:139], v[80:83], v[84:87]
    v_exp_f32 v13, v13
    v_mfma_f32_16x16x32_bf16 v[84:87], a[140:143], v[88:91], v[84:87]
    ds_read_b64_tr_b16 a[176:177], v214 offset:49152
    ds_read_b64_tr_b16 a[178:179], v214 offset:53248
    v_mfma_f32_16x16x32_bf16 v[116:119], a[140:143], v[120:123], v[204:207]
    v_exp_f32 v14, v14
    v_mfma_f32_16x16x32_bf16 v[116:119], a[136:139], v[112:115], v[116:119]
    ds_read_b64_tr_b16 a[180:181], v214 offset:57344
    v_cvt_pk_bf16_f32 v162, v12, v13
    v_mfma_f32_16x16x32_bf16 v[116:119], a[132:135], v[104:107], v[116:119]
    v_exp_f32 v15, v15
    v_mfma_f32_16x16x32_bf16 v[116:119], a[128:131], v[96:99], v[116:119]
    ds_read_b64_tr_b16 a[182:183], v214 offset:61440
    ds_read_b64_tr_b16 a[184:185], v215 offset:49152
    v_mfma_f32_16x16x32_bf16 v[28:31], a[144:147], v[0:3], v[192:195]
    v_exp_f32 v36, v36
    v_mfma_f32_16x16x32_bf16 v[28:31], a[148:151], v[8:11], v[28:31]
    ds_read_b64_tr_b16 a[186:187], v215 offset:53248
    v_cvt_pk_bf16_f32 v163, v14, v15
    v_mfma_f32_16x16x32_bf16 v[28:31], a[152:155], v[16:19], v[28:31]
    v_exp_f32 v37, v37
    v_mfma_f32_16x16x32_bf16 v[28:31], a[156:159], v[24:27], v[28:31]
    ds_read_b64_tr_b16 a[188:189], v215 offset:57344
    ds_read_b64_tr_b16 a[190:191], v215 offset:61440
    v_mfma_f32_16x16x32_bf16 v[60:63], a[156:159], v[56:59], v[196:199]
    v_exp_f32 v38, v38
    v_mfma_f32_16x16x32_bf16 v[60:63], a[152:155], v[48:51], v[60:63]
    v_cvt_pk_bf16_f32 v168, v36, v37
    v_mfma_f32_16x16x32_bf16 v[60:63], a[148:151], v[40:43], v[60:63]
    v_exp_f32 v39, v39
    v_mfma_f32_16x16x32_bf16 v[60:63], a[144:147], v[32:35], v[60:63]
    v_mfma_f32_16x16x32_bf16 v[92:95], a[144:147], v[64:67], v[200:203]
    v_exp_f32 v44, v44
    v_mfma_f32_16x16x32_bf16 v[92:95], a[148:151], v[72:75], v[92:95]
    v_cvt_pk_bf16_f32 v169, v38, v39
    v_mfma_f32_16x16x32_bf16 v[92:95], a[152:155], v[80:83], v[92:95]
    v_exp_f32 v45, v45
    v_mfma_f32_16x16x32_bf16 v[92:95], a[156:159], v[88:91], v[92:95]
    v_mfma_f32_16x16x32_bf16 v[124:127], a[156:159], v[120:123], v[204:207]
    v_exp_f32 v46, v46
    v_mfma_f32_16x16x32_bf16 v[124:127], a[152:155], v[112:115], v[124:127]
    v_cvt_pk_bf16_f32 v170, v44, v45
    v_mfma_f32_16x16x32_bf16 v[124:127], a[148:151], v[104:107], v[124:127]
    v_exp_f32 v47, v47
    v_mfma_f32_16x16x32_bf16 v[124:127], a[144:147], v[96:99], v[124:127]
    s_waitcnt lgkmcnt(0)
    ds_read_b32 v223, v222
    v_mfma_f32_16x16x32_bf16 a[0:3], a[160:163], v[128:131], a[0:3]
    v_exp_f32 v68, v68
    v_mfma_f32_16x16x32_bf16 a[0:3], a[164:167], v[132:135], a[0:3]
    ds_read_b128 a[128:131], v208 offset:32768
    v_cvt_pk_bf16_f32 v171, v46, v47
    v_mfma_f32_16x16x32_bf16 a[4:7], a[164:167], v[140:143], a[4:7]
    v_exp_f32 v69, v69
    v_mfma_f32_16x16x32_bf16 a[4:7], a[160:163], v[136:139], a[4:7]
    ds_read_b128 a[132:135], v209 offset:32768
    ds_read_b128 a[136:139], v210 offset:32768
    v_mfma_f32_16x16x32_bf16 a[8:11], a[160:163], v[144:147], a[8:11]
    v_exp_f32 v70, v70
    v_mfma_f32_16x16x32_bf16 a[8:11], a[164:167], v[148:151], a[8:11]
    ds_read_b128 a[140:143], v211 offset:32768
    v_cvt_pk_bf16_f32 v176, v68, v69
    v_mfma_f32_16x16x32_bf16 a[12:15], a[164:167], v[156:159], a[12:15]
    v_exp_f32 v71, v71
    v_mfma_f32_16x16x32_bf16 a[12:15], a[160:163], v[152:155], a[12:15]
    ds_read_b128 a[144:147], v208 offset:36864
    ds_read_b128 a[148:151], v209 offset:36864
    v_mfma_f32_16x16x32_bf16 a[28:31], a[168:171], v[152:155], a[28:31]
    v_exp_f32 v76, v76
    v_mfma_f32_16x16x32_bf16 a[28:31], a[172:175], v[156:159], a[28:31]
    ds_read_b128 a[152:155], v210 offset:36864
    v_cvt_pk_bf16_f32 v177, v70, v71
    v_mfma_f32_16x16x32_bf16 a[24:27], a[172:175], v[148:151], a[24:27]
    v_exp_f32 v77, v77
    v_mfma_f32_16x16x32_bf16 a[24:27], a[168:171], v[144:147], a[24:27]
    s_waitcnt lgkmcnt(7)
    ds_read_b128 a[156:159], v211 offset:36864
    v_cmp_gt_u32 vcc, v220, v223
    v_mfma_f32_16x16x32_bf16 a[20:23], a[168:171], v[136:139], a[20:23]
    v_exp_f32 v78, v78
    v_mfma_f32_16x16x32_bf16 a[20:23], a[172:175], v[140:143], a[20:23]
    s_add_u32 m0, s25, 0
    v_cvt_pk_bf16_f32 v178, v76, v77
    v_mfma_f32_16x16x32_bf16 a[16:19], a[172:175], v[132:135], a[16:19]
    v_exp_f32 v79, v79
    v_mfma_f32_16x16x32_bf16 a[16:19], a[168:171], v[128:131], a[16:19]
    s_cbranch_vccnz K1_pg1
K1_pg1_ok:
    v_mfma_f32_16x16x32_bf16 a[32:35], a[176:179], v[128:131], a[32:35]
    v_exp_f32 v100, v100
    v_mfma_f32_16x16x32_bf16 a[32:35], a[180:183], v[132:135], a[32:35]
    v_cvt_pk_bf16_f32 v179, v78, v79
    v_mfma_f32_16x16x32_bf16 a[36:39], a[180:183], v[140:143], a[36:39]
    v_exp_f32 v101, v101
    v_mfma_f32_16x16x32_bf16 a[36:39], a[176:179], v[136:139], a[36:39]
    buffer_load_dwordx4 v251, s[4:7], s23 offen offset:0  lds
    v_mfma_f32_16x16x32_bf16 a[40:43], a[176:179], v[144:147], a[40:43]
    v_exp_f32 v102, v102
    v_mfma_f32_16x16x32_bf16 a[40:43], a[180:183], v[148:151], a[40:43]
    v_cvt_pk_bf16_f32 v184, v100, v101
    v_mfma_f32_16x16x32_bf16 a[44:47], a[180:183], v[156:159], a[44:47]
    v_exp_f32 v103, v103
    v_mfma_f32_16x16x32_bf16 a[44:47], a[176:179], v[152:155], a[44:47]
    buffer_load_dwordx4 v252, s[4:7], s23 offen offset:1024  lds
    v_mfma_f32_16x16x32_bf16 a[60:63], a[184:187], v[152:155], a[60:63]
    v_exp_f32 v108, v108
    v_mfma_f32_16x16x32_bf16 a[60:63], a[188:191], v[156:159], a[60:63]
    v_cvt_pk_bf16_f32 v185, v102, v103
    v_mfma_f32_16x16x32_bf16 a[56:59], a[188:191], v[148:151], a[56:59]
    v_exp_f32 v109, v109
    v_mfma_f32_16x16x32_bf16 a[56:59], a[184:187], v[144:147], a[56:59]
    buffer_load_dwordx4 v251, s[4:7], s23 offen offset:2048  lds
    v_mfma_f32_16x16x32_bf16 a[52:55], a[184:187], v[136:139], a[52:55]
HOP0_5:
    s_cbranch_execz HOPRET0
    v_exp_f32 v110, v110
    v_mfma_f32_16x16x32_bf16 a[52:55], a[188:191], v[140:143], a[52:55]
    v_cvt_pk_bf16_f32 v186, v108, v109
    v_mfma_f32_16x16x32_bf16 a[48:51], a[188:191], v[132:135], a[48:51]
    v_exp_f32 v111, v111
    v_mfma_f32_16x16x32_bf16 a[48:51], a[184:187], v[128:131], a[48:51]
    buffer_load_dwordx4 v252, s[4:7], s23 offen offset:3072  lds
    v_smfmac_f32_16x16x64_bf16 a[208:211], a[192:195], v[128:135], v243
    s_waitcnt lgkmcnt(0)
    v_cvt_pk_bf16_f32 v187, v110, v111
    v_smfmac_f32_16x16x64_bf16 a[208:211], a[196:199], v[136:143], v243
    s_add_u32 s23, s23, 0x4000
    v_mfma_f32_16x16x32_bf16 v[4:7], a[128:131], v[0:3], v[192:195]
    v_exp_f32 v20, v20
    v_mfma_f32_16x16x32_bf16 v[4:7], a[132:135], v[8:11], v[4:7]
    ds_read_b64_tr_b16 a[160:161], v216 offset:49152
    ds_read_b64_tr_b16 a[162:163], v216 offset:53248
    v_mfma_f32_16x16x32_bf16 v[4:7], a[136:139], v[16:19], v[4:7]
    v_exp_f32 v21, v21
    v_mfma_f32_16x16x32_bf16 v[4:7], a[140:143], v[24:27], v[4:7]
    ds_read_b64_tr_b16 a[164:165], v216 offset:57344
    ds_read_b64_tr_b16 a[166:167], v216 offset:61440
    v_mfma_f32_16x16x32_bf16 v[36:39], a[140:143], v[56:59], v[196:199]
    v_exp_f32 v22, v22
    v_mfma_f32_16x16x32_bf16 v[36:39], a[136:139], v[48:51], v[36:39]
    ds_read_b64_tr_b16 a[168:169], v217 offset:49152
    v_cvt_pk_bf16_f32 v164, v20, v21
    v_mfma_f32_16x16x32_bf16 v[36:39], a[132:135], v[40:43], v[36:39]
    v_exp_f32 v23, v23
    v_mfma_f32_16x16x32_bf16 v[36:39], a[128:131], v[32:35], v[36:39]
    ds_read_b64_tr_b16 a[170:171], v217 offset:53248
    ds_read_b64_tr_b16 a[172:173], v217 offset:57344
    v_mfma_f32_16x16x32_bf16 v[68:71], a[128:131], v[64:67], v[200:203]
    v_exp_f32 v28, v28
    v_mfma_f32_16x16x32_bf16 v[68:71], a[132:135], v[72:75], v[68:71]
    ds_read_b64_tr_b16 a[174:175], v217 offset:61440
    v_cvt_pk_bf16_f32 v165, v22, v23
    v_mfma_f32_16x16x32_bf16 v[68:71], a[136:139], v[80:83], v[68:71]
    v_exp_f32 v29, v29
    v_mfma_f32_16x16x32_bf16 v[68:71], a[140:143], v[88:91], v[68:71]
    ds_read_b64_tr_b16 a[176:177], v218 offset:49152
    ds_read_b64_tr_b16 a[178:179], v218 offset:53248
    v_mfma_f32_16x16x32_bf16 v[100:103], a[140:143], v[120:123], v[204:207]
    v_exp_f32 v30, v30
    v_mfma_f32_16x16x32_bf16 v[100:103], a[136:139], v[112:115], v[100:103]
    ds_read_b64_tr_b16 a[180:181], v218 offset:57344
    v_cvt_pk_bf16_f32 v166, v28, v29
    v_mfma_f32_16x16x32_bf16 v[100:103], a[132:135], v[104:107], v[100:103]
    v_exp_f32 v31, v31
    v_mfma_f32_16x16x32_bf16 v[100:103], a[128:131], v[96:99], v[100:103]
    ds_read_b64_tr_b16 a[182:183], v218 offset:61440
    ds_read_b64_tr_b16 a[184:185], v219 offset:49152
    v_mfma_f32_16x16x32_bf16 v[12:15], a[144:147], v[0:3], v[192:195]
    v_exp_f32 v52, v52
    v_mfma_f32_16x16x32_bf16 v[12:15], a[148:151], v[8:11], v[12:15]
    ds_read_b64_tr_b16 a[186:187], v219 offset:53248
    v_cvt_pk_bf16_f32 v167, v30, v31
    v_mfma_f32_16x16x32_bf16 v[12:15], a[152:155], v[16:19], v[12:15]
    v_exp_f32 v53, v53
    v_mfma_f32_16x16x32_bf16 v[12:15], a[156:159], v[24:27], v[12:15]
    ds_read_b64_tr_b16 a[188:189], v219 offset:57344
    ds_read_b64_tr_b16 a[190:191], v219 offset:61440
    v_mfma_f32_16x16x32_bf16 v[44:47], a[156:159], v[56:59], v[196:199]
    v_exp_f32 v54, v54
    v_mfma_f32_16x16x32_bf16 v[44:47], a[152:155], v[48:51], v[44:47]
    s_add_u32 m0, s25, 16384
    v_add_u32 v220, 1, v220
    v_cvt_pk_bf16_f32 v172, v52, v53
    v_mfma_f32_16x16x32_bf16 v[44:47], a[148:151], v[40:43], v[44:47]
    v_exp_f32 v55, v55
    v_mfma_f32_16x16x32_bf16 v[44:47], a[144:147], v[32:35], v[44:47]
    buffer_load_dwordx4 v251, s[8:11], s24 offen offset:0  lds
    v_mfma_f32_16x16x32_bf16 v[76:79], a[144:147], v[64:67], v[200:203]
    v_exp_f32 v60, v60
    v_mfma_f32_16x16x32_bf16 v[76:79], a[148:151], v[72:75], v[76:79]
    v_cvt_pk_bf16_f32 v173, v54, v55
    v_xor_b32 v212, 0x10000, v212
    v_mfma_f32_16x16x32_bf16 v[76:79], a[152:155], v[80:83], v[76:79]
    v_exp_f32 v61, v61
    v_mfma_f32_16x16x32_bf16 v[76:79], a[156:159], v[88:91], v[76:79]
    buffer_load_dwordx4 v252, s[8:11], s24 offen offset:1024  lds
    v_mfma_f32_16x16x32_bf16 v[108:111], a[156:159], v[120:123], v[204:207]
    v_exp_f32 v62, v62
    v_mfma_f32_16x16x32_bf16 v[108:111], a[152:155], v[112:115], v[108:111]
    v_cvt_pk_bf16_f32 v174, v60, v61
    v_xor_b32 v213, 0x10000, v213
    v_mfma_f32_16x16x32_bf16 v[108:111], a[148:151], v[104:107], v[108:111]
    v_exp_f32 v63, v63
    v_mfma_f32_16x16x32_bf16 v[108:111], a[144:147], v[96:99], v[108:111]
    s_waitcnt lgkmcnt(0)
    v_xor_b32 v214, 0x10000, v214
    v_xor_b32 v215, 0x10000, v215
    v_mfma_f32_16x16x32_bf16 a[64:67], a[160:163], v[128:131], a[64:67]
    v_exp_f32 v84, v84
    v_mfma_f32_16x16x32_bf16 a[64:67], a[164:167], v[132:135], a[64:67]
    ds_read_b128 a[128:131], v208 offset:40960
    v_cvt_pk_bf16_f32 v175, v62, v63
    v_mfma_f32_16x16x32_bf16 a[68:71], a[164:167], v[140:143], a[68:71]
    v_exp_f32 v85, v85
    v_mfma_f32_16x16x32_bf16 a[68:71], a[160:163], v[136:139], a[68:71]
    ds_read_b128 a[132:135], v209 offset:40960
    ds_read_b128 a[136:139], v210 offset:40960
    v_mfma_f32_16x16x32_bf16 a[72:75], a[160:163], v[144:147], a[72:75]
    v_exp_f32 v86, v86
    v_mfma_f32_16x16x32_bf16 a[72:75], a[164:167], v[148:151], a[72:75]
    ds_read_b128 a[140:143], v211 offset:40960
    v_cvt_pk_bf16_f32 v180, v84, v85
    v_mfma_f32_16x16x32_bf16 a[76:79], a[164:167], v[156:159], a[76:79]
    v_exp_f32 v87, v87
    v_mfma_f32_16x16x32_bf16 a[76:79], a[160:163], v[152:155], a[76:79]
    ds_read_b128 a[144:147], v208 offset:45056
    ds_read_b128 a[148:151], v209 offset:45056
    v_mfma_f32_16x16x32_bf16 a[92:95], a[168:171], v[152:155], a[92:95]
    v_exp_f32 v92, v92
    v_mfma_f32_16x16x32_bf16 a[92:95], a[172:175], v[156:159], a[92:95]
    ds_read_b128 a[152:155], v210 offset:45056
    v_cvt_pk_bf16_f32 v181, v86, v87
    v_mfma_f32_16x16x32_bf16 a[88:91], a[172:175], v[148:151], a[88:91]
    v_exp_f32 v93, v93
    v_mfma_f32_16x16x32_bf16 a[88:91], a[168:171], v[144:147], a[88:91]
    ds_read_b128 a[156:159], v211 offset:45056
    v_mfma_f32_16x16x32_bf16 a[84:87], a[168:171], v[136:139], a[84:87]
    v_exp_f32 v94, v94
    v_mfma_f32_16x16x32_bf16 a[84:87], a[172:175], v[140:143], a[84:87]
    v_cvt_pk_bf16_f32 v182, v92, v93
    v_xor_b32 v216, 0x10000, v216
    v_mfma_f32_16x16x32_bf16 a[80:83], a[172:175], v[132:135], a[80:83]
    v_exp_f32 v95, v95
    v_mfma_f32_16x16x32_bf16 a[80:83], a[168:171], v[128:131], a[80:83]
    buffer_load_dwordx4 v251, s[8:11], s24 offen offset:2048  lds
    v_mfma_f32_16x16x32_bf16 a[96:99], a[176:179], v[128:131], a[96:99]
    v_exp_f32 v116, v116
    v_mfma_f32_16x16x32_bf16 a[96:99], a[180:183], v[132:135], a[96:99]
    v_cvt_pk_bf16_f32 v183, v94, v95
    v_xor_b32 v217, 0x10000, v217
    v_mfma_f32_16x16x32_bf16 a[100:103], a[180:183], v[140:143], a[100:103]
    v_exp_f32 v117, v117
    v_mfma_f32_16x16x32_bf16 a[100:103], a[176:179], v[136:139], a[100:103]
    buffer_load_dwordx4 v252, s[8:11], s24 offen offset:3072  lds
    v_mfma_f32_16x16x32_bf16 a[104:107], a[176:179], v[144:147], a[104:107]
    v_exp_f32 v118, v118
    v_mfma_f32_16x16x32_bf16 a[104:107], a[180:183], v[148:151], a[104:107]
    s_add_u32 s24, s24, 0x4000
    v_cvt_pk_bf16_f32 v188, v116, v117
    v_xor_b32 v218, 0x10000, v218
    v_mfma_f32_16x16x32_bf16 a[108:111], a[180:183], v[156:159], a[108:111]
    v_exp_f32 v119, v119
    v_mfma_f32_16x16x32_bf16 a[108:111], a[176:179], v[152:155], a[108:111]
    s_waitcnt vmcnt(8) lgkmcnt(0)
    ds_write_b32 v221, v220
    v_mfma_f32_16x16x32_bf16 a[124:127], a[184:187], v[152:155], a[124:127]
    v_exp_f32 v124, v124
    v_mfma_f32_16x16x32_bf16 a[124:127], a[188:191], v[156:159], a[124:127]
    v_cvt_pk_bf16_f32 v189, v118, v119
    v_xor_b32 v219, 0x10000, v219
    v_mfma_f32_16x16x32_bf16 a[120:123], a[188:191], v[148:151], a[120:123]
    s_xor_b32 s25, s25, 0x10000
    v_exp_f32 v125, v125
    v_mfma_f32_16x16x32_bf16 a[120:123], a[184:187], v[144:147], a[120:123]
    s_xor_b32 s26, s26, 0x10000
    v_xor_b32 v208, 0x10000, v208
    v_xor_b32 v209, 0x10000, v209
    v_mfma_f32_16x16x32_bf16 a[116:119], a[184:187], v[136:139], a[116:119]
    s_sub_u32 s27, s27, 1
    v_exp_f32 v126, v126
    v_mfma_f32_16x16x32_bf16 a[116:119], a[188:191], v[140:143], a[116:119]
    s_cmp_lg_u32 s27, 0
    v_cvt_pk_bf16_f32 v190, v124, v125
    v_xor_b32 v210, 0x10000, v210
    v_mfma_f32_16x16x32_bf16 a[112:115], a[188:191], v[132:135], a[112:115]
    v_exp_f32 v127, v127
    v_mfma_f32_16x16x32_bf16 a[112:115], a[184:187], v[128:131], a[112:115]
    v_cvt_pk_bf16_f32 v191, v126, v127
    v_xor_b32 v211, 0x10000, v211
    v_smfmac_f32_16x16x64_bf16 a[208:211], a[200:203], v[144:151], v243
    v_smfmac_f32_16x16x64_bf16 a[208:211], a[204:207], v[152:159], v243
    s_cbranch_scc1 K1_loop
    s_waitcnt lgkmcnt(0)
    s_barrier
    s_cmp_ge_u32 s48, 0x7f000000
    s_cbranch_scc1 K1_shwait
K1_shp_ret:
    s_getpc_b64 s[98:99]
K1_pc2:
    s_lshr_b32 s3, s2, 3
    s_lshl_b32 s3, s3, 2
    s_add_u32 s3, s3, s22
    s_mul_i32 s3, s3, 384
    v_min_u32 v241, 32, v249
    v_lshl_add_u32 v241, v241, 3, s3
    v_min_u32 v241, PK_last-K1_pc2, v241
    global_load_dword a255, v241, s[98:99]
    v_mfma_f32_16x16x32_bf16 v[20:23], a[128:131], v[0:3], v[192:195]
    v_exp_f32 v4, v4
    v_mfma_f32_16x16x32_bf16 v[20:23], a[132:135], v[8:11], v[20:23]
    ds_read_b64_tr_b16 a[160:161], v212 offset:16384
    ds_read_b64_tr_b16 a[162:163], v212 offset:20480
    v_mfma_f32_16x16x32_bf16 v[20:23], a[136:139], v[16:19], v[20:23]
    v_exp_f32 v5, v5
    v_mfma_f32_16x16x32_bf16 v[20:23], a[140:143], v[24:27], v[20:23]
    s_add_u32 s81, s78, 1638400
    ds_read_b64_tr_b16 a[164:165], v212 offset:24576
    ds_read_b64_tr_b16 a[166:167], v212 offset:28672
    v_mfma_f32_16x16x32_bf16 v[52:55], a[140:143], v[56:59], v[196:199]
    buffer_load_dwordx4 a[240:243], v249, s[16:19], s81 offen offset:2048 sc1
    v_exp_f32 v6, v6
    v_mfma_f32_16x16x32_bf16 v[52:55], a[136:139], v[48:51], v[52:55]
    ds_read_b64_tr_b16 a[168:169], v213 offset:16384
    v_cvt_pk_bf16_f32 v128, v4, v5
    v_mfma_f32_16x16x32_bf16 v[52:55], a[132:135], v[40:43], v[52:55]
    v_exp_f32 v7, v7
    v_mfma_f32_16x16x32_bf16 v[52:55], a[128:131], v[32:35], v[52:55]
    ds_read_b64_tr_b16 a[170:171], v213 offset:20480
    ds_read_b64_tr_b16 a[172:173], v213 offset:24576
    v_mfma_f32_16x16x32_bf16 v[84:87], a[128:131], v[64:67], v[200:203]
    v_exp_f32 v12, v12
    v_mfma_f32_16x16x32_bf16 v[84:87], a[132:135], v[72:75], v[84:87]
    s_add_u32 s81, s78, 1638400
    ds_read_b64_tr_b16 a[174:175], v213 offset:28672
    v_cvt_pk_bf16_f32 v129, v6, v7
    v_mfma_f32_16x16x32_bf16 v[84:87], a[136:139], v[80:83], v[84:87]
    buffer_load_dwordx4 a[244:247], v249, s[16:19], s81 offen offset:3072 sc1
    v_exp_f32 v13, v13
    v_mfma_f32_16x16x32_bf16 v[84:87], a[140:143], v[88:91], v[84:87]
    ds_read_b64_tr_b16 a[176:177], v214 offset:16384
    ds_read_b64_tr_b16 a[178:179], v214 offset:20480
    v_mfma_f32_16x16x32_bf16 v[116:119], a[140:143], v[120:123], v[204:207]
    v_exp_f32 v14, v14
    v_mfma_f32_16x16x32_bf16 v[116:119], a[136:139], v[112:115], v[116:119]
    ds_read_b64_tr_b16 a[180:181], v214 offset:24576
    v_cvt_pk_bf16_f32 v130, v12, v13
    v_mfma_f32_16x16x32_bf16 v[116:119], a[132:135], v[104:107], v[116:119]
    s_add_u32 s81, s78, 1638400
    v_exp_f32 v15, v15
    v_mfma_f32_16x16x32_bf16 v[116:119], a[128:131], v[96:99], v[116:119]
    s_add_u32 s81, s81, s79
    ds_read_b64_tr_b16 a[182:183], v214 offset:28672
    ds_read_b64_tr_b16 a[184:185], v215 offset:16384
    v_mfma_f32_16x16x32_bf16 v[28:31], a[144:147], v[0:3], v[192:195]
    buffer_load_dwordx4 a[248:251], v249, s[16:19], s81 offen offset:0 sc1
    v_exp_f32 v36, v36
    v_mfma_f32_16x16x32_bf16 v[28:31], a[148:151], v[8:11], v[28:31]
    ds_read_b64_tr_b16 a[186:187], v215 offset:20480
    v_cvt_pk_bf16_f32 v131, v14, v15
    v_mfma_f32_16x16x32_bf16 v[28:31], a[152:155], v[16:19], v[28:31]
    v_exp_f32 v37, v37
    v_mfma_f32_16x16x32_bf16 v[28:31], a[156:159], v[24:27], v[28:31]
    ds_read_b64_tr_b16 a[188:189], v215 offset:24576
    ds_read_b64_tr_b16 a[190:191], v215 offset:28672
    v_mfma_f32_16x16x32_bf16 v[60:63], a[156:159], v[56:59], v[196:199]
    v_exp_f32 v38, v38
    v_mfma_f32_16x16x32_bf16 v[60:63], a[152:155], v[48:51], v[60:63]
    s_add_u32 m0, s38, 98304
    v_cvt_pk_bf16_f32 v136, v36, v37
    v_mfma_f32_16x16x32_bf16 v[60:63], a[148:151], v[40:43], v[60:63]
    s_add_u32 s34, s92, 0
    v_exp_f32 v39, v39
    v_mfma_f32_16x16x32_bf16 v[60:63], a[144:147], v[32:35], v[60:63]
    buffer_load_dwordx4 v250, s[64:67], s34 offen offset:0 lds
    v_mfma_f32_16x16x32_bf16 v[92:95], a[144:147], v[64:67], v[200:203]
    v_exp_f32 v44, v44
    v_mfma_f32_16x16x32_bf16 v[92:95], a[148:151], v[72:75], v[92:95]
    v_cvt_pk_bf16_f32 v137, v38, v39
    v_mfma_f32_16x16x32_bf16 v[92:95], a[152:155], v[80:83], v[92:95]
    s_add_u32 s34, s92, 26624
    v_exp_f32 v45, v45
    v_mfma_f32_16x16x32_bf16 v[92:95], a[156:159], v[88:91], v[92:95]
    buffer_load_dwordx4 v250, s[64:67], s34 offen offset:1024 lds
    v_mfma_f32_16x16x32_bf16 v[124:127], a[156:159], v[120:123], v[204:207]
    v_exp_f32 v46, v46
    v_mfma_f32_16x16x32_bf16 v[124:127], a[152:155], v[112:115], v[124:127]
    v_cvt_pk_bf16_f32 v138, v44, v45
    v_mfma_f32_16x16x32_bf16 v[124:127], a[148:151], v[104:107], v[124:127]
    s_add_u32 s34, s92, 53248
    v_exp_f32 v47, v47
    v_mfma_f32_16x16x32_bf16 v[124:127], a[144:147], v[96:99], v[124:127]
    s_waitcnt lgkmcnt(0)
    buffer_load_dwordx4 v250, s[64:67], s34 offen offset:2048 lds
    v_mfma_f32_16x16x32_bf16 a[0:3], a[160:163], v[160:163], a[0:3]
    v_exp_f32 v68, v68
    v_mfma_f32_16x16x32_bf16 a[0:3], a[164:167], v[164:167], a[0:3]
    ds_read_b128 a[128:131], v208 offset:0
    v_cvt_pk_bf16_f32 v139, v46, v47
    v_mfma_f32_16x16x32_bf16 a[4:7], a[164:167], v[172:175], a[4:7]
    v_exp_f32 v69, v69
    v_mfma_f32_16x16x32_bf16 a[4:7], a[160:163], v[168:171], a[4:7]
    s_add_u32 s81, s78, 1802240
    ds_read_b128 a[132:135], v209 offset:0
    ds_read_b128 a[136:139], v210 offset:0
    v_mfma_f32_16x16x32_bf16 a[8:11], a[160:163], v[176:179], a[8:11]
    buffer_load_dwordx4 a[252:255], v249, s[16:19], s81 offen offset:0 sc1
    v_exp_f32 v70, v70
    v_mfma_f32_16x16x32_bf16 a[8:11], a[164:167], v[180:183], a[8:11]
    ds_read_b128 a[140:143], v211 offset:0
    v_cvt_pk_bf16_f32 v144, v68, v69
    v_mfma_f32_16x16x32_bf16 a[12:15], a[164:167], v[188:191], a[12:15]
    v_exp_f32 v71, v71
    v_mfma_f32_16x16x32_bf16 a[12:15], a[160:163], v[184:187], a[12:15]
    ds_read_b128 a[144:147], v208 offset:4096
    ds_read_b128 a[148:151], v209 offset:4096
    v_mfma_f32_16x16x32_bf16 a[28:31], a[168:171], v[184:187], a[28:31]
    v_exp_f32 v76, v76
    v_mfma_f32_16x16x32_bf16 a[28:31], a[172:175], v[188:191], a[28:31]
    s_add_u32 s81, s78, 2293760
    ds_read_b128 a[152:155], v210 offset:4096
    v_cvt_pk_bf16_f32 v145, v70, v71
    v_mfma_f32_16x16x32_bf16 a[24:27], a[172:175], v[180:183], a[24:27]
    buffer_load_dwordx4 a[212:215], v249, s[16:19], s81 offen offset:3072 sc1
    v_exp_f32 v77, v77
    v_mfma_f32_16x16x32_bf16 a[24:27], a[168:171], v[176:179], a[24:27]
    ds_read_b128 a[156:159], v211 offset:4096
    v_mfma_f32_16x16x32_bf16 a[20:23], a[168:171], v[168:171], a[20:23]
    v_exp_f32 v78, v78
    v_mfma_f32_16x16x32_bf16 a[20:23], a[172:175], v[172:175], a[20:23]
    v_cvt_pk_bf16_f32 v146, v76, v77
    v_mfma_f32_16x16x32_bf16 a[16:19], a[172:175], v[164:167], a[16:19]
    s_add_u32 s34, s92, 79872
    v_exp_f32 v79, v79
    v_mfma_f32_16x16x32_bf16 a[16:19], a[168:171], v[160:163], a[16:19]
    buffer_load_dwordx4 v250, s[64:67], s34 offen offset:3072 lds
    v_mfma_f32_16x16x32_bf16 a[32:35], a[176:179], v[160:163], a[32:35]
    v_exp_f32 v100, v100
    v_mfma_f32_16x16x32_bf16 a[32:35], a[180:183], v[164:167], a[32:35]
    s_add_u32 m0, s38, 102400
    v_cvt_pk_bf16_f32 v147, v78, v79
    v_mfma_f32_16x16x32_bf16 a[36:39], a[180:183], v[172:175], a[36:39]
    s_add_u32 s34, s92, 0
    v_exp_f32 v101, v101
    v_mfma_f32_16x16x32_bf16 a[36:39], a[176:179], v[168:171], a[36:39]
    buffer_load_dwordx4 v250, s[68:71], s34 offen offset:0 lds
    v_mfma_f32_16x16x32_bf16 a[40:43], a[176:179], v[176:179], a[40:43]
    v_exp_f32 v102, v102
    v_mfma_f32_16x16x32_bf16 a[40:43], a[180:183], v[180:183], a[40:43]
    v_cvt_pk_bf16_f32 v152, v100, v101
    v_mfma_f32_16x16x32_bf16 a[44:47], a[180:183], v[188:191], a[44:47]
    s_add_u32 s34, s92, 26624
    v_exp_f32 v103, v103
    v_mfma_f32_16x16x32_bf16 a[44:47], a[176:179], v[184:187], a[44:47]
    buffer_load_dwordx4 v250, s[68:71], s34 offen offset:1024 lds
    v_mfma_f32_16x16x32_bf16 a[60:63], a[184:187], v[184:187], a[60:63]
    v_exp_f32 v108, v108
    v_mfma_f32_16x16x32_bf16 a[60:63], a[188:191], v[188:191], a[60:63]
    v_cvt_pk_bf16_f32 v153, v102, v103
    v_mfma_f32_16x16x32_bf16 a[56:59], a[188:191], v[180:183], a[56:59]
    s_add_u32 s34, s92, 53248
    v_exp_f32 v109, v109
    v_mfma_f32_16x16x32_bf16 a[56:59], a[184:187], v[176:179], a[56:59]
    buffer_load_dwordx4 v250, s[68:71], s34 offen offset:2048 lds
    v_mfma_f32_16x16x32_bf16 a[52:55], a[184:187], v[168:171], a[52:55]
    v_exp_f32 v110, v110
    v_mfma_f32_16x16x32_bf16 a[52:55], a[188:191], v[172:175], a[52:55]
    v_cvt_pk_bf16_f32 v154, v108, v109
    v_mfma_f32_16x16x32_bf16 a[48:51], a[188:191], v[164:167], a[48:51]
    s_add_u32 s34, s92, 79872
    v_exp_f32 v111, v111
    v_mfma_f32_16x16x32_bf16 a[48:51], a[184:187], v[160:163], a[48:51]
    buffer_load_dwordx4 v250, s[68:71], s34 offen offset:3072 lds
    v_smfmac_f32_16x16x64_bf16 a[208:211], a[192:195], v[160:167], v243
    s_waitcnt lgkmcnt(0)
    v_cvt_pk_bf16_f32 v155, v110, v111
    v_smfmac_f32_16x16x64_bf16 a[208:211], a[196:199], v[168:175], v243
    v_mfma_f32_16x16x32_bf16 v[4:7], a[128:131], v[0:3], v[192:195]
    v_exp_f32 v20, v20
    v_mfma_f32_16x16x32_bf16 v[4:7], a[132:135], v[8:11], v[4:7]
    ds_read_b64_tr_b16 a[160:161], v216 offset:16384
    ds_read_b64_tr_b16 a[162:163], v216 offset:20480
    v_mfma_f32_16x16x32_bf16 v[4:7], a[136:139], v[16:19], v[4:7]
    s_add_u32 s81, s78, 2293760
    v_exp_f32 v21, v21
    v_mfma_f32_16x16x32_bf16 v[4:7], a[140:143], v[24:27], v[4:7]
    s_add_u32 s81, s81, s79
    ds_read_b64_tr_b16 a[164:165], v216 offset:24576
    ds_read_b64_tr_b16 a[166:167], v216 offset:28672
    v_mfma_f32_16x16x32_bf16 v[36:39], a[140:143], v[56:59], v[196:199]
    buffer_load_dwordx4 a[216:219], v249, s[16:19], s81 offen offset:0 sc1
    v_exp_f32 v22, v22
    v_mfma_f32_16x16x32_bf16 v[36:39], a[136:139], v[48:51], v[36:39]
    ds_read_b64_tr_b16 a[168:169], v217 offset:16384
    v_cvt_pk_bf16_f32 v132, v20, v21
    v_mfma_f32_16x16x32_bf16 v[36:39], a[132:135], v[40:43], v[36:39]
    v_exp_f32 v23, v23
    v_mfma_f32_16x16x32_bf16 v[36:39], a[128:131], v[32:35], v[36:39]
    ds_read_b64_tr_b16 a[170:171], v217 offset:20480
    ds_read_b64_tr_b16 a[172:173], v217 offset:24576
    v_mfma_f32_16x16x32_bf16 v[68:71], a[128:131], v[64:67], v[200:203]
    v_exp_f32 v28, v28
    v_mfma_f32_16x16x32_bf16 v[68:71], a[132:135], v[72:75], v[68:71]
    s_add_u32 s81, s78, 2457600
    ds_read_b64_tr_b16 a[174:175], v217 offset:28672
    v_cvt_pk_bf16_f32 v133, v22, v23
    v_mfma_f32_16x16x32_bf16 v[68:71], a[136:139], v[80:83], v[68:71]
    buffer_load_dwordx4 a[220:223], v249, s[16:19], s81 offen offset:0 sc1
    v_exp_f32 v29, v29
    v_mfma_f32_16x16x32_bf16 v[68:71], a[140:143], v[88:91], v[68:71]
    ds_read_b64_tr_b16 a[176:177], v218 offset:16384
    ds_read_b64_tr_b16 a[178:179], v218 offset:20480
    v_mfma_f32_16x16x32_bf16 v[100:103], a[140:143], v[120:123], v[204:207]
    v_exp_f32 v30, v30
    v_mfma_f32_16x16x32_bf16 v[100:103], a[136:139], v[112:115], v[100:103]
    ds_read_b64_tr_b16 a[180:181], v218 offset:24576
    v_cvt_pk_bf16_f32 v134, v28, v29
    v_mfma_f32_16x16x32_bf16 v[100:103], a[132:135], v[104:107], v[100:103]
    v_exp_f32 v31, v31
    v_mfma_f32_16x16x32_bf16 v[100:103], a[128:131], v[96:99], v[100:103]
    s_add_u32 s81, s78, 2457600
    ds_read_b64_tr_b16 a[182:183], v218 offset:28672
    ds_read_b64_tr_b16 a[184:185], v219 offset:16384
    v_mfma_f32_16x16x32_bf16 v[12:15], a[144:147], v[0:3], v[192:195]
    buffer_load_dwordx4 a[228:231], v249, s[16:19], s81 offen offset:2048 sc1
    v_exp_f32 v52, v52
    v_mfma_f32_16x16x32_bf16 v[12:15], a[148:151], v[8:11], v[12:15]
    ds_read_b64_tr_b16 a[186:187], v219 offset:20480
    v_cvt_pk_bf16_f32 v135, v30, v31
    v_mfma_f32_16x16x32_bf16 v[12:15], a[152:155], v[16:19], v[12:15]
    v_exp_f32 v53, v53
    v_mfma_f32_16x16x32_bf16 v[12:15], a[156:159], v[24:27], v[12:15]
    ds_read_b64_tr_b16 a[188:189], v219 offset:24576
    ds_read_b64_tr_b16 a[190:191], v219 offset:28672
    v_mfma_f32_16x16x32_bf16 v[44:47], a[156:159], v[56:59], v[196:199]
    v_exp_f32 v54, v54
    v_mfma_f32_16x16x32_bf16 v[44:47], a[152:155], v[48:51], v[44:47]
    s_add_u32 m0, s38, 131072
    v_cvt_pk_bf16_f32 v140, v52, v53
    v_mfma_f32_16x16x32_bf16 v[44:47], a[148:151], v[40:43], v[44:47]
    s_add_u32 s34, s92, 1105920
    v_exp_f32 v55, v55
    v_mfma_f32_16x16x32_bf16 v[44:47], a[144:147], v[32:35], v[44:47]
    buffer_load_dwordx4 v250, s[64:67], s34 offen offset:0 lds
    v_mfma_f32_16x16x32_bf16 v[76:79], a[144:147], v[64:67], v[200:203]
    v_exp_f32 v60, v60
    v_mfma_f32_16x16x32_bf16 v[76:79], a[148:151], v[72:75], v[76:79]
    v_cvt_pk_bf16_f32 v141, v54, v55
    v_mfma_f32_16x16x32_bf16 v[76:79], a[152:155], v[80:83], v[76:79]
    s_add_u32 s34, s92, 1132544
    v_exp_f32 v61, v61
    v_mfma_f32_16x16x32_bf16 v[76:79], a[156:159], v[88:91], v[76:79]
    buffer_load_dwordx4 v250, s[64:67], s34 offen offset:1024 lds
    v_mfma_f32_16x16x32_bf16 v[108:111], a[156:159], v[120:123], v[204:207]
    v_exp_f32 v62, v62
    v_mfma_f32_16x16x32_bf16 v[108:111], a[152:155], v[112:115], v[108:111]
    v_cvt_pk_bf16_f32 v142, v60, v61
    v_mfma_f32_16x16x32_bf16 v[108:111], a[148:151], v[104:107], v[108:111]
    s_add_u32 s34, s92, 1159168
    v_exp_f32 v63, v63
    v_mfma_f32_16x16x32_bf16 v[108:111], a[144:147], v[96:99], v[108:111]
    s_waitcnt lgkmcnt(0)
    buffer_load_dwordx4 v250, s[64:67], s34 offen offset:2048 lds
    v_mfma_f32_16x16x32_bf16 a[64:67], a[160:163], v[160:163], a[64:67]
    v_exp_f32 v84, v84
    v_mfma_f32_16x16x32_bf16 a[64:67], a[164:167], v[164:167], a[64:67]
    ds_read_b128 a[128:131], v208 offset:8192
    v_cvt_pk_bf16_f32 v143, v62, v63
    v_mfma_f32_16x16x32_bf16 a[68:71], a[164:167], v[172:175], a[68:71]
    v_exp_f32 v85, v85
    v_mfma_f32_16x16x32_bf16 a[68:71], a[160:163], v[168:171], a[68:71]
    s_add_u32 s81, s78, 2457600
    ds_read_b128 a[132:135], v209 offset:8192
    ds_read_b128 a[136:139], v210 offset:8192
    v_mfma_f32_16x16x32_bf16 a[72:75], a[160:163], v[176:179], a[72:75]
    buffer_load_dwordx4 a[232:235], v249, s[16:19], s81 offen offset:3072 sc1
    v_exp_f32 v86, v86
    v_mfma_f32_16x16x32_bf16 a[72:75], a[164:167], v[180:183], a[72:75]
    ds_read_b128 a[140:143], v211 offset:8192
    v_cvt_pk_bf16_f32 v148, v84, v85
    v_mfma_f32_16x16x32_bf16 a[76:79], a[164:167], v[188:191], a[76:79]
    v_exp_f32 v87, v87
    v_mfma_f32_16x16x32_bf16 a[76:79], a[160:163], v[184:187], a[76:79]
    ds_read_b128 a[144:147], v208 offset:12288
    ds_read_b128 a[148:151], v209 offset:12288
    v_mfma_f32_16x16x32_bf16 a[92:95], a[168:171], v[184:187], a[92:95]
    s_add_u32 s81, s78, 2457600
    v_exp_f32 v92, v92
    v_mfma_f32_16x16x32_bf16 a[92:95], a[172:175], v[188:191], a[92:95]
    s_add_u32 s81, s81, s79
    ds_read_b128 a[152:155], v210 offset:12288
    v_cvt_pk_bf16_f32 v149, v86, v87
    v_mfma_f32_16x16x32_bf16 a[88:91], a[172:175], v[180:183], a[88:91]
    buffer_load_dwordx4 a[236:239], v249, s[16:19], s81 offen offset:0 sc1
    v_exp_f32 v93, v93
    v_mfma_f32_16x16x32_bf16 a[88:91], a[168:171], v[176:179], a[88:91]
    ds_read_b128 a[156:159], v211 offset:12288
    v_mfma_f32_16x16x32_bf16 a[84:87], a[168:171], v[168:171], a[84:87]
    v_exp_f32 v94, v94
    v_mfma_f32_16x16x32_bf16 a[84:87], a[172:175], v[172:175], a[84:87]
    v_cvt_pk_bf16_f32 v150, v92, v93
    v_mfma_f32_16x16x32_bf16 a[80:83], a[172:175], v[164:167], a[80:83]
    s_add_u32 s34, s92, 1185792
    v_exp_f32 v95, v95
    v_mfma_f32_16x16x32_bf16 a[80:83], a[168:171], v[160:163], a[80:83]
    buffer_load_dwordx4 v250, s[64:67], s34 offen offset:3072 lds
    v_mfma_f32_16x16x32_bf16 a[96:99], a[176:179], v[160:163], a[96:99]
    v_exp_f32 v116, v116
    v_mfma_f32_16x16x32_bf16 a[96:99], a[180:183], v[164:167], a[96:99]
    s_add_u32 m0, s38, 135168
    v_cvt_pk_bf16_f32 v151, v94, v95
    v_mfma_f32_16x16x32_bf16 a[100:103], a[180:183], v[172:175], a[100:103]
    s_add_u32 s34, s92, 1105920
    v_exp_f32 v117, v117
    v_mfma_f32_16x16x32_bf16 a[100:103], a[176:179], v[168:171], a[100:103]
    buffer_load_dwordx4 v250, s[68:71], s34 offen offset:0 lds
    v_mfma_f32_16x16x32_bf16 a[104:107], a[176:179], v[176:179], a[104:107]
    v_exp_f32 v118, v118
    v_mfma_f32_16x16x32_bf16 a[104:107], a[180:183], v[180:183], a[104:107]
    v_cvt_pk_bf16_f32 v156, v116, v117
    v_mfma_f32_16x16x32_bf16 a[108:111], a[180:183], v[188:191], a[108:111]
    s_add_u32 s34, s92, 1132544
    v_exp_f32 v119, v119
    v_mfma_f32_16x16x32_bf16 a[108:111], a[176:179], v[184:187], a[108:111]
    buffer_load_dwordx4 v250, s[68:71], s34 offen offset:1024 lds
    v_mfma_f32_16x16x32_bf16 a[124:127], a[184:187], v[184:187], a[124:127]
    v_exp_f32 v124, v124
    v_mfma_f32_16x16x32_bf16 a[124:127], a[188:191], v[188:191], a[124:127]
    v_cvt_pk_bf16_f32 v157, v118, v119
    v_mfma_f32_16x16x32_bf16 a[120:123], a[188:191], v[180:183], a[120:123]
    s_add_u32 s34, s92, 1159168
    v_exp_f32 v125, v125
    v_mfma_f32_16x16x32_bf16 a[120:123], a[184:187], v[176:179], a[120:123]
    buffer_load_dwordx4 v250, s[68:71], s34 offen offset:2048 lds
    v_mfma_f32_16x16x32_bf16 a[116:119], a[184:187], v[168:171], a[116:119]
    v_exp_f32 v126, v126
    v_mfma_f32_16x16x32_bf16 a[116:119], a[188:191], v[172:175], a[116:119]
    v_cvt_pk_bf16_f32 v158, v124, v125
    v_mfma_f32_16x16x32_bf16 a[112:115], a[188:191], v[164:167], a[112:115]
    s_add_u32 s34, s92, 1185792
    v_exp_f32 v127, v127
    v_mfma_f32_16x16x32_bf16 a[112:115], a[184:187], v[160:163], a[112:115]
    buffer_load_dwordx4 v250, s[68:71], s34 offen offset:3072 lds
    v_smfmac_f32_16x16x64_bf16 a[208:211], a[200:203], v[176:183], v243
    s_waitcnt vmcnt(35) lgkmcnt(0)
    v_cvt_pk_bf16_f32 v159, v126, v127
    v_smfmac_f32_16x16x64_bf16 a[208:211], a[204:207], v[184:191], v243
    s_barrier
    v_mfma_f32_16x16x32_bf16 v[20:23], a[128:131], v[0:3], v[192:195]
    v_exp_f32 v4, v4
    v_mfma_f32_16x16x32_bf16 v[20:23], a[132:135], v[8:11], v[20:23]
    ds_read_b64_tr_b16 a[160:161], v212 offset:49152
    ds_read_b64_tr_b16 a[162:163], v212 offset:53248
    v_mfma_f32_16x16x32_bf16 v[20:23], a[136:139], v[16:19], v[20:23]
    v_exp_f32 v5, v5
    v_mfma_f32_16x16x32_bf16 v[20:23], a[140:143], v[24:27], v[20:23]
    ds_read_b64_tr_b16 a[164:165], v212 offset:57344
    ds_read_b64_tr_b16 a[166:167], v212 offset:61440
    v_mfma_f32_16x16x32_bf16 v[52:55], a[140:143], v[56:59], v[196:199]
    v_exp_f32 v6, v6
    v_mfma_f32_16x16x32_bf16 v[52:55], a[136:139], v[48:51], v[52:55]
    ds_read_b64_tr_b16 a[168:169], v213 offset:49152
    v_cvt_pk_bf16_f32 v160, v4, v5
    v_mfma_f32_16x16x32_bf16 v[52:55], a[132:135], v[40:43], v[52:55]
    v_exp_f32 v7, v7
    v_mfma_f32_16x16x32_bf16 v[52:55], a[128:131], v[32:35], v[52:55]
    ds_read_b64_tr_b16 a[170:171], v213 offset:53248
    ds_read_b64_tr_b16 a[172:173], v213 offset:57344
    v_mfma_f32_16x16x32_bf16 v[84:87], a[128:131], v[64:67], v[200:203]
    s_add_u32 m0, s38, 0
    v_exp_f32 v12, v12
    v_mfma_f32_16x16x32_bf16 v[84:87], a[132:135], v[72:75], v[84:87]
    s_add_u32 s34, s92, 110592
    ds_read_b64_tr_b16 a[174:175], v213 offset:61440
    v_cvt_pk_bf16_f32 v161, v6, v7
    v_mfma_f32_16x16x32_bf16 v[84:87], a[136:139], v[80:83], v[84:87]
    buffer_load_dwordx4 v250, s[64:67], s34 offen offset:0 lds
    v_exp_f32 v13, v13
    v_mfma_f32_16x16x32_bf16 v[84:87], a[140:143], v[88:91], v[84:87]
    ds_read_b64_tr_b16 a[176:177], v214 offset:49152
    ds_read_b64_tr_b16 a[178:179], v214 offset:53248
    v_mfma_f32_16x16x32_bf16 v[116:119], a[140:143], v[120:123], v[204:207]
    v_exp_f32 v14, v14
    v_mfma_f32_16x16x32_bf16 v[116:119], a[136:139], v[112:115], v[116:119]
    ds_read_b64_tr_b16 a[180:181], v214 offset:57344
    v_cvt_pk_bf16_f32 v162, v12, v13
    v_mfma_f32_16x16x32_bf16 v[116:119], a[132:135], v[104:107], v[116:119]
    v_exp_f32 v15, v15
    v_mfma_f32_16x16x32_bf16 v[116:119], a[128:131], v[96:99], v[116:119]
    s_add_u32 s34, s92, 137216
    ds_read_b64_tr_b16 a[182:183], v214 offset:61440
    ds_read_b64_tr_b16 a[184:185], v215 offset:49152
    v_mfma_f32_16x16x32_bf16 v[28:31], a[144:147], v[0:3], v[192:195]
    buffer_load_dwordx4 v250, s[64:67], s34 offen offset:1024 lds
    v_exp_f32 v36, v36
    v_mfma_f32_16x16x32_bf16 v[28:31], a[148:151], v[8:11], v[28:31]
HOP0_6:
    s_cbranch_execz HOPRET0
    ds_read_b64_tr_b16 a[186:187], v215 offset:53248
    v_cvt_pk_bf16_f32 v163, v14, v15
    v_mfma_f32_16x16x32_bf16 v[28:31], a[152:155], v[16:19], v[28:31]
    v_exp_f32 v37, v37
    v_mfma_f32_16x16x32_bf16 v[28:31], a[156:159], v[24:27], v[28:31]
    ds_read_b64_tr_b16 a[188:189], v215 offset:57344
    ds_read_b64_tr_b16 a[190:191], v215 offset:61440
    v_mfma_f32_16x16x32_bf16 v[60:63], a[156:159], v[56:59], v[196:199]
    v_exp_f32 v38, v38
    v_mfma_f32_16x16x32_bf16 v[60:63], a[152:155], v[48:51], v[60:63]
    v_xor_b32 v212, 0x10000, v212
    v_cvt_pk_bf16_f32 v168, v36, v37
    v_mfma_f32_16x16x32_bf16 v[60:63], a[148:151], v[40:43], v[60:63]
    s_add_u32 s34, s92, 163840
    v_exp_f32 v39, v39
    v_mfma_f32_16x16x32_bf16 v[60:63], a[144:147], v[32:35], v[60:63]
    buffer_load_dwordx4 v250, s[64:67], s34 offen offset:2048 lds
    v_mfma_f32_16x16x32_bf16 v[92:95], a[144:147], v[64:67], v[200:203]
    v_exp_f32 v44, v44
    v_mfma_f32_16x16x32_bf16 v[92:95], a[148:151], v[72:75], v[92:95]
    v_xor_b32 v213, 0x10000, v213
    v_cvt_pk_bf16_f32 v169, v38, v39
    v_mfma_f32_16x16x32_bf16 v[92:95], a[152:155], v[80:83], v[92:95]
    s_add_u32 s34, s92, 190464
    v_exp_f32 v45, v45
    v_mfma_f32_16x16x32_bf16 v[92:95], a[156:159], v[88:91], v[92:95]
    buffer_load_dwordx4 v250, s[64:67], s34 offen offset:3072 lds
    v_mfma_f32_16x16x32_bf16 v[124:127], a[156:159], v[120:123], v[204:207]
    v_exp_f32 v46, v46
    v_mfma_f32_16x16x32_bf16 v[124:127], a[152:155], v[112:115], v[124:127]
    s_add_u32 m0, s38, 4096
    v_xor_b32 v214, 0x10000, v214
    v_xor_b32 v215, 0x10000, v215
    v_cvt_pk_bf16_f32 v170, v44, v45
    v_mfma_f32_16x16x32_bf16 v[124:127], a[148:151], v[104:107], v[124:127]
    s_add_u32 s34, s92, 110592
    v_exp_f32 v47, v47
    v_mfma_f32_16x16x32_bf16 v[124:127], a[144:147], v[96:99], v[124:127]
    s_waitcnt lgkmcnt(0)
    buffer_load_dwordx4 v250, s[68:71], s34 offen offset:0 lds
    v_mfma_f32_16x16x32_bf16 a[0:3], a[160:163], v[128:131], a[0:3]
    v_exp_f32 v68, v68
    v_mfma_f32_16x16x32_bf16 a[0:3], a[164:167], v[132:135], a[0:3]
    ds_read_b64_tr_b16 a[128:129], v216 offset:49152
    v_cvt_pk_bf16_f32 v171, v46, v47
    v_mfma_f32_16x16x32_bf16 a[4:7], a[164:167], v[140:143], a[4:7]
    v_exp_f32 v69, v69
    v_mfma_f32_16x16x32_bf16 a[4:7], a[160:163], v[136:139], a[4:7]
    ds_read_b64_tr_b16 a[130:131], v216 offset:53248
    ds_read_b64_tr_b16 a[132:133], v216 offset:57344
    v_mfma_f32_16x16x32_bf16 a[8:11], a[160:163], v[144:147], a[8:11]
    v_exp_f32 v70, v70
    v_mfma_f32_16x16x32_bf16 a[8:11], a[164:167], v[148:151], a[8:11]
    ds_read_b64_tr_b16 a[134:135], v216 offset:61440
    v_cvt_pk_bf16_f32 v176, v68, v69
    v_mfma_f32_16x16x32_bf16 a[12:15], a[164:167], v[156:159], a[12:15]
    v_exp_f32 v71, v71
    v_mfma_f32_16x16x32_bf16 a[12:15], a[160:163], v[152:155], a[12:15]
    ds_read_b64_tr_b16 a[136:137], v217 offset:49152
    ds_read_b64_tr_b16 a[138:139], v217 offset:53248
    v_mfma_f32_16x16x32_bf16 a[28:31], a[168:171], v[152:155], a[28:31]
    v_exp_f32 v76, v76
    v_mfma_f32_16x16x32_bf16 a[28:31], a[172:175], v[156:159], a[28:31]
    ds_read_b64_tr_b16 a[140:141], v217 offset:57344
    v_cvt_pk_bf16_f32 v177, v70, v71
    v_mfma_f32_16x16x32_bf16 a[24:27], a[172:175], v[148:151], a[24:27]
    v_exp_f32 v77, v77
    v_mfma_f32_16x16x32_bf16 a[24:27], a[168:171], v[144:147], a[24:27]
    ds_read_b64_tr_b16 a[142:143], v217 offset:61440
    ds_read_b64_tr_b16 a[144:145], v218 offset:49152
    v_mfma_f32_16x16x32_bf16 a[20:23], a[168:171], v[136:139], a[20:23]
    v_exp_f32 v78, v78
    v_mfma_f32_16x16x32_bf16 a[20:23], a[172:175], v[140:143], a[20:23]
    ds_read_b64_tr_b16 a[146:147], v218 offset:53248
    v_cvt_pk_bf16_f32 v178, v76, v77
    v_mfma_f32_16x16x32_bf16 a[16:19], a[172:175], v[132:135], a[16:19]
    v_exp_f32 v79, v79
    v_mfma_f32_16x16x32_bf16 a[16:19], a[168:171], v[128:131], a[16:19]
    ds_read_b64_tr_b16 a[148:149], v218 offset:57344
    ds_read_b64_tr_b16 a[150:151], v218 offset:61440
    v_mfma_f32_16x16x32_bf16 a[32:35], a[176:179], v[128:131], a[32:35]
    v_exp_f32 v100, v100
    v_mfma_f32_16x16x32_bf16 a[32:35], a[180:183], v[132:135], a[32:35]
    ds_read_b64_tr_b16 a[152:153], v219 offset:49152
    v_cvt_pk_bf16_f32 v179, v78, v79
    v_mfma_f32_16x16x32_bf16 a[36:39], a[180:183], v[140:143], a[36:39]
    v_exp_f32 v101, v101
    v_mfma_f32_16x16x32_bf16 a[36:39], a[176:179], v[136:139], a[36:39]
    ds_read_b64_tr_b16 a[154:155], v219 offset:53248
    ds_read_b64_tr_b16 a[156:157], v219 offset:57344
    v_mfma_f32_16x16x32_bf16 a[40:43], a[176:179], v[144:147], a[40:43]
    v_exp_f32 v102, v102
    v_mfma_f32_16x16x32_bf16 a[40:43], a[180:183], v[148:151], a[40:43]
    ds_read_b64_tr_b16 a[158:159], v219 offset:61440
    v_cvt_pk_bf16_f32 v184, v100, v101
    v_mfma_f32_16x16x32_bf16 a[44:47], a[180:183], v[156:159], a[44:47]
    s_add_u32 s34, s92, 137216
    v_exp_f32 v103, v103
    v_mfma_f32_16x16x32_bf16 a[44:47], a[176:179], v[152:155], a[44:47]
    buffer_load_dwordx4 v250, s[68:71], s34 offen offset:1024 lds
    v_mfma_f32_16x16x32_bf16 a[60:63], a[184:187], v[152:155], a[60:63]
    v_exp_f32 v108, v108
    v_mfma_f32_16x16x32_bf16 a[60:63], a[188:191], v[156:159], a[60:63]
    v_xor_b32 v216, 0x10000, v216
    v_cvt_pk_bf16_f32 v185, v102, v103
    v_mfma_f32_16x16x32_bf16 a[56:59], a[188:191], v[148:151], a[56:59]
    s_add_u32 s34, s92, 163840
    v_exp_f32 v109, v109
    v_mfma_f32_16x16x32_bf16 a[56:59], a[184:187], v[144:147], a[56:59]
    buffer_load_dwordx4 v250, s[68:71], s34 offen offset:2048 lds
    v_mfma_f32_16x16x32_bf16 a[52:55], a[184:187], v[136:139], a[52:55]
    v_exp_f32 v110, v110
    v_mfma_f32_16x16x32_bf16 a[52:55], a[188:191], v[140:143], a[52:55]
    v_xor_b32 v217, 0x10000, v217
    v_cvt_pk_bf16_f32 v186, v108, v109
    v_mfma_f32_16x16x32_bf16 a[48:51], a[188:191], v[132:135], a[48:51]
    s_add_u32 s34, s92, 190464
    v_exp_f32 v111, v111
    v_mfma_f32_16x16x32_bf16 a[48:51], a[184:187], v[128:131], a[48:51]
    buffer_load_dwordx4 v250, s[68:71], s34 offen offset:3072 lds
    v_smfmac_f32_16x16x64_bf16 a[208:211], a[192:195], v[128:135], v243
    s_waitcnt vmcnt(35) lgkmcnt(0)
    v_xor_b32 v218, 0x10000, v218
    v_xor_b32 v219, 0x10000, v219
    v_cvt_pk_bf16_f32 v187, v110, v111
    v_smfmac_f32_16x16x64_bf16 a[208:211], a[196:199], v[136:143], v243
    s_barrier
    v_mfma_f32_16x16x32_bf16 a[64:67], a[128:131], v[128:131], a[64:67]
    v_exp_f32 v20, v20
    v_mfma_f32_16x16x32_bf16 a[64:67], a[132:135], v[132:135], a[64:67]
    ds_read_b64_tr_b16 a[160:161], v212 offset:16384
    ds_read_b64_tr_b16 a[162:163], v212 offset:20480
    v_mfma_f32_16x16x32_bf16 a[68:71], a[132:135], v[140:143], a[68:71]
    v_exp_f32 v21, v21
    v_mfma_f32_16x16x32_bf16 a[68:71], a[128:131], v[136:139], a[68:71]
    s_add_u32 s81, s78, 163840
    ds_read_b64_tr_b16 a[164:165], v213 offset:16384
    ds_read_b64_tr_b16 a[166:167], v213 offset:20480
    v_mfma_f32_16x16x32_bf16 a[72:75], a[128:131], v[144:147], a[72:75]
    buffer_load_dwordx4 v[100:103], v249, s[16:19], s81 offen offset:0 sc1
    v_exp_f32 v22, v22
    v_mfma_f32_16x16x32_bf16 a[72:75], a[132:135], v[148:151], a[72:75]
    ds_read_b64_tr_b16 a[168:169], v214 offset:16384
    v_cvt_pk_bf16_f32 v164, v20, v21
    v_mfma_f32_16x16x32_bf16 a[76:79], a[132:135], v[156:159], a[76:79]
    v_exp_f32 v23, v23
    v_mfma_f32_16x16x32_bf16 a[76:79], a[128:131], v[152:155], a[76:79]
    ds_read_b64_tr_b16 a[170:171], v214 offset:20480
    ds_read_b64_tr_b16 a[172:173], v215 offset:16384
    v_mfma_f32_16x16x32_bf16 a[92:95], a[136:139], v[152:155], a[92:95]
    v_exp_f32 v28, v28
    v_mfma_f32_16x16x32_bf16 a[92:95], a[140:143], v[156:159], a[92:95]
    s_add_u32 s81, s78, 163840
    ds_read_b64_tr_b16 a[174:175], v215 offset:20480
    v_cvt_pk_bf16_f32 v165, v22, v23
    v_mfma_f32_16x16x32_bf16 a[88:91], a[140:143], v[148:151], a[88:91]
    buffer_load_dwordx4 v[108:111], v249, s[16:19], s81 offen offset:2048 sc1
    v_exp_f32 v29, v29
    v_mfma_f32_16x16x32_bf16 a[88:91], a[136:139], v[144:147], a[88:91]
    ds_read_b64_tr_b16 a[176:177], v216 offset:16384
    ds_read_b64_tr_b16 a[178:179], v216 offset:20480
    v_mfma_f32_16x16x32_bf16 a[84:87], a[136:139], v[136:139], a[84:87]
    v_exp_f32 v30, v30
    v_mfma_f32_16x16x32_bf16 a[84:87], a[140:143], v[140:143], a[84:87]
    ds_read_b64_tr_b16 a[180:181], v217 offset:16384
    v_cvt_pk_bf16_f32 v166, v28, v29
    v_mfma_f32_16x16x32_bf16 a[80:83], a[140:143], v[132:135], a[80:83]
    v_exp_f32 v31, v31
    v_mfma_f32_16x16x32_bf16 a[80:83], a[136:139], v[128:131], a[80:83]
    s_add_u32 s81, s78, 1802240
    ds_read_b64_tr_b16 a[182:183], v217 offset:20480
    ds_read_b64_tr_b16 a[184:185], v218 offset:16384
    v_mfma_f32_16x16x32_bf16 a[96:99], a[144:147], v[128:131], a[96:99]
    buffer_load_dwordx4 v[192:195], v249, s[16:19], s81 offen offset:1024 sc1
    v_exp_f32 v52, v52
    v_mfma_f32_16x16x32_bf16 a[96:99], a[148:151], v[132:135], a[96:99]
    ds_read_b64_tr_b16 a[186:187], v218 offset:20480
    v_cvt_pk_bf16_f32 v167, v30, v31
    v_mfma_f32_16x16x32_bf16 a[100:103], a[148:151], v[140:143], a[100:103]
    v_exp_f32 v53, v53
    v_mfma_f32_16x16x32_bf16 a[100:103], a[144:147], v[136:139], a[100:103]
    ds_read_b64_tr_b16 a[188:189], v219 offset:16384
    ds_read_b64_tr_b16 a[190:191], v219 offset:20480
    v_mfma_f32_16x16x32_bf16 a[104:107], a[144:147], v[144:147], a[104:107]
    v_exp_f32 v54, v54
    v_mfma_f32_16x16x32_bf16 a[104:107], a[148:151], v[148:151], a[104:107]
    v_cvt_pk_bf16_f32 v172, v52, v53
    v_mfma_f32_16x16x32_bf16 a[108:111], a[148:151], v[156:159], a[108:111]
    s_add_u32 s81, s78, 1802240
    v_exp_f32 v55, v55
    v_mfma_f32_16x16x32_bf16 a[108:111], a[144:147], v[152:155], a[108:111]
    buffer_load_dwordx4 v[196:199], v249, s[16:19], s81 offen offset:2048 sc1
    v_mfma_f32_16x16x32_bf16 a[124:127], a[152:155], v[152:155], a[124:127]
    v_exp_f32 v60, v60
    v_mfma_f32_16x16x32_bf16 a[124:127], a[156:159], v[156:159], a[124:127]
    v_cvt_pk_bf16_f32 v173, v54, v55
    v_mfma_f32_16x16x32_bf16 a[120:123], a[156:159], v[148:151], a[120:123]
    s_add_u32 s81, s78, 1802240
    v_exp_f32 v61, v61
    v_mfma_f32_16x16x32_bf16 a[120:123], a[152:155], v[144:147], a[120:123]
    buffer_load_dwordx4 v[200:203], v249, s[16:19], s81 offen offset:3072 sc1
    v_mfma_f32_16x16x32_bf16 a[116:119], a[152:155], v[136:139], a[116:119]
    v_exp_f32 v62, v62
    v_mfma_f32_16x16x32_bf16 a[116:119], a[156:159], v[140:143], a[116:119]
    s_add_u32 s81, s78, 1802240
    v_cvt_pk_bf16_f32 v174, v60, v61
    v_mfma_f32_16x16x32_bf16 a[112:115], a[156:159], v[132:135], a[112:115]
    s_add_u32 s81, s81, s79
    v_exp_f32 v63, v63
    v_mfma_f32_16x16x32_bf16 a[112:115], a[152:155], v[128:131], a[112:115]
    s_waitcnt lgkmcnt(0)
    buffer_load_dwordx4 v[204:207], v249, s[16:19], s81 offen offset:0 sc1
    v_mfma_f32_16x16x32_bf16 a[0:3], a[160:163], v[160:163], a[0:3]
    s_mul_i32 s3, s22, 3072
    v_exp_f32 v84, v84
    v_mfma_f32_16x16x32_bf16 a[4:7], a[160:163], v[168:171], a[4:7]
    s_add_u32 m0, s3, 36864
    ds_read_b64_tr_b16 a[128:129], v212 offset:24576
    v_cvt_pk_bf16_f32 v175, v62, v63
    v_mfma_f32_16x16x32_bf16 a[8:11], a[160:163], v[176:179], a[8:11]
    buffer_load_dwordx4 v228, s[72:75], s84 offen offset:0 lds
    v_exp_f32 v85, v85
    v_mfma_f32_16x16x32_bf16 a[12:15], a[160:163], v[184:187], a[12:15]
    ds_read_b64_tr_b16 a[130:131], v212 offset:28672
    ds_read_b64_tr_b16 a[132:133], v213 offset:24576
    v_mfma_f32_16x16x32_bf16 a[28:31], a[164:167], v[184:187], a[28:31]
    v_exp_f32 v86, v86
    v_mfma_f32_16x16x32_bf16 a[24:27], a[164:167], v[176:179], a[24:27]
    s_add_u32 s81, s78, 327680
    ds_read_b64_tr_b16 a[134:135], v213 offset:28672
    v_cvt_pk_bf16_f32 v180, v84, v85
    v_mfma_f32_16x16x32_bf16 a[20:23], a[164:167], v[168:171], a[20:23]
    buffer_load_dwordx4 v[128:131], v249, s[16:19], s81 offen offset:2048 sc1
    v_exp_f32 v87, v87
    v_mfma_f32_16x16x32_bf16 a[16:19], a[164:167], v[160:163], a[16:19]
    ds_read_b64_tr_b16 a[136:137], v214 offset:24576
    ds_read_b64_tr_b16 a[138:139], v214 offset:28672
    v_mfma_f32_16x16x32_bf16 a[32:35], a[168:171], v[160:163], a[32:35]
    s_mul_i32 s3, s22, 3072
    v_exp_f32 v92, v92
    v_mfma_f32_16x16x32_bf16 a[36:39], a[168:171], v[168:171], a[36:39]
    s_add_u32 m0, s3, 37824
    ds_read_b64_tr_b16 a[140:141], v215 offset:24576
    v_cvt_pk_bf16_f32 v181, v86, v87
    v_mfma_f32_16x16x32_bf16 a[40:43], a[168:171], v[176:179], a[40:43]
    buffer_load_dwordx4 v228, s[72:75], s84 offen offset:64 lds
    v_exp_f32 v93, v93
    v_mfma_f32_16x16x32_bf16 a[44:47], a[168:171], v[184:187], a[44:47]
    ds_read_b64_tr_b16 a[142:143], v215 offset:28672
    ds_read_b64_tr_b16 a[144:145], v216 offset:24576
    v_mfma_f32_16x16x32_bf16 a[60:63], a[172:175], v[184:187], a[60:63]
    v_exp_f32 v94, v94
    v_mfma_f32_16x16x32_bf16 a[56:59], a[172:175], v[176:179], a[56:59]
    s_add_u32 s81, s78, 327680
    ds_read_b64_tr_b16 a[146:147], v216 offset:28672
    v_cvt_pk_bf16_f32 v182, v92, v93
    v_mfma_f32_16x16x32_bf16 a[52:55], a[172:175], v[168:171], a[52:55]
    buffer_load_dwordx4 v[132:135], v249, s[16:19], s81 offen offset:3072 sc1
    v_exp_f32 v95, v95
    v_mfma_f32_16x16x32_bf16 a[48:51], a[172:175], v[160:163], a[48:51]
    ds_read_b64_tr_b16 a[148:149], v217 offset:24576
    ds_read_b64_tr_b16 a[150:151], v217 offset:28672
    v_mfma_f32_16x16x32_bf16 a[64:67], a[176:179], v[160:163], a[64:67]
    s_mul_i32 s3, s22, 3072
    v_exp_f32 v116, v116
    v_mfma_f32_16x16x32_bf16 a[68:71], a[176:179], v[168:171], a[68:71]
    s_add_u32 m0, s3, 38912
    ds_read_b64_tr_b16 a[152:153], v218 offset:24576
    v_cvt_pk_bf16_f32 v183, v94, v95
    v_mfma_f32_16x16x32_bf16 a[72:75], a[176:179], v[176:179], a[72:75]
    buffer_load_dwordx4 v228, s[72:75], s85 offen offset:0 lds
    v_exp_f32 v117, v117
    v_mfma_f32_16x16x32_bf16 a[76:79], a[176:179], v[184:187], a[76:79]
    ds_read_b64_tr_b16 a[154:155], v218 offset:28672
    ds_read_b64_tr_b16 a[156:157], v219 offset:24576
    v_mfma_f32_16x16x32_bf16 a[92:95], a[180:183], v[184:187], a[92:95]
    v_exp_f32 v118, v118
    v_mfma_f32_16x16x32_bf16 a[88:91], a[180:183], v[176:179], a[88:91]
    s_add_u32 s81, s78, 327680
    ds_read_b64_tr_b16 a[158:159], v219 offset:28672
    v_cvt_pk_bf16_f32 v188, v116, v117
    v_mfma_f32_16x16x32_bf16 a[84:87], a[180:183], v[168:171], a[84:87]
    s_add_u32 s81, s81, s79
    v_exp_f32 v119, v119
    v_mfma_f32_16x16x32_bf16 a[80:83], a[180:183], v[160:163], a[80:83]
    buffer_load_dwordx4 v[136:139], v249, s[16:19], s81 offen offset:0 sc1
    v_mfma_f32_16x16x32_bf16 a[96:99], a[184:187], v[160:163], a[96:99]
    v_exp_f32 v124, v124
    v_mfma_f32_16x16x32_bf16 a[100:103], a[184:187], v[168:171], a[100:103]
    v_cvt_pk_bf16_f32 v189, v118, v119
    v_mfma_f32_16x16x32_bf16 a[104:107], a[184:187], v[176:179], a[104:107]
    s_add_u32 s81, s78, 491520
    v_exp_f32 v125, v125
    v_mfma_f32_16x16x32_bf16 a[108:111], a[184:187], v[184:187], a[108:111]
    buffer_load_dwordx4 v[140:143], v249, s[16:19], s81 offen offset:0 sc1
    v_mfma_f32_16x16x32_bf16 a[124:127], a[188:191], v[184:187], a[124:127]
    v_exp_f32 v126, v126
    v_mfma_f32_16x16x32_bf16 a[120:123], a[188:191], v[176:179], a[120:123]
    v_cvt_pk_bf16_f32 v190, v124, v125
    v_mfma_f32_16x16x32_bf16 a[116:119], a[188:191], v[168:171], a[116:119]
    v_exp_f32 v127, v127
    v_mfma_f32_16x16x32_bf16 a[112:115], a[188:191], v[160:163], a[112:115]
    v_smfmac_f32_16x16x64_bf16 a[208:211], a[200:203], v[144:151], v243
    s_waitcnt lgkmcnt(0)
    v_cvt_pk_bf16_f32 v191, v126, v127
    v_smfmac_f32_16x16x64_bf16 a[208:211], a[204:207], v[152:159], v243
    s_nop 0
    v_smfmac_f32_16x16x64_bf16 a[208:211], a[192:195], v[160:167], v243
    s_lshl_b32 s98, s22, 2
    v_smfmac_f32_16x16x64_bf16 a[208:211], a[196:199], v[168:175], v243
    s_add_u32 s99, s98, 32768
    s_add_u32 s81, s78, 0
    buffer_load_dwordx4 v[84:87], v249, s[16:19], s81 offen offset:1024 sc1
    v_smfmac_f32_16x16x64_bf16 a[208:211], a[200:203], v[176:183], v243
    s_lshl_b32 s3, s21, 2
    v_smfmac_f32_16x16x64_bf16 a[208:211], a[204:207], v[184:191], v243
    s_add_u32 s3, s3, s22
    v_mov_b32 v241, s99
    v_mfma_f32_16x16x32_bf16 a[0:3], a[128:131], v[164:167], a[0:3]
    s_lshl_b32 s3, s3, 19
    s_add_u32 s81, s78, 0
    buffer_load_dwordx4 v[92:95], v249, s[16:19], s81 offen offset:3072 sc1
    v_mfma_f32_16x16x32_bf16 a[16:19], a[132:135], v[164:167], a[16:19]
    s_lshl_b32 s98, s20, 12
    v_mov_b32 v240, 32768
    v_mfma_f32_16x16x32_bf16 a[4:7], a[128:131], v[172:175], a[4:7]
    s_add_u32 s3, s3, s98
    s_add_u32 s81, s78, 163840
    s_add_u32 s81, s81, s79
    buffer_load_dwordx4 v[116:119], v249, s[16:19], s81 offen offset:0 sc1
    v_mfma_f32_16x16x32_bf16 a[20:23], a[132:135], v[172:175], a[20:23]
    s_add_u32 s30, s3, 4194304
    v_mfma_f32_16x16x32_bf16 a[8:11], a[128:131], v[180:183], a[8:11]
    s_add_u32 s31, s3, 4325376
    s_add_u32 s81, s78, 327680
    buffer_load_dwordx4 v[124:127], v249, s[16:19], s81 offen offset:1024 sc1
    v_mfma_f32_16x16x32_bf16 a[24:27], a[132:135], v[180:183], a[24:27]
    s_add_u32 s32, s3, 4456448
    v_accvgpr_read_b32 v220, a208
    v_accvgpr_read_b32 v221, a209
    v_mfma_f32_16x16x32_bf16 a[12:15], a[128:131], v[188:191], a[12:15]
    s_add_u32 s33, s3, 4587520
    v_accvgpr_read_b32 v222, a210
    v_accvgpr_read_b32 v223, a211
    v_mfma_f32_16x16x32_bf16 a[28:31], a[132:135], v[188:191], a[28:31]
    s_lshr_b32 s3, s37, 2
    v_accvgpr_read_b32 v236, a208
    v_accvgpr_read_b32 v237, a209
    v_mfma_f32_16x16x32_bf16 a[32:35], a[136:139], v[164:167], a[32:35]
    s_add_u32 m0, s3, 94208
    v_accvgpr_read_b32 v238, a210
    v_accvgpr_read_b32 v239, a211
    v_mfma_f32_16x16x32_bf16 a[48:51], a[140:143], v[164:167], a[48:51]
    s_mov_b32 s3, 0x5d800000
    v_permlane16_swap_b32 v236, v220
    v_permlane16_swap_b32 v237, v221
    v_mfma_f32_16x16x32_bf16 a[36:39], a[136:139], v[172:175], a[36:39]
    v_permlane16_swap_b32 v238, v222
    v_permlane16_swap_b32 v239, v223
    v_mfma_f32_16x16x32_bf16 a[52:55], a[140:143], v[172:175], a[52:55]
    v_add_f32 v220, v220, v236
    v_add_f32 v221, v221, v237
    v_mfma_f32_16x16x32_bf16 a[40:43], a[136:139], v[180:183], a[40:43]
    v_add_f32 v222, v222, v238
    v_add_f32 v223, v223, v239
    v_mfma_f32_16x16x32_bf16 a[56:59], a[140:143], v[180:183], a[56:59]
    v_add_f32 v236, v220, v221
    v_add_f32 v237, v222, v223
    v_mfma_f32_16x16x32_bf16 a[44:47], a[136:139], v[188:191], a[44:47]
    v_add_f32 v236, v236, v237
    v_cmp_nge_f32 vcc, s3, v236
    v_mfma_f32_16x16x32_bf16 a[60:63], a[140:143], v[188:191], a[60:63]
    v_rcp_f32 v220, v220
    v_mfma_f32_16x16x32_bf16 a[64:67], a[144:147], v[164:167], a[64:67]
    s_or_b32 s3, vcc_lo, vcc_hi
    v_mov_b32 v242, s3
    v_accvgpr_read_b32 v4, a0
    v_mfma_f32_16x16x32_bf16 a[80:83], a[148:151], v[164:167], a[80:83]
    ds_write_b32 v241, v242
    v_accvgpr_read_b32 v5, a1
    v_mfma_f32_16x16x32_bf16 a[68:71], a[144:147], v[172:175], a[68:71]
    v_accvgpr_read_b32 v6, a2
    v_accvgpr_read_b32 v7, a3
    v_mfma_f32_16x16x32_bf16 a[84:87], a[148:151], v[172:175], a[84:87]
    v_accvgpr_read_b32 v12, a16
    v_accvgpr_read_b32 v13, a17
    v_mfma_f32_16x16x32_bf16 a[72:75], a[144:147], v[180:183], a[72:75]
    s_add_u32 s81, s78, 491520
    buffer_load_dwordx4 v[144:147], v249, s[16:19], s81 offen offset:1024 sc1
    v_mfma_f32_16x16x32_bf16 a[88:91], a[148:151], v[180:183], a[88:91]
    v_accvgpr_read_b32 v14, a18
    v_accvgpr_read_b32 v15, a19
    v_mfma_f32_16x16x32_bf16 a[76:79], a[144:147], v[188:191], a[76:79]
    s_waitcnt lgkmcnt(0)
    v_mul_f32 v4, v4, v220
    v_mul_f32 v5, v5, v220
    v_mfma_f32_16x16x32_bf16 a[92:95], a[148:151], v[188:191], a[92:95]
    s_barrier
    v_mul_f32 v6, v6, v220
    v_mul_f32 v7, v7, v220
    v_mfma_f32_16x16x32_bf16 a[96:99], a[152:155], v[164:167], a[96:99]
    ds_read_b128 v[236:239], v240
    v_mul_f32 v12, v12, v220
    v_mfma_f32_16x16x32_bf16 a[112:115], a[156:159], v[164:167], a[112:115]
    s_add_u32 s81, s78, 491520
    buffer_load_dwordx4 v[148:151], v249, s[16:19], s81 offen offset:2048 sc1
    v_mfma_f32_16x16x32_bf16 a[100:103], a[152:155], v[172:175], a[100:103]
    v_mul_f32 v13, v13, v220
    v_mul_f32 v14, v14, v220
    v_mfma_f32_16x16x32_bf16 a[116:119], a[156:159], v[172:175], a[116:119]
    v_mul_f32 v15, v15, v220
    v_cvt_pk_bf16_f32 v20, v4, v5
    v_mfma_f32_16x16x32_bf16 a[104:107], a[152:155], v[180:183], a[104:107]
    v_cvt_pk_bf16_f32 v21, v6, v7
    v_cvt_pk_bf16_f32 v22, v12, v13
    v_mfma_f32_16x16x32_bf16 a[120:123], a[156:159], v[180:183], a[120:123]
    s_waitcnt lgkmcnt(0)
    v_cvt_pk_bf16_f32 v23, v14, v15
    v_or3_b32 v236, v236, v237, v238
    v_mfma_f32_16x16x32_bf16 a[108:111], a[152:155], v[188:191], a[108:111]
    buffer_store_dwordx4 v[20:23], v249, s[16:19], s30 offen offset:0 sc1
    v_mfma_f32_16x16x32_bf16 a[124:127], a[156:159], v[188:191], a[124:127]
    v_or_b32 v236, v236, v239
    v_cmp_ne_u32 vcc, 0, v236
    v_rcp_f32 v221, v221
    v_rcp_f32 v222, v222
    v_rcp_f32 v223, v223
    s_cbranch_vccnz K1_retry
K1_noretry:
    buffer_load_dwordx4 v248, s[16:19], 0 offen sc1 lds
    s_bitcmp1_b32 s2, 3
    s_cbranch_scc1 K1_eb
    v_accvgpr_read_b32 v28, a4
    v_accvgpr_read_b32 v29, a5
    v_accvgpr_read_b32 v30, a6
    v_accvgpr_read_b32 v31, a7
    v_accvgpr_read_b32 v36, a20
    v_accvgpr_read_b32 v37, a21
    v_accvgpr_read_b32 v38, a22
    v_accvgpr_read_b32 v39, a23
    v_pk_mul_f32 v[28:29], v[28:29], v[220:221] op_sel:[0,1]
    v_pk_mul_f32 v[30:31], v[30:31], v[220:221] op_sel:[0,1]
    v_pk_mul_f32 v[36:37], v[36:37], v[220:221] op_sel:[0,1]
    v_pk_mul_f32 v[38:39], v[38:39], v[220:221] op_sel:[0,1]
    v_cvt_pk_bf16_f32 v44, v28, v29
    v_cvt_pk_bf16_f32 v45, v30, v31
    v_cvt_pk_bf16_f32 v46, v36, v37
    v_cvt_pk_bf16_f32 v47, v38, v39
    buffer_store_dwordx4 v[44:47], v249, s[16:19], s31 offen offset:0 sc1
    v_accvgpr_read_b32 v52, a8
    v_accvgpr_read_b32 v53, a9
    v_accvgpr_read_b32 v54, a10
    v_accvgpr_read_b32 v55, a11
    v_accvgpr_read_b32 v60, a24
    v_accvgpr_read_b32 v61, a25
    v_accvgpr_read_b32 v62, a26
    v_accvgpr_read_b32 v63, a27
    v_pk_mul_f32 v[52:53], v[52:53], v[222:223] op_sel_hi:[1,0]
    v_pk_mul_f32 v[54:55], v[54:55], v[222:223] op_sel_hi:[1,0]
    v_pk_mul_f32 v[60:61], v[60:61], v[222:223] op_sel_hi:[1,0]
    v_pk_mul_f32 v[62:63], v[62:63], v[222:223] op_sel_hi:[1,0]
    v_cvt_pk_bf16_f32 v68, v52, v53
    v_cvt_pk_bf16_f32 v69, v54, v55
    v_cvt_pk_bf16_f32 v70, v60, v61
    v_cvt_pk_bf16_f32 v71, v62, v63
    buffer_store_dwordx4 v[68:71], v249, s[16:19], s32 offen offset:0 sc1
    v_accvgpr_read_b32 v4, a12
    v_accvgpr_read_b32 v5, a13
    v_accvgpr_read_b32 v6, a14
    v_accvgpr_read_b32 v7, a15
    v_accvgpr_read_b32 v12, a28
    v_accvgpr_read_b32 v13, a29
    v_accvgpr_read_b32 v14, a30
    v_accvgpr_read_b32 v15, a31
    v_pk_mul_f32 v[4:5], v[4:5], v[222:223] op_sel:[0,1]
    v_pk_mul_f32 v[6:7], v[6:7], v[222:223] op_sel:[0,1]
    v_pk_mul_f32 v[12:13], v[12:13], v[222:223] op_sel:[0,1]
    v_pk_mul_f32 v[14:15], v[14:15], v[222:223] op_sel:[0,1]
    v_cvt_pk_bf16_f32 v20, v4, v5
    v_cvt_pk_bf16_f32 v21, v6, v7
    v_cvt_pk_bf16_f32 v22, v12, v13
    v_cvt_pk_bf16_f32 v23, v14, v15
    buffer_store_dwordx4 v[20:23], v249, s[16:19], s33 offen offset:0 sc1
    v_accvgpr_read_b32 v28, a32
    v_accvgpr_read_b32 v29, a33
    v_accvgpr_read_b32 v30, a34
    v_accvgpr_read_b32 v31, a35
    v_accvgpr_read_b32 v36, a48
    v_accvgpr_read_b32 v37, a49
    v_accvgpr_read_b32 v38, a50
    v_accvgpr_read_b32 v39, a51
    v_pk_mul_f32 v[28:29], v[28:29], v[220:221] op_sel_hi:[1,0]
    v_pk_mul_f32 v[30:31], v[30:31], v[220:221] op_sel_hi:[1,0]
    v_pk_mul_f32 v[36:37], v[36:37], v[220:221] op_sel_hi:[1,0]
    v_pk_mul_f32 v[38:39], v[38:39], v[220:221] op_sel_hi:[1,0]
    v_cvt_pk_bf16_f32 v44, v28, v29
    v_cvt_pk_bf16_f32 v45, v30, v31
    v_cvt_pk_bf16_f32 v46, v36, v37
    v_cvt_pk_bf16_f32 v47, v38, v39
    buffer_store_dwordx4 v[44:47], v249, s[16:19], s30 offen offset:1024 sc1
    v_accvgpr_read_b32 v52, a36
    v_accvgpr_read_b32 v53, a37
    v_accvgpr_read_b32 v54, a38
    v_accvgpr_read_b32 v55, a39
    v_accvgpr_read_b32 v60, a52
    v_accvgpr_read_b32 v61, a53
    v_accvgpr_read_b32 v62, a54
    v_accvgpr_read_b32 v63, a55
    v_pk_mul_f32 v[52:53], v[52:53], v[220:221] op_sel:[0,1]
    v_pk_mul_f32 v[54:55], v[54:55], v[220:221] op_sel:[0,1]
    v_pk_mul_f32 v[60:61], v[60:61], v[220:221] op_sel:[0,1]
    v_pk_mul_f32 v[62:63], v[62:63], v[220:221] op_sel:[0,1]
    v_cvt_pk_bf16_f32 v68, v52, v53
    v_cvt_pk_bf16_f32 v69, v54, v55
    v_cvt_pk_bf16_f32 v70, v60, v61
    v_cvt_pk_bf16_f32 v71, v62, v63
    buffer_store_dwordx4 v[68:71], v249, s[16:19], s31 offen offset:1024 sc1
    v_accvgpr_read_b32 v4, a40
    v_accvgpr_read_b32 v5, a41
    v_accvgpr_read_b32 v6, a42
    v_accvgpr_read_b32 v7, a43
    v_accvgpr_read_b32 v12, a56
    v_accvgpr_read_b32 v13, a57
    v_accvgpr_read_b32 v14, a58
    v_accvgpr_read_b32 v15, a59
    v_pk_mul_f32 v[4:5], v[4:5], v[222:223] op_sel_hi:[1,0]
    v_pk_mul_f32 v[6:7], v[6:7], v[222:223] op_sel_hi:[1,0]
    v_pk_mul_f32 v[12:13], v[12:13], v[222:223] op_sel_hi:[1,0]
    v_pk_mul_f32 v[14:15], v[14:15], v[222:223] op_sel_hi:[1,0]
    v_cvt_pk_bf16_f32 v20, v4, v5
    v_cvt_pk_bf16_f32 v21, v6, v7
    v_cvt_pk_bf16_f32 v22, v12, v13
    v_cvt_pk_bf16_f32 v23, v14, v15
    buffer_store_dwordx4 v[20:23], v249, s[16:19], s32 offen offset:1024 sc1
    v_accvgpr_read_b32 v28, a44
    v_accvgpr_read_b32 v29, a45
    v_accvgpr_read_b32 v30, a46
    v_accvgpr_read_b32 v31, a47
    v_accvgpr_read_b32 v36, a60
    v_accvgpr_read_b32 v37, a61
    v_accvgpr_read_b32 v38, a62
    v_accvgpr_read_b32 v39, a63
    v_pk_mul_f32 v[28:29], v[28:29], v[222:223] op_sel:[0,1]
    v_pk_mul_f32 v[30:31], v[30:31], v[222:223] op_sel:[0,1]
    v_pk_mul_f32 v[36:37], v[36:37], v[222:223] op_sel:[0,1]
    v_pk_mul_f32 v[38:39], v[38:39], v[222:223] op_sel:[0,1]
    v_cvt_pk_bf16_f32 v44, v28, v29
    v_cvt_pk_bf16_f32 v45, v30, v31
    v_cvt_pk_bf16_f32 v46, v36, v37
    v_cvt_pk_bf16_f32 v47, v38, v39
    buffer_store_dwordx4 v[44:47], v249, s[16:19], s33 offen offset:1024 sc1
    v_accvgpr_read_b32 v52, a64
    v_accvgpr_read_b32 v53, a65
    v_accvgpr_read_b32 v54, a66
    v_accvgpr_read_b32 v55, a67
    v_accvgpr_read_b32 v60, a80
    v_accvgpr_read_b32 v61, a81
    v_accvgpr_read_b32 v62, a82
    v_accvgpr_read_b32 v63, a83
    v_pk_mul_f32 v[52:53], v[52:53], v[220:221] op_sel_hi:[1,0]
    v_pk_mul_f32 v[54:55], v[54:55], v[220:221] op_sel_hi:[1,0]
    v_pk_mul_f32 v[60:61], v[60:61], v[220:221] op_sel_hi:[1,0]
    v_pk_mul_f32 v[62:63], v[62:63], v[220:221] op_sel_hi:[1,0]
    v_cvt_pk_bf16_f32 v68, v52, v53
    v_cvt_pk_bf16_f32 v69, v54, v55
    v_cvt_pk_bf16_f32 v70, v60, v61
    v_cvt_pk_bf16_f32 v71, v62, v63
HOP0_7:
    s_cbranch_execz HOPRET0
    buffer_store_dwordx4 v[68:71], v249, s[16:19], s30 offen offset:2048 sc1
    v_accvgpr_read_b32 v4, a68
    v_accvgpr_read_b32 v5, a69
    v_accvgpr_read_b32 v6, a70
    v_accvgpr_read_b32 v7, a71
    v_accvgpr_read_b32 v12, a84
    v_accvgpr_read_b32 v13, a85
    v_accvgpr_read_b32 v14, a86
    v_accvgpr_read_b32 v15, a87
    v_pk_mul_f32 v[4:5], v[4:5], v[220:221] op_sel:[0,1]
    v_pk_mul_f32 v[6:7], v[6:7], v[220:221] op_sel:[0,1]
    v_pk_mul_f32 v[12:13], v[12:13], v[220:221] op_sel:[0,1]
    v_pk_mul_f32 v[14:15], v[14:15], v[220:221] op_sel:[0,1]
    v_cvt_pk_bf16_f32 v20, v4, v5
    v_cvt_pk_bf16_f32 v21, v6, v7
    v_cvt_pk_bf16_f32 v22, v12, v13
    v_cvt_pk_bf16_f32 v23, v14, v15
    buffer_store_dwordx4 v[20:23], v249, s[16:19], s31 offen offset:2048 sc1
    v_accvgpr_read_b32 v28, a72
    v_accvgpr_read_b32 v29, a73
    v_accvgpr_read_b32 v30, a74
    v_accvgpr_read_b32 v31, a75
    v_accvgpr_read_b32 v36, a88
    v_accvgpr_read_b32 v37, a89
    v_accvgpr_read_b32 v38, a90
    v_accvgpr_read_b32 v39, a91
    v_pk_mul_f32 v[28:29], v[28:29], v[222:223] op_sel_hi:[1,0]
    v_pk_mul_f32 v[30:31], v[30:31], v[222:223] op_sel_hi:[1,0]
    v_pk_mul_f32 v[36:37], v[36:37], v[222:223] op_sel_hi:[1,0]
    v_pk_mul_f32 v[38:39], v[38:39], v[222:223] op_sel_hi:[1,0]
    v_cvt_pk_bf16_f32 v44, v28, v29
    v_cvt_pk_bf16_f32 v45, v30, v31
    v_cvt_pk_bf16_f32 v46, v36, v37
    v_cvt_pk_bf16_f32 v47, v38, v39
    buffer_store_dwordx4 v[44:47], v249, s[16:19], s32 offen offset:2048 sc1
    v_accvgpr_read_b32 v52, a76
    v_accvgpr_read_b32 v53, a77
    v_accvgpr_read_b32 v54, a78
    v_accvgpr_read_b32 v55, a79
    v_accvgpr_read_b32 v60, a92
    v_accvgpr_read_b32 v61, a93
    v_accvgpr_read_b32 v62, a94
    v_accvgpr_read_b32 v63, a95
    v_pk_mul_f32 v[52:53], v[52:53], v[222:223] op_sel:[0,1]
    v_pk_mul_f32 v[54:55], v[54:55], v[222:223] op_sel:[0,1]
    v_pk_mul_f32 v[60:61], v[60:61], v[222:223] op_sel:[0,1]
    v_pk_mul_f32 v[62:63], v[62:63], v[222:223] op_sel:[0,1]
    v_cvt_pk_bf16_f32 v68, v52, v53
    v_cvt_pk_bf16_f32 v69, v54, v55
    v_cvt_pk_bf16_f32 v70, v60, v61
    v_cvt_pk_bf16_f32 v71, v62, v63
    buffer_store_dwordx4 v[68:71], v249, s[16:19], s33 offen offset:2048 sc1
    v_accvgpr_read_b32 v4, a96
    v_accvgpr_read_b32 v5, a97
    v_accvgpr_read_b32 v6, a98
    v_accvgpr_read_b32 v7, a99
    v_accvgpr_read_b32 v12, a112
    v_accvgpr_read_b32 v13, a113
    v_accvgpr_read_b32 v14, a114
    v_accvgpr_read_b32 v15, a115
    v_pk_mul_f32 v[4:5], v[4:5], v[220:221] op_sel_hi:[1,0]
    v_pk_mul_f32 v[6:7], v[6:7], v[220:221] op_sel_hi:[1,0]
    v_pk_mul_f32 v[12:13], v[12:13], v[220:221] op_sel_hi:[1,0]
    v_pk_mul_f32 v[14:15], v[14:15], v[220:221] op_sel_hi:[1,0]
    v_cvt_pk_bf16_f32 v20, v4, v5
    v_cvt_pk_bf16_f32 v21, v6, v7
    v_cvt_pk_bf16_f32 v22, v12, v13
    v_cvt_pk_bf16_f32 v23, v14, v15
    buffer_store_dwordx4 v[20:23], v249, s[16:19], s30 offen offset:3072 sc1
    v_accvgpr_read_b32 v28, a100
    v_accvgpr_read_b32 v29, a101
    v_accvgpr_read_b32 v30, a102
    v_accvgpr_read_b32 v31, a103
    v_accvgpr_read_b32 v36, a116
    v_accvgpr_read_b32 v37, a117
    v_accvgpr_read_b32 v38, a118
    v_accvgpr_read_b32 v39, a119
    v_pk_mul_f32 v[28:29], v[28:29], v[220:221] op_sel:[0,1]
    v_pk_mul_f32 v[30:31], v[30:31], v[220:221] op_sel:[0,1]
    v_pk_mul_f32 v[36:37], v[36:37], v[220:221] op_sel:[0,1]
    v_pk_mul_f32 v[38:39], v[38:39], v[220:221] op_sel:[0,1]
    v_cvt_pk_bf16_f32 v44, v28, v29
    v_cvt_pk_bf16_f32 v45, v30, v31
    v_cvt_pk_bf16_f32 v46, v36, v37
    v_cvt_pk_bf16_f32 v47, v38, v39
    buffer_store_dwordx4 v[44:47], v249, s[16:19], s31 offen offset:3072 sc1
    v_accvgpr_read_b32 v52, a104
    v_accvgpr_read_b32 v53, a105
    v_accvgpr_read_b32 v54, a106
    v_accvgpr_read_b32 v55, a107
    v_accvgpr_read_b32 v60, a120
    v_accvgpr_read_b32 v61, a121
    v_accvgpr_read_b32 v62, a122
    v_accvgpr_read_b32 v63, a123
    v_pk_mul_f32 v[52:53], v[52:53], v[222:223] op_sel_hi:[1,0]
    v_pk_mul_f32 v[54:55], v[54:55], v[222:223] op_sel_hi:[1,0]
    v_pk_mul_f32 v[60:61], v[60:61], v[222:223] op_sel_hi:[1,0]
    v_pk_mul_f32 v[62:63], v[62:63], v[222:223] op_sel_hi:[1,0]
    v_cvt_pk_bf16_f32 v68, v52, v53
    v_cvt_pk_bf16_f32 v69, v54, v55
    v_cvt_pk_bf16_f32 v70, v60, v61
    v_cvt_pk_bf16_f32 v71, v62, v63
    buffer_store_dwordx4 v[68:71], v249, s[16:19], s32 offen offset:3072 sc1
    v_accvgpr_read_b32 v4, a108
    v_accvgpr_read_b32 v5, a109
    v_accvgpr_read_b32 v6, a110
    v_accvgpr_read_b32 v7, a111
    v_accvgpr_read_b32 v12, a124
    v_accvgpr_read_b32 v13, a125
    v_accvgpr_read_b32 v14, a126
    v_accvgpr_read_b32 v15, a127
    v_pk_mul_f32 v[4:5], v[4:5], v[222:223] op_sel:[0,1]
    v_pk_mul_f32 v[6:7], v[6:7], v[222:223] op_sel:[0,1]
    v_pk_mul_f32 v[12:13], v[12:13], v[222:223] op_sel:[0,1]
    v_pk_mul_f32 v[14:15], v[14:15], v[222:223] op_sel:[0,1]
    v_cvt_pk_bf16_f32 v20, v4, v5
    v_cvt_pk_bf16_f32 v21, v6, v7
    v_cvt_pk_bf16_f32 v22, v12, v13
    v_cvt_pk_bf16_f32 v23, v14, v15
    buffer_store_dwordx4 v[20:23], v249, s[16:19], s33 offen offset:3072 sc1
    s_branch K1_j1
K1_eb:
    s_add_u32 s81, s78, 0
    buffer_load_dwordx4 v[80:83], v249, s[16:19], s81 offen offset:0 sc1
    v_accvgpr_read_b32 v72, a4
    v_accvgpr_read_b32 v73, a5
    v_accvgpr_read_b32 v74, a6
    v_accvgpr_read_b32 v75, a7
    v_accvgpr_read_b32 v76, a20
    v_accvgpr_read_b32 v77, a21
    v_accvgpr_read_b32 v78, a22
    v_accvgpr_read_b32 v79, a23
    v_pk_mul_f32 v[72:73], v[72:73], v[220:221] op_sel:[0,1]
    v_pk_mul_f32 v[74:75], v[74:75], v[220:221] op_sel:[0,1]
    v_pk_mul_f32 v[76:77], v[76:77], v[220:221] op_sel:[0,1]
    v_pk_mul_f32 v[78:79], v[78:79], v[220:221] op_sel:[0,1]
    v_cvt_pk_bf16_f32 v0, v72, v73
    v_cvt_pk_bf16_f32 v1, v74, v75
    v_cvt_pk_bf16_f32 v2, v76, v77
    v_cvt_pk_bf16_f32 v3, v78, v79
    buffer_load_dwordx4 v[88:91], v249, s[16:19], s81 offen offset:2048 sc1
    v_accvgpr_read_b32 v64, a8
    v_accvgpr_read_b32 v65, a9
    v_accvgpr_read_b32 v66, a10
    v_accvgpr_read_b32 v67, a11
    v_accvgpr_read_b32 v68, a24
    v_accvgpr_read_b32 v69, a25
    v_accvgpr_read_b32 v70, a26
    v_accvgpr_read_b32 v71, a27
    v_pk_mul_f32 v[64:65], v[64:65], v[222:223] op_sel_hi:[1,0]
    v_pk_mul_f32 v[66:67], v[66:67], v[222:223] op_sel_hi:[1,0]
    v_pk_mul_f32 v[68:69], v[68:69], v[222:223] op_sel_hi:[1,0]
    v_pk_mul_f32 v[70:71], v[70:71], v[222:223] op_sel_hi:[1,0]
    v_cvt_pk_bf16_f32 v4, v64, v65
    v_cvt_pk_bf16_f32 v5, v66, v67
    v_cvt_pk_bf16_f32 v6, v68, v69
    v_cvt_pk_bf16_f32 v7, v70, v71
    s_add_u32 s81, s81, s79
    buffer_load_dwordx4 v[96:99], v249, s[16:19], s81 offen offset:0 sc1
    v_accvgpr_read_b32 v72, a12
    v_accvgpr_read_b32 v73, a13
    v_accvgpr_read_b32 v74, a14
    v_accvgpr_read_b32 v75, a15
    v_accvgpr_read_b32 v76, a28
    v_accvgpr_read_b32 v77, a29
    v_accvgpr_read_b32 v78, a30
    v_accvgpr_read_b32 v79, a31
    v_pk_mul_f32 v[72:73], v[72:73], v[222:223] op_sel:[0,1]
    v_pk_mul_f32 v[74:75], v[74:75], v[222:223] op_sel:[0,1]
    v_pk_mul_f32 v[76:77], v[76:77], v[222:223] op_sel:[0,1]
    v_pk_mul_f32 v[78:79], v[78:79], v[222:223] op_sel:[0,1]
    v_cvt_pk_bf16_f32 v8, v72, v73
    v_cvt_pk_bf16_f32 v9, v74, v75
    v_cvt_pk_bf16_f32 v10, v76, v77
    v_cvt_pk_bf16_f32 v11, v78, v79
    s_add_u32 s81, s78, 163840
    buffer_load_dwordx4 v[104:107], v249, s[16:19], s81 offen offset:1024 sc1
    v_accvgpr_read_b32 v64, a32
    v_accvgpr_read_b32 v65, a33
    v_accvgpr_read_b32 v66, a34
    v_accvgpr_read_b32 v67, a35
    v_accvgpr_read_b32 v68, a48
    v_accvgpr_read_b32 v69, a49
    v_accvgpr_read_b32 v70, a50
    v_accvgpr_read_b32 v71, a51
    v_pk_mul_f32 v[64:65], v[64:65], v[220:221] op_sel_hi:[1,0]
    v_pk_mul_f32 v[66:67], v[66:67], v[220:221] op_sel_hi:[1,0]
    v_pk_mul_f32 v[68:69], v[68:69], v[220:221] op_sel_hi:[1,0]
    v_pk_mul_f32 v[70:71], v[70:71], v[220:221] op_sel_hi:[1,0]
    v_cvt_pk_bf16_f32 v12, v64, v65
    v_cvt_pk_bf16_f32 v13, v66, v67
    v_cvt_pk_bf16_f32 v14, v68, v69
    v_cvt_pk_bf16_f32 v15, v70, v71
    buffer_load_dwordx4 v[112:115], v249, s[16:19], s81 offen offset:3072 sc1
    v_accvgpr_read_b32 v72, a36
    v_accvgpr_read_b32 v73, a37
    v_accvgpr_read_b32 v74, a38
    v_accvgpr_read_b32 v75, a39
    v_accvgpr_read_b32 v76, a52
    v_accvgpr_read_b32 v77, a53
    v_accvgpr_read_b32 v78, a54
    v_accvgpr_read_b32 v79, a55
    v_pk_mul_f32 v[72:73], v[72:73], v[220:221] op_sel:[0,1]
    v_pk_mul_f32 v[74:75], v[74:75], v[220:221] op_sel:[0,1]
    v_pk_mul_f32 v[76:77], v[76:77], v[220:221] op_sel:[0,1]
    v_pk_mul_f32 v[78:79], v[78:79], v[220:221] op_sel:[0,1]
    v_cvt_pk_bf16_f32 v16, v72, v73
    v_cvt_pk_bf16_f32 v17, v74, v75
    v_cvt_pk_bf16_f32 v18, v76, v77
    v_cvt_pk_bf16_f32 v19, v78, v79
    s_add_u32 s81, s78, 327680
    buffer_load_dwordx4 v[120:123], v249, s[16:19], s81 offen offset:0 sc1
    v_accvgpr_read_b32 v64, a40
    v_accvgpr_read_b32 v65, a41
    v_accvgpr_read_b32 v66, a42
    v_accvgpr_read_b32 v67, a43
    v_accvgpr_read_b32 v68, a56
    v_accvgpr_read_b32 v69, a57
    v_accvgpr_read_b32 v70, a58
    v_accvgpr_read_b32 v71, a59
    v_pk_mul_f32 v[64:65], v[64:65], v[222:223] op_sel_hi:[1,0]
    v_pk_mul_f32 v[66:67], v[66:67], v[222:223] op_sel_hi:[1,0]
    v_pk_mul_f32 v[68:69], v[68:69], v[222:223] op_sel_hi:[1,0]
    v_pk_mul_f32 v[70:71], v[70:71], v[222:223] op_sel_hi:[1,0]
    v_cvt_pk_bf16_f32 v60, v64, v65
    v_cvt_pk_bf16_f32 v61, v66, v67
    v_cvt_pk_bf16_f32 v62, v68, v69
    v_cvt_pk_bf16_f32 v63, v70, v71
    s_add_u32 s81, s78, 491520
    buffer_load_dwordx4 v[152:155], v249, s[16:19], s81 offen offset:3072 sc1
    v_accvgpr_read_b32 v72, a44
    v_accvgpr_read_b32 v73, a45
    v_accvgpr_read_b32 v74, a46
    v_accvgpr_read_b32 v75, a47
    v_accvgpr_read_b32 v76, a60
    v_accvgpr_read_b32 v77, a61
    v_accvgpr_read_b32 v78, a62
    v_accvgpr_read_b32 v79, a63
    v_pk_mul_f32 v[72:73], v[72:73], v[222:223] op_sel:[0,1]
    v_pk_mul_f32 v[74:75], v[74:75], v[222:223] op_sel:[0,1]
    v_pk_mul_f32 v[76:77], v[76:77], v[222:223] op_sel:[0,1]
    v_pk_mul_f32 v[78:79], v[78:79], v[222:223] op_sel:[0,1]
    v_cvt_pk_bf16_f32 v24, v72, v73
    v_cvt_pk_bf16_f32 v25, v74, v75
    v_cvt_pk_bf16_f32 v26, v76, v77
    v_cvt_pk_bf16_f32 v27, v78, v79
    s_add_u32 s81, s81, s79
    buffer_load_dwordx4 v[156:159], v249, s[16:19], s81 offen offset:0 sc1
    s_add_u32 s81, s78, 1966080
    buffer_load_dwordx4 a[160:163], v249, s[16:19], s81 offen offset:0 sc1
    v_accvgpr_read_b32 v64, a64
    v_accvgpr_read_b32 v65, a65
    v_accvgpr_read_b32 v66, a66
    v_accvgpr_read_b32 v67, a67
    v_accvgpr_read_b32 v68, a80
    v_accvgpr_read_b32 v69, a81
    v_accvgpr_read_b32 v70, a82
    v_accvgpr_read_b32 v71, a83
    v_pk_mul_f32 v[64:65], v[64:65], v[220:221] op_sel_hi:[1,0]
    v_pk_mul_f32 v[66:67], v[66:67], v[220:221] op_sel_hi:[1,0]
    v_pk_mul_f32 v[68:69], v[68:69], v[220:221] op_sel_hi:[1,0]
    v_pk_mul_f32 v[70:71], v[70:71], v[220:221] op_sel_hi:[1,0]
    v_cvt_pk_bf16_f32 v28, v64, v65
    v_cvt_pk_bf16_f32 v29, v66, v67
    v_cvt_pk_bf16_f32 v30, v68, v69
    v_cvt_pk_bf16_f32 v31, v70, v71
    buffer_load_dwordx4 a[164:167], v249, s[16:19], s81 offen offset:1024 sc1
    v_accvgpr_read_b32 v72, a68
    v_accvgpr_read_b32 v73, a69
    v_accvgpr_read_b32 v74, a70
    v_accvgpr_read_b32 v75, a71
    v_accvgpr_read_b32 v76, a84
    v_accvgpr_read_b32 v77, a85
    v_accvgpr_read_b32 v78, a86
    v_accvgpr_read_b32 v79, a87
    v_pk_mul_f32 v[72:73], v[72:73], v[220:221] op_sel:[0,1]
    v_pk_mul_f32 v[74:75], v[74:75], v[220:221] op_sel:[0,1]
    v_pk_mul_f32 v[76:77], v[76:77], v[220:221] op_sel:[0,1]
    v_pk_mul_f32 v[78:79], v[78:79], v[220:221] op_sel:[0,1]
    v_cvt_pk_bf16_f32 v32, v72, v73
    v_cvt_pk_bf16_f32 v33, v74, v75
    v_cvt_pk_bf16_f32 v34, v76, v77
    v_cvt_pk_bf16_f32 v35, v78, v79
    buffer_load_dwordx4 a[168:171], v249, s[16:19], s81 offen offset:2048 sc1
    v_accvgpr_read_b32 v64, a72
    v_accvgpr_read_b32 v65, a73
    v_accvgpr_read_b32 v66, a74
    v_accvgpr_read_b32 v67, a75
    v_accvgpr_read_b32 v68, a88
    v_accvgpr_read_b32 v69, a89
    v_accvgpr_read_b32 v70, a90
    v_accvgpr_read_b32 v71, a91
    v_pk_mul_f32 v[64:65], v[64:65], v[222:223] op_sel_hi:[1,0]
    v_pk_mul_f32 v[66:67], v[66:67], v[222:223] op_sel_hi:[1,0]
    v_pk_mul_f32 v[68:69], v[68:69], v[222:223] op_sel_hi:[1,0]
    v_pk_mul_f32 v[70:71], v[70:71], v[222:223] op_sel_hi:[1,0]
    v_cvt_pk_bf16_f32 v36, v64, v65
    v_cvt_pk_bf16_f32 v37, v66, v67
    v_cvt_pk_bf16_f32 v38, v68, v69
    v_cvt_pk_bf16_f32 v39, v70, v71
    buffer_load_dwordx4 a[172:175], v249, s[16:19], s81 offen offset:3072 sc1
    v_accvgpr_read_b32 v72, a76
    v_accvgpr_read_b32 v73, a77
    v_accvgpr_read_b32 v74, a78
    v_accvgpr_read_b32 v75, a79
    v_accvgpr_read_b32 v76, a92
    v_accvgpr_read_b32 v77, a93
    v_accvgpr_read_b32 v78, a94
    v_accvgpr_read_b32 v79, a95
    v_pk_mul_f32 v[72:73], v[72:73], v[222:223] op_sel:[0,1]
    v_pk_mul_f32 v[74:75], v[74:75], v[222:223] op_sel:[0,1]
    v_pk_mul_f32 v[76:77], v[76:77], v[222:223] op_sel:[0,1]
    v_pk_mul_f32 v[78:79], v[78:79], v[222:223] op_sel:[0,1]
    v_cvt_pk_bf16_f32 v40, v72, v73
    v_cvt_pk_bf16_f32 v41, v74, v75
    v_cvt_pk_bf16_f32 v42, v76, v77
    v_cvt_pk_bf16_f32 v43, v78, v79
    s_add_u32 s81, s81, s79
    buffer_load_dwordx4 a[176:179], v249, s[16:19], s81 offen offset:0 sc1
    v_accvgpr_read_b32 v64, a96
    v_accvgpr_read_b32 v65, a97
    v_accvgpr_read_b32 v66, a98
    v_accvgpr_read_b32 v67, a99
    v_accvgpr_read_b32 v68, a112
    v_accvgpr_read_b32 v69, a113
    v_accvgpr_read_b32 v70, a114
    v_accvgpr_read_b32 v71, a115
    v_pk_mul_f32 v[64:65], v[64:65], v[220:221] op_sel_hi:[1,0]
    v_pk_mul_f32 v[66:67], v[66:67], v[220:221] op_sel_hi:[1,0]
    v_pk_mul_f32 v[68:69], v[68:69], v[220:221] op_sel_hi:[1,0]
    v_pk_mul_f32 v[70:71], v[70:71], v[220:221] op_sel_hi:[1,0]
    v_cvt_pk_bf16_f32 v44, v64, v65
    v_cvt_pk_bf16_f32 v45, v66, v67
    v_cvt_pk_bf16_f32 v46, v68, v69
    v_cvt_pk_bf16_f32 v47, v70, v71
    s_add_u32 s81, s78, 2129920
    buffer_load_dwordx4 a[180:183], v249, s[16:19], s81 offen offset:0 sc1
    v_accvgpr_read_b32 v72, a100
    v_accvgpr_read_b32 v73, a101
    v_accvgpr_read_b32 v74, a102
    v_accvgpr_read_b32 v75, a103
    v_accvgpr_read_b32 v76, a116
    v_accvgpr_read_b32 v77, a117
    v_accvgpr_read_b32 v78, a118
    v_accvgpr_read_b32 v79, a119
    v_pk_mul_f32 v[72:73], v[72:73], v[220:221] op_sel:[0,1]
    v_pk_mul_f32 v[74:75], v[74:75], v[220:221] op_sel:[0,1]
    v_pk_mul_f32 v[76:77], v[76:77], v[220:221] op_sel:[0,1]
    v_pk_mul_f32 v[78:79], v[78:79], v[220:221] op_sel:[0,1]
    v_cvt_pk_bf16_f32 v48, v72, v73
    v_cvt_pk_bf16_f32 v49, v74, v75
    v_cvt_pk_bf16_f32 v50, v76, v77
    v_cvt_pk_bf16_f32 v51, v78, v79
    buffer_load_dwordx4 a[184:187], v249, s[16:19], s81 offen offset:1024 sc1
    v_accvgpr_read_b32 v64, a104
    v_accvgpr_read_b32 v65, a105
    v_accvgpr_read_b32 v66, a106
    v_accvgpr_read_b32 v67, a107
    v_accvgpr_read_b32 v68, a120
    v_accvgpr_read_b32 v69, a121
    v_accvgpr_read_b32 v70, a122
    v_accvgpr_read_b32 v71, a123
    v_pk_mul_f32 v[64:65], v[64:65], v[222:223] op_sel_hi:[1,0]
    v_pk_mul_f32 v[66:67], v[66:67], v[222:223] op_sel_hi:[1,0]
    v_pk_mul_f32 v[68:69], v[68:69], v[222:223] op_sel_hi:[1,0]
    v_pk_mul_f32 v[70:71], v[70:71], v[222:223] op_sel_hi:[1,0]
    v_cvt_pk_bf16_f32 v52, v64, v65
    v_cvt_pk_bf16_f32 v53, v66, v67
    v_cvt_pk_bf16_f32 v54, v68, v69
    v_cvt_pk_bf16_f32 v55, v70, v71
    buffer_load_dwordx4 a[188:191], v249, s[16:19], s81 offen offset:2048 sc1
    buffer_load_dwordx4 a[192:195], v249, s[16:19], s81 offen offset:3072 sc1
    v_accvgpr_read_b32 v72, a108
    v_accvgpr_read_b32 v73, a109
    v_accvgpr_read_b32 v74, a110
    v_accvgpr_read_b32 v75, a111
    v_accvgpr_read_b32 v76, a124
    v_accvgpr_read_b32 v77, a125
    v_accvgpr_read_b32 v78, a126
    v_accvgpr_read_b32 v79, a127
    v_pk_mul_f32 v[72:73], v[72:73], v[222:223] op_sel:[0,1]
    v_pk_mul_f32 v[74:75], v[74:75], v[222:223] op_sel:[0,1]
    v_pk_mul_f32 v[76:77], v[76:77], v[222:223] op_sel:[0,1]
    v_pk_mul_f32 v[78:79], v[78:79], v[222:223] op_sel:[0,1]
    v_cvt_pk_bf16_f32 v56, v72, v73
    v_cvt_pk_bf16_f32 v57, v74, v75
    v_cvt_pk_bf16_f32 v58, v76, v77
    v_cvt_pk_bf16_f32 v59, v78, v79
    buffer_store_dwordx4 v[0:3], v249, s[16:19], s31 offen offset:0 sc1
    buffer_store_dwordx4 v[4:7], v249, s[16:19], s32 offen offset:0 sc1
    buffer_store_dwordx4 v[8:11], v249, s[16:19], s33 offen offset:0 sc1
    buffer_store_dwordx4 v[12:15], v249, s[16:19], s30 offen offset:1024 sc1
    buffer_store_dwordx4 v[16:19], v249, s[16:19], s31 offen offset:1024 sc1
    buffer_store_dwordx4 v[60:63], v249, s[16:19], s32 offen offset:1024 sc1
    buffer_store_dwordx4 v[24:27], v249, s[16:19], s33 offen offset:1024 sc1
    buffer_store_dwordx4 v[28:31], v249, s[16:19], s30 offen offset:2048 sc1
    buffer_store_dwordx4 v[32:35], v249, s[16:19], s31 offen offset:2048 sc1
    buffer_store_dwordx4 v[36:39], v249, s[16:19], s32 offen offset:2048 sc1
    buffer_store_dwordx4 v[40:43], v249, s[16:19], s33 offen offset:2048 sc1
    buffer_store_dwordx4 v[44:47], v249, s[16:19], s30 offen offset:3072 sc1
    buffer_store_dwordx4 v[48:51], v249, s[16:19], s31 offen offset:3072 sc1
    buffer_store_dwordx4 v[52:55], v249, s[16:19], s32 offen offset:3072 sc1
    buffer_store_dwordx4 v[56:59], v249, s[16:19], s33 offen offset:3072 sc1
K1_j1:
    s_mov_b64 exec, 0
    s_cmp_eq_u32 s22, 0
    s_cbranch_scc1 HOP1_0
    s_cmp_eq_u32 s22, 1
    s_cbranch_scc1 HOP1_1
    s_cmp_eq_u32 s22, 2
    s_cbranch_scc1 HOP1_2
    s_branch HOP1_3
HOPRET1:
    s_mov_b64 exec, -1
    s_lshl_b32 s3, s21, 2
    s_add_u32 s3, s3, s22
    s_lshl_b32 s3, s3, 5
    s_add_u32 s3, s3, s20
    s_lshl_b32 s3, s3, 4
    s_add_u32 s3, s3, 2904064
    v_mov_b32 v234, 0
    v_mov_b32 v235, s55
    s_mov_b64 exec, 1
    s_waitcnt vmcnt(0)
    buffer_store_dword v235, v234, s[16:19], s3 offen sc1
    s_mov_b64 exec, -1
    s_bitcmp1_b32 s2, 3
    s_cbranch_scc1 K1_j2
    s_add_u32 s81, s78, 0
    buffer_load_dwordx4 v[80:83], v249, s[16:19], s81 offen offset:0 sc1
    buffer_load_dwordx4 v[88:91], v249, s[16:19], s81 offen offset:2048 sc1
    s_add_u32 s81, s81, s79
    buffer_load_dwordx4 v[96:99], v249, s[16:19], s81 offen offset:0 sc1
    s_add_u32 s81, s78, 163840
    buffer_load_dwordx4 v[104:107], v249, s[16:19], s81 offen offset:1024 sc1
    buffer_load_dwordx4 v[112:115], v249, s[16:19], s81 offen offset:3072 sc1
    s_add_u32 s81, s78, 327680
    buffer_load_dwordx4 v[120:123], v249, s[16:19], s81 offen offset:0 sc1
    s_add_u32 s81, s78, 491520
    buffer_load_dwordx4 v[152:155], v249, s[16:19], s81 offen offset:3072 sc1
    s_add_u32 s81, s81, s79
    buffer_load_dwordx4 v[156:159], v249, s[16:19], s81 offen offset:0 sc1
    s_add_u32 s81, s78, 1966080
    buffer_load_dwordx4 a[160:163], v249, s[16:19], s81 offen offset:0 sc1
    buffer_load_dwordx4 a[164:167], v249, s[16:19], s81 offen offset:1024 sc1
    buffer_load_dwordx4 a[168:171], v249, s[16:19], s81 offen offset:2048 sc1
    buffer_load_dwordx4 a[172:175], v249, s[16:19], s81 offen offset:3072 sc1
    s_add_u32 s81, s81, s79
    buffer_load_dwordx4 a[176:179], v249, s[16:19], s81 offen offset:0 sc1
    s_add_u32 s81, s78, 2129920
    buffer_load_dwordx4 a[180:183], v249, s[16:19], s81 offen offset:0 sc1
    buffer_load_dwordx4 a[184:187], v249, s[16:19], s81 offen offset:1024 sc1
    buffer_load_dwordx4 a[188:191], v249, s[16:19], s81 offen offset:2048 sc1
    buffer_load_dwordx4 a[192:195], v249, s[16:19], s81 offen offset:3072 sc1
K1_j2:
    s_add_u32 s81, s81, s79
    buffer_load_dwordx4 a[196:199], v249, s[16:19], s81 offen offset:0 sc1
    s_add_u32 s81, s78, 2293760
    buffer_load_dwordx4 a[200:203], v249, s[16:19], s81 offen offset:0 sc1
    buffer_load_dwordx4 a[204:207], v249, s[16:19], s81 offen offset:1024 sc1
    buffer_load_dwordx4 a[208:211], v249, s[16:19], s81 offen offset:2048 sc1
    v_mov_b32 v253, v232
    v_mov_b32 v254, v233
    v_lshrrev_b32 v234, 6, v249
    v_lshlrev_b32 v234, 7, v234
    v_bfe_u32 v235, v249, 4, 2
    v_lshl_add_u32 v234, v235, 3, v234
    v_add_u32 v234, 0x18000, v234
    v_bfe_u32 v235, v249, 7, 2
    v_xor_b32 v235, s22, v235
    v_lshl_add_u32 v252, v235, 5, v234
    v_add_u32 v248, 94208, v229
    v_and_b32 v235, 16, v249
    v_mul_u32_u24 v235, 80, v235
    v_add_u32 v251, v235, v248
    s_barrier
    ds_read_b128 v[0:3], v251 offset:0
    ds_read_b128 v[4:7], v251 offset:192
    ds_read_b128 v[8:11], v251 offset:320
    ds_read_b128 v[12:15], v251 offset:512
    ds_read_b128 v[16:19], v251 offset:640
    ds_read_b128 v[20:23], v251 offset:832
    ds_read_b128 v[24:27], v251 offset:960
    ds_read_b128 v[28:31], v251 offset:1152
    ds_read_b128 v[32:35], v251 offset:64
    ds_read_b128 v[36:39], v251 offset:256
    ds_read_b128 v[40:43], v251 offset:384
    ds_read_b128 v[44:47], v251 offset:576
    ds_read_b64_tr_b16 v[160:161], v252 offset:0
    ds_read_b64_tr_b16 v[162:163], v252 offset:2048
    ds_read_b64_tr_b16 v[164:165], v252 offset:4096
    ds_read_b64_tr_b16 v[166:167], v252 offset:6144
    s_add_u32 s81, s78, 2457600
    buffer_load_dwordx4 a[224:227], v249, s[16:19], s81 offen offset:1024 sc1
    ds_read_b64_tr_b16 v[168:169], v252 offset:8192
    ds_read_b64_tr_b16 v[170:171], v252 offset:10240
    ds_read_b64_tr_b16 v[172:173], v252 offset:12288
    ds_read_b64_tr_b16 v[174:175], v252 offset:14336
    ds_read_b64_tr_b16 v[176:177], v252 offset:16384
    ds_read_b64_tr_b16 v[178:179], v252 offset:18432
    ds_read_b64_tr_b16 v[180:181], v252 offset:20480
    ds_read_b64_tr_b16 v[182:183], v252 offset:22528
    s_add_u32 s81, s78, 655360
    buffer_load_dwordx4 a[0:3], v249, s[16:19], s81 offen offset:0 sc1
    ds_read_b64_tr_b16 v[184:185], v252 offset:24576
    ds_read_b64_tr_b16 v[186:187], v252 offset:26624
    ds_read_b64_tr_b16 v[188:189], v252 offset:28672
    ds_read_b64_tr_b16 v[190:191], v252 offset:30720
    ds_read_b64_tr_b16 a[128:129], v252 offset:32768
    ds_read_b64_tr_b16 a[130:131], v252 offset:34816
    ds_read_b64_tr_b16 a[132:133], v252 offset:36864
    ds_read_b64_tr_b16 a[134:135], v252 offset:38912
    buffer_load_dwordx4 a[4:7], v249, s[16:19], s81 offen offset:1024 sc1
    ds_read_b64_tr_b16 a[136:137], v252 offset:40960
    ds_read_b64_tr_b16 a[138:139], v252 offset:43008
    ds_read_b64_tr_b16 a[140:141], v252 offset:45056
    ds_read_b64_tr_b16 a[142:143], v252 offset:47104
    ds_read_b64_tr_b16 a[144:145], v252 offset:49152
    ds_read_b64_tr_b16 a[146:147], v252 offset:51200
    ds_read_b64_tr_b16 a[148:149], v252 offset:53248
    ds_read_b64_tr_b16 a[150:151], v252 offset:55296
    buffer_load_dwordx4 a[8:11], v249, s[16:19], s81 offen offset:2048 sc1
    ds_read_b64_tr_b16 a[152:153], v252 offset:57344
    ds_read_b64_tr_b16 a[154:155], v252 offset:59392
    ds_read_b64_tr_b16 a[156:157], v252 offset:61440
    ds_read_b64_tr_b16 a[158:159], v252 offset:63488
    v_subrev_u32 v252, 0x18000, v252
    ds_read_b64_tr_b16 v[48:49], v252 offset:0
    ds_read_b64_tr_b16 v[50:51], v252 offset:2048
    ds_read_b64_tr_b16 v[52:53], v252 offset:4096
    ds_read_b64_tr_b16 v[54:55], v252 offset:6144
    buffer_load_dwordx4 a[12:15], v249, s[16:19], s81 offen offset:3072 sc1
    ds_read_b64_tr_b16 v[56:57], v252 offset:8192
    ds_read_b64_tr_b16 v[58:59], v252 offset:10240
    ds_read_b64_tr_b16 v[60:61], v252 offset:12288
HOP1_0:
    s_cbranch_execz HOP1_4
    ds_read_b64_tr_b16 v[62:63], v252 offset:14336
    ds_read_b64_tr_b16 v[64:65], v252 offset:16384
    ds_read_b64_tr_b16 v[66:67], v252 offset:18432
    ds_read_b64_tr_b16 v[68:69], v252 offset:20480
    ds_read_b64_tr_b16 v[70:71], v252 offset:22528
    s_add_u32 s81, s81, s79
    buffer_load_dwordx4 a[16:19], v249, s[16:19], s81 offen offset:0 sc1
    ds_read_b64_tr_b16 v[72:73], v252 offset:24576
    ds_read_b64_tr_b16 v[74:75], v252 offset:26624
    ds_read_b64_tr_b16 v[76:77], v252 offset:28672
    ds_read_b64_tr_b16 v[78:79], v252 offset:30720
    s_waitcnt lgkmcnt(0)
    v_mfma_f32_16x16x32_bf16 v[240:243], v[160:163], v[0:3], 0
    v_mfma_f32_16x16x32_bf16 v[244:247], v[164:167], v[0:3], 0
    s_add_u32 s81, s78, 819200
    buffer_load_dwordx4 a[20:23], v249, s[16:19], s81 offen offset:0 sc1
    v_mfma_f32_16x16x32_bf16 v[240:243], v[168:171], v[4:7], v[240:243]
    v_mfma_f32_16x16x32_bf16 v[244:247], v[172:175], v[4:7], v[244:247]
    v_mfma_f32_16x16x32_bf16 v[240:243], v[176:179], v[8:11], v[240:243]
    v_mfma_f32_16x16x32_bf16 v[244:247], v[180:183], v[8:11], v[244:247]
    buffer_load_dwordx4 a[24:27], v249, s[16:19], s81 offen offset:1024 sc1
    v_mfma_f32_16x16x32_bf16 v[240:243], v[184:187], v[12:15], v[240:243]
    v_mfma_f32_16x16x32_bf16 v[244:247], v[188:191], v[12:15], v[244:247]
    v_mfma_f32_16x16x32_bf16 v[240:243], a[128:131], v[16:19], v[240:243]
    v_mfma_f32_16x16x32_bf16 v[244:247], a[132:135], v[16:19], v[244:247]
    buffer_load_dwordx4 a[28:31], v249, s[16:19], s81 offen offset:2048 sc1
    v_mfma_f32_16x16x32_bf16 v[240:243], a[136:139], v[20:23], v[240:243]
    v_mfma_f32_16x16x32_bf16 v[244:247], a[140:143], v[20:23], v[244:247]
    v_mfma_f32_16x16x32_bf16 v[240:243], a[144:147], v[24:27], v[240:243]
    v_mfma_f32_16x16x32_bf16 v[244:247], a[148:151], v[24:27], v[244:247]
    buffer_load_dwordx4 a[32:35], v249, s[16:19], s81 offen offset:3072 sc1
    v_mfma_f32_16x16x32_bf16 v[240:243], a[152:155], v[28:31], v[240:243]
    v_mfma_f32_16x16x32_bf16 v[244:247], a[156:159], v[28:31], v[244:247]
    v_mfma_f32_16x16x32_bf16 v[240:243], v[48:51], v[32:35], v[240:243]
    v_mfma_f32_16x16x32_bf16 v[244:247], v[52:55], v[32:35], v[244:247]
    s_add_u32 s81, s81, s79
    buffer_load_dwordx4 a[36:39], v249, s[16:19], s81 offen offset:0 sc1
    v_mfma_f32_16x16x32_bf16 v[240:243], v[56:59], v[36:39], v[240:243]
    v_mfma_f32_16x16x32_bf16 v[244:247], v[60:63], v[36:39], v[244:247]
    v_mfma_f32_16x16x32_bf16 v[240:243], v[64:67], v[40:43], v[240:243]
    v_mfma_f32_16x16x32_bf16 v[244:247], v[68:71], v[40:43], v[244:247]
    s_add_u32 s81, s78, 983040
    buffer_load_dwordx4 a[40:43], v249, s[16:19], s81 offen offset:0 sc1
    v_mfma_f32_16x16x32_bf16 v[240:243], v[72:75], v[44:47], v[240:243]
    v_mfma_f32_16x16x32_bf16 v[244:247], v[76:79], v[44:47], v[244:247]
    buffer_load_dwordx4 a[44:47], v249, s[16:19], s81 offen offset:1024 sc1
    buffer_load_dwordx4 a[48:51], v249, s[16:19], s81 offen offset:2048 sc1
    buffer_load_dwordx4 a[52:55], v249, s[16:19], s81 offen offset:3072 sc1
    s_add_u32 s81, s81, s79
    buffer_load_dwordx4 a[56:59], v249, s[16:19], s81 offen offset:0 sc1
    s_add_u32 s81, s78, 1146880
    buffer_load_dwordx4 a[60:63], v249, s[16:19], s81 offen offset:0 sc1
    buffer_load_dwordx4 a[64:67], v249, s[16:19], s81 offen offset:1024 sc1
    buffer_load_dwordx4 a[68:71], v249, s[16:19], s81 offen offset:2048 sc1
    buffer_load_dwordx4 a[72:75], v249, s[16:19], s81 offen offset:3072 sc1
    s_add_u32 s81, s81, s79
    buffer_load_dwordx4 a[76:79], v249, s[16:19], s81 offen offset:0 sc1
    s_add_u32 s81, s78, 1310720
    buffer_load_dwordx4 a[80:83], v249, s[16:19], s81 offen offset:0 sc1
    buffer_load_dwordx4 a[84:87], v249, s[16:19], s81 offen offset:1024 sc1
    s_mul_i32 s3, s22, 3072
    s_add_u32 s3, s3, 36864
    v_and_b32 v248, 0xf0, v249
    v_lshl_add_u32 v248, v248, 3, v229
    v_lshrrev_b32 v248, 1, v248
    v_add_u32 v248, s3, v248
    ds_read_b64 v[232:233], v248 offset:0
    ds_read_b64 v[234:235], v248 offset:32
    ds_read_b64 v[236:237], v248 offset:1024
    ds_read_b64 v[238:239], v248 offset:1056
    ds_read_b32 v228, v248 offset:2048
    ds_read_b32 v248, v248 offset:2052
    v_and_b32 v0, 0xf0, v249
    v_and_b32 v1, 0x100, v249
    v_lshl_add_u32 v0, v1, 3, v0
    s_and_b32 s3, s20, 0x1b
    s_lshl_b32 s3, s3, 1
    s_and_b32 s98, s2, 1
    s_add_u32 s3, s3, s98
    s_lshl_b32 s3, s3, 8
    s_add_u32 s3, s3, 2904064
    s_cmp_eq_u32 s22, 0
    s_cselect_b32 s3, s3, 0x7f000000
    buffer_load_dword v1, v0, s[16:19], s3 offen sc1
    buffer_load_dwordx4 a[88:91], v249, s[16:19], s81 offen offset:2048 sc1
    buffer_load_dwordx4 a[92:95], v249, s[16:19], s81 offen offset:3072 sc1
    s_add_u32 s81, s81, s79
    buffer_load_dwordx4 a[96:99], v249, s[16:19], s81 offen offset:0 sc1
    s_add_u32 s81, s78, 1474560
    buffer_load_dwordx4 a[100:103], v249, s[16:19], s81 offen offset:0 sc1
    buffer_load_dwordx4 a[104:107], v249, s[16:19], s81 offen offset:1024 sc1
    buffer_load_dwordx4 a[108:111], v249, s[16:19], s81 offen offset:2048 sc1
    buffer_load_dwordx4 a[112:115], v249, s[16:19], s81 offen offset:3072 sc1
    s_add_u32 s81, s81, s79
    buffer_load_dwordx4 a[116:119], v249, s[16:19], s81 offen offset:0 sc1
    s_add_u32 s81, s78, 1638400
    buffer_load_dwordx4 a[120:123], v249, s[16:19], s81 offen offset:0 sc1
    buffer_load_dwordx4 a[124:127], v249, s[16:19], s81 offen offset:1024 sc1
    s_waitcnt lgkmcnt(0)
    s_cmp_lg_u32 s22, 0
    s_waitcnt vmcnt(10)
    s_cbranch_scc1 S1_ok
    v_cmp_ne_u32 vcc, s55, v1
    s_cbranch_vccz S1_ok
S1_spin:
    s_mov_b32 s98, 262144
S1_loop:
    buffer_load_dword v1, v0, s[16:19], s3 offen sc1
    s_sub_u32 s98, s98, 1
    s_waitcnt vmcnt(0)
    s_cbranch_scc1 S1_ok
    v_cmp_ne_u32 vcc, s55, v1
    s_cbranch_vccz S1_ok
    s_sleep 6
    s_branch S1_loop
S1_ok:
    s_barrier
    s_add_u32 s82, s50, 0
    buffer_load_dwordx4 a[132:135], v225, s[16:19], s82 offen sc1
    buffer_load_dwordx4 a[136:139], v226, s[16:19], s82 offen sc1
    buffer_load_dwordx4 a[140:143], v227, s[16:19], s82 offen sc1
    buffer_load_dwordx4 a[128:131], v224, s[16:19], s82 offen sc1
    s_add_u32 s82, s50, 4096
    buffer_load_dwordx4 v[164:167], v225, s[16:19], s82 offen sc1
    buffer_load_dwordx4 v[168:171], v226, s[16:19], s82 offen sc1
    buffer_load_dwordx4 v[172:175], v227, s[16:19], s82 offen sc1
    buffer_load_dwordx4 v[160:163], v224, s[16:19], s82 offen sc1
    s_add_u32 s82, s50, 8192
    buffer_load_dwordx4 v[180:183], v225, s[16:19], s82 offen sc1
    buffer_load_dwordx4 v[184:187], v226, s[16:19], s82 offen sc1
    buffer_load_dwordx4 v[188:191], v227, s[16:19], s82 offen sc1
    buffer_load_dwordx4 v[176:179], v224, s[16:19], s82 offen sc1
    s_add_u32 s82, s50, 12288
    buffer_load_dwordx4 a[148:151], v225, s[16:19], s82 offen sc1
    buffer_load_dwordx4 a[152:155], v226, s[16:19], s82 offen sc1
    buffer_load_dwordx4 a[156:159], v227, s[16:19], s82 offen sc1
    buffer_load_dwordx4 a[144:147], v224, s[16:19], s82 offen sc1
    s_lshl_b32 s3, s2, 2
    s_add_u32 s3, s3, s22
    s_xor_b32 s98, s3, 4
    s_mul_i32 s20, s3, 5120
    s_add_u32 s20, s20, 24117248
    s_mul_i32 s21, s98, 5120
    s_add_u32 s21, s21, 24117248
    s_lshl_b32 s23, s3, 4
    s_add_u32 s23, s23, 2969600
    s_lshl_b32 s24, s98, 4
    s_add_u32 s24, s24, 2969600
    s_waitcnt vmcnt(12)
    v_mfma_f32_16x16x32_bf16 v[0:3], v[80:83], a[128:131], 0
    s_add_u32 s82, s50, 16384
    v_mfma_f32_16x16x32_bf16 v[20:23], v[80:83], a[132:135], 0
    buffer_load_dwordx4 v[212:215], v225, s[16:19], s82 offen sc1
    v_mfma_f32_16x16x32_bf16 v[40:43], v[80:83], a[136:139], 0
    v_mfma_f32_16x16x32_bf16 v[60:63], v[80:83], a[140:143], 0
    v_mfma_f32_16x16x32_bf16 v[64:67], v[84:87], a[140:143], 0
    v_mfma_f32_16x16x32_bf16 v[44:47], v[84:87], a[136:139], 0
    buffer_load_dwordx4 v[216:219], v226, s[16:19], s82 offen sc1
    v_mfma_f32_16x16x32_bf16 v[24:27], v[84:87], a[132:135], 0
    v_mfma_f32_16x16x32_bf16 v[4:7], v[84:87], a[128:131], 0
    v_mfma_f32_16x16x32_bf16 v[8:11], v[88:91], a[128:131], 0
    v_mfma_f32_16x16x32_bf16 v[28:31], v[88:91], a[132:135], 0
    v_mfma_f32_16x16x32_bf16 v[48:51], v[88:91], a[136:139], 0
    buffer_load_dwordx4 v[220:223], v227, s[16:19], s82 offen sc1
    v_mfma_f32_16x16x32_bf16 v[68:71], v[88:91], a[140:143], 0
    v_mfma_f32_16x16x32_bf16 v[72:75], v[92:95], a[140:143], 0
    v_mfma_f32_16x16x32_bf16 v[52:55], v[92:95], a[136:139], 0
    v_mfma_f32_16x16x32_bf16 v[32:35], v[92:95], a[132:135], 0
    v_mfma_f32_16x16x32_bf16 v[12:15], v[92:95], a[128:131], 0
    buffer_load_dwordx4 v[208:211], v224, s[16:19], s82 offen sc1
    v_mfma_f32_16x16x32_bf16 v[16:19], v[96:99], a[128:131], 0
    v_mfma_f32_16x16x32_bf16 v[36:39], v[96:99], a[132:135], 0
    v_mfma_f32_16x16x32_bf16 v[56:59], v[96:99], a[136:139], 0
    v_mfma_f32_16x16x32_bf16 v[76:79], v[96:99], a[140:143], 0
    s_waitcnt vmcnt(12)
    v_mfma_f32_16x16x32_bf16 v[0:3], v[100:103], v[160:163], v[0:3]
    s_add_u32 s82, s50, 20480
    v_mfma_f32_16x16x32_bf16 v[20:23], v[100:103], v[164:167], v[20:23]
    buffer_load_dwordx4 a[132:135], v225, s[16:19], s82 offen sc1
    v_mfma_f32_16x16x32_bf16 v[40:43], v[100:103], v[168:171], v[40:43]
    v_mfma_f32_16x16x32_bf16 v[60:63], v[100:103], v[172:175], v[60:63]
    v_mfma_f32_16x16x32_bf16 v[64:67], v[104:107], v[172:175], v[64:67]
    v_mfma_f32_16x16x32_bf16 v[44:47], v[104:107], v[168:171], v[44:47]
    buffer_load_dwordx4 a[136:139], v226, s[16:19], s82 offen sc1
    v_mfma_f32_16x16x32_bf16 v[24:27], v[104:107], v[164:167], v[24:27]
    v_mfma_f32_16x16x32_bf16 v[4:7], v[104:107], v[160:163], v[4:7]
    v_mfma_f32_16x16x32_bf16 v[8:11], v[108:111], v[160:163], v[8:11]
    v_mfma_f32_16x16x32_bf16 v[28:31], v[108:111], v[164:167], v[28:31]
    v_mfma_f32_16x16x32_bf16 v[48:51], v[108:111], v[168:171], v[48:51]
    buffer_load_dwordx4 a[140:143], v227, s[16:19], s82 offen sc1
    v_mfma_f32_16x16x32_bf16 v[68:71], v[108:111], v[172:175], v[68:71]
    v_mfma_f32_16x16x32_bf16 v[72:75], v[112:115], v[172:175], v[72:75]
    v_mfma_f32_16x16x32_bf16 v[52:55], v[112:115], v[168:171], v[52:55]
    v_mfma_f32_16x16x32_bf16 v[32:35], v[112:115], v[164:167], v[32:35]
    v_mfma_f32_16x16x32_bf16 v[12:15], v[112:115], v[160:163], v[12:15]
    buffer_load_dwordx4 a[128:131], v224, s[16:19], s82 offen sc1
    v_mfma_f32_16x16x32_bf16 v[16:19], v[116:119], v[160:163], v[16:19]
    v_mfma_f32_16x16x32_bf16 v[36:39], v[116:119], v[164:167], v[36:39]
    v_mfma_f32_16x16x32_bf16 v[56:59], v[116:119], v[168:171], v[56:59]
    v_mfma_f32_16x16x32_bf16 v[76:79], v[116:119], v[172:175], v[76:79]
    s_waitcnt vmcnt(12)
    v_mfma_f32_16x16x32_bf16 v[0:3], v[120:123], v[176:179], v[0:3]
    s_add_u32 s82, s50, 24576
    v_mfma_f32_16x16x32_bf16 v[20:23], v[120:123], v[180:183], v[20:23]
    buffer_load_dwordx4 v[164:167], v225, s[16:19], s82 offen sc1
    v_mfma_f32_16x16x32_bf16 v[40:43], v[120:123], v[184:187], v[40:43]
    v_mfma_f32_16x16x32_bf16 v[60:63], v[120:123], v[188:191], v[60:63]
    v_mfma_f32_16x16x32_bf16 v[64:67], v[124:127], v[188:191], v[64:67]
    v_mfma_f32_16x16x32_bf16 v[44:47], v[124:127], v[184:187], v[44:47]
    buffer_load_dwordx4 v[168:171], v226, s[16:19], s82 offen sc1
    v_mfma_f32_16x16x32_bf16 v[24:27], v[124:127], v[180:183], v[24:27]
    v_mfma_f32_16x16x32_bf16 v[4:7], v[124:127], v[176:179], v[4:7]
    v_mfma_f32_16x16x32_bf16 v[8:11], v[128:131], v[176:179], v[8:11]
    v_mfma_f32_16x16x32_bf16 v[28:31], v[128:131], v[180:183], v[28:31]
    v_mfma_f32_16x16x32_bf16 v[48:51], v[128:131], v[184:187], v[48:51]
    buffer_load_dwordx4 v[172:175], v227, s[16:19], s82 offen sc1
    v_mfma_f32_16x16x32_bf16 v[68:71], v[128:131], v[188:191], v[68:71]
    v_mfma_f32_16x16x32_bf16 v[72:75], v[132:135], v[188:191], v[72:75]
    v_mfma_f32_16x16x32_bf16 v[52:55], v[132:135], v[184:187], v[52:55]
    v_mfma_f32_16x16x32_bf16 v[32:35], v[132:135], v[180:183], v[32:35]
    v_mfma_f32_16x16x32_bf16 v[12:15], v[132:135], v[176:179], v[12:15]
    buffer_load_dwordx4 v[160:163], v224, s[16:19], s82 offen sc1
    v_mfma_f32_16x16x32_bf16 v[16:19], v[136:139], v[176:179], v[16:19]
    v_mfma_f32_16x16x32_bf16 v[36:39], v[136:139], v[180:183], v[36:39]
    v_mfma_f32_16x16x32_bf16 v[56:59], v[136:139], v[184:187], v[56:59]
    v_mfma_f32_16x16x32_bf16 v[76:79], v[136:139], v[188:191], v[76:79]
    s_waitcnt vmcnt(12)
    v_mfma_f32_16x16x32_bf16 v[0:3], v[140:143], a[144:147], v[0:3]
    s_add_u32 s82, s50, 28672
    v_mfma_f32_16x16x32_bf16 v[20:23], v[140:143], a[148:151], v[20:23]
    buffer_load_dwordx4 v[180:183], v225, s[16:19], s82 offen sc1
    v_mfma_f32_16x16x32_bf16 v[40:43], v[140:143], a[152:155], v[40:43]
    v_mfma_f32_16x16x32_bf16 v[60:63], v[140:143], a[156:159], v[60:63]
    v_mfma_f32_16x16x32_bf16 v[64:67], v[144:147], a[156:159], v[64:67]
    v_mfma_f32_16x16x32_bf16 v[44:47], v[144:147], a[152:155], v[44:47]
    buffer_load_dwordx4 v[184:187], v226, s[16:19], s82 offen sc1
    v_mfma_f32_16x16x32_bf16 v[24:27], v[144:147], a[148:151], v[24:27]
    v_mfma_f32_16x16x32_bf16 v[4:7], v[144:147], a[144:147], v[4:7]
    v_mfma_f32_16x16x32_bf16 v[8:11], v[148:151], a[144:147], v[8:11]
    v_mfma_f32_16x16x32_bf16 v[28:31], v[148:151], a[148:151], v[28:31]
    v_mfma_f32_16x16x32_bf16 v[48:51], v[148:151], a[152:155], v[48:51]
    buffer_load_dwordx4 v[188:191], v227, s[16:19], s82 offen sc1
    v_mfma_f32_16x16x32_bf16 v[68:71], v[148:151], a[156:159], v[68:71]
    v_mfma_f32_16x16x32_bf16 v[72:75], v[152:155], a[156:159], v[72:75]
    v_mfma_f32_16x16x32_bf16 v[52:55], v[152:155], a[152:155], v[52:55]
    v_mfma_f32_16x16x32_bf16 v[32:35], v[152:155], a[148:151], v[32:35]
    v_mfma_f32_16x16x32_bf16 v[12:15], v[152:155], a[144:147], v[12:15]
    buffer_load_dwordx4 v[176:179], v224, s[16:19], s82 offen sc1
    v_mfma_f32_16x16x32_bf16 v[16:19], v[156:159], a[144:147], v[16:19]
    v_mfma_f32_16x16x32_bf16 v[36:39], v[156:159], a[148:151], v[36:39]
    v_mfma_f32_16x16x32_bf16 v[56:59], v[156:159], a[152:155], v[56:59]
    v_mfma_f32_16x16x32_bf16 v[76:79], v[156:159], a[156:159], v[76:79]
    s_waitcnt vmcnt(12)
    v_mfma_f32_16x16x32_bf16 v[0:3], a[0:3], v[208:211], v[0:3]
    s_add_u32 s82, s50, 32768
    v_mfma_f32_16x16x32_bf16 v[20:23], a[0:3], v[212:215], v[20:23]
    buffer_load_dwordx4 a[148:151], v225, s[16:19], s82 offen sc1
    v_mfma_f32_16x16x32_bf16 v[40:43], a[0:3], v[216:219], v[40:43]
    v_mfma_f32_16x16x32_bf16 v[60:63], a[0:3], v[220:223], v[60:63]
    v_mfma_f32_16x16x32_bf16 v[64:67], a[4:7], v[220:223], v[64:67]
    v_mfma_f32_16x16x32_bf16 v[44:47], a[4:7], v[216:219], v[44:47]
    buffer_load_dwordx4 a[152:155], v226, s[16:19], s82 offen sc1
    v_mfma_f32_16x16x32_bf16 v[24:27], a[4:7], v[212:215], v[24:27]
    v_mfma_f32_16x16x32_bf16 v[4:7], a[4:7], v[208:211], v[4:7]
    v_mfma_f32_16x16x32_bf16 v[8:11], a[8:11], v[208:211], v[8:11]
    v_mfma_f32_16x16x32_bf16 v[28:31], a[8:11], v[212:215], v[28:31]
    v_mfma_f32_16x16x32_bf16 v[48:51], a[8:11], v[216:219], v[48:51]
    buffer_load_dwordx4 a[156:159], v227, s[16:19], s82 offen sc1
    v_mfma_f32_16x16x32_bf16 v[68:71], a[8:11], v[220:223], v[68:71]
    v_mfma_f32_16x16x32_bf16 v[72:75], a[12:15], v[220:223], v[72:75]
    v_mfma_f32_16x16x32_bf16 v[52:55], a[12:15], v[216:219], v[52:55]
    v_mfma_f32_16x16x32_bf16 v[32:35], a[12:15], v[212:215], v[32:35]
    v_mfma_f32_16x16x32_bf16 v[12:15], a[12:15], v[208:211], v[12:15]
    buffer_load_dwordx4 a[144:147], v224, s[16:19], s82 offen sc1
    v_mfma_f32_16x16x32_bf16 v[16:19], a[16:19], v[208:211], v[16:19]
    v_mfma_f32_16x16x32_bf16 v[36:39], a[16:19], v[212:215], v[36:39]
    v_mfma_f32_16x16x32_bf16 v[56:59], a[16:19], v[216:219], v[56:59]
    v_mfma_f32_16x16x32_bf16 v[76:79], a[16:19], v[220:223], v[76:79]
    s_waitcnt vmcnt(12)
    v_mfma_f32_16x16x32_bf16 v[0:3], a[20:23], a[128:131], v[0:3]
    s_add_u32 s82, s50, 36864
    v_mfma_f32_16x16x32_bf16 v[20:23], a[20:23], a[132:135], v[20:23]
    buffer_load_dwordx4 v[212:215], v225, s[16:19], s82 offen sc1
    v_mfma_f32_16x16x32_bf16 v[40:43], a[20:23], a[136:139], v[40:43]
    v_mfma_f32_16x16x32_bf16 v[60:63], a[20:23], a[140:143], v[60:63]
    v_mfma_f32_16x16x32_bf16 v[64:67], a[24:27], a[140:143], v[64:67]
    v_mfma_f32_16x16x32_bf16 v[44:47], a[24:27], a[136:139], v[44:47]
    buffer_load_dwordx4 v[216:219], v226, s[16:19], s82 offen sc1
    v_mfma_f32_16x16x32_bf16 v[24:27], a[24:27], a[132:135], v[24:27]
    v_mfma_f32_16x16x32_bf16 v[4:7], a[24:27], a[128:131], v[4:7]
    v_mfma_f32_16x16x32_bf16 v[8:11], a[28:31], a[128:131], v[8:11]
    v_mfma_f32_16x16x32_bf16 v[28:31], a[28:31], a[132:135], v[28:31]
    v_mfma_f32_16x16x32_bf16 v[48:51], a[28:31], a[136:139], v[48:51]
    buffer_load_dwordx4 v[220:223], v227, s[16:19], s82 offen sc1
    v_mfma_f32_16x16x32_bf16 v[68:71], a[28:31], a[140:143], v[68:71]
    v_mfma_f32_16x16x32_bf16 v[72:75], a[32:35], a[140:143], v[72:75]
    v_mfma_f32_16x16x32_bf16 v[52:55], a[32:35], a[136:139], v[52:55]
    v_mfma_f32_16x16x32_bf16 v[32:35], a[32:35], a[132:135], v[32:35]
    v_mfma_f32_16x16x32_bf16 v[12:15], a[32:35], a[128:131], v[12:15]
    buffer_load_dwordx4 v[208:211], v224, s[16:19], s82 offen sc1
    v_mfma_f32_16x16x32_bf16 v[16:19], a[36:39], a[128:131], v[16:19]
    v_mfma_f32_16x16x32_bf16 v[36:39], a[36:39], a[132:135], v[36:39]
    v_mfma_f32_16x16x32_bf16 v[56:59], a[36:39], a[136:139], v[56:59]
    v_mfma_f32_16x16x32_bf16 v[76:79], a[36:39], a[140:143], v[76:79]
    s_waitcnt vmcnt(12)
    v_mfma_f32_16x16x32_bf16 v[0:3], a[40:43], v[160:163], v[0:3]
    s_add_u32 s82, s50, 40960
    v_mfma_f32_16x16x32_bf16 v[20:23], a[40:43], v[164:167], v[20:23]
    buffer_load_dwordx4 a[132:135], v225, s[16:19], s82 offen sc1
    v_mfma_f32_16x16x32_bf16 v[40:43], a[40:43], v[168:171], v[40:43]
    v_mfma_f32_16x16x32_bf16 v[60:63], a[40:43], v[172:175], v[60:63]
    v_mfma_f32_16x16x32_bf16 v[64:67], a[44:47], v[172:175], v[64:67]
    v_mfma_f32_16x16x32_bf16 v[44:47], a[44:47], v[168:171], v[44:47]
    buffer_load_dwordx4 a[136:139], v226, s[16:19], s82 offen sc1
    v_mfma_f32_16x16x32_bf16 v[24:27], a[44:47], v[164:167], v[24:27]
    v_mfma_f32_16x16x32_bf16 v[4:7], a[44:47], v[160:163], v[4:7]
    v_mfma_f32_16x16x32_bf16 v[8:11], a[48:51], v[160:163], v[8:11]
    v_mfma_f32_16x16x32_bf16 v[28:31], a[48:51], v[164:167], v[28:31]
    v_mfma_f32_16x16x32_bf16 v[48:51], a[48:51], v[168:171], v[48:51]
    buffer_load_dwordx4 a[140:143], v227, s[16:19], s82 offen sc1
    v_mfma_f32_16x16x32_bf16 v[68:71], a[48:51], v[172:175], v[68:71]
    v_mfma_f32_16x16x32_bf16 v[72:75], a[52:55], v[172:175], v[72:75]
    v_mfma_f32_16x16x32_bf16 v[52:55], a[52:55], v[168:171], v[52:55]
    v_mfma_f32_16x16x32_bf16 v[32:35], a[52:55], v[164:167], v[32:35]
    v_mfma_f32_16x16x32_bf16 v[12:15], a[52:55], v[160:163], v[12:15]
    buffer_load_dwordx4 a[128:131], v224, s[16:19], s82 offen sc1
    v_mfma_f32_16x16x32_bf16 v[16:19], a[56:59], v[160:163], v[16:19]
    v_mfma_f32_16x16x32_bf16 v[36:39], a[56:59], v[164:167], v[36:39]
    v_mfma_f32_16x16x32_bf16 v[56:59], a[56:59], v[168:171], v[56:59]
    v_mfma_f32_16x16x32_bf16 v[76:79], a[56:59], v[172:175], v[76:79]
    s_waitcnt vmcnt(12)
    v_mfma_f32_16x16x32_bf16 v[0:3], a[60:63], v[176:179], v[0:3]
    s_add_u32 s82, s50, 45056
    v_mfma_f32_16x16x32_bf16 v[20:23], a[60:63], v[180:183], v[20:23]
    buffer_load_dwordx4 v[164:167], v225, s[16:19], s82 offen sc1
    v_mfma_f32_16x16x32_bf16 v[40:43], a[60:63], v[184:187], v[40:43]
    v_mfma_f32_16x16x32_bf16 v[60:63], a[60:63], v[188:191], v[60:63]
    v_mfma_f32_16x16x32_bf16 v[64:67], a[64:67], v[188:191], v[64:67]
    v_mfma_f32_16x16x32_bf16 v[44:47], a[64:67], v[184:187], v[44:47]
    buffer_load_dwordx4 v[168:171], v226, s[16:19], s82 offen sc1
    v_mfma_f32_16x16x32_bf16 v[24:27], a[64:67], v[180:183], v[24:27]
    v_mfma_f32_16x16x32_bf16 v[4:7], a[64:67], v[176:179], v[4:7]
    v_mfma_f32_16x16x32_bf16 v[8:11], a[68:71], v[176:179], v[8:11]
    v_mfma_f32_16x16x32_bf16 v[28:31], a[68:71], v[180:183], v[28:31]
    v_mfma_f32_16x16x32_bf16 v[48:51], a[68:71], v[184:187], v[48:51]
    buffer_load_dwordx4 v[172:175], v227, s[16:19], s82 offen sc1
    v_mfma_f32_16x16x32_bf16 v[68:71], a[68:71], v[188:191], v[68:71]
    v_mfma_f32_16x16x32_bf16 v[72:75], a[72:75], v[188:191], v[72:75]
    v_mfma_f32_16x16x32_bf16 v[52:55], a[72:75], v[184:187], v[52:55]
    v_mfma_f32_16x16x32_bf16 v[32:35], a[72:75], v[180:183], v[32:35]
    v_mfma_f32_16x16x32_bf16 v[12:15], a[72:75], v[176:179], v[12:15]
    buffer_load_dwordx4 v[160:163], v224, s[16:19], s82 offen sc1
    v_mfma_f32_16x16x32_bf16 v[16:19], a[76:79], v[176:179], v[16:19]
    v_mfma_f32_16x16x32_bf16 v[36:39], a[76:79], v[180:183], v[36:39]
    v_mfma_f32_16x16x32_bf16 v[56:59], a[76:79], v[184:187], v[56:59]
    v_mfma_f32_16x16x32_bf16 v[76:79], a[76:79], v[188:191], v[76:79]
    s_waitcnt vmcnt(12)
    v_mfma_f32_16x16x32_bf16 v[0:3], a[80:83], a[144:147], v[0:3]
    s_add_u32 s82, s50, 49152
    v_mfma_f32_16x16x32_bf16 v[20:23], a[80:83], a[148:151], v[20:23]
    buffer_load_dwordx4 v[180:183], v225, s[16:19], s82 offen sc1
    v_mfma_f32_16x16x32_bf16 v[40:43], a[80:83], a[152:155], v[40:43]
    v_mfma_f32_16x16x32_bf16 v[60:63], a[80:83], a[156:159], v[60:63]
    v_mfma_f32_16x16x32_bf16 v[64:67], a[84:87], a[156:159], v[64:67]
    v_mfma_f32_16x16x32_bf16 v[44:47], a[84:87], a[152:155], v[44:47]
    buffer_load_dwordx4 v[184:187], v226, s[16:19], s82 offen sc1
    v_mfma_f32_16x16x32_bf16 v[24:27], a[84:87], a[148:151], v[24:27]
    v_mfma_f32_16x16x32_bf16 v[4:7], a[84:87], a[144:147], v[4:7]
    v_mfma_f32_16x16x32_bf16 v[8:11], a[88:91], a[144:147], v[8:11]
    v_mfma_f32_16x16x32_bf16 v[28:31], a[88:91], a[148:151], v[28:31]
    v_mfma_f32_16x16x32_bf16 v[48:51], a[88:91], a[152:155], v[48:51]
    buffer_load_dwordx4 v[188:191], v227, s[16:19], s82 offen sc1
    v_mfma_f32_16x16x32_bf16 v[68:71], a[88:91], a[156:159], v[68:71]
    v_mfma_f32_16x16x32_bf16 v[72:75], a[92:95], a[156:159], v[72:75]
    v_mfma_f32_16x16x32_bf16 v[52:55], a[92:95], a[152:155], v[52:55]
    v_mfma_f32_16x16x32_bf16 v[32:35], a[92:95], a[148:151], v[32:35]
    v_mfma_f32_16x16x32_bf16 v[12:15], a[92:95], a[144:147], v[12:15]
    buffer_load_dwordx4 v[176:179], v224, s[16:19], s82 offen sc1
    v_mfma_f32_16x16x32_bf16 v[16:19], a[96:99], a[144:147], v[16:19]
    v_mfma_f32_16x16x32_bf16 v[36:39], a[96:99], a[148:151], v[36:39]
    v_mfma_f32_16x16x32_bf16 v[56:59], a[96:99], a[152:155], v[56:59]
    v_mfma_f32_16x16x32_bf16 v[76:79], a[96:99], a[156:159], v[76:79]
    s_waitcnt vmcnt(12)
    v_mfma_f32_16x16x32_bf16 v[0:3], a[100:103], v[208:211], v[0:3]
    s_add_u32 s82, s50, 53248
    v_mfma_f32_16x16x32_bf16 v[20:23], a[100:103], v[212:215], v[20:23]
    buffer_load_dwordx4 a[148:151], v225, s[16:19], s82 offen sc1
    v_mfma_f32_16x16x32_bf16 v[40:43], a[100:103], v[216:219], v[40:43]
    v_mfma_f32_16x16x32_bf16 v[60:63], a[100:103], v[220:223], v[60:63]
    v_mfma_f32_16x16x32_bf16 v[64:67], a[104:107], v[220:223], v[64:67]
    v_mfma_f32_16x16x32_bf16 v[44:47], a[104:107], v[216:219], v[44:47]
    buffer_load_dwordx4 a[152:155], v226, s[16:19], s82 offen sc1
    v_mfma_f32_16x16x32_bf16 v[24:27], a[104:107], v[212:215], v[24:27]
    v_mfma_f32_16x16x32_bf16 v[4:7], a[104:107], v[208:211], v[4:7]
    v_mfma_f32_16x16x32_bf16 v[8:11], a[108:111], v[208:211], v[8:11]
    v_mfma_f32_16x16x32_bf16 v[28:31], a[108:111], v[212:215], v[28:31]
    v_mfma_f32_16x16x32_bf16 v[48:51], a[108:111], v[216:219], v[48:51]
    buffer_load_dwordx4 a[156:159], v227, s[16:19], s82 offen sc1
    v_mfma_f32_16x16x32_bf16 v[68:71], a[108:111], v[220:223], v[68:71]
    v_mfma_f32_16x16x32_bf16 v[72:75], a[112:115], v[220:223], v[72:75]
    v_mfma_f32_16x16x32_bf16 v[52:55], a[112:115], v[216:219], v[52:55]
    v_mfma_f32_16x16x32_bf16 v[32:35], a[112:115], v[212:215], v[32:35]
    v_mfma_f32_16x16x32_bf16 v[12:15], a[112:115], v[208:211], v[12:15]
    buffer_load_dwordx4 a[144:147], v224, s[16:19], s82 offen sc1
    v_mfma_f32_16x16x32_bf16 v[16:19], a[116:119], v[208:211], v[16:19]
    v_mfma_f32_16x16x32_bf16 v[36:39], a[116:119], v[212:215], v[36:39]
    v_mfma_f32_16x16x32_bf16 v[56:59], a[116:119], v[216:219], v[56:59]
    v_mfma_f32_16x16x32_bf16 v[76:79], a[116:119], v[220:223], v[76:79]
    s_waitcnt vmcnt(12)
    v_mfma_f32_16x16x32_bf16 v[0:3], a[120:123], a[128:131], v[0:3]
    s_add_u32 s82, s50, 57344
    v_mfma_f32_16x16x32_bf16 v[20:23], a[120:123], a[132:135], v[20:23]
    buffer_load_dwordx4 v[212:215], v225, s[16:19], s82 offen sc1
    v_mfma_f32_16x16x32_bf16 v[40:43], a[120:123], a[136:139], v[40:43]
    v_mfma_f32_16x16x32_bf16 v[60:63], a[120:123], a[140:143], v[60:63]
    v_mfma_f32_16x16x32_bf16 v[64:67], a[124:127], a[140:143], v[64:67]
    v_mfma_f32_16x16x32_bf16 v[44:47], a[124:127], a[136:139], v[44:47]
    buffer_load_dwordx4 v[216:219], v226, s[16:19], s82 offen sc1
    v_mfma_f32_16x16x32_bf16 v[24:27], a[124:127], a[132:135], v[24:27]
    v_mfma_f32_16x16x32_bf16 v[4:7], a[124:127], a[128:131], v[4:7]
    v_mfma_f32_16x16x32_bf16 v[8:11], a[240:243], a[128:131], v[8:11]
    v_mfma_f32_16x16x32_bf16 v[28:31], a[240:243], a[132:135], v[28:31]
    v_mfma_f32_16x16x32_bf16 v[48:51], a[240:243], a[136:139], v[48:51]
    buffer_load_dwordx4 v[220:223], v227, s[16:19], s82 offen sc1
    v_mfma_f32_16x16x32_bf16 v[68:71], a[240:243], a[140:143], v[68:71]
    v_mfma_f32_16x16x32_bf16 v[72:75], a[244:247], a[140:143], v[72:75]
    v_mfma_f32_16x16x32_bf16 v[52:55], a[244:247], a[136:139], v[52:55]
    v_mfma_f32_16x16x32_bf16 v[32:35], a[244:247], a[132:135], v[32:35]
    v_mfma_f32_16x16x32_bf16 v[12:15], a[244:247], a[128:131], v[12:15]
    buffer_load_dwordx4 v[208:211], v224, s[16:19], s82 offen sc1
    v_mfma_f32_16x16x32_bf16 v[16:19], a[248:251], a[128:131], v[16:19]
    v_mfma_f32_16x16x32_bf16 v[36:39], a[248:251], a[132:135], v[36:39]
    v_mfma_f32_16x16x32_bf16 v[56:59], a[248:251], a[136:139], v[56:59]
    v_mfma_f32_16x16x32_bf16 v[76:79], a[248:251], a[140:143], v[76:79]
    s_waitcnt vmcnt(12)
    v_mfma_f32_16x16x32_bf16 v[0:3], a[252:255], v[160:163], v[0:3]
    s_add_u32 s82, s50, 61440
    v_mfma_f32_16x16x32_bf16 v[20:23], a[252:255], v[164:167], v[20:23]
    buffer_load_dwordx4 a[132:135], v225, s[16:19], s82 offen sc1
    v_mfma_f32_16x16x32_bf16 v[40:43], a[252:255], v[168:171], v[40:43]
    v_mfma_f32_16x16x32_bf16 v[60:63], a[252:255], v[172:175], v[60:63]
    v_mfma_f32_16x16x32_bf16 v[64:67], v[192:195], v[172:175], v[64:67]
    v_mfma_f32_16x16x32_bf16 v[44:47], v[192:195], v[168:171], v[44:47]
    buffer_load_dwordx4 a[136:139], v226, s[16:19], s82 offen sc1
    v_mfma_f32_16x16x32_bf16 v[24:27], v[192:195], v[164:167], v[24:27]
    v_mfma_f32_16x16x32_bf16 v[4:7], v[192:195], v[160:163], v[4:7]
    v_mfma_f32_16x16x32_bf16 v[8:11], v[196:199], v[160:163], v[8:11]
    v_mfma_f32_16x16x32_bf16 v[28:31], v[196:199], v[164:167], v[28:31]
    v_mfma_f32_16x16x32_bf16 v[48:51], v[196:199], v[168:171], v[48:51]
    buffer_load_dwordx4 a[140:143], v227, s[16:19], s82 offen sc1
    v_mfma_f32_16x16x32_bf16 v[68:71], v[196:199], v[172:175], v[68:71]
    v_mfma_f32_16x16x32_bf16 v[72:75], v[200:203], v[172:175], v[72:75]
    v_mfma_f32_16x16x32_bf16 v[52:55], v[200:203], v[168:171], v[52:55]
    v_mfma_f32_16x16x32_bf16 v[32:35], v[200:203], v[164:167], v[32:35]
    v_mfma_f32_16x16x32_bf16 v[12:15], v[200:203], v[160:163], v[12:15]
    buffer_load_dwordx4 a[128:131], v224, s[16:19], s82 offen sc1
    v_mfma_f32_16x16x32_bf16 v[16:19], v[204:207], v[160:163], v[16:19]
    v_mfma_f32_16x16x32_bf16 v[36:39], v[204:207], v[164:167], v[36:39]
    v_mfma_f32_16x16x32_bf16 v[56:59], v[204:207], v[168:171], v[56:59]
    v_mfma_f32_16x16x32_bf16 v[76:79], v[204:207], v[172:175], v[76:79]
    s_waitcnt vmcnt(12)
    v_mfma_f32_16x16x32_bf16 v[0:3], a[160:163], v[176:179], v[0:3]
    s_add_u32 s82, s80, 0
    v_mfma_f32_16x16x32_bf16 v[20:23], a[160:163], v[180:183], v[20:23]
    buffer_load_dwordx4 v[164:167], v225, s[16:19], s82 offen sc1
    v_mfma_f32_16x16x32_bf16 v[40:43], a[160:163], v[184:187], v[40:43]
    v_mfma_f32_16x16x32_bf16 v[60:63], a[160:163], v[188:191], v[60:63]
    v_mfma_f32_16x16x32_bf16 v[64:67], a[164:167], v[188:191], v[64:67]
    v_mfma_f32_16x16x32_bf16 v[44:47], a[164:167], v[184:187], v[44:47]
    buffer_load_dwordx4 v[168:171], v226, s[16:19], s82 offen sc1
    v_mfma_f32_16x16x32_bf16 v[24:27], a[164:167], v[180:183], v[24:27]
    v_mfma_f32_16x16x32_bf16 v[4:7], a[164:167], v[176:179], v[4:7]
    v_mfma_f32_16x16x32_bf16 v[8:11], a[168:171], v[176:179], v[8:11]
    v_mfma_f32_16x16x32_bf16 v[28:31], a[168:171], v[180:183], v[28:31]
    v_mfma_f32_16x16x32_bf16 v[48:51], a[168:171], v[184:187], v[48:51]
    buffer_load_dwordx4 v[172:175], v227, s[16:19], s82 offen sc1
    v_mfma_f32_16x16x32_bf16 v[68:71], a[168:171], v[188:191], v[68:71]
    v_mfma_f32_16x16x32_bf16 v[72:75], a[172:175], v[188:191], v[72:75]
    v_mfma_f32_16x16x32_bf16 v[52:55], a[172:175], v[184:187], v[52:55]
    v_mfma_f32_16x16x32_bf16 v[32:35], a[172:175], v[180:183], v[32:35]
    v_mfma_f32_16x16x32_bf16 v[12:15], a[172:175], v[176:179], v[12:15]
    buffer_load_dwordx4 v[160:163], v224, s[16:19], s82 offen sc1
    v_mfma_f32_16x16x32_bf16 v[16:19], a[176:179], v[176:179], v[16:19]
    v_mfma_f32_16x16x32_bf16 v[36:39], a[176:179], v[180:183], v[36:39]
    v_mfma_f32_16x16x32_bf16 v[56:59], a[176:179], v[184:187], v[56:59]
    v_mfma_f32_16x16x32_bf16 v[76:79], a[176:179], v[188:191], v[76:79]
    s_waitcnt vmcnt(7)
    v_mfma_f32_16x16x32_bf16 v[20:23], a[180:183], a[148:151], v[20:23]
    s_add_u32 s82, s80, 4096
    v_mfma_f32_16x16x32_bf16 v[20:23], a[200:203], v[212:215], v[20:23]
    buffer_load_dwordx4 v[180:183], v225, s[16:19], s82 offen sc1
    v_mfma_f32_16x16x32_bf16 v[20:23], a[220:223], a[132:135], v[20:23]
    v_mfma_f32_16x16x32_bf16 v[24:27], a[224:227], a[132:135], v[24:27]
    s_add_u32 s82, s80, 4096
    v_mfma_f32_16x16x32_bf16 v[24:27], a[204:207], v[212:215], v[24:27]
    buffer_load_dwordx4 v[184:187], v226, s[16:19], s82 offen sc1
    v_mfma_f32_16x16x32_bf16 v[24:27], a[184:187], a[148:151], v[24:27]
    v_mfma_f32_16x16x32_bf16 v[28:31], a[188:191], a[148:151], v[28:31]
    s_add_u32 s82, s80, 4096
    v_mfma_f32_16x16x32_bf16 v[28:31], a[208:211], v[212:215], v[28:31]
    buffer_load_dwordx4 v[188:191], v227, s[16:19], s82 offen sc1
    v_mfma_f32_16x16x32_bf16 v[28:31], a[228:231], a[132:135], v[28:31]
    v_mfma_f32_16x16x32_bf16 v[32:35], a[232:235], a[132:135], v[32:35]
    v_mfma_f32_16x16x32_bf16 v[32:35], a[212:215], v[212:215], v[32:35]
    s_add_u32 s82, s80, 4096
    ds_write_b128 v231, v[20:23] offset:0
    v_mfma_f32_16x16x32_bf16 v[32:35], a[192:195], a[148:151], v[32:35]
    buffer_load_dwordx4 v[176:179], v224, s[16:19], s82 offen sc1
    v_mfma_f32_16x16x32_bf16 v[36:39], a[196:199], a[148:151], v[36:39]
    ds_write_b128 v231, v[24:27] offset:1024
    v_mfma_f32_16x16x32_bf16 v[36:39], a[216:219], v[212:215], v[36:39]
    v_mfma_f32_16x16x32_bf16 v[36:39], a[236:239], a[132:135], v[36:39]
    s_waitcnt vmcnt(10)
    v_mfma_f32_16x16x32_bf16 v[40:43], a[180:183], a[152:155], v[40:43]
    s_add_u32 s82, s80, 8192
    ds_write_b128 v231, v[28:31] offset:2048
    v_mfma_f32_16x16x32_bf16 v[40:43], a[200:203], v[216:219], v[40:43]
    buffer_load_dwordx4 a[148:151], v225, s[16:19], s82 offen sc1
    v_mfma_f32_16x16x32_bf16 v[40:43], a[220:223], a[136:139], v[40:43]
    v_mfma_f32_16x16x32_bf16 v[44:47], a[224:227], a[136:139], v[44:47]
    s_add_u32 s82, s80, 12288
    ds_write_b128 v231, v[32:35] offset:3072
    v_mfma_f32_16x16x32_bf16 v[44:47], a[204:207], v[216:219], v[44:47]
    buffer_load_dwordx4 v[212:215], v225, s[16:19], s82 offen sc1
    v_mfma_f32_16x16x32_bf16 v[44:47], a[184:187], a[152:155], v[44:47]
    v_mfma_f32_16x16x32_bf16 v[48:51], a[188:191], a[152:155], v[48:51]
    s_add_u32 s82, s80, 16384
    ds_write_b128 v231, v[36:39] offset:4096
    v_mfma_f32_16x16x32_bf16 v[48:51], a[208:211], v[216:219], v[48:51]
    buffer_load_dwordx4 a[132:135], v225, s[16:19], s82 offen sc1
    v_mfma_f32_16x16x32_bf16 v[48:51], a[228:231], a[136:139], v[48:51]
    v_mfma_f32_16x16x32_bf16 v[52:55], a[232:235], a[136:139], v[52:55]
    ds_write_b128 v253, v[40:43] offset:0
    v_mfma_f32_16x16x32_bf16 v[52:55], a[212:215], v[216:219], v[52:55]
    v_mfma_f32_16x16x32_bf16 v[52:55], a[192:195], a[152:155], v[52:55]
    v_mfma_f32_16x16x32_bf16 v[56:59], a[196:199], a[152:155], v[56:59]
    ds_write_b128 v253, v[44:47] offset:1024
    v_mfma_f32_16x16x32_bf16 v[56:59], a[216:219], v[216:219], v[56:59]
    v_mfma_f32_16x16x32_bf16 v[56:59], a[236:239], a[136:139], v[56:59]
    s_waitcnt vmcnt(12)
    v_mfma_f32_16x16x32_bf16 v[60:63], a[180:183], a[156:159], v[60:63]
    s_add_u32 s82, s80, 8192
    ds_write_b128 v253, v[48:51] offset:2048
    v_mfma_f32_16x16x32_bf16 v[60:63], a[200:203], v[220:223], v[60:63]
HOP1_1:
    s_cbranch_execz HOP1_5
    buffer_load_dwordx4 a[152:155], v226, s[16:19], s82 offen sc1
    v_mfma_f32_16x16x32_bf16 v[60:63], a[220:223], a[140:143], v[60:63]
    v_mfma_f32_16x16x32_bf16 v[64:67], a[224:227], a[140:143], v[64:67]
    s_add_u32 s82, s80, 12288
    ds_write_b128 v253, v[52:55] offset:3072
    v_mfma_f32_16x16x32_bf16 v[64:67], a[204:207], v[220:223], v[64:67]
    buffer_load_dwordx4 v[216:219], v226, s[16:19], s82 offen sc1
    v_mfma_f32_16x16x32_bf16 v[64:67], a[184:187], a[156:159], v[64:67]
    v_mfma_f32_16x16x32_bf16 v[68:71], a[188:191], a[156:159], v[68:71]
    s_add_u32 s82, s80, 16384
    ds_write_b128 v253, v[56:59] offset:4096
    v_mfma_f32_16x16x32_bf16 v[68:71], a[208:211], v[220:223], v[68:71]
    buffer_load_dwordx4 a[136:139], v226, s[16:19], s82 offen sc1
    v_mfma_f32_16x16x32_bf16 v[68:71], a[228:231], a[140:143], v[68:71]
    v_mfma_f32_16x16x32_bf16 v[72:75], a[232:235], a[140:143], v[72:75]
    ds_write_b128 v254, v[60:63] offset:0
    v_mfma_f32_16x16x32_bf16 v[72:75], a[212:215], v[220:223], v[72:75]
    v_mfma_f32_16x16x32_bf16 v[72:75], a[192:195], a[156:159], v[72:75]
    v_mfma_f32_16x16x32_bf16 v[76:79], a[196:199], a[156:159], v[76:79]
    ds_write_b128 v254, v[64:67] offset:1024
    v_mfma_f32_16x16x32_bf16 v[76:79], a[216:219], v[220:223], v[76:79]
    v_mfma_f32_16x16x32_bf16 v[76:79], a[236:239], a[140:143], v[76:79]
    s_waitcnt vmcnt(14)
    v_mfma_f32_16x16x32_bf16 v[0:3], a[180:183], a[144:147], v[0:3]
    s_add_u32 s82, s80, 8192
    ds_write_b128 v254, v[68:71] offset:2048
    v_mfma_f32_16x16x32_bf16 v[0:3], a[200:203], v[208:211], v[0:3]
    buffer_load_dwordx4 a[156:159], v227, s[16:19], s82 offen sc1
    v_mfma_f32_16x16x32_bf16 v[0:3], a[220:223], a[128:131], v[0:3]
    v_mfma_f32_16x16x32_bf16 v[4:7], a[224:227], a[128:131], v[4:7]
    s_add_u32 s82, s80, 12288
    ds_write_b128 v254, v[72:75] offset:3072
    v_mfma_f32_16x16x32_bf16 v[4:7], a[204:207], v[208:211], v[4:7]
    buffer_load_dwordx4 v[220:223], v227, s[16:19], s82 offen sc1
    v_mfma_f32_16x16x32_bf16 v[4:7], a[184:187], a[144:147], v[4:7]
    v_mfma_f32_16x16x32_bf16 v[8:11], a[188:191], a[144:147], v[8:11]
    ds_write_b128 v254, v[76:79] offset:4096
    v_mfma_f32_16x16x32_bf16 v[8:11], a[208:211], v[208:211], v[8:11]
    v_mfma_f32_16x16x32_bf16 v[8:11], a[228:231], a[128:131], v[8:11]
    v_mfma_f32_16x16x32_bf16 v[12:15], a[232:235], a[128:131], v[12:15]
    v_mfma_f32_16x16x32_bf16 v[12:15], a[212:215], v[208:211], v[12:15]
    s_waitcnt lgkmcnt(0)
    v_mfma_f32_16x16x32_bf16 v[12:15], a[192:195], a[144:147], v[12:15]
    s_barrier
    ds_read_b128 v[20:23], v230 offset:0
    ds_read_b128 v[40:43], v230 offset:5120
    v_mfma_f32_16x16x32_bf16 v[16:19], a[196:199], a[144:147], v[16:19]
    ds_read_b128 v[60:63], v230 offset:10240
    ds_read_b128 v[24:27], v230 offset:1024
    v_mfma_f32_16x16x32_bf16 v[16:19], a[216:219], v[208:211], v[16:19]
    ds_read_b128 v[44:47], v230 offset:6144
    ds_read_b128 v[64:67], v230 offset:11264
    v_mfma_f32_16x16x32_bf16 v[16:19], a[236:239], a[128:131], v[16:19]
    ds_read_b128 v[28:31], v230 offset:2048
    ds_read_b128 v[48:51], v230 offset:7168
    ds_read_b128 v[68:71], v230 offset:12288
    ds_read_b128 v[32:35], v230 offset:3072
    ds_read_b128 v[52:55], v230 offset:8192
    ds_read_b128 v[72:75], v230 offset:13312
    ds_read_b128 v[36:39], v230 offset:4096
    ds_read_b128 v[56:59], v230 offset:9216
    ds_read_b128 v[76:79], v230 offset:14336
    s_add_u32 s82, s80, 16384
    buffer_load_dwordx4 a[140:143], v227, s[16:19], s82 offen sc1
    s_add_u32 s82, s80, 8192
    buffer_load_dwordx4 a[144:147], v224, s[16:19], s82 offen sc1
    s_add_u32 s82, s80, 12288
    buffer_load_dwordx4 v[208:211], v224, s[16:19], s82 offen sc1
    s_add_u32 s82, s80, 16384
    buffer_load_dwordx4 a[128:131], v224, s[16:19], s82 offen sc1
    s_waitcnt lgkmcnt(12)
    v_pk_add_f32 v[0:1], v[0:1], v[20:21]
    v_pk_add_f32 v[40:41], v[40:41], v[60:61]
    v_pk_add_f32 v[2:3], v[2:3], v[22:23]
    v_pk_add_f32 v[42:43], v[42:43], v[62:63]
    v_pk_add_f32 v[0:1], v[0:1], v[40:41]
    v_pk_add_f32 v[2:3], v[2:3], v[42:43]
    buffer_store_dwordx4 v[0:3], v249, s[16:19], s20 offen offset:0 sc1
    s_waitcnt lgkmcnt(9)
    v_pk_add_f32 v[4:5], v[4:5], v[24:25]
    v_pk_add_f32 v[44:45], v[44:45], v[64:65]
    v_pk_add_f32 v[6:7], v[6:7], v[26:27]
    v_pk_add_f32 v[46:47], v[46:47], v[66:67]
    v_pk_add_f32 v[4:5], v[4:5], v[44:45]
    v_pk_add_f32 v[6:7], v[6:7], v[46:47]
    buffer_store_dwordx4 v[4:7], v249, s[16:19], s20 offen offset:1024 sc1
    s_waitcnt lgkmcnt(6)
    v_pk_add_f32 v[8:9], v[8:9], v[28:29]
    v_pk_add_f32 v[48:49], v[48:49], v[68:69]
    v_pk_add_f32 v[10:11], v[10:11], v[30:31]
    v_pk_add_f32 v[50:51], v[50:51], v[70:71]
    v_pk_add_f32 v[8:9], v[8:9], v[48:49]
    v_pk_add_f32 v[10:11], v[10:11], v[50:51]
    buffer_store_dwordx4 v[8:11], v249, s[16:19], s20 offen offset:2048 sc1
    s_waitcnt lgkmcnt(3)
    v_pk_add_f32 v[12:13], v[12:13], v[32:33]
    v_pk_add_f32 v[52:53], v[52:53], v[72:73]
    v_pk_add_f32 v[14:15], v[14:15], v[34:35]
    v_pk_add_f32 v[54:55], v[54:55], v[74:75]
    v_pk_add_f32 v[12:13], v[12:13], v[52:53]
    v_pk_add_f32 v[14:15], v[14:15], v[54:55]
    buffer_store_dwordx4 v[12:15], v249, s[16:19], s20 offen offset:3072 sc1
    s_waitcnt lgkmcnt(0)
    v_pk_add_f32 v[16:17], v[16:17], v[36:37]
    v_pk_add_f32 v[56:57], v[56:57], v[76:77]
    v_pk_add_f32 v[18:19], v[18:19], v[38:39]
    v_pk_add_f32 v[58:59], v[58:59], v[78:79]
    v_pk_add_f32 v[16:17], v[16:17], v[56:57]
    v_pk_add_f32 v[18:19], v[18:19], v[58:59]
    s_add_u32 s20, s20, 4096
    s_barrier
    buffer_store_dwordx4 v[16:19], v249, s[16:19], s20 offen offset:0 sc1
    s_waitcnt vmcnt(21)
    v_mfma_f32_16x16x32_bf16 v[0:3], v[80:83], v[160:163], 0
    v_mfma_f32_16x16x32_bf16 v[20:23], v[80:83], v[164:167], 0
    v_mfma_f32_16x16x32_bf16 v[40:43], v[80:83], v[168:171], 0
    v_mfma_f32_16x16x32_bf16 v[60:63], v[80:83], v[172:175], 0
    v_mfma_f32_16x16x32_bf16 v[64:67], v[84:87], v[172:175], 0
    v_mfma_f32_16x16x32_bf16 v[44:47], v[84:87], v[168:171], 0
    v_mfma_f32_16x16x32_bf16 v[24:27], v[84:87], v[164:167], 0
    v_mfma_f32_16x16x32_bf16 v[4:7], v[84:87], v[160:163], 0
    v_mfma_f32_16x16x32_bf16 v[8:11], v[88:91], v[160:163], 0
    v_mfma_f32_16x16x32_bf16 v[28:31], v[88:91], v[164:167], 0
    v_mfma_f32_16x16x32_bf16 v[48:51], v[88:91], v[168:171], 0
    v_mfma_f32_16x16x32_bf16 v[68:71], v[88:91], v[172:175], 0
    v_mfma_f32_16x16x32_bf16 v[72:75], v[92:95], v[172:175], 0
    v_mfma_f32_16x16x32_bf16 v[52:55], v[92:95], v[168:171], 0
    v_mfma_f32_16x16x32_bf16 v[32:35], v[92:95], v[164:167], 0
    v_mfma_f32_16x16x32_bf16 v[12:15], v[92:95], v[160:163], 0
    v_mfma_f32_16x16x32_bf16 v[16:19], v[96:99], v[160:163], 0
    v_mfma_f32_16x16x32_bf16 v[36:39], v[96:99], v[164:167], 0
    v_mfma_f32_16x16x32_bf16 v[56:59], v[96:99], v[168:171], 0
    v_mfma_f32_16x16x32_bf16 v[76:79], v[96:99], v[172:175], 0
    s_waitcnt vmcnt(17)
    v_mfma_f32_16x16x32_bf16 v[0:3], v[100:103], v[176:179], v[0:3]
    s_add_u32 s82, s80, 20480
    v_mov_b32 v80, v232
    v_mov_b32 v81, v233
    v_mfma_f32_16x16x32_bf16 v[20:23], v[100:103], v[180:183], v[20:23]
    buffer_load_dwordx4 v[164:167], v225, s[16:19], s82 offen sc1
    v_mfma_f32_16x16x32_bf16 v[40:43], v[100:103], v[184:187], v[40:43]
    v_mov_b32 v82, v234
    v_mov_b32 v83, v235
    v_mfma_f32_16x16x32_bf16 v[60:63], v[100:103], v[188:191], v[60:63]
    v_mov_b32 v84, v236
    v_mov_b32 v85, v237
    v_mfma_f32_16x16x32_bf16 v[64:67], v[104:107], v[188:191], v[64:67]
    v_mov_b32 v86, v238
    v_mov_b32 v87, v239
    v_mfma_f32_16x16x32_bf16 v[44:47], v[104:107], v[184:187], v[44:47]
    buffer_load_dwordx4 v[168:171], v226, s[16:19], s82 offen sc1
    v_mfma_f32_16x16x32_bf16 v[24:27], v[104:107], v[180:183], v[24:27]
    v_mov_b32 v88, v228
    v_mov_b32 v89, v248
    v_mfma_f32_16x16x32_bf16 v[4:7], v[104:107], v[176:179], v[4:7]
    v_mfma_f32_16x16x32_bf16 v[8:11], v[108:111], v[176:179], v[8:11]
    v_mfma_f32_16x16x32_bf16 v[28:31], v[108:111], v[180:183], v[28:31]
    v_mfma_f32_16x16x32_bf16 v[48:51], v[108:111], v[184:187], v[48:51]
    buffer_load_dwordx4 v[172:175], v227, s[16:19], s82 offen sc1
    v_mfma_f32_16x16x32_bf16 v[68:71], v[108:111], v[188:191], v[68:71]
    v_mfma_f32_16x16x32_bf16 v[72:75], v[112:115], v[188:191], v[72:75]
    v_mfma_f32_16x16x32_bf16 v[52:55], v[112:115], v[184:187], v[52:55]
    v_mfma_f32_16x16x32_bf16 v[32:35], v[112:115], v[180:183], v[32:35]
    v_mfma_f32_16x16x32_bf16 v[12:15], v[112:115], v[176:179], v[12:15]
    buffer_load_dwordx4 v[160:163], v224, s[16:19], s82 offen sc1
    v_mfma_f32_16x16x32_bf16 v[16:19], v[116:119], v[176:179], v[16:19]
    v_mfma_f32_16x16x32_bf16 v[36:39], v[116:119], v[180:183], v[36:39]
    v_mfma_f32_16x16x32_bf16 v[56:59], v[116:119], v[184:187], v[56:59]
    v_mfma_f32_16x16x32_bf16 v[76:79], v[116:119], v[188:191], v[76:79]
    s_waitcnt vmcnt(11)
    v_mfma_f32_16x16x32_bf16 v[0:3], v[120:123], a[144:147], v[0:3]
    s_add_u32 s82, s80, 24576
    v_add_u32 v248, 94208, v229
    v_lshrrev_b32 v228, 6, v249
    v_mfma_f32_16x16x32_bf16 v[20:23], v[120:123], a[148:151], v[20:23]
    buffer_load_dwordx4 v[180:183], v225, s[16:19], s82 offen sc1
    v_mfma_f32_16x16x32_bf16 v[40:43], v[120:123], a[152:155], v[40:43]
    v_mul_u32_u24 v228, 1216, v228
    v_add_u32 v228, v228, v249
    v_mfma_f32_16x16x32_bf16 v[60:63], v[120:123], a[156:159], v[60:63]
    v_mov_b32 v236, 0
    v_mov_b32 v237, s55
    v_mfma_f32_16x16x32_bf16 v[64:67], v[124:127], a[156:159], v[64:67]
    v_mfma_f32_16x16x32_bf16 v[44:47], v[124:127], a[152:155], v[44:47]
    buffer_load_dwordx4 v[184:187], v226, s[16:19], s82 offen sc1
    v_mfma_f32_16x16x32_bf16 v[24:27], v[124:127], a[148:151], v[24:27]
    v_mfma_f32_16x16x32_bf16 v[4:7], v[124:127], a[144:147], v[4:7]
    v_mfma_f32_16x16x32_bf16 v[8:11], v[128:131], a[144:147], v[8:11]
    v_mfma_f32_16x16x32_bf16 v[28:31], v[128:131], a[148:151], v[28:31]
    v_mfma_f32_16x16x32_bf16 v[48:51], v[128:131], a[152:155], v[48:51]
    buffer_load_dwordx4 v[188:191], v227, s[16:19], s82 offen sc1
    v_mfma_f32_16x16x32_bf16 v[68:71], v[128:131], a[156:159], v[68:71]
    v_mfma_f32_16x16x32_bf16 v[72:75], v[132:135], a[156:159], v[72:75]
    v_mfma_f32_16x16x32_bf16 v[52:55], v[132:135], a[152:155], v[52:55]
    v_mfma_f32_16x16x32_bf16 v[32:35], v[132:135], a[148:151], v[32:35]
    v_mfma_f32_16x16x32_bf16 v[12:15], v[132:135], a[144:147], v[12:15]
    buffer_load_dwordx4 v[176:179], v224, s[16:19], s82 offen sc1
    v_mfma_f32_16x16x32_bf16 v[16:19], v[136:139], a[144:147], v[16:19]
    v_mfma_f32_16x16x32_bf16 v[36:39], v[136:139], a[148:151], v[36:39]
    v_mfma_f32_16x16x32_bf16 v[56:59], v[136:139], a[152:155], v[56:59]
    v_mfma_f32_16x16x32_bf16 v[76:79], v[136:139], a[156:159], v[76:79]
    s_waitcnt vmcnt(14)
    v_mfma_f32_16x16x32_bf16 v[0:3], v[140:143], v[208:211], v[0:3]
    s_add_u32 s82, s80, 28672
    v_mfma_f32_16x16x32_bf16 v[20:23], v[140:143], v[212:215], v[20:23]
    buffer_load_dwordx4 a[148:151], v225, s[16:19], s82 offen sc1
    v_mfma_f32_16x16x32_bf16 v[40:43], v[140:143], v[216:219], v[40:43]
    v_mfma_f32_16x16x32_bf16 v[60:63], v[140:143], v[220:223], v[60:63]
    v_mfma_f32_16x16x32_bf16 v[64:67], v[144:147], v[220:223], v[64:67]
    v_mfma_f32_16x16x32_bf16 v[44:47], v[144:147], v[216:219], v[44:47]
    buffer_load_dwordx4 a[152:155], v226, s[16:19], s82 offen sc1
    v_mfma_f32_16x16x32_bf16 v[24:27], v[144:147], v[212:215], v[24:27]
    v_mfma_f32_16x16x32_bf16 v[4:7], v[144:147], v[208:211], v[4:7]
    v_mfma_f32_16x16x32_bf16 v[8:11], v[148:151], v[208:211], v[8:11]
    v_mfma_f32_16x16x32_bf16 v[28:31], v[148:151], v[212:215], v[28:31]
    v_mfma_f32_16x16x32_bf16 v[48:51], v[148:151], v[216:219], v[48:51]
    buffer_load_dwordx4 a[156:159], v227, s[16:19], s82 offen sc1
    v_mfma_f32_16x16x32_bf16 v[68:71], v[148:151], v[220:223], v[68:71]
    v_mfma_f32_16x16x32_bf16 v[72:75], v[152:155], v[220:223], v[72:75]
    v_mfma_f32_16x16x32_bf16 v[52:55], v[152:155], v[216:219], v[52:55]
    v_mfma_f32_16x16x32_bf16 v[32:35], v[152:155], v[212:215], v[32:35]
    v_mfma_f32_16x16x32_bf16 v[12:15], v[152:155], v[208:211], v[12:15]
    buffer_load_dwordx4 a[144:147], v224, s[16:19], s82 offen sc1
    v_mfma_f32_16x16x32_bf16 v[16:19], v[156:159], v[208:211], v[16:19]
    v_mfma_f32_16x16x32_bf16 v[36:39], v[156:159], v[212:215], v[36:39]
    v_mfma_f32_16x16x32_bf16 v[56:59], v[156:159], v[216:219], v[56:59]
    v_mfma_f32_16x16x32_bf16 v[76:79], v[156:159], v[220:223], v[76:79]
    s_waitcnt vmcnt(12)
    v_mfma_f32_16x16x32_bf16 v[0:3], a[0:3], a[128:131], v[0:3]
    s_add_u32 s82, s80, 32768
    ds_read_b128 v[100:103], v248 offset:2560
    v_mfma_f32_16x16x32_bf16 v[20:23], a[0:3], a[132:135], v[20:23]
    buffer_load_dwordx4 v[212:215], v225, s[16:19], s82 offen sc1
    v_mfma_f32_16x16x32_bf16 v[40:43], a[0:3], a[136:139], v[40:43]
    ds_read_b128 v[120:123], v248 offset:2880
    v_mfma_f32_16x16x32_bf16 v[60:63], a[0:3], a[140:143], v[60:63]
    ds_read_b128 v[104:107], v248 offset:2624
    v_mfma_f32_16x16x32_bf16 v[64:67], a[4:7], a[140:143], v[64:67]
    buffer_load_dwordx4 v[216:219], v226, s[16:19], s82 offen sc1
    v_mfma_f32_16x16x32_bf16 v[44:47], a[4:7], a[136:139], v[44:47]
    ds_read_b128 v[124:127], v248 offset:2944
    v_mfma_f32_16x16x32_bf16 v[24:27], a[4:7], a[132:135], v[24:27]
    ds_read_b128 v[108:111], v248 offset:2688
    v_mfma_f32_16x16x32_bf16 v[4:7], a[4:7], a[128:131], v[4:7]
    ds_read_b128 v[128:131], v248 offset:3008
    v_mfma_f32_16x16x32_bf16 v[8:11], a[8:11], a[128:131], v[8:11]
    buffer_load_dwordx4 v[220:223], v227, s[16:19], s82 offen sc1
    v_mfma_f32_16x16x32_bf16 v[28:31], a[8:11], a[132:135], v[28:31]
    ds_read_b128 v[112:115], v248 offset:2752
    v_mfma_f32_16x16x32_bf16 v[48:51], a[8:11], a[136:139], v[48:51]
    ds_read_b128 v[132:135], v248 offset:3072
    v_mfma_f32_16x16x32_bf16 v[68:71], a[8:11], a[140:143], v[68:71]
    ds_read_b128 v[116:119], v248 offset:2816
    v_mfma_f32_16x16x32_bf16 v[72:75], a[12:15], a[140:143], v[72:75]
    buffer_load_dwordx4 v[208:211], v224, s[16:19], s82 offen sc1
    v_mfma_f32_16x16x32_bf16 v[52:55], a[12:15], a[136:139], v[52:55]
    ds_read_b128 v[136:139], v248 offset:3136
    v_mfma_f32_16x16x32_bf16 v[32:35], a[12:15], a[132:135], v[32:35]
    v_mfma_f32_16x16x32_bf16 v[12:15], a[12:15], a[128:131], v[12:15]
    v_mfma_f32_16x16x32_bf16 v[16:19], a[16:19], a[128:131], v[16:19]
    buffer_store_dword v237, v236, s[16:19], s23 offen sc1
    v_mfma_f32_16x16x32_bf16 v[36:39], a[16:19], a[132:135], v[36:39]
    v_mfma_f32_16x16x32_bf16 v[56:59], a[16:19], a[136:139], v[56:59]
    v_mfma_f32_16x16x32_bf16 v[76:79], a[16:19], a[140:143], v[76:79]
    s_waitcnt vmcnt(13) lgkmcnt(0)
    v_mfma_f32_16x16x32_bf16 v[0:3], a[20:23], v[160:163], v[0:3]
    s_add_u32 s82, s80, 36864
    v_mfma_f32_16x16x32_bf16 v[20:23], a[20:23], v[164:167], v[20:23]
    buffer_load_dwordx4 a[132:135], v225, s[16:19], s82 offen sc1
    v_mfma_f32_16x16x32_bf16 v[40:43], a[20:23], v[168:171], v[40:43]
    v_mfma_f32_16x16x32_bf16 v[60:63], a[20:23], v[172:175], v[60:63]
    v_mfma_f32_16x16x32_bf16 v[64:67], a[24:27], v[172:175], v[64:67]
    v_mfma_f32_16x16x32_bf16 v[44:47], a[24:27], v[168:171], v[44:47]
    buffer_load_dwordx4 a[136:139], v226, s[16:19], s82 offen sc1
    v_mfma_f32_16x16x32_bf16 v[24:27], a[24:27], v[164:167], v[24:27]
    v_mfma_f32_16x16x32_bf16 v[4:7], a[24:27], v[160:163], v[4:7]
    v_mfma_f32_16x16x32_bf16 v[8:11], a[28:31], v[160:163], v[8:11]
    v_mfma_f32_16x16x32_bf16 v[28:31], a[28:31], v[164:167], v[28:31]
    v_mfma_f32_16x16x32_bf16 v[48:51], a[28:31], v[168:171], v[48:51]
    buffer_load_dwordx4 a[140:143], v227, s[16:19], s82 offen sc1
    v_mfma_f32_16x16x32_bf16 v[68:71], a[28:31], v[172:175], v[68:71]
    v_mfma_f32_16x16x32_bf16 v[72:75], a[32:35], v[172:175], v[72:75]
    v_mfma_f32_16x16x32_bf16 v[52:55], a[32:35], v[168:171], v[52:55]
    v_mfma_f32_16x16x32_bf16 v[32:35], a[32:35], v[164:167], v[32:35]
    v_mfma_f32_16x16x32_bf16 v[12:15], a[32:35], v[160:163], v[12:15]
    buffer_load_dwordx4 a[128:131], v224, s[16:19], s82 offen sc1
    v_mfma_f32_16x16x32_bf16 v[16:19], a[36:39], v[160:163], v[16:19]
    v_mfma_f32_16x16x32_bf16 v[36:39], a[36:39], v[164:167], v[36:39]
    v_mfma_f32_16x16x32_bf16 v[56:59], a[36:39], v[168:171], v[56:59]
    v_mfma_f32_16x16x32_bf16 v[76:79], a[36:39], v[172:175], v[76:79]
    s_waitcnt vmcnt(13)
    v_mfma_f32_16x16x32_bf16 v[0:3], a[40:43], v[176:179], v[0:3]
    s_add_u32 s82, s80, 40960
    v_mfma_f32_16x16x32_bf16 v[20:23], a[40:43], v[180:183], v[20:23]
    buffer_load_dwordx4 v[164:167], v225, s[16:19], s82 offen sc1
    v_mfma_f32_16x16x32_bf16 v[40:43], a[40:43], v[184:187], v[40:43]
    v_mfma_f32_16x16x32_bf16 v[60:63], a[40:43], v[188:191], v[60:63]
    v_mfma_f32_16x16x32_bf16 v[64:67], a[44:47], v[188:191], v[64:67]
    buffer_load_dwordx4 v[168:171], v226, s[16:19], s82 offen sc1
    v_mfma_f32_16x16x32_bf16 v[44:47], a[44:47], v[184:187], v[44:47]
    v_mfma_f32_16x16x32_bf16 v[24:27], a[44:47], v[180:183], v[24:27]
    v_mfma_f32_16x16x32_bf16 v[4:7], a[44:47], v[176:179], v[4:7]
    v_mfma_f32_16x16x32_bf16 v[8:11], a[48:51], v[176:179], v[8:11]
    buffer_load_dwordx4 v[172:175], v227, s[16:19], s82 offen sc1
    v_mfma_f32_16x16x32_bf16 v[28:31], a[48:51], v[180:183], v[28:31]
    v_mfma_f32_16x16x32_bf16 v[48:51], a[48:51], v[184:187], v[48:51]
    v_mfma_f32_16x16x32_bf16 v[68:71], a[48:51], v[188:191], v[68:71]
    v_mfma_f32_16x16x32_bf16 v[72:75], a[52:55], v[188:191], v[72:75]
    buffer_load_dwordx4 v[160:163], v224, s[16:19], s82 offen sc1
    v_mfma_f32_16x16x32_bf16 v[52:55], a[52:55], v[184:187], v[52:55]
    v_mfma_f32_16x16x32_bf16 v[32:35], a[52:55], v[180:183], v[32:35]
    v_mfma_f32_16x16x32_bf16 v[12:15], a[52:55], v[176:179], v[12:15]
    s_add_u32 s82, s80, 57344
    v_mfma_f32_16x16x32_bf16 v[16:19], a[56:59], v[176:179], v[16:19]
    buffer_load_dwordx4 a[4:7], v225, s[16:19], s82 offen sc1
    v_mfma_f32_16x16x32_bf16 v[36:39], a[56:59], v[180:183], v[36:39]
    v_mfma_f32_16x16x32_bf16 v[56:59], a[56:59], v[184:187], v[56:59]
    v_mfma_f32_16x16x32_bf16 v[76:79], a[56:59], v[188:191], v[76:79]
    s_waitcnt vmcnt(14)
    v_mfma_f32_16x16x32_bf16 v[0:3], a[60:63], a[144:147], v[0:3]
    s_add_u32 s82, s80, 61440
    v_mfma_f32_16x16x32_bf16 v[20:23], a[60:63], a[148:151], v[20:23]
    buffer_load_dwordx4 a[20:23], v225, s[16:19], s82 offen sc1
    v_mfma_f32_16x16x32_bf16 v[40:43], a[60:63], a[152:155], v[40:43]
    v_mfma_f32_16x16x32_bf16 v[60:63], a[60:63], a[156:159], v[60:63]
    s_add_u32 s82, s80, 45056
    v_mfma_f32_16x16x32_bf16 v[64:67], a[64:67], a[156:159], v[64:67]
    buffer_load_dwordx4 v[180:183], v225, s[16:19], s82 offen sc1
    v_mfma_f32_16x16x32_bf16 v[44:47], a[64:67], a[152:155], v[44:47]
    v_mfma_f32_16x16x32_bf16 v[24:27], a[64:67], a[148:151], v[24:27]
    v_mfma_f32_16x16x32_bf16 v[4:7], a[64:67], a[144:147], v[4:7]
    s_add_u32 s82, s80, 57344
    v_mfma_f32_16x16x32_bf16 v[8:11], a[68:71], a[144:147], v[8:11]
    buffer_load_dwordx4 a[8:11], v226, s[16:19], s82 offen sc1
    v_mfma_f32_16x16x32_bf16 v[28:31], a[68:71], a[148:151], v[28:31]
    v_mfma_f32_16x16x32_bf16 v[48:51], a[68:71], a[152:155], v[48:51]
    v_mfma_f32_16x16x32_bf16 v[68:71], a[68:71], a[156:159], v[68:71]
    s_add_u32 s82, s80, 61440
    v_mfma_f32_16x16x32_bf16 v[72:75], a[72:75], a[156:159], v[72:75]
    buffer_load_dwordx4 a[24:27], v226, s[16:19], s82 offen sc1
    v_mfma_f32_16x16x32_bf16 v[52:55], a[72:75], a[152:155], v[52:55]
    v_mfma_f32_16x16x32_bf16 v[32:35], a[72:75], a[148:151], v[32:35]
    v_mfma_f32_16x16x32_bf16 v[12:15], a[72:75], a[144:147], v[12:15]
    s_add_u32 s82, s80, 45056
    v_mfma_f32_16x16x32_bf16 v[16:19], a[76:79], a[144:147], v[16:19]
    buffer_load_dwordx4 v[184:187], v226, s[16:19], s82 offen sc1
    v_mfma_f32_16x16x32_bf16 v[36:39], a[76:79], a[148:151], v[36:39]
    v_mfma_f32_16x16x32_bf16 v[56:59], a[76:79], a[152:155], v[56:59]
    v_mfma_f32_16x16x32_bf16 v[76:79], a[76:79], a[156:159], v[76:79]
    s_waitcnt vmcnt(15)
    v_mfma_f32_16x16x32_bf16 v[0:3], a[80:83], v[208:211], v[0:3]
    s_add_u32 s82, s80, 49152
    ds_read_b128 a[48:51], v251 offset:704
    v_mfma_f32_16x16x32_bf16 v[20:23], a[80:83], v[212:215], v[20:23]
    buffer_load_dwordx4 a[148:151], v225, s[16:19], s82 offen sc1
    v_mfma_f32_16x16x32_bf16 v[40:43], a[80:83], v[216:219], v[40:43]
    ds_read_b128 a[52:55], v251 offset:896
    v_mfma_f32_16x16x32_bf16 v[60:63], a[80:83], v[220:223], v[60:63]
    s_add_u32 s82, s80, 49152
    ds_read_b128 a[56:59], v251 offset:1024
    v_mfma_f32_16x16x32_bf16 v[64:67], a[84:87], v[220:223], v[64:67]
    buffer_load_dwordx4 a[152:155], v226, s[16:19], s82 offen sc1
    v_mfma_f32_16x16x32_bf16 v[44:47], a[84:87], v[216:219], v[44:47]
    ds_read_b128 a[60:63], v251 offset:1216
    v_mfma_f32_16x16x32_bf16 v[24:27], a[84:87], v[212:215], v[24:27]
    ds_read_b128 a[64:67], v251 offset:128
    v_mfma_f32_16x16x32_bf16 v[4:7], a[84:87], v[208:211], v[4:7]
    s_add_u32 s82, s80, 57344
    ds_read_b128 a[68:71], v251 offset:448
    v_mfma_f32_16x16x32_bf16 v[8:11], a[88:91], v[208:211], v[8:11]
    buffer_load_dwordx4 a[12:15], v227, s[16:19], s82 offen sc1
    v_mfma_f32_16x16x32_bf16 v[28:31], a[88:91], v[212:215], v[28:31]
    ds_read_b128 a[72:75], v251 offset:768
    v_mfma_f32_16x16x32_bf16 v[48:51], a[88:91], v[216:219], v[48:51]
    ds_read_b128 a[76:79], v251 offset:1088
    v_mfma_f32_16x16x32_bf16 v[68:71], a[88:91], v[220:223], v[68:71]
    s_add_u32 s82, s80, 61440
    v_mfma_f32_16x16x32_bf16 v[72:75], a[92:95], v[220:223], v[72:75]
    buffer_load_dwordx4 a[28:31], v227, s[16:19], s82 offen sc1
    v_mfma_f32_16x16x32_bf16 v[52:55], a[92:95], v[216:219], v[52:55]
    v_mfma_f32_16x16x32_bf16 v[32:35], a[92:95], v[212:215], v[32:35]
    v_mfma_f32_16x16x32_bf16 v[12:15], a[92:95], v[208:211], v[12:15]
    s_add_u32 s82, s80, 45056
    v_mfma_f32_16x16x32_bf16 v[16:19], a[96:99], v[208:211], v[16:19]
    buffer_load_dwordx4 v[188:191], v227, s[16:19], s82 offen sc1
    v_mfma_f32_16x16x32_bf16 v[36:39], a[96:99], v[212:215], v[36:39]
    v_mfma_f32_16x16x32_bf16 v[56:59], a[96:99], v[216:219], v[56:59]
    v_mfma_f32_16x16x32_bf16 v[76:79], a[96:99], v[220:223], v[76:79]
    s_waitcnt vmcnt(15) lgkmcnt(0)
    v_mfma_f32_16x16x32_bf16 v[0:3], a[100:103], a[128:131], v[0:3]
    v_mfma_f32_16x16x32_bf16 v[20:23], a[100:103], a[132:135], v[20:23]
    buffer_load_dword v238, v236, s[16:19], s24 offen sc1
    v_mfma_f32_16x16x32_bf16 v[40:43], a[100:103], a[136:139], v[40:43]
    v_mfma_f32_16x16x32_bf16 v[60:63], a[100:103], a[140:143], v[60:63]
    s_add_u32 s82, s80, 53248
    v_mfma_f32_16x16x32_bf16 v[64:67], a[104:107], a[140:143], v[64:67]
    buffer_load_dwordx4 v[212:215], v225, s[16:19], s82 offen sc1
    v_mfma_f32_16x16x32_bf16 v[44:47], a[104:107], a[136:139], v[44:47]
    v_mfma_f32_16x16x32_bf16 v[24:27], a[104:107], a[132:135], v[24:27]
    s_add_u32 s82, s80, 53248
    v_mfma_f32_16x16x32_bf16 v[4:7], a[104:107], a[128:131], v[4:7]
    buffer_load_dwordx4 v[216:219], v226, s[16:19], s82 offen sc1
    v_mfma_f32_16x16x32_bf16 v[8:11], a[108:111], a[128:131], v[8:11]
    v_mfma_f32_16x16x32_bf16 v[28:31], a[108:111], a[132:135], v[28:31]
    s_add_u32 s82, s80, 49152
    v_mfma_f32_16x16x32_bf16 v[48:51], a[108:111], a[136:139], v[48:51]
    buffer_load_dwordx4 a[156:159], v227, s[16:19], s82 offen sc1
    v_mfma_f32_16x16x32_bf16 v[68:71], a[108:111], a[140:143], v[68:71]
    v_mfma_f32_16x16x32_bf16 v[72:75], a[112:115], a[140:143], v[72:75]
    s_add_u32 s82, s80, 53248
    v_mfma_f32_16x16x32_bf16 v[52:55], a[112:115], a[136:139], v[52:55]
    buffer_load_dwordx4 v[220:223], v227, s[16:19], s82 offen sc1
    v_mfma_f32_16x16x32_bf16 v[32:35], a[112:115], a[132:135], v[32:35]
    v_mfma_f32_16x16x32_bf16 v[12:15], a[112:115], a[128:131], v[12:15]
    s_add_u32 s82, s80, 57344
    v_mfma_f32_16x16x32_bf16 v[16:19], a[116:119], a[128:131], v[16:19]
    buffer_load_dwordx4 a[0:3], v224, s[16:19], s82 offen sc1
    v_mfma_f32_16x16x32_bf16 v[36:39], a[116:119], a[132:135], v[36:39]
    v_mfma_f32_16x16x32_bf16 v[56:59], a[116:119], a[136:139], v[56:59]
    v_mfma_f32_16x16x32_bf16 v[76:79], a[116:119], a[140:143], v[76:79]
    s_waitcnt vmcnt(17)
    v_mfma_f32_16x16x32_bf16 v[0:3], a[120:123], v[160:163], v[0:3]
    s_add_u32 s82, s80, 61440
    v_mfma_f32_16x16x32_bf16 v[20:23], a[120:123], v[164:167], v[20:23]
    buffer_load_dwordx4 a[16:19], v224, s[16:19], s82 offen sc1
    v_mfma_f32_16x16x32_bf16 v[40:43], a[120:123], v[168:171], v[40:43]
    v_mfma_f32_16x16x32_bf16 v[60:63], a[120:123], v[172:175], v[60:63]
    v_mfma_f32_16x16x32_bf16 v[64:67], a[124:127], v[172:175], v[64:67]
    s_add_u32 s82, s80, 45056
    v_mfma_f32_16x16x32_bf16 v[44:47], a[124:127], v[168:171], v[44:47]
    buffer_load_dwordx4 v[176:179], v224, s[16:19], s82 offen sc1
    v_mfma_f32_16x16x32_bf16 v[24:27], a[124:127], v[164:167], v[24:27]
    v_mfma_f32_16x16x32_bf16 v[4:7], a[124:127], v[160:163], v[4:7]
    v_mfma_f32_16x16x32_bf16 v[8:11], a[240:243], v[160:163], v[8:11]
    v_mfma_f32_16x16x32_bf16 v[28:31], a[240:243], v[164:167], v[28:31]
    s_add_u32 s82, s80, 49152
    v_mfma_f32_16x16x32_bf16 v[48:51], a[240:243], v[168:171], v[48:51]
    buffer_load_dwordx4 a[144:147], v224, s[16:19], s82 offen sc1
    v_mfma_f32_16x16x32_bf16 v[68:71], a[240:243], v[172:175], v[68:71]
    v_mfma_f32_16x16x32_bf16 v[72:75], a[244:247], v[172:175], v[72:75]
    v_mfma_f32_16x16x32_bf16 v[52:55], a[244:247], v[168:171], v[52:55]
    v_mfma_f32_16x16x32_bf16 v[32:35], a[244:247], v[164:167], v[32:35]
    s_add_u32 s82, s80, 53248
    v_mfma_f32_16x16x32_bf16 v[12:15], a[244:247], v[160:163], v[12:15]
    buffer_load_dwordx4 v[208:211], v224, s[16:19], s82 offen sc1
    v_mfma_f32_16x16x32_bf16 v[16:19], a[248:251], v[160:163], v[16:19]
    v_mfma_f32_16x16x32_bf16 v[36:39], a[248:251], v[164:167], v[36:39]
    v_mfma_f32_16x16x32_bf16 v[56:59], a[248:251], v[168:171], v[56:59]
    v_mfma_f32_16x16x32_bf16 v[76:79], a[248:251], v[172:175], v[76:79]
    s_waitcnt vmcnt(8)
    v_cmp_ne_u32 vcc, s55, v238
    s_cbranch_vccnz SP_spin
SP_ok:
    v_mfma_f32_16x16x32_bf16 v[20:23], a[200:203], a[4:7], v[20:23]
    buffer_load_dwordx4 v[140:143], v249, s[16:19], s21 offen offset:0 sc1
    v_mfma_f32_16x16x32_bf16 v[20:23], a[220:223], a[20:23], v[20:23]
    v_mfma_f32_16x16x32_bf16 v[20:23], a[252:255], v[180:183], v[20:23]
    v_mfma_f32_16x16x32_bf16 v[20:23], a[160:163], a[148:151], v[20:23]
    buffer_load_dwordx4 v[144:147], v249, s[16:19], s21 offen offset:1024 sc1
    v_mfma_f32_16x16x32_bf16 v[20:23], a[180:183], v[212:215], v[20:23]
    v_mfma_f32_16x16x32_bf16 v[24:27], a[184:187], v[212:215], v[24:27]
    v_mfma_f32_16x16x32_bf16 v[24:27], a[164:167], a[148:151], v[24:27]
    v_mfma_f32_16x16x32_bf16 v[24:27], v[192:195], v[180:183], v[24:27]
    v_mfma_f32_16x16x32_bf16 v[24:27], a[224:227], a[20:23], v[24:27]
    v_mfma_f32_16x16x32_bf16 v[24:27], a[204:207], a[4:7], v[24:27]
    s_waitcnt vmcnt(9)
    v_mfma_f32_16x16x32_bf16 v[40:43], a[200:203], a[8:11], v[40:43]
    buffer_load_dwordx4 v[148:151], v249, s[16:19], s21 offen offset:2048 sc1
    v_mfma_f32_16x16x32_bf16 v[40:43], a[220:223], a[24:27], v[40:43]
    v_mfma_f32_16x16x32_bf16 v[40:43], a[252:255], v[184:187], v[40:43]
    ds_write_b128 v231, v[20:23] offset:0
    v_mfma_f32_16x16x32_bf16 v[40:43], a[160:163], a[152:155], v[40:43]
    v_mfma_f32_16x16x32_bf16 v[40:43], a[180:183], v[216:219], v[40:43]
    buffer_load_dwordx4 v[152:155], v249, s[16:19], s21 offen offset:3072 sc1
    v_mfma_f32_16x16x32_bf16 v[44:47], a[184:187], v[216:219], v[44:47]
    v_mfma_f32_16x16x32_bf16 v[44:47], a[164:167], a[152:155], v[44:47]
    v_mfma_f32_16x16x32_bf16 v[44:47], v[192:195], v[184:187], v[44:47]
    ds_write_b128 v231, v[24:27] offset:1024
    v_mfma_f32_16x16x32_bf16 v[44:47], a[224:227], a[24:27], v[44:47]
    v_mfma_f32_16x16x32_bf16 v[44:47], a[204:207], a[8:11], v[44:47]
    s_waitcnt vmcnt(9)
    v_mfma_f32_16x16x32_bf16 v[60:63], a[200:203], a[12:15], v[60:63]
    s_add_u32 s21, s21, 4096
    buffer_load_dwordx4 v[156:159], v249, s[16:19], s21 offen offset:0 sc1
    v_mfma_f32_16x16x32_bf16 v[60:63], a[220:223], a[28:31], v[60:63]
    v_mfma_f32_16x16x32_bf16 v[60:63], a[252:255], v[188:191], v[60:63]
    ds_write_b128 v253, v[40:43] offset:0
    v_mfma_f32_16x16x32_bf16 v[60:63], a[160:163], a[156:159], v[60:63]
    v_mfma_f32_16x16x32_bf16 v[60:63], a[180:183], v[220:223], v[60:63]
    v_mfma_f32_16x16x32_bf16 v[64:67], a[184:187], v[220:223], v[64:67]
    v_mfma_f32_16x16x32_bf16 v[64:67], a[164:167], a[156:159], v[64:67]
    v_mfma_f32_16x16x32_bf16 v[64:67], v[192:195], v[188:191], v[64:67]
    ds_write_b128 v253, v[44:47] offset:1024
    v_mfma_f32_16x16x32_bf16 v[64:67], a[224:227], a[28:31], v[64:67]
    v_mfma_f32_16x16x32_bf16 v[64:67], a[204:207], a[12:15], v[64:67]
    s_waitcnt vmcnt(5)
    v_mfma_f32_16x16x32_bf16 v[0:3], a[200:203], a[0:3], v[0:3]
    v_mfma_f32_16x16x32_bf16 v[0:3], a[220:223], a[16:19], v[0:3]
    v_mfma_f32_16x16x32_bf16 v[0:3], a[252:255], v[176:179], v[0:3]
    ds_write_b128 v254, v[60:63] offset:0
    v_mfma_f32_16x16x32_bf16 v[0:3], a[160:163], a[144:147], v[0:3]
    v_mfma_f32_16x16x32_bf16 v[0:3], a[180:183], v[208:211], v[0:3]
    v_mfma_f32_16x16x32_bf16 v[4:7], a[184:187], v[208:211], v[4:7]
    v_mfma_f32_16x16x32_bf16 v[4:7], a[164:167], a[144:147], v[4:7]
    v_mfma_f32_16x16x32_bf16 v[4:7], v[192:195], v[176:179], v[4:7]
    ds_write_b128 v254, v[64:67] offset:1024
    v_mfma_f32_16x16x32_bf16 v[4:7], a[224:227], a[16:19], v[4:7]
    s_waitcnt vmcnt(3)
    v_lshlrev_b32 v92, 16, v80
    v_and_b32 v93, 0xffff0000, v80
    v_mfma_f32_16x16x32_bf16 v[4:7], a[204:207], a[0:3], v[4:7]
    v_lshlrev_b32 v94, 16, v81
    v_and_b32 v95, 0xffff0000, v81
    v_mfma_f32_16x16x32_bf16 v[28:31], a[208:211], a[4:7], v[28:31]
    v_fma_f32 v140, v100, v140, v92
    v_fma_f32 v141, v101, v141, v93
    v_mfma_f32_16x16x32_bf16 v[28:31], a[228:231], a[20:23], v[28:31]
    s_waitcnt lgkmcnt(0)
    v_fma_f32 v142, v102, v142, v94
    v_fma_f32 v143, v103, v143, v95
    v_mfma_f32_16x16x32_bf16 v[28:31], v[196:199], v[180:183], v[28:31]
    s_barrier
    ds_read_b128 v[20:23], v230 offset:0
    ds_read_b128 v[40:43], v230 offset:5120
    v_mfma_f32_16x16x32_bf16 v[28:31], a[168:171], a[148:151], v[28:31]
    ds_read_b128 v[60:63], v230 offset:10240
    ds_read_b128 v[24:27], v230 offset:1024
    v_mfma_f32_16x16x32_bf16 v[28:31], a[188:191], v[212:215], v[28:31]
    ds_read_b128 v[44:47], v230 offset:6144
    ds_read_b128 v[64:67], v230 offset:11264
    v_mfma_f32_16x16x32_bf16 v[32:35], a[192:195], v[212:215], v[32:35]
HOP1_2:
    s_cbranch_execz HOP1_6
    v_lshlrev_b32 v92, 16, v82
    v_and_b32 v93, 0xffff0000, v82
    v_mfma_f32_16x16x32_bf16 v[32:35], a[172:175], a[148:151], v[32:35]
    v_lshlrev_b32 v94, 16, v83
    v_and_b32 v95, 0xffff0000, v83
    v_mfma_f32_16x16x32_bf16 v[32:35], v[200:203], v[180:183], v[32:35]
    v_fma_f32 v144, v104, v144, v92
    v_fma_f32 v145, v105, v145, v93
    v_mfma_f32_16x16x32_bf16 v[32:35], a[232:235], a[20:23], v[32:35]
    v_fma_f32 v146, v106, v146, v94
    v_fma_f32 v147, v107, v147, v95
    v_mfma_f32_16x16x32_bf16 v[32:35], a[212:215], a[4:7], v[32:35]
    v_mfma_f32_16x16x32_bf16 v[36:39], a[216:219], a[4:7], v[36:39]
    s_waitcnt lgkmcnt(0)
    v_add_f32 v20, v20, v40
    v_add_f32 v21, v21, v41
    v_mfma_f32_16x16x32_bf16 v[36:39], a[236:239], a[20:23], v[36:39]
    v_add_f32 v22, v22, v42
    v_add_f32 v23, v23, v43
    v_mfma_f32_16x16x32_bf16 v[36:39], v[204:207], v[180:183], v[36:39]
    ds_write_b128 v231, v[28:31] offset:2048
    v_mfma_f32_16x16x32_bf16 v[36:39], a[176:179], a[148:151], v[36:39]
    v_add_f32 v0, v0, v60
    v_add_f32 v1, v1, v61
    v_mfma_f32_16x16x32_bf16 v[36:39], a[196:199], v[212:215], v[36:39]
    v_add_f32 v2, v2, v62
    v_add_f32 v3, v3, v63
    v_mfma_f32_16x16x32_bf16 v[48:51], a[208:211], a[8:11], v[48:51]
    v_add_f32 v0, v0, v20
    v_add_f32 v1, v1, v21
    v_mfma_f32_16x16x32_bf16 v[48:51], a[228:231], a[24:27], v[48:51]
    v_add_f32 v2, v2, v22
    v_add_f32 v3, v3, v23
    v_mfma_f32_16x16x32_bf16 v[48:51], v[196:199], v[184:187], v[48:51]
    ds_write_b128 v231, v[32:35] offset:3072
    v_mfma_f32_16x16x32_bf16 v[48:51], a[168:171], a[152:155], v[48:51]
    v_fmac_f32 v140, v100, v0
    v_fmac_f32 v141, v101, v1
    v_mfma_f32_16x16x32_bf16 v[48:51], a[188:191], v[216:219], v[48:51]
    v_fmac_f32 v142, v102, v2
    v_fmac_f32 v143, v103, v3
    v_mfma_f32_16x16x32_bf16 v[52:55], a[192:195], v[216:219], v[52:55]
    s_lshr_b32 s3, s77, 1
    v_mul_f32 v20, v140, v120
    v_mul_f32 v21, v141, v121
    v_mfma_f32_16x16x32_bf16 v[52:55], a[172:175], a[152:155], v[52:55]
    s_lshl_b32 s3, s3, 8
    v_mul_f32 v22, v142, v122
    v_mul_f32 v23, v143, v123
    v_mfma_f32_16x16x32_bf16 v[52:55], v[200:203], v[184:187], v[52:55]
    s_and_b32 s98, s77, 1
    ds_write_b128 v231, v[36:39] offset:4096
    v_mfma_f32_16x16x32_bf16 v[52:55], a[232:235], a[24:27], v[52:55]
    s_lshl_b32 s98, s98, 3
    v_cvt_pk_bf16_f32 v160, v20, v21
    v_cvt_pk_bf16_f32 v161, v22, v23
    v_mfma_f32_16x16x32_bf16 v[52:55], a[212:215], a[8:11], v[52:55]
    s_add_u32 s3, s3, s98
    v_add_f32 v24, v24, v44
    v_add_f32 v25, v25, v45
    v_mfma_f32_16x16x32_bf16 v[56:59], a[216:219], a[8:11], v[56:59]
    s_lshl_b32 s98, s83, 10
    v_add_f32 v26, v26, v46
    v_add_f32 v27, v27, v47
    v_mfma_f32_16x16x32_bf16 v[56:59], a[236:239], a[24:27], v[56:59]
    s_add_u32 s3, s3, s98
    v_add_f32 v4, v4, v64
    v_add_f32 v5, v5, v65
    v_mfma_f32_16x16x32_bf16 v[56:59], v[204:207], v[184:187], v[56:59]
    s_add_u32 s99, s3, 2686976
    ds_write_b128 v253, v[48:51] offset:2048
    v_mfma_f32_16x16x32_bf16 v[56:59], a[176:179], a[152:155], v[56:59]
    s_lshl_b32 s3, s76, 1
    v_add_f32 v6, v6, v66
    v_add_f32 v7, v7, v67
    v_mfma_f32_16x16x32_bf16 v[56:59], a[196:199], v[216:219], v[56:59]
    s_add_u32 s3, s3, s77
    v_add_f32 v4, v4, v24
    v_add_f32 v5, v5, v25
    v_mfma_f32_16x16x32_bf16 v[68:71], a[208:211], a[12:15], v[68:71]
    s_lshl_b32 s3, s3, 2
    v_add_f32 v6, v6, v26
    v_add_f32 v7, v7, v27
    v_mfma_f32_16x16x32_bf16 v[68:71], a[228:231], a[28:31], v[68:71]
    s_add_u32 s3, s3, s22
    v_fmac_f32 v144, v104, v4
    v_fmac_f32 v145, v105, v5
    v_mfma_f32_16x16x32_bf16 v[68:71], v[196:199], v[188:191], v[68:71]
    s_lshl_b32 s3, s3, 4
    ds_write_b128 v253, v[52:55] offset:3072
    v_mfma_f32_16x16x32_bf16 v[68:71], a[168:171], a[156:159], v[68:71]
    s_add_u32 s26, s3, 3018752
    v_fmac_f32 v146, v106, v6
    v_fmac_f32 v147, v107, v7
    v_mfma_f32_16x16x32_bf16 v[68:71], a[188:191], v[220:223], v[68:71]
    s_add_u32 s98, s88, 8192
    v_mul_f32 v24, v144, v124
    v_mul_f32 v25, v145, v125
    v_mfma_f32_16x16x32_bf16 v[72:75], a[192:195], v[220:223], v[72:75]
    v_mul_f32 v26, v146, v126
    v_mul_f32 v27, v147, v127
    v_mfma_f32_16x16x32_bf16 v[72:75], a[172:175], a[156:159], v[72:75]
    s_waitcnt vmcnt(0)
    v_cvt_pk_bf16_f32 v162, v24, v25
    v_cvt_pk_bf16_f32 v163, v26, v27
    v_mfma_f32_16x16x32_bf16 v[72:75], v[200:203], v[188:191], v[72:75]
    ds_write_b128 v253, v[56:59] offset:4096
    v_mfma_f32_16x16x32_bf16 v[72:75], a[232:235], a[28:31], v[72:75]
    buffer_store_dwordx4 v[160:163], v249, s[16:19], s88 offen sc1
    v_mfma_f32_16x16x32_bf16 v[72:75], a[212:215], a[12:15], v[72:75]
    v_lshlrev_b32 v92, 16, v84
    v_and_b32 v93, 0xffff0000, v84
    v_mfma_f32_16x16x32_bf16 v[76:79], a[216:219], a[12:15], v[76:79]
    v_lshlrev_b32 v94, 16, v85
    v_and_b32 v95, 0xffff0000, v85
    v_mfma_f32_16x16x32_bf16 v[76:79], a[236:239], a[28:31], v[76:79]
    v_fma_f32 v148, v108, v148, v92
    v_fma_f32 v149, v109, v149, v93
    v_mfma_f32_16x16x32_bf16 v[76:79], v[204:207], v[188:191], v[76:79]
    ds_write_b128 v254, v[68:71] offset:2048
    v_mfma_f32_16x16x32_bf16 v[76:79], a[176:179], a[156:159], v[76:79]
    v_fma_f32 v150, v110, v150, v94
    v_fma_f32 v151, v111, v151, v95
    v_mfma_f32_16x16x32_bf16 v[76:79], a[196:199], v[220:223], v[76:79]
    v_lshlrev_b32 v92, 16, v86
    v_and_b32 v93, 0xffff0000, v86
    v_mfma_f32_16x16x32_bf16 v[8:11], a[208:211], a[0:3], v[8:11]
    v_lshlrev_b32 v94, 16, v87
    v_and_b32 v95, 0xffff0000, v87
    v_mfma_f32_16x16x32_bf16 v[8:11], a[228:231], a[16:19], v[8:11]
    v_fma_f32 v152, v112, v152, v92
    v_fma_f32 v153, v113, v153, v93
    v_mfma_f32_16x16x32_bf16 v[8:11], v[196:199], v[176:179], v[8:11]
    ds_write_b128 v254, v[72:75] offset:3072
    v_mfma_f32_16x16x32_bf16 v[8:11], a[168:171], a[144:147], v[8:11]
    v_fma_f32 v154, v114, v154, v94
    v_fma_f32 v155, v115, v155, v95
    v_mfma_f32_16x16x32_bf16 v[8:11], a[188:191], v[208:211], v[8:11]
    v_lshlrev_b32 v92, 16, v88
    v_and_b32 v93, 0xffff0000, v88
    v_mfma_f32_16x16x32_bf16 v[12:15], a[192:195], v[208:211], v[12:15]
    v_lshlrev_b32 v94, 16, v89
    v_and_b32 v95, 0xffff0000, v89
    v_mfma_f32_16x16x32_bf16 v[12:15], a[172:175], a[144:147], v[12:15]
    v_fma_f32 v156, v116, v156, v92
    v_fma_f32 v157, v117, v157, v93
    v_mfma_f32_16x16x32_bf16 v[12:15], v[200:203], v[176:179], v[12:15]
    ds_write_b128 v254, v[76:79] offset:4096
    v_mfma_f32_16x16x32_bf16 v[12:15], a[232:235], a[16:19], v[12:15]
    v_fma_f32 v158, v118, v158, v94
    v_fma_f32 v159, v119, v159, v95
    v_mfma_f32_16x16x32_bf16 v[12:15], a[212:215], a[0:3], v[12:15]
    v_mfma_f32_16x16x32_bf16 v[16:19], a[216:219], a[0:3], v[16:19]
    s_waitcnt lgkmcnt(0)
    v_mfma_f32_16x16x32_bf16 v[16:19], a[236:239], a[16:19], v[16:19]
    s_barrier
    ds_read_b128 v[28:31], v230 offset:2048
    ds_read_b128 v[48:51], v230 offset:7168
    v_mfma_f32_16x16x32_bf16 v[16:19], v[204:207], v[176:179], v[16:19]
    ds_read_b128 v[68:71], v230 offset:12288
    ds_read_b128 v[32:35], v230 offset:3072
    v_mfma_f32_16x16x32_bf16 v[16:19], a[176:179], a[144:147], v[16:19]
    ds_read_b128 v[52:55], v230 offset:8192
    ds_read_b128 v[72:75], v230 offset:13312
    v_mfma_f32_16x16x32_bf16 v[16:19], a[196:199], v[208:211], v[16:19]
    ds_read_b128 v[36:39], v230 offset:4096
    ds_read_b128 v[56:59], v230 offset:9216
    ds_read_b128 v[76:79], v230 offset:14336
    v_pk_add_f32 v[236:237], v[140:141], v[142:143]
    v_pk_mul_f32 v[238:239], v[140:141], v[140:141]
    v_pk_fma_f32 v[238:239], v[142:143], v[142:143], v[238:239]
    v_pk_add_f32 v[236:237], v[236:237], v[144:145]
    v_pk_fma_f32 v[238:239], v[144:145], v[144:145], v[238:239]
    v_pk_add_f32 v[236:237], v[236:237], v[146:147]
    v_pk_fma_f32 v[238:239], v[146:147], v[146:147], v[238:239]
    v_lshlrev_b32 v96, 10, v249
    v_mov_b32 v97, s55
    s_waitcnt lgkmcnt(6)
    v_pk_add_f32 v[8:9], v[8:9], v[28:29]
    v_pk_add_f32 v[48:49], v[48:49], v[68:69]
    v_pk_add_f32 v[10:11], v[10:11], v[30:31]
    v_pk_add_f32 v[50:51], v[50:51], v[70:71]
    v_pk_add_f32 v[8:9], v[8:9], v[48:49]
    v_pk_add_f32 v[10:11], v[10:11], v[50:51]
    v_pk_fma_f32 v[148:149], v[108:109], v[8:9], v[148:149]
    v_pk_fma_f32 v[150:151], v[110:111], v[10:11], v[150:151]
    v_pk_mul_f32 v[28:29], v[148:149], v[128:129]
    v_pk_mul_f32 v[30:31], v[150:151], v[130:131]
    v_cvt_pk_bf16_f32 v164, v28, v29
    v_cvt_pk_bf16_f32 v165, v30, v31
    v_pk_add_f32 v[236:237], v[236:237], v[148:149]
    v_pk_fma_f32 v[238:239], v[148:149], v[148:149], v[238:239]
    v_pk_add_f32 v[236:237], v[236:237], v[150:151]
    v_pk_fma_f32 v[238:239], v[150:151], v[150:151], v[238:239]
    s_waitcnt lgkmcnt(3)
    v_pk_add_f32 v[12:13], v[12:13], v[32:33]
    v_pk_add_f32 v[52:53], v[52:53], v[72:73]
    v_pk_add_f32 v[14:15], v[14:15], v[34:35]
    v_pk_add_f32 v[54:55], v[54:55], v[74:75]
    v_pk_add_f32 v[12:13], v[12:13], v[52:53]
    v_pk_add_f32 v[14:15], v[14:15], v[54:55]
    v_pk_fma_f32 v[152:153], v[112:113], v[12:13], v[152:153]
    v_pk_fma_f32 v[154:155], v[114:115], v[14:15], v[154:155]
    v_pk_mul_f32 v[32:33], v[152:153], v[132:133]
    v_pk_mul_f32 v[34:35], v[154:155], v[134:135]
    v_cvt_pk_bf16_f32 v166, v32, v33
    v_cvt_pk_bf16_f32 v167, v34, v35
    buffer_store_dwordx4 v[164:167], v249, s[16:19], s98 offen sc1
    v_pk_add_f32 v[236:237], v[236:237], v[152:153]
    v_pk_fma_f32 v[238:239], v[152:153], v[152:153], v[238:239]
    v_pk_add_f32 v[236:237], v[236:237], v[154:155]
    v_pk_fma_f32 v[238:239], v[154:155], v[154:155], v[238:239]
    s_waitcnt lgkmcnt(0)
    s_barrier
    v_pk_add_f32 v[16:17], v[16:17], v[36:37]
    v_pk_add_f32 v[56:57], v[56:57], v[76:77]
    v_pk_add_f32 v[18:19], v[18:19], v[38:39]
    v_pk_add_f32 v[58:59], v[58:59], v[78:79]
    v_pk_add_f32 v[16:17], v[16:17], v[56:57]
    v_pk_add_f32 v[18:19], v[18:19], v[58:59]
    v_pk_fma_f32 v[156:157], v[116:117], v[16:17], v[156:157]
    v_pk_fma_f32 v[158:159], v[118:119], v[18:19], v[158:159]
    v_pk_mul_f32 v[36:37], v[156:157], v[136:137]
    v_pk_mul_f32 v[38:39], v[158:159], v[138:139]
    v_cvt_pk_bf16_f32 v168, v36, v37
    v_cvt_pk_bf16_f32 v169, v38, v39
    buffer_store_dwordx2 v[168:169], v249, s[16:19], s89 offen sc1
    v_pk_add_f32 v[236:237], v[236:237], v[156:157]
    v_pk_fma_f32 v[238:239], v[156:157], v[156:157], v[238:239]
    v_pk_add_f32 v[236:237], v[236:237], v[158:159]
    v_pk_fma_f32 v[238:239], v[158:159], v[158:159], v[238:239]
    v_add_f32 v236, v236, v237
    v_add_f32 v237, v238, v239
    v_mov_b32 v238, v236
    v_mov_b32 v239, v237
    s_nop 0
    v_permlane32_swap_b32 v238, v236
    v_permlane32_swap_b32 v239, v237
    v_add_f32 v236, v236, v238
    v_add_f32 v237, v237, v239
    v_mov_b32 v238, v236
    v_mov_b32 v239, v237
    s_nop 0
    v_permlane16_swap_b32 v238, v236
    v_permlane16_swap_b32 v239, v237
    v_add_f32 v236, v236, v238
    v_add_f32 v237, v237, v239
    s_mov_b64 exec, 0xffff
    buffer_store_dwordx2 v[236:237], v249, s[16:19], s99 offen sc1
    s_mov_b64 exec, 15
    s_waitcnt vmcnt(3)
    buffer_store_dword v97, v96, s[16:19], s26 offen sc1
    s_mov_b64 exec, -1
    v_accvgpr_write_b32 a0, v140
    v_accvgpr_write_b32 a1, v141
    v_accvgpr_write_b32 a2, v142
    v_accvgpr_write_b32 a3, v143
    v_accvgpr_write_b32 a4, v144
    v_accvgpr_write_b32 a5, v145
    v_accvgpr_write_b32 a6, v146
    v_accvgpr_write_b32 a7, v147
    v_accvgpr_write_b32 a8, v148
    v_accvgpr_write_b32 a9, v149
    v_accvgpr_write_b32 a10, v150
    v_accvgpr_write_b32 a11, v151
    v_accvgpr_write_b32 a12, v152
    v_accvgpr_write_b32 a13, v153
    v_accvgpr_write_b32 a14, v154
    v_accvgpr_write_b32 a15, v155
    v_accvgpr_write_b32 a16, v156
    v_accvgpr_write_b32 a17, v157
    v_accvgpr_write_b32 a18, v158
    v_accvgpr_write_b32 a19, v159
    s_add_u32 m0, s38, 32768
    s_add_u32 s34, s92, 1216512
    buffer_load_dwordx4 v250, s[64:67], s34 offen offset:0 lds
    s_add_u32 s34, s92, 1243136
    buffer_load_dwordx4 v250, s[64:67], s34 offen offset:1024 lds
    s_add_u32 s34, s92, 1269760
    buffer_load_dwordx4 v250, s[64:67], s34 offen offset:2048 lds
    s_add_u32 s34, s92, 1296384
    buffer_load_dwordx4 v250, s[64:67], s34 offen offset:3072 lds
    s_add_u32 m0, s38, 36864
    s_add_u32 s34, s92, 1216512
    buffer_load_dwordx4 v250, s[68:71], s34 offen offset:0 lds
    s_add_u32 s34, s92, 1243136
    buffer_load_dwordx4 v250, s[68:71], s34 offen offset:1024 lds
    s_add_u32 s34, s92, 1269760
    buffer_load_dwordx4 v250, s[68:71], s34 offen offset:2048 lds
    s_add_u32 s34, s92, 1296384
    buffer_load_dwordx4 v250, s[68:71], s34 offen offset:3072 lds
    s_mul_i32 s80, s76, 55296
    s_lshr_b32 s3, s37, 1
    s_add_u32 s80, s80, s3
    s_add_u32 s80, s80, 30408704
    s_add_u32 s3, s22, 0
    s_and_b32 s3, s3, 3
    s_mul_i32 s3, s3, 55296
    v_add_u32 v224, s3, v249
    s_add_u32 s3, s22, 1
    s_and_b32 s3, s3, 3
    s_mul_i32 s3, s3, 55296
    v_add_u32 v225, s3, v249
    s_add_u32 s3, s22, 2
    s_and_b32 s3, s3, 3
    s_mul_i32 s3, s3, 55296
    v_add_u32 v226, s3, v249
    s_add_u32 s3, s22, 3
    s_and_b32 s3, s3, 3
    s_mul_i32 s3, s3, 55296
    v_add_u32 v227, s3, v249
    s_mov_b32 s72, s42
    s_and_b32 s73, s43, 0xffff
    s_mov_b32 s74, 2621440
    s_mov_b32 s75, 0x20000
    s_add_u32 s28, s38, 0
    s_mul_i32 s29, s22, 14336
    s_add_u32 s29, s29, 0x1a000
    v_lshrrev_b32 v234, 6, v249
    v_lshlrev_b32 v234, 7, v234
    v_bfe_u32 v235, v249, 4, 2
    v_lshl_add_u32 v234, v235, 3, v234
    v_add_u32 v234, 0x18000, v234
    v_bfe_u32 v235, v249, 7, 2
    v_xor_b32 v235, 0, v235
    v_lshl_add_u32 v216, v235, 5, v234
    v_bfe_u32 v235, v249, 7, 2
    v_xor_b32 v235, 1, v235
    v_lshl_add_u32 v217, v235, 5, v234
    v_bfe_u32 v235, v249, 7, 2
    v_xor_b32 v235, 2, v235
    v_lshl_add_u32 v218, v235, 5, v234
    v_bfe_u32 v235, v249, 7, 2
    v_xor_b32 v235, 3, v235
    v_lshl_add_u32 v219, v235, 5, v234
    s_lshl_b32 s3, s91, 2
    s_add_u32 s3, s3, s22
    s_lshl_b32 s24, s3, 5
    s_add_u32 s24, s24, s90
    s_lshl_b32 s24, s24, 4
    s_add_u32 s24, s24, 2936832
    s_lshl_b32 s3, s3, 2
    s_mul_i32 s20, s3, 20480
    s_add_u32 s20, s20, 20971520
    v_add_u32 v220, 0, v249
    v_add_u32 v221, 20480, v249
    v_add_u32 v222, 40960, v249
    v_add_u32 v223, 61440, v249
    s_lshl_b32 s21, s3, 10
    s_add_u32 s21, s21, 2686976
    s_mul_i32 s3, s3, 55296
    s_lshl_b32 s98, s90, 11
    s_add_u32 s3, s3, s98
    s_add_u32 s30, s3, 30408704
    s_add_u32 s31, s3, 30464000
    s_add_u32 s32, s3, 30519296
    s_add_u32 s33, s3, 30574592
    ds_read_b64_tr_b16 a[192:193], v216 offset:0
    ds_read_b64_tr_b16 a[194:195], v216 offset:2048
    ds_read_b64_tr_b16 a[208:209], v216 offset:4096
    ds_read_b64_tr_b16 a[210:211], v216 offset:6144
    ds_read_b64_tr_b16 a[196:197], v217 offset:0
    ds_read_b64_tr_b16 a[198:199], v217 offset:2048
    ds_read_b64_tr_b16 a[212:213], v217 offset:4096
    ds_read_b64_tr_b16 a[214:215], v217 offset:6144
    ds_read_b64_tr_b16 a[200:201], v218 offset:0
    ds_read_b64_tr_b16 a[202:203], v218 offset:2048
    ds_read_b64_tr_b16 a[216:217], v218 offset:4096
    ds_read_b64_tr_b16 a[218:219], v218 offset:6144
    ds_read_b64_tr_b16 a[204:205], v219 offset:0
    ds_read_b64_tr_b16 a[206:207], v219 offset:2048
    ds_read_b64_tr_b16 a[220:221], v219 offset:4096
    ds_read_b64_tr_b16 a[222:223], v219 offset:6144
    v_lshlrev_b32 v251, 2, v249
    v_and_b32 v251, 64, v251
    v_add_u32 v248, 0x18000, v229
    s_lshl_b32 s3, s22, 7
    v_add3_u32 v251, v251, v248, s3
    s_add_u32 m0, s38, 65536
    s_add_u32 s34, s93, 0
    buffer_load_dwordx4 v250, s[64:67], s34 offen offset:0 lds
    s_add_u32 s34, s93, 26624
    buffer_load_dwordx4 v250, s[64:67], s34 offen offset:1024 lds
    s_add_u32 s34, s93, 53248
    buffer_load_dwordx4 v250, s[64:67], s34 offen offset:2048 lds
    s_add_u32 s34, s93, 79872
    buffer_load_dwordx4 v250, s[64:67], s34 offen offset:3072 lds
    s_add_u32 m0, s38, 69632
    s_add_u32 s34, s93, 0
    buffer_load_dwordx4 v250, s[68:71], s34 offen offset:0 lds
    s_add_u32 s34, s93, 26624
    buffer_load_dwordx4 v250, s[68:71], s34 offen offset:1024 lds
    s_add_u32 s34, s93, 53248
    buffer_load_dwordx4 v250, s[68:71], s34 offen offset:2048 lds
    s_add_u32 s34, s93, 79872
    buffer_load_dwordx4 v250, s[68:71], s34 offen offset:3072 lds
    v_and_b32 v236, 0x1f0, v249
    s_and_b32 s3, s2, 6
    s_lshl_b32 s3, s3, 2
    s_add_u32 s3, s3, s91
    s_lshl_b32 s3, s3, 2
    s_add_u32 s3, s3, s22
    s_lshl_b32 s3, s3, 9
    s_add_u32 s3, s3, 3018752
    s_add_u32 s27, s3, 0x10000
    s_cmp_lt_u32 s2, 216
    s_cselect_b32 s3, s3, 0x7f000000
    buffer_load_dword v237, v236, s[16:19], s3 offen sc1
    s_add_u32 s26, s26, 0x10000
    s_mov_b64 exec, 15
    s_waitcnt vmcnt(18)
    buffer_store_dword v97, v96, s[16:19], s26 offen sc1
    s_mov_b64 exec, -1
    s_cmp_ge_u32 s2, 216
    s_cbranch_scc1 G2_idle
    s_waitcnt vmcnt(1)
    v_cmp_ne_u32 vcc, s55, v237
    s_cbranch_vccz S2_ok
S2_spin:
    s_mov_b32 s98, 262144
S2_loop:
    buffer_load_dword v237, v236, s[16:19], s3 offen sc1
    s_sub_u32 s98, s98, 1
    s_waitcnt vmcnt(0)
    s_cbranch_scc1 S2_ok
    v_cmp_ne_u32 vcc, s55, v237
    s_cbranch_vccz S2_ok
    s_sleep 6
    s_branch S2_loop
S2_ok:
    s_add_u32 s23, s20, 0
    buffer_load_dwordx4 a[96:99], v220, s[16:19], s23 offen offset:0 sc1
    buffer_load_dwordx4 a[100:103], v221, s[16:19], s23 offen offset:0 sc1
    buffer_load_dwordx4 a[104:107], v222, s[16:19], s23 offen offset:0 sc1
    buffer_load_dwordx4 a[108:111], v223, s[16:19], s23 offen offset:0 sc1
    buffer_load_dwordx4 a[112:115], v220, s[16:19], s23 offen offset:1024 sc1
    buffer_load_dwordx4 a[116:119], v221, s[16:19], s23 offen offset:1024 sc1
    buffer_load_dwordx4 a[120:123], v222, s[16:19], s23 offen offset:1024 sc1
    buffer_load_dwordx4 a[124:127], v223, s[16:19], s23 offen offset:1024 sc1
    s_waitcnt lgkmcnt(0)
    s_barrier
    ds_read_b64_tr_b16 v[128:129], v252 offset:32768
    ds_read_b64_tr_b16 v[130:131], v252 offset:34816
    ds_read_b64_tr_b16 v[132:133], v252 offset:36864
    ds_read_b64_tr_b16 v[134:135], v252 offset:38912
    ds_read_b64_tr_b16 v[136:137], v252 offset:40960
    ds_read_b64_tr_b16 v[138:139], v252 offset:43008
    ds_read_b64_tr_b16 v[140:141], v252 offset:45056
    ds_read_b64_tr_b16 v[142:143], v252 offset:47104
    ds_read_b64_tr_b16 v[144:145], v252 offset:49152
    ds_read_b64_tr_b16 v[146:147], v252 offset:51200
    ds_read_b64_tr_b16 v[148:149], v252 offset:53248
    ds_read_b64_tr_b16 v[150:151], v252 offset:55296
    ds_read_b64_tr_b16 v[152:153], v252 offset:57344
    ds_read_b64_tr_b16 v[154:155], v252 offset:59392
    ds_read_b64_tr_b16 v[156:157], v252 offset:61440
    ds_read_b64_tr_b16 v[158:159], v252 offset:63488
    v_add_u32 v252, 0x10000, v252
    ds_read_b64_tr_b16 v[160:161], v252 offset:0
    ds_read_b64_tr_b16 v[162:163], v252 offset:2048
    ds_read_b64_tr_b16 v[164:165], v252 offset:4096
    ds_read_b64_tr_b16 v[166:167], v252 offset:6144
    ds_read_b64_tr_b16 v[168:169], v252 offset:8192
    ds_read_b64_tr_b16 v[170:171], v252 offset:10240
    ds_read_b64_tr_b16 v[172:173], v252 offset:12288
    ds_read_b64_tr_b16 v[174:175], v252 offset:14336
    ds_read_b64_tr_b16 v[176:177], v252 offset:16384
    ds_read_b64_tr_b16 v[178:179], v252 offset:18432
    ds_read_b64_tr_b16 v[180:181], v252 offset:20480
    ds_read_b64_tr_b16 v[182:183], v252 offset:22528
    ds_read_b64_tr_b16 v[184:185], v252 offset:24576
    ds_read_b64_tr_b16 v[186:187], v252 offset:26624
    ds_read_b64_tr_b16 v[188:189], v252 offset:28672
    ds_read_b64_tr_b16 v[190:191], v252 offset:30720
    s_waitcnt lgkmcnt(0)
    v_mfma_f32_16x16x32_bf16 v[240:243], v[128:131], a[48:51], v[240:243]
    buffer_load_dwordx4 a[128:131], v220, s[16:19], s23 offen offset:2048 sc1
    v_mfma_f32_16x16x32_bf16 v[244:247], v[132:135], a[48:51], v[244:247]
    v_mfma_f32_16x16x32_bf16 v[240:243], v[136:139], a[52:55], v[240:243]
    v_mfma_f32_16x16x32_bf16 v[244:247], v[140:143], a[52:55], v[244:247]
    v_mfma_f32_16x16x32_bf16 v[240:243], v[144:147], a[56:59], v[240:243]
    buffer_load_dwordx4 a[132:135], v221, s[16:19], s23 offen offset:2048 sc1
    v_mfma_f32_16x16x32_bf16 v[244:247], v[148:151], a[56:59], v[244:247]
    v_mfma_f32_16x16x32_bf16 v[240:243], v[152:155], a[60:63], v[240:243]
    v_mfma_f32_16x16x32_bf16 v[244:247], v[156:159], a[60:63], v[244:247]
    v_mfma_f32_16x16x32_bf16 v[240:243], v[160:163], a[64:67], v[240:243]
    buffer_load_dwordx4 a[136:139], v222, s[16:19], s23 offen offset:2048 sc1
    v_mfma_f32_16x16x32_bf16 v[244:247], v[164:167], a[64:67], v[244:247]
    v_mfma_f32_16x16x32_bf16 v[240:243], v[168:171], a[68:71], v[240:243]
    v_mfma_f32_16x16x32_bf16 v[244:247], v[172:175], a[68:71], v[244:247]
    v_mfma_f32_16x16x32_bf16 v[240:243], v[176:179], a[72:75], v[240:243]
    buffer_load_dwordx4 a[140:143], v223, s[16:19], s23 offen offset:2048 sc1
    v_mfma_f32_16x16x32_bf16 v[244:247], v[180:183], a[72:75], v[244:247]
    v_mfma_f32_16x16x32_bf16 v[240:243], v[184:187], a[76:79], v[240:243]
    v_mfma_f32_16x16x32_bf16 v[244:247], v[188:191], a[76:79], v[244:247]
    buffer_load_dword v237, v236, s[16:19], s27 offen sc1
    s_nop 6
    ds_write_b128 v251, v[240:243]
    ds_write_b128 v251, v[244:247] offset:512
    s_waitcnt vmcnt(9)
    v_mfma_f32_16x16x32_bf16 v[0:3], a[192:195], a[96:99], 0
    ds_read_b64_tr_b16 a[224:225], v216 offset:8192
    v_mfma_f32_16x16x32_bf16 v[4:7], a[192:195], a[100:103], 0
    ds_read_b64_tr_b16 a[226:227], v216 offset:10240
    v_mfma_f32_16x16x32_bf16 v[8:11], a[192:195], a[104:107], 0
    ds_read_b64_tr_b16 a[240:241], v216 offset:12288
    v_mfma_f32_16x16x32_bf16 v[12:15], a[192:195], a[108:111], 0
    buffer_load_dwordx4 a[144:147], v220, s[16:19], s23 offen offset:3072 sc1
    v_mfma_f32_16x16x32_bf16 v[76:79], a[208:211], a[108:111], 0
    ds_read_b64_tr_b16 a[242:243], v216 offset:14336
    v_mfma_f32_16x16x32_bf16 v[72:75], a[208:211], a[104:107], 0
    ds_read_b64_tr_b16 a[228:229], v217 offset:8192
    v_mfma_f32_16x16x32_bf16 v[68:71], a[208:211], a[100:103], 0
    ds_read_b64_tr_b16 a[230:231], v217 offset:10240
    v_mfma_f32_16x16x32_bf16 v[64:67], a[208:211], a[96:99], 0
    buffer_load_dwordx4 a[148:151], v221, s[16:19], s23 offen offset:3072 sc1
    v_mfma_f32_16x16x32_bf16 v[16:19], a[196:199], a[96:99], 0
    ds_read_b64_tr_b16 a[244:245], v217 offset:12288
    v_mfma_f32_16x16x32_bf16 v[20:23], a[196:199], a[100:103], 0
    ds_read_b64_tr_b16 a[246:247], v217 offset:14336
    v_mfma_f32_16x16x32_bf16 v[24:27], a[196:199], a[104:107], 0
    ds_read_b64_tr_b16 a[232:233], v218 offset:8192
    v_mfma_f32_16x16x32_bf16 v[28:31], a[196:199], a[108:111], 0
    buffer_load_dwordx4 a[152:155], v222, s[16:19], s23 offen offset:3072 sc1
    v_mfma_f32_16x16x32_bf16 v[92:95], a[212:215], a[108:111], 0
    ds_read_b64_tr_b16 a[234:235], v218 offset:10240
    v_mfma_f32_16x16x32_bf16 v[88:91], a[212:215], a[104:107], 0
    ds_read_b64_tr_b16 a[248:249], v218 offset:12288
    v_mfma_f32_16x16x32_bf16 v[84:87], a[212:215], a[100:103], 0
    ds_read_b64_tr_b16 a[250:251], v218 offset:14336
    v_mfma_f32_16x16x32_bf16 v[80:83], a[212:215], a[96:99], 0
    buffer_load_dwordx4 a[156:159], v223, s[16:19], s23 offen offset:3072 sc1
    v_mfma_f32_16x16x32_bf16 v[32:35], a[200:203], a[96:99], 0
    ds_read_b64_tr_b16 a[236:237], v219 offset:8192
    v_mfma_f32_16x16x32_bf16 v[36:39], a[200:203], a[100:103], 0
    ds_read_b64_tr_b16 a[238:239], v219 offset:10240
    v_mfma_f32_16x16x32_bf16 v[40:43], a[200:203], a[104:107], 0
    ds_read_b64_tr_b16 a[252:253], v219 offset:12288
    v_mfma_f32_16x16x32_bf16 v[44:47], a[200:203], a[108:111], 0
    s_add_u32 s23, s20, 4096
    ds_read_b64_tr_b16 a[254:255], v219 offset:14336
    v_mfma_f32_16x16x32_bf16 v[108:111], a[216:219], a[108:111], 0
    buffer_load_dwordx4 a[160:163], v220, s[16:19], s23 offen offset:0 sc1
    v_mfma_f32_16x16x32_bf16 v[104:107], a[216:219], a[104:107], 0
    v_mfma_f32_16x16x32_bf16 v[100:103], a[216:219], a[100:103], 0
    v_mfma_f32_16x16x32_bf16 v[96:99], a[216:219], a[96:99], 0
    v_mfma_f32_16x16x32_bf16 v[48:51], a[204:207], a[96:99], 0
    buffer_load_dwordx4 a[164:167], v221, s[16:19], s23 offen offset:0 sc1
    v_mfma_f32_16x16x32_bf16 v[52:55], a[204:207], a[100:103], 0
    v_mfma_f32_16x16x32_bf16 v[56:59], a[204:207], a[104:107], 0
    v_mfma_f32_16x16x32_bf16 v[60:63], a[204:207], a[108:111], 0
    v_mfma_f32_16x16x32_bf16 v[124:127], a[220:223], a[108:111], 0
    buffer_load_dwordx4 a[168:171], v222, s[16:19], s23 offen offset:0 sc1
    v_mfma_f32_16x16x32_bf16 v[120:123], a[220:223], a[104:107], 0
    v_mfma_f32_16x16x32_bf16 v[116:119], a[220:223], a[100:103], 0
    s_waitcnt vmcnt(12) lgkmcnt(0)
    v_mfma_f32_16x16x32_bf16 v[112:115], a[220:223], a[96:99], 0
    s_barrier
    s_waitcnt vmcnt(7)
    v_cmp_ne_u32 vcc, s55, v237
    s_cbranch_vccnz S2b_spin
S2b_ok:
    v_mfma_f32_16x16x32_bf16 v[0:3], a[224:227], a[112:115], v[0:3]
    ds_read_b64_tr_b16 a[192:193], v216 offset:16384
    ds_read_b64_tr_b16 a[194:195], v216 offset:18432
    v_mfma_f32_16x16x32_bf16 v[4:7], a[224:227], a[116:119], v[4:7]
    ds_read_b64_tr_b16 a[208:209], v216 offset:20480
    ds_read_b64_tr_b16 a[210:211], v216 offset:22528
    v_mfma_f32_16x16x32_bf16 v[8:11], a[224:227], a[120:123], v[8:11]
    ds_read_b64_tr_b16 a[196:197], v217 offset:16384
    ds_read_b64_tr_b16 a[198:199], v217 offset:18432
    v_mfma_f32_16x16x32_bf16 v[12:15], a[224:227], a[124:127], v[12:15]
    buffer_load_dwordx4 v[204:207], v249, s[16:19], s21 offen offset:3072 sc1
    v_mfma_f32_16x16x32_bf16 v[76:79], a[240:243], a[124:127], v[76:79]
    ds_read_b64_tr_b16 a[212:213], v217 offset:20480
    ds_read_b64_tr_b16 a[214:215], v217 offset:22528
    v_mfma_f32_16x16x32_bf16 v[72:75], a[240:243], a[120:123], v[72:75]
    ds_read_b64_tr_b16 a[200:201], v218 offset:16384
    ds_read_b64_tr_b16 a[202:203], v218 offset:18432
    v_mfma_f32_16x16x32_bf16 v[68:71], a[240:243], a[116:119], v[68:71]
    ds_read_b64_tr_b16 a[216:217], v218 offset:20480
    ds_read_b64_tr_b16 a[218:219], v218 offset:22528
    v_mfma_f32_16x16x32_bf16 v[64:67], a[240:243], a[112:115], v[64:67]
    buffer_load_dwordx4 v[200:203], v249, s[16:19], s21 offen offset:2048 sc1
    v_mfma_f32_16x16x32_bf16 v[16:19], a[228:231], a[112:115], v[16:19]
    ds_read_b64_tr_b16 a[204:205], v219 offset:16384
    ds_read_b64_tr_b16 a[206:207], v219 offset:18432
    v_mfma_f32_16x16x32_bf16 v[20:23], a[228:231], a[116:119], v[20:23]
    ds_read_b64_tr_b16 a[220:221], v219 offset:20480
    ds_read_b64_tr_b16 a[222:223], v219 offset:22528
    v_mfma_f32_16x16x32_bf16 v[24:27], a[228:231], a[120:123], v[24:27]
    ds_read_b128 v[128:131], v248 offset:0
    ds_read_b128 v[132:135], v248 offset:64
    v_mfma_f32_16x16x32_bf16 v[28:31], a[228:231], a[124:127], v[28:31]
HOP1_3:
    s_cbranch_execz HOPRET1
    buffer_load_dwordx4 v[196:199], v249, s[16:19], s21 offen offset:1024 sc1
    v_mfma_f32_16x16x32_bf16 v[92:95], a[244:247], a[124:127], v[92:95]
    ds_read_b128 v[136:139], v248 offset:512
    ds_read_b128 v[140:143], v248 offset:576
    v_mfma_f32_16x16x32_bf16 v[88:91], a[244:247], a[120:123], v[88:91]
    ds_read_b128 v[144:147], v248 offset:128
    ds_read_b128 v[148:151], v248 offset:192
    v_mfma_f32_16x16x32_bf16 v[84:87], a[244:247], a[116:119], v[84:87]
    ds_read_b128 v[152:155], v248 offset:640
    ds_read_b128 v[156:159], v248 offset:704
    v_mfma_f32_16x16x32_bf16 v[80:83], a[244:247], a[112:115], v[80:83]
    buffer_load_dwordx4 v[192:195], v249, s[16:19], s21 offen offset:0 sc1
    v_mfma_f32_16x16x32_bf16 v[32:35], a[232:235], a[112:115], v[32:35]
    ds_read_b128 v[160:163], v248 offset:256
    ds_read_b128 v[164:167], v248 offset:320
    v_mfma_f32_16x16x32_bf16 v[36:39], a[232:235], a[116:119], v[36:39]
    ds_read_b128 v[168:171], v248 offset:768
    ds_read_b128 v[172:175], v248 offset:832
    v_mfma_f32_16x16x32_bf16 v[40:43], a[232:235], a[120:123], v[40:43]
    ds_read_b128 v[176:179], v248 offset:384
    ds_read_b128 v[180:183], v248 offset:448
    v_mfma_f32_16x16x32_bf16 v[44:47], a[232:235], a[124:127], v[44:47]
    ds_read_b128 v[184:187], v248 offset:896
    ds_read_b128 v[188:191], v248 offset:960
    v_mfma_f32_16x16x32_bf16 v[108:111], a[248:251], a[124:127], v[108:111]
    buffer_load_dwordx4 a[172:175], v223, s[16:19], s23 offen offset:0 sc1
    v_mfma_f32_16x16x32_bf16 v[104:107], a[248:251], a[120:123], v[104:107]
    v_mfma_f32_16x16x32_bf16 v[100:103], a[248:251], a[116:119], v[100:103]
    v_mfma_f32_16x16x32_bf16 v[96:99], a[248:251], a[112:115], v[96:99]
    v_mfma_f32_16x16x32_bf16 v[48:51], a[236:239], a[112:115], v[48:51]
    buffer_load_dwordx4 a[176:179], v220, s[16:19], s23 offen offset:1024 sc1
    v_mfma_f32_16x16x32_bf16 v[52:55], a[236:239], a[116:119], v[52:55]
    v_mfma_f32_16x16x32_bf16 v[56:59], a[236:239], a[120:123], v[56:59]
    v_mfma_f32_16x16x32_bf16 v[60:63], a[236:239], a[124:127], v[60:63]
    v_mfma_f32_16x16x32_bf16 v[124:127], a[252:255], a[124:127], v[124:127]
    buffer_load_dwordx4 a[180:183], v221, s[16:19], s23 offen offset:1024 sc1
    v_mfma_f32_16x16x32_bf16 v[120:123], a[252:255], a[120:123], v[120:123]
    v_mfma_f32_16x16x32_bf16 v[116:119], a[252:255], a[116:119], v[116:119]
    v_mfma_f32_16x16x32_bf16 v[112:115], a[252:255], a[112:115], v[112:115]
    s_waitcnt lgkmcnt(0)
    v_mfma_f32_16x16x32_bf16 v[0:3], a[192:195], a[128:131], v[0:3]
    ds_read_b64_tr_b16 a[224:225], v216 offset:24576
    v_add_u32 v251, s86, v249
    v_mfma_f32_16x16x32_bf16 v[4:7], a[192:195], a[132:135], v[4:7]
    ds_read_b64_tr_b16 a[226:227], v216 offset:26624
    v_add_u32 v252, s87, v249
    v_mfma_f32_16x16x32_bf16 v[8:11], a[192:195], a[136:139], v[8:11]
    ds_read_b64_tr_b16 a[240:241], v216 offset:28672
    v_cmp_gt_u32 vcc, 0x100, v249
    v_mfma_f32_16x16x32_bf16 v[12:15], a[192:195], a[140:143], v[12:15]
    buffer_load_dwordx4 a[184:187], v222, s[16:19], s23 offen offset:1024 sc1
    v_mfma_f32_16x16x32_bf16 v[76:79], a[208:211], a[140:143], v[76:79]
    ds_read_b64_tr_b16 a[242:243], v216 offset:30720
    v_subrev_u32 v252, 0x100, v252
    v_mfma_f32_16x16x32_bf16 v[72:75], a[208:211], a[136:139], v[72:75]
    ds_read_b64_tr_b16 a[228:229], v217 offset:24576
    s_nop 0
    v_mfma_f32_16x16x32_bf16 v[68:71], a[208:211], a[132:135], v[68:71]
    ds_read_b64_tr_b16 a[230:231], v217 offset:26624
    v_cndmask_b32 v251, v252, v251, vcc
    v_mfma_f32_16x16x32_bf16 v[64:67], a[208:211], a[128:131], v[64:67]
    buffer_load_dwordx4 a[188:191], v223, s[16:19], s23 offen offset:1024 sc1
    v_mfma_f32_16x16x32_bf16 v[16:19], a[196:199], a[128:131], v[16:19]
    ds_read_b64_tr_b16 a[244:245], v217 offset:28672
    v_mfma_f32_16x16x32_bf16 v[20:23], a[196:199], a[132:135], v[20:23]
    ds_read_b64_tr_b16 a[246:247], v217 offset:30720
    v_mfma_f32_16x16x32_bf16 v[24:27], a[196:199], a[136:139], v[24:27]
    ds_read_b64_tr_b16 a[232:233], v218 offset:24576
    v_mfma_f32_16x16x32_bf16 v[28:31], a[196:199], a[140:143], v[28:31]
    buffer_load_dwordx4 a[64:67], v220, s[16:19], s23 offen offset:2048 sc1
    v_mfma_f32_16x16x32_bf16 v[92:95], a[212:215], a[140:143], v[92:95]
    ds_read_b64_tr_b16 a[234:235], v218 offset:26624
    v_mfma_f32_16x16x32_bf16 v[88:91], a[212:215], a[136:139], v[88:91]
    ds_read_b64_tr_b16 a[248:249], v218 offset:28672
    v_mfma_f32_16x16x32_bf16 v[84:87], a[212:215], a[132:135], v[84:87]
    ds_read_b64_tr_b16 a[250:251], v218 offset:30720
    v_mfma_f32_16x16x32_bf16 v[80:83], a[212:215], a[128:131], v[80:83]
    buffer_load_dwordx4 a[68:71], v221, s[16:19], s23 offen offset:2048 sc1
    v_mfma_f32_16x16x32_bf16 v[32:35], a[200:203], a[128:131], v[32:35]
    ds_read_b64_tr_b16 a[236:237], v219 offset:24576
    v_mfma_f32_16x16x32_bf16 v[36:39], a[200:203], a[132:135], v[36:39]
    ds_read_b64_tr_b16 a[238:239], v219 offset:26624
    v_mfma_f32_16x16x32_bf16 v[40:43], a[200:203], a[136:139], v[40:43]
    ds_read_b64_tr_b16 a[252:253], v219 offset:28672
    v_mfma_f32_16x16x32_bf16 v[44:47], a[200:203], a[140:143], v[44:47]
    ds_read_b64_tr_b16 a[254:255], v219 offset:30720
    v_mfma_f32_16x16x32_bf16 v[108:111], a[216:219], a[140:143], v[108:111]
    buffer_load_dwordx4 a[72:75], v222, s[16:19], s23 offen offset:2048 sc1
    v_mfma_f32_16x16x32_bf16 v[104:107], a[216:219], a[136:139], v[104:107]
    v_mfma_f32_16x16x32_bf16 v[100:103], a[216:219], a[132:135], v[100:103]
    v_mfma_f32_16x16x32_bf16 v[96:99], a[216:219], a[128:131], v[96:99]
    v_mfma_f32_16x16x32_bf16 v[48:51], a[204:207], a[128:131], v[48:51]
    buffer_load_dwordx4 a[76:79], v223, s[16:19], s23 offen offset:2048 sc1
    v_mfma_f32_16x16x32_bf16 v[52:55], a[204:207], a[132:135], v[52:55]
    v_mfma_f32_16x16x32_bf16 v[56:59], a[204:207], a[136:139], v[56:59]
    v_mfma_f32_16x16x32_bf16 v[60:63], a[204:207], a[140:143], v[60:63]
    s_add_u32 s81, s51, 0
    v_mfma_f32_16x16x32_bf16 v[124:127], a[220:223], a[140:143], v[124:127]
    buffer_load_dwordx4 a[20:23], v249, s[16:19], s81 offen offset:0 sc1
    v_mfma_f32_16x16x32_bf16 v[120:123], a[220:223], a[136:139], v[120:123]
    v_mfma_f32_16x16x32_bf16 v[116:119], a[220:223], a[132:135], v[116:119]
    v_mfma_f32_16x16x32_bf16 v[112:115], a[220:223], a[128:131], v[112:115]
    s_waitcnt vmcnt(17) lgkmcnt(0)
    v_mfma_f32_16x16x32_bf16 v[0:3], a[224:227], a[144:147], v[0:3]
    s_waitcnt vmcnt(10)
    ds_read_b64_tr_b16 a[192:193], v216 offset:32768
    v_add_f32 v192, v192, v194
    v_mfma_f32_16x16x32_bf16 v[4:7], a[224:227], a[148:151], v[4:7]
    ds_read_b64_tr_b16 a[194:195], v216 offset:34816
    v_add_f32 v196, v196, v198
    v_mfma_f32_16x16x32_bf16 v[8:11], a[224:227], a[152:155], v[8:11]
    ds_read_b64_tr_b16 a[208:209], v216 offset:36864
    v_add_f32 v200, v200, v202
    v_mfma_f32_16x16x32_bf16 v[12:15], a[224:227], a[156:159], v[12:15]
    buffer_load_dwordx4 a[80:83], v220, s[16:19], s23 offen offset:3072 sc1
    v_mfma_f32_16x16x32_bf16 v[76:79], a[240:243], a[156:159], v[76:79]
    ds_read_b64_tr_b16 a[210:211], v216 offset:38912
    v_add_f32 v204, v204, v206
    v_mfma_f32_16x16x32_bf16 v[72:75], a[240:243], a[152:155], v[72:75]
    ds_read_b64_tr_b16 a[196:197], v217 offset:32768
    v_add_f32 v193, v193, v195
    v_mfma_f32_16x16x32_bf16 v[68:71], a[240:243], a[148:151], v[68:71]
    ds_read_b64_tr_b16 a[198:199], v217 offset:34816
    v_add_f32 v197, v197, v199
    v_mfma_f32_16x16x32_bf16 v[64:67], a[240:243], a[144:147], v[64:67]
    buffer_load_dwordx4 a[84:87], v221, s[16:19], s23 offen offset:3072 sc1
    v_mfma_f32_16x16x32_bf16 v[16:19], a[228:231], a[144:147], v[16:19]
    ds_read_b64_tr_b16 a[212:213], v217 offset:36864
    v_add_f32 v201, v201, v203
    v_mfma_f32_16x16x32_bf16 v[20:23], a[228:231], a[148:151], v[20:23]
    ds_read_b64_tr_b16 a[214:215], v217 offset:38912
    v_add_f32 v205, v205, v207
    v_mfma_f32_16x16x32_bf16 v[24:27], a[228:231], a[152:155], v[24:27]
    ds_read_b64_tr_b16 a[200:201], v218 offset:32768
    v_mov_b32 v194, v192
    v_mfma_f32_16x16x32_bf16 v[28:31], a[228:231], a[156:159], v[28:31]
    buffer_load_dwordx4 a[88:91], v222, s[16:19], s23 offen offset:3072 sc1
    v_mfma_f32_16x16x32_bf16 v[92:95], a[244:247], a[156:159], v[92:95]
    ds_read_b64_tr_b16 a[202:203], v218 offset:34816
    v_mov_b32 v198, v196
    v_mfma_f32_16x16x32_bf16 v[88:91], a[244:247], a[152:155], v[88:91]
    ds_read_b64_tr_b16 a[216:217], v218 offset:36864
    v_mov_b32 v202, v200
    v_mfma_f32_16x16x32_bf16 v[84:87], a[244:247], a[148:151], v[84:87]
    ds_read_b64_tr_b16 a[218:219], v218 offset:38912
    v_mov_b32 v206, v204
    v_mfma_f32_16x16x32_bf16 v[80:83], a[244:247], a[144:147], v[80:83]
    buffer_load_dwordx4 a[92:95], v223, s[16:19], s23 offen offset:3072 sc1
    v_mfma_f32_16x16x32_bf16 v[32:35], a[232:235], a[144:147], v[32:35]
    ds_read_b64_tr_b16 a[204:205], v219 offset:32768
    v_mov_b32 v195, v193
    v_mfma_f32_16x16x32_bf16 v[36:39], a[232:235], a[148:151], v[36:39]
    ds_read_b64_tr_b16 a[206:207], v219 offset:34816
    v_mov_b32 v199, v197
    v_mfma_f32_16x16x32_bf16 v[40:43], a[232:235], a[152:155], v[40:43]
    ds_read_b64_tr_b16 a[220:221], v219 offset:36864
    v_mov_b32 v203, v201
    v_mfma_f32_16x16x32_bf16 v[44:47], a[232:235], a[156:159], v[44:47]
    s_add_u32 s23, s20, 8192
    ds_read_b64_tr_b16 a[222:223], v219 offset:38912
    v_mov_b32 v207, v205
    v_mfma_f32_16x16x32_bf16 v[108:111], a[248:251], a[156:159], v[108:111]
    buffer_load_dwordx4 a[96:99], v220, s[16:19], s23 offen offset:0 sc1
    v_mfma_f32_16x16x32_bf16 v[104:107], a[248:251], a[152:155], v[104:107]
    v_permlane32_swap_b32 v194, v192
    v_permlane32_swap_b32 v198, v196
    v_mfma_f32_16x16x32_bf16 v[100:103], a[248:251], a[148:151], v[100:103]
    v_permlane32_swap_b32 v202, v200
    v_permlane32_swap_b32 v206, v204
    v_mfma_f32_16x16x32_bf16 v[96:99], a[248:251], a[144:147], v[96:99]
    v_permlane32_swap_b32 v195, v193
    v_permlane32_swap_b32 v199, v197
    v_mfma_f32_16x16x32_bf16 v[48:51], a[236:239], a[144:147], v[48:51]
    buffer_load_dwordx4 a[100:103], v221, s[16:19], s23 offen offset:0 sc1
    v_mfma_f32_16x16x32_bf16 v[52:55], a[236:239], a[148:151], v[52:55]
    v_permlane32_swap_b32 v203, v201
    v_permlane32_swap_b32 v207, v205
    v_mfma_f32_16x16x32_bf16 v[56:59], a[236:239], a[152:155], v[56:59]
    v_add_f32 v192, v192, v194
    v_add_f32 v196, v196, v198
    v_mfma_f32_16x16x32_bf16 v[60:63], a[236:239], a[156:159], v[60:63]
    v_add_f32 v200, v200, v202
    v_add_f32 v204, v204, v206
    v_mfma_f32_16x16x32_bf16 v[124:127], a[252:255], a[156:159], v[124:127]
    buffer_load_dwordx4 a[24:27], v249, s[16:19], s81 offen offset:1024 sc1
    v_mfma_f32_16x16x32_bf16 v[120:123], a[252:255], a[152:155], v[120:123]
    v_add_f32 v193, v193, v195
    v_add_f32 v197, v197, v199
    v_mfma_f32_16x16x32_bf16 v[116:119], a[252:255], a[148:151], v[116:119]
    v_mfma_f32_16x16x32_bf16 v[112:115], a[252:255], a[144:147], v[112:115]
    s_waitcnt vmcnt(16) lgkmcnt(0)
    v_mfma_f32_16x16x32_bf16 v[0:3], a[192:195], a[160:163], v[0:3]
    ds_read_b64_tr_b16 a[224:225], v216 offset:40960
    v_add_f32 v201, v201, v203
    v_mfma_f32_16x16x32_bf16 v[4:7], a[192:195], a[164:167], v[4:7]
    ds_read_b64_tr_b16 a[226:227], v216 offset:43008
    v_add_f32 v205, v205, v207
    v_mfma_f32_16x16x32_bf16 v[8:11], a[192:195], a[168:171], v[8:11]
    ds_read_b64_tr_b16 a[240:241], v216 offset:45056
    v_mov_b32 v194, v192
    v_mfma_f32_16x16x32_bf16 v[12:15], a[192:195], a[172:175], v[12:15]
    buffer_load_dwordx4 a[104:107], v222, s[16:19], s23 offen offset:0 sc1
    v_mfma_f32_16x16x32_bf16 v[76:79], a[208:211], a[172:175], v[76:79]
    ds_read_b64_tr_b16 a[242:243], v216 offset:47104
    v_mov_b32 v198, v196
    v_mfma_f32_16x16x32_bf16 v[72:75], a[208:211], a[168:171], v[72:75]
    ds_read_b64_tr_b16 a[228:229], v217 offset:40960
    v_mov_b32 v202, v200
    v_mfma_f32_16x16x32_bf16 v[68:71], a[208:211], a[164:167], v[68:71]
    ds_read_b64_tr_b16 a[230:231], v217 offset:43008
    v_mov_b32 v206, v204
    v_mfma_f32_16x16x32_bf16 v[64:67], a[208:211], a[160:163], v[64:67]
    buffer_load_dwordx4 a[108:111], v223, s[16:19], s23 offen offset:0 sc1
    v_mfma_f32_16x16x32_bf16 v[16:19], a[196:199], a[160:163], v[16:19]
    ds_read_b64_tr_b16 a[244:245], v217 offset:45056
    v_mov_b32 v195, v193
    v_mfma_f32_16x16x32_bf16 v[20:23], a[196:199], a[164:167], v[20:23]
    ds_read_b64_tr_b16 a[246:247], v217 offset:47104
    v_mov_b32 v199, v197
    v_mfma_f32_16x16x32_bf16 v[24:27], a[196:199], a[168:171], v[24:27]
    ds_read_b64_tr_b16 a[232:233], v218 offset:40960
    v_mov_b32 v203, v201
    v_mfma_f32_16x16x32_bf16 v[28:31], a[196:199], a[172:175], v[28:31]
    buffer_load_dwordx4 a[112:115], v220, s[16:19], s23 offen offset:1024 sc1
    v_mfma_f32_16x16x32_bf16 v[92:95], a[212:215], a[172:175], v[92:95]
    ds_read_b64_tr_b16 a[234:235], v218 offset:43008
    v_mov_b32 v207, v205
    v_mfma_f32_16x16x32_bf16 v[88:91], a[212:215], a[168:171], v[88:91]
    ds_read_b64_tr_b16 a[248:249], v218 offset:45056
    v_permlane16_swap_b32 v194, v192
    v_mfma_f32_16x16x32_bf16 v[84:87], a[212:215], a[164:167], v[84:87]
    ds_read_b64_tr_b16 a[250:251], v218 offset:47104
    v_permlane16_swap_b32 v198, v196
    v_mfma_f32_16x16x32_bf16 v[80:83], a[212:215], a[160:163], v[80:83]
    buffer_load_dwordx4 a[116:119], v221, s[16:19], s23 offen offset:1024 sc1
    v_mfma_f32_16x16x32_bf16 v[32:35], a[200:203], a[160:163], v[32:35]
    ds_read_b64_tr_b16 a[236:237], v219 offset:40960
    v_permlane16_swap_b32 v202, v200
    v_mfma_f32_16x16x32_bf16 v[36:39], a[200:203], a[164:167], v[36:39]
    ds_read_b64_tr_b16 a[238:239], v219 offset:43008
    v_permlane16_swap_b32 v206, v204
    v_mfma_f32_16x16x32_bf16 v[40:43], a[200:203], a[168:171], v[40:43]
    ds_read_b64_tr_b16 a[252:253], v219 offset:45056
    v_permlane16_swap_b32 v195, v193
    v_mfma_f32_16x16x32_bf16 v[44:47], a[200:203], a[172:175], v[44:47]
    ds_read_b64_tr_b16 a[254:255], v219 offset:47104
    v_permlane16_swap_b32 v199, v197
    v_mfma_f32_16x16x32_bf16 v[108:111], a[216:219], a[172:175], v[108:111]
    buffer_load_dwordx4 a[120:123], v222, s[16:19], s23 offen offset:1024 sc1
    v_mfma_f32_16x16x32_bf16 v[104:107], a[216:219], a[168:171], v[104:107]
    v_permlane16_swap_b32 v203, v201
    v_permlane16_swap_b32 v207, v205
    v_mfma_f32_16x16x32_bf16 v[100:103], a[216:219], a[164:167], v[100:103]
    v_add_f32 v192, v192, v194
    v_add_f32 v196, v196, v198
    v_mfma_f32_16x16x32_bf16 v[96:99], a[216:219], a[160:163], v[96:99]
    v_add_f32 v200, v200, v202
    v_add_f32 v204, v204, v206
    v_mfma_f32_16x16x32_bf16 v[48:51], a[204:207], a[160:163], v[48:51]
    buffer_load_dwordx4 a[124:127], v223, s[16:19], s23 offen offset:1024 sc1
    v_mfma_f32_16x16x32_bf16 v[52:55], a[204:207], a[164:167], v[52:55]
    v_add_f32 v193, v193, v195
    v_add_f32 v197, v197, v199
    v_mfma_f32_16x16x32_bf16 v[56:59], a[204:207], a[168:171], v[56:59]
    v_add_f32 v201, v201, v203
    v_add_f32 v205, v205, v207
    v_mfma_f32_16x16x32_bf16 v[60:63], a[204:207], a[172:175], v[60:63]
    v_mul_f32 v208, 0xbacccccd, v192
    v_mul_f32 v209, 0xbacccccd, v196
    v_mfma_f32_16x16x32_bf16 v[124:127], a[220:223], a[172:175], v[124:127]
    buffer_load_dwordx4 a[28:31], v249, s[16:19], s81 offen offset:2048 sc1
    v_mfma_f32_16x16x32_bf16 v[120:123], a[220:223], a[168:171], v[120:123]
    v_mul_f32 v210, 0xbacccccd, v200
    v_mul_f32 v211, 0xbacccccd, v204
    v_mfma_f32_16x16x32_bf16 v[116:119], a[220:223], a[164:167], v[116:119]
    v_mfma_f32_16x16x32_bf16 v[112:115], a[220:223], a[160:163], v[112:115]
    s_waitcnt vmcnt(19) lgkmcnt(0)
    v_mfma_f32_16x16x32_bf16 v[0:3], a[224:227], a[176:179], v[0:3]
    ds_read_b64_tr_b16 a[192:193], v216 offset:49152
    v_mul_f32 v193, 0x3acccccd, v193
    v_mfma_f32_16x16x32_bf16 v[4:7], a[224:227], a[180:183], v[4:7]
    ds_read_b64_tr_b16 a[194:195], v216 offset:51200
    v_mul_f32 v197, 0x3acccccd, v197
    v_mfma_f32_16x16x32_bf16 v[8:11], a[224:227], a[184:187], v[8:11]
    ds_read_b64_tr_b16 a[208:209], v216 offset:53248
    v_mul_f32 v201, 0x3acccccd, v201
    v_mfma_f32_16x16x32_bf16 v[12:15], a[224:227], a[188:191], v[12:15]
    buffer_load_dwordx4 a[128:131], v220, s[16:19], s23 offen offset:2048 sc1
    v_mfma_f32_16x16x32_bf16 v[76:79], a[240:243], a[188:191], v[76:79]
    ds_read_b64_tr_b16 a[210:211], v216 offset:55296
    v_mul_f32 v205, 0x3acccccd, v205
    v_mfma_f32_16x16x32_bf16 v[72:75], a[240:243], a[184:187], v[72:75]
    ds_read_b64_tr_b16 a[196:197], v217 offset:49152
    v_mul_f32 v194, 0x33800000, v208
    v_mfma_f32_16x16x32_bf16 v[68:71], a[240:243], a[180:183], v[68:71]
    ds_read_b64_tr_b16 a[198:199], v217 offset:51200
    v_mul_f32 v198, 0x33800000, v209
    v_mfma_f32_16x16x32_bf16 v[64:67], a[240:243], a[176:179], v[64:67]
    buffer_load_dwordx4 a[132:135], v221, s[16:19], s23 offen offset:2048 sc1
    v_mfma_f32_16x16x32_bf16 v[16:19], a[228:231], a[176:179], v[16:19]
    ds_read_b64_tr_b16 a[212:213], v217 offset:53248
    v_mul_f32 v202, 0x33800000, v210
    v_mfma_f32_16x16x32_bf16 v[20:23], a[228:231], a[180:183], v[20:23]
    ds_read_b64_tr_b16 a[214:215], v217 offset:55296
    v_mul_f32 v206, 0x33800000, v211
    v_mfma_f32_16x16x32_bf16 v[24:27], a[228:231], a[184:187], v[24:27]
    ds_read_b64_tr_b16 a[200:201], v218 offset:49152
    v_fma_f32 v193, -v208, v208, v193
    v_mfma_f32_16x16x32_bf16 v[28:31], a[228:231], a[188:191], v[28:31]
    buffer_load_dwordx4 a[136:139], v222, s[16:19], s23 offen offset:2048 sc1
    v_mfma_f32_16x16x32_bf16 v[92:95], a[244:247], a[188:191], v[92:95]
    ds_read_b64_tr_b16 a[202:203], v218 offset:51200
    v_fma_f32 v197, -v209, v209, v197
    v_mfma_f32_16x16x32_bf16 v[88:91], a[244:247], a[184:187], v[88:91]
    ds_read_b64_tr_b16 a[216:217], v218 offset:53248
    v_fma_f32 v201, -v210, v210, v201
    v_mfma_f32_16x16x32_bf16 v[84:87], a[244:247], a[180:183], v[84:87]
    ds_read_b64_tr_b16 a[218:219], v218 offset:55296
    v_fma_f32 v205, -v211, v211, v205
    v_mfma_f32_16x16x32_bf16 v[80:83], a[244:247], a[176:179], v[80:83]
    buffer_load_dwordx4 a[140:143], v223, s[16:19], s23 offen offset:2048 sc1
    v_mfma_f32_16x16x32_bf16 v[32:35], a[232:235], a[176:179], v[32:35]
    ds_read_b64_tr_b16 a[204:205], v219 offset:49152
    v_mul_f32 v194, v194, v208
    v_mfma_f32_16x16x32_bf16 v[36:39], a[232:235], a[180:183], v[36:39]
    ds_read_b64_tr_b16 a[206:207], v219 offset:51200
    v_mul_f32 v198, v198, v209
    v_mfma_f32_16x16x32_bf16 v[40:43], a[232:235], a[184:187], v[40:43]
    ds_read_b64_tr_b16 a[220:221], v219 offset:53248
    v_mul_f32 v202, v202, v210
    v_mfma_f32_16x16x32_bf16 v[44:47], a[232:235], a[188:191], v[44:47]
    ds_read_b64_tr_b16 a[222:223], v219 offset:55296
    v_mul_f32 v206, v206, v211
    v_mfma_f32_16x16x32_bf16 v[108:111], a[248:251], a[188:191], v[108:111]
    buffer_load_dwordx4 a[144:147], v220, s[16:19], s23 offen offset:3072 sc1
    v_mfma_f32_16x16x32_bf16 v[104:107], a[248:251], a[184:187], v[104:107]
    v_max_f32 v193, v194, v193
    v_max_f32 v197, v198, v197
    v_mfma_f32_16x16x32_bf16 v[100:103], a[248:251], a[180:183], v[100:103]
    v_max_f32 v201, v202, v201
    v_max_f32 v205, v206, v205
    v_mfma_f32_16x16x32_bf16 v[96:99], a[248:251], a[176:179], v[96:99]
    v_add_f32 v193, 0x3727c5ac, v193
    v_add_f32 v197, 0x3727c5ac, v197
    v_mfma_f32_16x16x32_bf16 v[48:51], a[236:239], a[176:179], v[48:51]
    buffer_load_dwordx4 a[148:151], v221, s[16:19], s23 offen offset:3072 sc1
    v_mfma_f32_16x16x32_bf16 v[52:55], a[236:239], a[180:183], v[52:55]
    v_add_f32 v201, 0x3727c5ac, v201
    v_add_f32 v205, 0x3727c5ac, v205
    v_mfma_f32_16x16x32_bf16 v[56:59], a[236:239], a[184:187], v[56:59]
    v_sqrt_f32 v212, v193
    v_mfma_f32_16x16x32_bf16 v[60:63], a[236:239], a[188:191], v[60:63]
    v_sqrt_f32 v213, v197
    v_mfma_f32_16x16x32_bf16 v[124:127], a[252:255], a[188:191], v[124:127]
    buffer_load_dwordx4 a[32:35], v249, s[16:19], s81 offen offset:3072 sc1
    v_mfma_f32_16x16x32_bf16 v[120:123], a[252:255], a[184:187], v[120:123]
    v_sqrt_f32 v214, v201
    v_mfma_f32_16x16x32_bf16 v[116:119], a[252:255], a[180:183], v[116:119]
    v_sqrt_f32 v215, v205
    v_mfma_f32_16x16x32_bf16 v[112:115], a[252:255], a[176:179], v[112:115]
    s_waitcnt vmcnt(22) lgkmcnt(0)
    v_mfma_f32_16x16x32_bf16 v[0:3], a[192:195], a[64:67], v[0:3]
    ds_read_b64_tr_b16 a[224:225], v216 offset:57344
    ds_read_b64_tr_b16 a[226:227], v216 offset:59392
    v_mfma_f32_16x16x32_bf16 v[4:7], a[192:195], a[68:71], v[4:7]
    ds_read_b64_tr_b16 a[240:241], v216 offset:61440
    ds_read_b64_tr_b16 a[242:243], v216 offset:63488
    v_mfma_f32_16x16x32_bf16 v[8:11], a[192:195], a[72:75], v[8:11]
    ds_read_b64_tr_b16 a[228:229], v217 offset:57344
    ds_read_b64_tr_b16 a[230:231], v217 offset:59392
    v_mfma_f32_16x16x32_bf16 v[12:15], a[192:195], a[76:79], v[12:15]
    buffer_load_dwordx4 a[152:155], v222, s[16:19], s23 offen offset:3072 sc1
    v_mfma_f32_16x16x32_bf16 v[76:79], a[208:211], a[76:79], v[76:79]
    ds_read_b64_tr_b16 a[244:245], v217 offset:61440
    ds_read_b64_tr_b16 a[246:247], v217 offset:63488
    v_mfma_f32_16x16x32_bf16 v[72:75], a[208:211], a[72:75], v[72:75]
    ds_read_b64_tr_b16 a[232:233], v218 offset:57344
    ds_read_b64_tr_b16 a[234:235], v218 offset:59392
    v_mfma_f32_16x16x32_bf16 v[68:71], a[208:211], a[68:71], v[68:71]
    ds_read_b64_tr_b16 a[248:249], v218 offset:61440
    ds_read_b64_tr_b16 a[250:251], v218 offset:63488
    v_mfma_f32_16x16x32_bf16 v[64:67], a[208:211], a[64:67], v[64:67]
    buffer_load_dwordx4 a[156:159], v223, s[16:19], s23 offen offset:3072 sc1
    v_mfma_f32_16x16x32_bf16 v[16:19], a[196:199], a[64:67], v[16:19]
    ds_read_b64_tr_b16 a[236:237], v219 offset:57344
    ds_read_b64_tr_b16 a[238:239], v219 offset:59392
    v_mfma_f32_16x16x32_bf16 v[20:23], a[196:199], a[68:71], v[20:23]
    ds_read_b64_tr_b16 a[252:253], v219 offset:61440
    ds_read_b64_tr_b16 a[254:255], v219 offset:63488
    v_mfma_f32_16x16x32_bf16 v[24:27], a[196:199], a[72:75], v[24:27]
    s_add_u32 s23, s20, 12288
    v_fmac_f32 v0, v208, v128
    v_fmac_f32 v1, v208, v129
    v_fmac_f32 v2, v208, v130
    v_mfma_f32_16x16x32_bf16 v[28:31], a[196:199], a[76:79], v[28:31]
    buffer_load_dwordx4 a[160:163], v220, s[16:19], s23 offen offset:0 sc1
    v_mfma_f32_16x16x32_bf16 v[92:95], a[212:215], a[76:79], v[92:95]
    v_fmac_f32 v3, v208, v131
    v_fmac_f32 v0, v212, v132
    v_mfma_f32_16x16x32_bf16 v[88:91], a[212:215], a[72:75], v[88:91]
    v_fmac_f32 v1, v212, v133
    v_fmac_f32 v2, v212, v134
    v_mfma_f32_16x16x32_bf16 v[84:87], a[212:215], a[68:71], v[84:87]
    v_fmac_f32 v3, v212, v135
    v_fmac_f32 v4, v209, v128
    v_mfma_f32_16x16x32_bf16 v[80:83], a[212:215], a[64:67], v[80:83]
    buffer_load_dwordx4 a[164:167], v221, s[16:19], s23 offen offset:0 sc1
    v_mfma_f32_16x16x32_bf16 v[32:35], a[200:203], a[64:67], v[32:35]
    v_fmac_f32 v5, v209, v129
    v_fmac_f32 v6, v209, v130
    v_mfma_f32_16x16x32_bf16 v[36:39], a[200:203], a[68:71], v[36:39]
    v_fmac_f32 v7, v209, v131
    v_fmac_f32 v4, v213, v132
    v_mfma_f32_16x16x32_bf16 v[40:43], a[200:203], a[72:75], v[40:43]
    v_fmac_f32 v5, v213, v133
    v_fmac_f32 v6, v213, v134
    v_mfma_f32_16x16x32_bf16 v[44:47], a[200:203], a[76:79], v[44:47]
    v_fmac_f32 v7, v213, v135
    v_fmac_f32 v8, v210, v128
    v_mfma_f32_16x16x32_bf16 v[108:111], a[216:219], a[76:79], v[108:111]
    buffer_load_dwordx4 a[168:171], v222, s[16:19], s23 offen offset:0 sc1
    v_mfma_f32_16x16x32_bf16 v[104:107], a[216:219], a[72:75], v[104:107]
    v_fmac_f32 v9, v210, v129
    v_fmac_f32 v10, v210, v130
    v_fmac_f32 v11, v210, v131
    v_mfma_f32_16x16x32_bf16 v[100:103], a[216:219], a[68:71], v[100:103]
    v_fmac_f32 v8, v214, v132
    v_fmac_f32 v9, v214, v133
    v_mfma_f32_16x16x32_bf16 v[96:99], a[216:219], a[64:67], v[96:99]
    v_fmac_f32 v10, v214, v134
    v_fmac_f32 v11, v214, v135
    v_mfma_f32_16x16x32_bf16 v[48:51], a[204:207], a[64:67], v[48:51]
    buffer_load_dwordx4 a[172:175], v223, s[16:19], s23 offen offset:0 sc1
    v_mfma_f32_16x16x32_bf16 v[52:55], a[204:207], a[68:71], v[52:55]
    v_fmac_f32 v12, v211, v128
    v_fmac_f32 v13, v211, v129
    v_mfma_f32_16x16x32_bf16 v[56:59], a[204:207], a[72:75], v[56:59]
    v_fmac_f32 v14, v211, v130
    v_fmac_f32 v15, v211, v131
    v_mfma_f32_16x16x32_bf16 v[60:63], a[204:207], a[76:79], v[60:63]
    s_add_u32 s81, s81, s79
    v_fmac_f32 v12, v215, v132
    v_fmac_f32 v13, v215, v133
    v_mfma_f32_16x16x32_bf16 v[124:127], a[220:223], a[76:79], v[124:127]
    buffer_load_dwordx4 a[36:39], v249, s[16:19], s81 offen offset:0 sc1
    v_mfma_f32_16x16x32_bf16 v[120:123], a[220:223], a[72:75], v[120:123]
    v_fmac_f32 v14, v215, v134
    v_fmac_f32 v15, v215, v135
    v_mfma_f32_16x16x32_bf16 v[116:119], a[220:223], a[68:71], v[116:119]
    v_subrev_u32 v216, 0x18000, v216
    v_subrev_u32 v217, 0x18000, v217
    v_mfma_f32_16x16x32_bf16 v[112:115], a[220:223], a[64:67], v[112:115]
    s_waitcnt vmcnt(24) lgkmcnt(0)
    v_subrev_u32 v218, 0x18000, v218
    v_subrev_u32 v219, 0x18000, v219
    v_mfma_f32_16x16x32_bf16 v[64:67], a[240:243], a[80:83], v[64:67]
    ds_read_b64_tr_b16 a[192:193], v216 offset:0
    ds_read_b64_tr_b16 a[194:195], v216 offset:2048
    v_mfma_f32_16x16x32_bf16 v[68:71], a[240:243], a[84:87], v[68:71]
    ds_read_b64_tr_b16 a[208:209], v216 offset:4096
    ds_read_b64_tr_b16 a[210:211], v216 offset:6144
    v_mfma_f32_16x16x32_bf16 v[72:75], a[240:243], a[88:91], v[72:75]
    ds_read_b64_tr_b16 a[196:197], v217 offset:0
    ds_read_b64_tr_b16 a[198:199], v217 offset:2048
    v_mfma_f32_16x16x32_bf16 v[76:79], a[240:243], a[92:95], v[76:79]
    buffer_load_dwordx4 a[176:179], v220, s[16:19], s23 offen offset:1024 sc1
    v_mfma_f32_16x16x32_bf16 v[28:31], a[228:231], a[92:95], v[28:31]
    ds_read_b64_tr_b16 a[212:213], v217 offset:4096
    ds_read_b64_tr_b16 a[214:215], v217 offset:6144
    v_mfma_f32_16x16x32_bf16 v[24:27], a[228:231], a[88:91], v[24:27]
    ds_read_b64_tr_b16 a[200:201], v218 offset:0
    ds_read_b64_tr_b16 a[202:203], v218 offset:2048
    v_mfma_f32_16x16x32_bf16 v[20:23], a[228:231], a[84:87], v[20:23]
    ds_read_b64_tr_b16 a[216:217], v218 offset:4096
    ds_read_b64_tr_b16 a[218:219], v218 offset:6144
    v_mfma_f32_16x16x32_bf16 v[16:19], a[228:231], a[80:83], v[16:19]
    buffer_load_dwordx4 a[180:183], v221, s[16:19], s23 offen offset:1024 sc1
    v_mfma_f32_16x16x32_bf16 v[80:83], a[244:247], a[80:83], v[80:83]
    ds_read_b64_tr_b16 a[204:205], v219 offset:0
    ds_read_b64_tr_b16 a[206:207], v219 offset:2048
    v_mfma_f32_16x16x32_bf16 v[84:87], a[244:247], a[84:87], v[84:87]
    ds_read_b64_tr_b16 a[220:221], v219 offset:4096
    ds_read_b64_tr_b16 a[222:223], v219 offset:6144
    v_mfma_f32_16x16x32_bf16 v[88:91], a[244:247], a[88:91], v[88:91]
    v_fmac_f32 v64, v208, v136
    v_fmac_f32 v65, v208, v137
    v_mfma_f32_16x16x32_bf16 v[92:95], a[244:247], a[92:95], v[92:95]
    buffer_load_dwordx4 a[184:187], v222, s[16:19], s23 offen offset:1024 sc1
    v_mfma_f32_16x16x32_bf16 v[44:47], a[232:235], a[92:95], v[44:47]
    v_fmac_f32 v66, v208, v138
    v_fmac_f32 v67, v208, v139
    v_mfma_f32_16x16x32_bf16 v[40:43], a[232:235], a[88:91], v[40:43]
    v_fmac_f32 v64, v212, v140
    v_fmac_f32 v65, v212, v141
    v_mfma_f32_16x16x32_bf16 v[36:39], a[232:235], a[84:87], v[36:39]
    v_fmac_f32 v66, v212, v142
    v_fmac_f32 v67, v212, v143
    v_mfma_f32_16x16x32_bf16 v[32:35], a[232:235], a[80:83], v[32:35]
    buffer_load_dwordx4 a[188:191], v223, s[16:19], s23 offen offset:1024 sc1
    v_mfma_f32_16x16x32_bf16 v[96:99], a[248:251], a[80:83], v[96:99]
    v_fmac_f32 v68, v209, v136
    v_fmac_f32 v69, v209, v137
    v_mfma_f32_16x16x32_bf16 v[100:103], a[248:251], a[84:87], v[100:103]
    v_fmac_f32 v70, v209, v138
    v_fmac_f32 v71, v209, v139
    v_mfma_f32_16x16x32_bf16 v[104:107], a[248:251], a[88:91], v[104:107]
    v_fmac_f32 v68, v213, v140
    v_fmac_f32 v69, v213, v141
    v_mfma_f32_16x16x32_bf16 v[108:111], a[248:251], a[92:95], v[108:111]
    v_fmac_f32 v70, v213, v142
    v_fmac_f32 v71, v213, v143
    v_mfma_f32_16x16x32_bf16 v[60:63], a[236:239], a[92:95], v[60:63]
    buffer_load_dwordx4 a[64:67], v220, s[16:19], s23 offen offset:2048 sc1
    v_mfma_f32_16x16x32_bf16 v[56:59], a[236:239], a[88:91], v[56:59]
    v_fmac_f32 v72, v210, v136
    v_fmac_f32 v73, v210, v137
    v_mfma_f32_16x16x32_bf16 v[52:55], a[236:239], a[84:87], v[52:55]
    v_fmac_f32 v74, v210, v138
    v_fmac_f32 v75, v210, v139
    v_mfma_f32_16x16x32_bf16 v[48:51], a[236:239], a[80:83], v[48:51]
    v_fmac_f32 v72, v214, v140
    v_fmac_f32 v73, v214, v141
    v_mfma_f32_16x16x32_bf16 v[112:115], a[252:255], a[80:83], v[112:115]
    buffer_load_dwordx4 a[68:71], v221, s[16:19], s23 offen offset:2048 sc1
    v_mfma_f32_16x16x32_bf16 v[116:119], a[252:255], a[84:87], v[116:119]
    v_fmac_f32 v74, v214, v142
    v_fmac_f32 v75, v214, v143
    v_mfma_f32_16x16x32_bf16 v[120:123], a[252:255], a[88:91], v[120:123]
    v_fmac_f32 v76, v211, v136
    v_fmac_f32 v77, v211, v137
    v_mfma_f32_16x16x32_bf16 v[124:127], a[252:255], a[92:95], v[124:127]
    s_add_u32 s81, s51, 327680
    v_fmac_f32 v78, v211, v138
    v_fmac_f32 v79, v211, v139
    v_mfma_f32_16x16x32_bf16 v[12:15], a[224:227], a[92:95], v[12:15]
    buffer_load_dwordx4 a[40:43], v249, s[16:19], s81 offen offset:0 sc1
    v_mfma_f32_16x16x32_bf16 v[8:11], a[224:227], a[88:91], v[8:11]
    v_fmac_f32 v76, v215, v140
    v_fmac_f32 v77, v215, v141
    v_mfma_f32_16x16x32_bf16 v[4:7], a[224:227], a[84:87], v[4:7]
    v_fmac_f32 v78, v215, v142
    v_fmac_f32 v79, v215, v143
    v_mfma_f32_16x16x32_bf16 v[0:3], a[224:227], a[80:83], v[0:3]
    s_waitcnt vmcnt(26) lgkmcnt(0)
    v_mfma_f32_16x16x32_bf16 v[16:19], a[196:199], a[96:99], v[16:19]
    ds_read_b64_tr_b16 a[224:225], v216 offset:8192
    ds_read_b64_tr_b16 a[226:227], v216 offset:10240
    v_mfma_f32_16x16x32_bf16 v[20:23], a[196:199], a[100:103], v[20:23]
    ds_read_b64_tr_b16 a[240:241], v216 offset:12288
    ds_read_b64_tr_b16 a[242:243], v216 offset:14336
    v_mfma_f32_16x16x32_bf16 v[24:27], a[196:199], a[104:107], v[24:27]
    ds_read_b64_tr_b16 a[228:229], v217 offset:8192
    ds_read_b64_tr_b16 a[230:231], v217 offset:10240
    v_mfma_f32_16x16x32_bf16 v[28:31], a[196:199], a[108:111], v[28:31]
    buffer_load_dwordx4 a[72:75], v222, s[16:19], s23 offen offset:2048 sc1
    v_mfma_f32_16x16x32_bf16 v[92:95], a[212:215], a[108:111], v[92:95]
    ds_read_b64_tr_b16 a[244:245], v217 offset:12288
    ds_read_b64_tr_b16 a[246:247], v217 offset:14336
    v_mfma_f32_16x16x32_bf16 v[88:91], a[212:215], a[104:107], v[88:91]
    ds_read_b64_tr_b16 a[232:233], v218 offset:8192
    ds_read_b64_tr_b16 a[234:235], v218 offset:10240
    v_mfma_f32_16x16x32_bf16 v[84:87], a[212:215], a[100:103], v[84:87]
    ds_read_b64_tr_b16 a[248:249], v218 offset:12288
    ds_read_b64_tr_b16 a[250:251], v218 offset:14336
    v_mfma_f32_16x16x32_bf16 v[80:83], a[212:215], a[96:99], v[80:83]
    buffer_load_dwordx4 a[76:79], v223, s[16:19], s23 offen offset:2048 sc1
    v_mfma_f32_16x16x32_bf16 v[32:35], a[200:203], a[96:99], v[32:35]
    ds_read_b64_tr_b16 a[236:237], v219 offset:8192
    ds_read_b64_tr_b16 a[238:239], v219 offset:10240
    v_mfma_f32_16x16x32_bf16 v[36:39], a[200:203], a[100:103], v[36:39]
    ds_read_b64_tr_b16 a[252:253], v219 offset:12288
    ds_read_b64_tr_b16 a[254:255], v219 offset:14336
    v_mfma_f32_16x16x32_bf16 v[40:43], a[200:203], a[104:107], v[40:43]
    v_fmac_f32 v16, v208, v144
    v_fmac_f32 v17, v208, v145
    v_mfma_f32_16x16x32_bf16 v[44:47], a[200:203], a[108:111], v[44:47]
    buffer_load_dwordx4 a[80:83], v220, s[16:19], s23 offen offset:3072 sc1
    v_mfma_f32_16x16x32_bf16 v[108:111], a[216:219], a[108:111], v[108:111]
    v_fmac_f32 v18, v208, v146
    v_fmac_f32 v19, v208, v147
    v_mfma_f32_16x16x32_bf16 v[104:107], a[216:219], a[104:107], v[104:107]
    v_fmac_f32 v16, v212, v148
    v_fmac_f32 v17, v212, v149
    v_mfma_f32_16x16x32_bf16 v[100:103], a[216:219], a[100:103], v[100:103]
    v_fmac_f32 v18, v212, v150
    v_fmac_f32 v19, v212, v151
    v_mfma_f32_16x16x32_bf16 v[96:99], a[216:219], a[96:99], v[96:99]
    buffer_load_dwordx4 a[84:87], v221, s[16:19], s23 offen offset:3072 sc1
    v_mfma_f32_16x16x32_bf16 v[48:51], a[204:207], a[96:99], v[48:51]
HOP1_4:
    s_cbranch_execz HOPRET1
    v_fmac_f32 v20, v209, v144
    v_fmac_f32 v21, v209, v145
    v_mfma_f32_16x16x32_bf16 v[52:55], a[204:207], a[100:103], v[52:55]
    v_fmac_f32 v22, v209, v146
    v_fmac_f32 v23, v209, v147
    v_mfma_f32_16x16x32_bf16 v[56:59], a[204:207], a[104:107], v[56:59]
    v_fmac_f32 v20, v213, v148
    v_fmac_f32 v21, v213, v149
    v_mfma_f32_16x16x32_bf16 v[60:63], a[204:207], a[108:111], v[60:63]
    v_fmac_f32 v22, v213, v150
    v_fmac_f32 v23, v213, v151
    v_mfma_f32_16x16x32_bf16 v[124:127], a[220:223], a[108:111], v[124:127]
    buffer_load_dwordx4 a[88:91], v222, s[16:19], s23 offen offset:3072 sc1
    v_mfma_f32_16x16x32_bf16 v[120:123], a[220:223], a[104:107], v[120:123]
    v_fmac_f32 v24, v210, v144
    v_fmac_f32 v25, v210, v145
    v_mfma_f32_16x16x32_bf16 v[116:119], a[220:223], a[100:103], v[116:119]
    v_fmac_f32 v26, v210, v146
    v_fmac_f32 v27, v210, v147
    v_mfma_f32_16x16x32_bf16 v[112:115], a[220:223], a[96:99], v[112:115]
    v_fmac_f32 v24, v214, v148
    v_fmac_f32 v25, v214, v149
    v_mfma_f32_16x16x32_bf16 v[0:3], a[192:195], a[96:99], v[0:3]
    buffer_load_dwordx4 a[92:95], v223, s[16:19], s23 offen offset:3072 sc1
    v_mfma_f32_16x16x32_bf16 v[4:7], a[192:195], a[100:103], v[4:7]
    v_fmac_f32 v26, v214, v150
    v_fmac_f32 v27, v214, v151
    v_mfma_f32_16x16x32_bf16 v[8:11], a[192:195], a[104:107], v[8:11]
    v_fmac_f32 v28, v211, v144
    v_fmac_f32 v29, v211, v145
    v_mfma_f32_16x16x32_bf16 v[12:15], a[192:195], a[108:111], v[12:15]
    v_fmac_f32 v30, v211, v146
    v_fmac_f32 v31, v211, v147
    v_mfma_f32_16x16x32_bf16 v[76:79], a[208:211], a[108:111], v[76:79]
    buffer_load_dwordx4 a[44:47], v249, s[16:19], s81 offen offset:1024 sc1
    v_mfma_f32_16x16x32_bf16 v[72:75], a[208:211], a[104:107], v[72:75]
    v_fmac_f32 v28, v215, v148
    v_fmac_f32 v29, v215, v149
    v_mfma_f32_16x16x32_bf16 v[68:71], a[208:211], a[100:103], v[68:71]
    v_fmac_f32 v30, v215, v150
    v_fmac_f32 v31, v215, v151
    v_mfma_f32_16x16x32_bf16 v[64:67], a[208:211], a[96:99], v[64:67]
    s_waitcnt vmcnt(29) lgkmcnt(0)
    v_mfma_f32_16x16x32_bf16 v[80:83], a[244:247], a[112:115], v[80:83]
    ds_read_b64_tr_b16 a[192:193], v216 offset:16384
    ds_read_b64_tr_b16 a[194:195], v216 offset:18432
    v_mfma_f32_16x16x32_bf16 v[84:87], a[244:247], a[116:119], v[84:87]
    ds_read_b64_tr_b16 a[208:209], v216 offset:20480
    ds_read_b64_tr_b16 a[210:211], v216 offset:22528
    v_mfma_f32_16x16x32_bf16 v[88:91], a[244:247], a[120:123], v[88:91]
    s_add_u32 s23, s20, 16384
    ds_read_b64_tr_b16 a[196:197], v217 offset:16384
    ds_read_b64_tr_b16 a[198:199], v217 offset:18432
    v_mfma_f32_16x16x32_bf16 v[92:95], a[244:247], a[124:127], v[92:95]
    buffer_load_dwordx4 a[96:99], v220, s[16:19], s23 offen offset:0 sc1
    v_mfma_f32_16x16x32_bf16 v[44:47], a[232:235], a[124:127], v[44:47]
    ds_read_b64_tr_b16 a[212:213], v217 offset:20480
    ds_read_b64_tr_b16 a[214:215], v217 offset:22528
    v_mfma_f32_16x16x32_bf16 v[40:43], a[232:235], a[120:123], v[40:43]
    ds_read_b64_tr_b16 a[200:201], v218 offset:16384
    ds_read_b64_tr_b16 a[202:203], v218 offset:18432
    v_mfma_f32_16x16x32_bf16 v[36:39], a[232:235], a[116:119], v[36:39]
    ds_read_b64_tr_b16 a[216:217], v218 offset:20480
    ds_read_b64_tr_b16 a[218:219], v218 offset:22528
    v_mfma_f32_16x16x32_bf16 v[32:35], a[232:235], a[112:115], v[32:35]
    buffer_load_dwordx4 a[100:103], v221, s[16:19], s23 offen offset:0 sc1
    v_mfma_f32_16x16x32_bf16 v[96:99], a[248:251], a[112:115], v[96:99]
    ds_read_b64_tr_b16 a[204:205], v219 offset:16384
    ds_read_b64_tr_b16 a[206:207], v219 offset:18432
    v_mfma_f32_16x16x32_bf16 v[100:103], a[248:251], a[116:119], v[100:103]
    ds_read_b64_tr_b16 a[220:221], v219 offset:20480
    ds_read_b64_tr_b16 a[222:223], v219 offset:22528
    v_mfma_f32_16x16x32_bf16 v[104:107], a[248:251], a[120:123], v[104:107]
    v_fmac_f32 v80, v208, v152
    v_fmac_f32 v81, v208, v153
    v_mfma_f32_16x16x32_bf16 v[108:111], a[248:251], a[124:127], v[108:111]
    buffer_load_dwordx4 a[104:107], v222, s[16:19], s23 offen offset:0 sc1
    v_mfma_f32_16x16x32_bf16 v[60:63], a[236:239], a[124:127], v[60:63]
    v_fmac_f32 v82, v208, v154
    v_fmac_f32 v83, v208, v155
    v_mfma_f32_16x16x32_bf16 v[56:59], a[236:239], a[120:123], v[56:59]
    v_fmac_f32 v80, v212, v156
    v_fmac_f32 v81, v212, v157
    v_mfma_f32_16x16x32_bf16 v[52:55], a[236:239], a[116:119], v[52:55]
    v_fmac_f32 v82, v212, v158
    v_fmac_f32 v83, v212, v159
    v_mfma_f32_16x16x32_bf16 v[48:51], a[236:239], a[112:115], v[48:51]
    buffer_load_dwordx4 a[108:111], v223, s[16:19], s23 offen offset:0 sc1
    v_mfma_f32_16x16x32_bf16 v[112:115], a[252:255], a[112:115], v[112:115]
    v_fmac_f32 v84, v209, v152
    v_fmac_f32 v85, v209, v153
    v_mfma_f32_16x16x32_bf16 v[116:119], a[252:255], a[116:119], v[116:119]
    v_fmac_f32 v86, v209, v154
    v_fmac_f32 v87, v209, v155
    v_mfma_f32_16x16x32_bf16 v[120:123], a[252:255], a[120:123], v[120:123]
    v_fmac_f32 v84, v213, v156
    v_fmac_f32 v85, v213, v157
    v_mfma_f32_16x16x32_bf16 v[124:127], a[252:255], a[124:127], v[124:127]
    v_fmac_f32 v86, v213, v158
    v_fmac_f32 v87, v213, v159
    v_mfma_f32_16x16x32_bf16 v[12:15], a[224:227], a[124:127], v[12:15]
    buffer_load_dwordx4 a[48:51], v249, s[16:19], s81 offen offset:2048 sc1
    v_mfma_f32_16x16x32_bf16 v[8:11], a[224:227], a[120:123], v[8:11]
    v_fmac_f32 v88, v210, v152
    v_fmac_f32 v89, v210, v153
    v_mfma_f32_16x16x32_bf16 v[4:7], a[224:227], a[116:119], v[4:7]
    v_fmac_f32 v90, v210, v154
    v_fmac_f32 v91, v210, v155
    v_mfma_f32_16x16x32_bf16 v[0:3], a[224:227], a[112:115], v[0:3]
    v_fmac_f32 v88, v214, v156
    v_fmac_f32 v89, v214, v157
    v_mfma_f32_16x16x32_bf16 v[64:67], a[240:243], a[112:115], v[64:67]
    buffer_load_dwordx4 a[52:55], v249, s[16:19], s81 offen offset:3072 sc1
    v_mfma_f32_16x16x32_bf16 v[68:71], a[240:243], a[116:119], v[68:71]
    v_fmac_f32 v90, v214, v158
    v_fmac_f32 v91, v214, v159
    v_mfma_f32_16x16x32_bf16 v[72:75], a[240:243], a[120:123], v[72:75]
    v_fmac_f32 v92, v211, v152
    v_fmac_f32 v93, v211, v153
    v_mfma_f32_16x16x32_bf16 v[76:79], a[240:243], a[124:127], v[76:79]
    s_add_u32 s81, s81, s79
    v_fmac_f32 v94, v211, v154
    v_fmac_f32 v95, v211, v155
    v_mfma_f32_16x16x32_bf16 v[28:31], a[228:231], a[124:127], v[28:31]
    buffer_load_dwordx4 a[56:59], v249, s[16:19], s81 offen offset:0 sc1
    v_mfma_f32_16x16x32_bf16 v[24:27], a[228:231], a[120:123], v[24:27]
    v_fmac_f32 v92, v215, v156
    v_fmac_f32 v93, v215, v157
    v_mfma_f32_16x16x32_bf16 v[20:23], a[228:231], a[116:119], v[20:23]
    v_fmac_f32 v94, v215, v158
    v_fmac_f32 v95, v215, v159
    v_mfma_f32_16x16x32_bf16 v[16:19], a[228:231], a[112:115], v[16:19]
    s_waitcnt vmcnt(31) lgkmcnt(0)
    v_mfma_f32_16x16x32_bf16 v[32:35], a[200:203], a[128:131], v[32:35]
    ds_read_b64_tr_b16 a[224:225], v216 offset:24576
    ds_read_b64_tr_b16 a[226:227], v216 offset:26624
    v_mfma_f32_16x16x32_bf16 v[36:39], a[200:203], a[132:135], v[36:39]
    ds_read_b64_tr_b16 a[240:241], v216 offset:28672
    ds_read_b64_tr_b16 a[242:243], v216 offset:30720
    v_mfma_f32_16x16x32_bf16 v[40:43], a[200:203], a[136:139], v[40:43]
    ds_read_b64_tr_b16 a[228:229], v217 offset:24576
    ds_read_b64_tr_b16 a[230:231], v217 offset:26624
    v_mfma_f32_16x16x32_bf16 v[44:47], a[200:203], a[140:143], v[44:47]
    buffer_load_dwordx4 a[112:115], v220, s[16:19], s23 offen offset:1024 sc1
    v_mfma_f32_16x16x32_bf16 v[108:111], a[216:219], a[140:143], v[108:111]
    ds_read_b64_tr_b16 a[244:245], v217 offset:28672
    ds_read_b64_tr_b16 a[246:247], v217 offset:30720
    v_mfma_f32_16x16x32_bf16 v[104:107], a[216:219], a[136:139], v[104:107]
    ds_read_b64_tr_b16 a[232:233], v218 offset:24576
    ds_read_b64_tr_b16 a[234:235], v218 offset:26624
    v_mfma_f32_16x16x32_bf16 v[100:103], a[216:219], a[132:135], v[100:103]
    ds_read_b64_tr_b16 a[248:249], v218 offset:28672
    ds_read_b64_tr_b16 a[250:251], v218 offset:30720
    v_mfma_f32_16x16x32_bf16 v[96:99], a[216:219], a[128:131], v[96:99]
    buffer_load_dwordx4 a[116:119], v221, s[16:19], s23 offen offset:1024 sc1
    v_mfma_f32_16x16x32_bf16 v[48:51], a[204:207], a[128:131], v[48:51]
    ds_read_b64_tr_b16 a[236:237], v219 offset:24576
    ds_read_b64_tr_b16 a[238:239], v219 offset:26624
    v_mfma_f32_16x16x32_bf16 v[52:55], a[204:207], a[132:135], v[52:55]
    ds_read_b64_tr_b16 a[252:253], v219 offset:28672
    ds_read_b64_tr_b16 a[254:255], v219 offset:30720
    v_mfma_f32_16x16x32_bf16 v[56:59], a[204:207], a[136:139], v[56:59]
    v_fmac_f32 v32, v208, v160
    v_fmac_f32 v33, v208, v161
    v_mfma_f32_16x16x32_bf16 v[60:63], a[204:207], a[140:143], v[60:63]
    buffer_load_dwordx4 a[120:123], v222, s[16:19], s23 offen offset:1024 sc1
    v_mfma_f32_16x16x32_bf16 v[124:127], a[220:223], a[140:143], v[124:127]
    v_fmac_f32 v34, v208, v162
    v_fmac_f32 v35, v208, v163
    v_mfma_f32_16x16x32_bf16 v[120:123], a[220:223], a[136:139], v[120:123]
    v_fmac_f32 v32, v212, v164
    v_fmac_f32 v33, v212, v165
    v_mfma_f32_16x16x32_bf16 v[116:119], a[220:223], a[132:135], v[116:119]
    v_fmac_f32 v34, v212, v166
    v_fmac_f32 v35, v212, v167
    v_mfma_f32_16x16x32_bf16 v[112:115], a[220:223], a[128:131], v[112:115]
    buffer_load_dwordx4 a[124:127], v223, s[16:19], s23 offen offset:1024 sc1
    v_mfma_f32_16x16x32_bf16 v[0:3], a[192:195], a[128:131], v[0:3]
    v_fmac_f32 v36, v209, v160
    v_fmac_f32 v37, v209, v161
    v_mfma_f32_16x16x32_bf16 v[4:7], a[192:195], a[132:135], v[4:7]
    v_fmac_f32 v38, v209, v162
    v_fmac_f32 v39, v209, v163
    v_mfma_f32_16x16x32_bf16 v[8:11], a[192:195], a[136:139], v[8:11]
    v_fmac_f32 v36, v213, v164
    v_fmac_f32 v37, v213, v165
    v_mfma_f32_16x16x32_bf16 v[12:15], a[192:195], a[140:143], v[12:15]
    s_add_u32 s81, s51, 655360
    v_fmac_f32 v38, v213, v166
    v_fmac_f32 v39, v213, v167
    v_mfma_f32_16x16x32_bf16 v[76:79], a[208:211], a[140:143], v[76:79]
    buffer_load_dwordx4 v[128:131], v249, s[16:19], s81 offen offset:0 sc1
    v_mfma_f32_16x16x32_bf16 v[72:75], a[208:211], a[136:139], v[72:75]
    v_fmac_f32 v40, v210, v160
    v_fmac_f32 v41, v210, v161
    v_mfma_f32_16x16x32_bf16 v[68:71], a[208:211], a[132:135], v[68:71]
    v_fmac_f32 v42, v210, v162
    v_fmac_f32 v43, v210, v163
    v_mfma_f32_16x16x32_bf16 v[64:67], a[208:211], a[128:131], v[64:67]
    v_fmac_f32 v40, v214, v164
    v_fmac_f32 v41, v214, v165
    v_mfma_f32_16x16x32_bf16 v[16:19], a[196:199], a[128:131], v[16:19]
    buffer_load_dwordx4 v[132:135], v249, s[16:19], s81 offen offset:1024 sc1
    v_mfma_f32_16x16x32_bf16 v[20:23], a[196:199], a[132:135], v[20:23]
    v_fmac_f32 v42, v214, v166
    v_fmac_f32 v43, v214, v167
    v_mfma_f32_16x16x32_bf16 v[24:27], a[196:199], a[136:139], v[24:27]
    v_fmac_f32 v44, v211, v160
    v_fmac_f32 v45, v211, v161
    v_mfma_f32_16x16x32_bf16 v[28:31], a[196:199], a[140:143], v[28:31]
    v_fmac_f32 v46, v211, v162
    v_fmac_f32 v47, v211, v163
    v_mfma_f32_16x16x32_bf16 v[92:95], a[212:215], a[140:143], v[92:95]
    buffer_load_dwordx4 v[136:139], v249, s[16:19], s81 offen offset:2048 sc1
    v_mfma_f32_16x16x32_bf16 v[88:91], a[212:215], a[136:139], v[88:91]
    v_fmac_f32 v44, v215, v164
    v_fmac_f32 v45, v215, v165
    v_mfma_f32_16x16x32_bf16 v[84:87], a[212:215], a[132:135], v[84:87]
    s_waitcnt vmcnt(33) lgkmcnt(0)
    v_fmac_f32 v46, v215, v166
    v_fmac_f32 v47, v215, v167
    v_mfma_f32_16x16x32_bf16 v[80:83], a[212:215], a[128:131], v[80:83]
    s_barrier
    v_mfma_f32_16x16x32_bf16 v[96:99], a[248:251], a[144:147], v[96:99]
    ds_read_b64_tr_b16 a[192:193], v216 offset:32768
    ds_read_b64_tr_b16 a[194:195], v216 offset:34816
    v_mfma_f32_16x16x32_bf16 v[100:103], a[248:251], a[148:151], v[100:103]
    ds_read_b64_tr_b16 a[196:197], v216 offset:40960
    ds_read_b64_tr_b16 a[198:199], v216 offset:43008
    v_mfma_f32_16x16x32_bf16 v[104:107], a[248:251], a[152:155], v[104:107]
    ds_read_b64_tr_b16 a[200:201], v216 offset:36864
    ds_read_b64_tr_b16 a[202:203], v216 offset:38912
    v_mfma_f32_16x16x32_bf16 v[108:111], a[248:251], a[156:159], v[108:111]
    buffer_load_dwordx4 a[128:131], v220, s[16:19], s23 offen offset:2048 sc1
    v_mfma_f32_16x16x32_bf16 v[60:63], a[236:239], a[156:159], v[60:63]
    ds_read_b64_tr_b16 a[204:205], v216 offset:45056
    ds_read_b64_tr_b16 a[206:207], v216 offset:47104
    v_mfma_f32_16x16x32_bf16 v[56:59], a[236:239], a[152:155], v[56:59]
    ds_read_b64_tr_b16 a[208:209], v217 offset:32768
    ds_read_b64_tr_b16 a[210:211], v217 offset:34816
    v_mfma_f32_16x16x32_bf16 v[52:55], a[236:239], a[148:151], v[52:55]
    ds_read_b64_tr_b16 a[212:213], v217 offset:40960
    ds_read_b64_tr_b16 a[214:215], v217 offset:43008
    v_mfma_f32_16x16x32_bf16 v[48:51], a[236:239], a[144:147], v[48:51]
    buffer_load_dwordx4 a[132:135], v221, s[16:19], s23 offen offset:2048 sc1
    v_mfma_f32_16x16x32_bf16 v[112:115], a[252:255], a[144:147], v[112:115]
    ds_read_b64_tr_b16 a[216:217], v217 offset:36864
    ds_read_b64_tr_b16 a[218:219], v217 offset:38912
    v_mfma_f32_16x16x32_bf16 v[116:119], a[252:255], a[148:151], v[116:119]
    ds_read_b64_tr_b16 a[220:221], v217 offset:45056
    ds_read_b64_tr_b16 a[222:223], v217 offset:47104
    v_mfma_f32_16x16x32_bf16 v[120:123], a[252:255], a[152:155], v[120:123]
    v_fmac_f32 v96, v208, v168
    v_fmac_f32 v97, v208, v169
    v_mfma_f32_16x16x32_bf16 v[124:127], a[252:255], a[156:159], v[124:127]
    buffer_load_dwordx4 a[136:139], v222, s[16:19], s23 offen offset:2048 sc1
    v_mfma_f32_16x16x32_bf16 v[12:15], a[224:227], a[156:159], v[12:15]
    v_fmac_f32 v98, v208, v170
    v_fmac_f32 v99, v208, v171
    v_mfma_f32_16x16x32_bf16 v[8:11], a[224:227], a[152:155], v[8:11]
    v_fmac_f32 v96, v212, v172
    v_fmac_f32 v97, v212, v173
    v_mfma_f32_16x16x32_bf16 v[4:7], a[224:227], a[148:151], v[4:7]
    v_fmac_f32 v98, v212, v174
    v_fmac_f32 v99, v212, v175
    v_mfma_f32_16x16x32_bf16 v[0:3], a[224:227], a[144:147], v[0:3]
    buffer_load_dwordx4 a[140:143], v223, s[16:19], s23 offen offset:2048 sc1
    v_mfma_f32_16x16x32_bf16 v[64:67], a[240:243], a[144:147], v[64:67]
    v_fmac_f32 v100, v209, v168
    v_fmac_f32 v101, v209, v169
    v_mfma_f32_16x16x32_bf16 v[68:71], a[240:243], a[148:151], v[68:71]
    v_fmac_f32 v102, v209, v170
    v_fmac_f32 v103, v209, v171
    v_mfma_f32_16x16x32_bf16 v[72:75], a[240:243], a[152:155], v[72:75]
    v_fmac_f32 v100, v213, v172
    v_fmac_f32 v101, v213, v173
    v_mfma_f32_16x16x32_bf16 v[76:79], a[240:243], a[156:159], v[76:79]
    v_fmac_f32 v102, v213, v174
    v_fmac_f32 v103, v213, v175
    v_mfma_f32_16x16x32_bf16 v[28:31], a[228:231], a[156:159], v[28:31]
    buffer_load_dwordx4 v[140:143], v249, s[16:19], s81 offen offset:3072 sc1
    v_mfma_f32_16x16x32_bf16 v[24:27], a[228:231], a[152:155], v[24:27]
    v_fmac_f32 v104, v210, v168
    v_fmac_f32 v105, v210, v169
    v_mfma_f32_16x16x32_bf16 v[20:23], a[228:231], a[148:151], v[20:23]
    v_fmac_f32 v106, v210, v170
    v_fmac_f32 v107, v210, v171
    v_mfma_f32_16x16x32_bf16 v[16:19], a[228:231], a[144:147], v[16:19]
    s_add_u32 s81, s81, s79
    v_fmac_f32 v104, v214, v172
    v_fmac_f32 v105, v214, v173
    v_mfma_f32_16x16x32_bf16 v[80:83], a[244:247], a[144:147], v[80:83]
    buffer_load_dwordx4 v[144:147], v249, s[16:19], s81 offen offset:0 sc1
    v_mfma_f32_16x16x32_bf16 v[84:87], a[244:247], a[148:151], v[84:87]
    v_fmac_f32 v106, v214, v174
    v_fmac_f32 v107, v214, v175
    v_mfma_f32_16x16x32_bf16 v[88:91], a[244:247], a[152:155], v[88:91]
    v_fmac_f32 v108, v211, v168
    v_fmac_f32 v109, v211, v169
    v_mfma_f32_16x16x32_bf16 v[92:95], a[244:247], a[156:159], v[92:95]
    s_add_u32 s81, s51, 983040
    v_fmac_f32 v110, v211, v170
    v_fmac_f32 v111, v211, v171
    v_mfma_f32_16x16x32_bf16 v[44:47], a[232:235], a[156:159], v[44:47]
    buffer_load_dwordx4 v[148:151], v249, s[16:19], s81 offen offset:0 sc1
    v_mfma_f32_16x16x32_bf16 v[40:43], a[232:235], a[152:155], v[40:43]
    v_fmac_f32 v108, v215, v172
    v_fmac_f32 v109, v215, v173
    v_mfma_f32_16x16x32_bf16 v[36:39], a[232:235], a[148:151], v[36:39]
    v_fmac_f32 v110, v215, v174
    v_fmac_f32 v111, v215, v175
    v_mfma_f32_16x16x32_bf16 v[32:35], a[232:235], a[144:147], v[32:35]
    s_waitcnt vmcnt(31) lgkmcnt(0)
    v_mfma_f32_16x16x32_bf16 v[0:3], a[192:195], a[160:163], v[0:3]
    ds_read_b64_tr_b16 a[224:225], v216 offset:49152
    ds_read_b64_tr_b16 a[226:227], v216 offset:51200
    v_mfma_f32_16x16x32_bf16 v[0:3], a[196:199], a[176:179], v[0:3]
    ds_read_b64_tr_b16 a[228:229], v216 offset:57344
    ds_read_b64_tr_b16 a[230:231], v216 offset:59392
    v_mfma_f32_16x16x32_bf16 v[4:7], a[196:199], a[180:183], v[4:7]
    ds_read_b64_tr_b16 a[232:233], v216 offset:53248
    ds_read_b64_tr_b16 a[234:235], v216 offset:55296
    v_mfma_f32_16x16x32_bf16 v[4:7], a[192:195], a[164:167], v[4:7]
    buffer_load_dwordx4 a[144:147], v220, s[16:19], s23 offen offset:3072 sc1
    v_mfma_f32_16x16x32_bf16 v[8:11], a[192:195], a[168:171], v[8:11]
    ds_read_b64_tr_b16 a[236:237], v216 offset:61440
    ds_read_b64_tr_b16 a[238:239], v216 offset:63488
    v_mfma_f32_16x16x32_bf16 v[8:11], a[196:199], a[184:187], v[8:11]
    ds_read_b64_tr_b16 a[240:241], v217 offset:49152
    ds_read_b64_tr_b16 a[242:243], v217 offset:51200
    v_mfma_f32_16x16x32_bf16 v[12:15], a[196:199], a[188:191], v[12:15]
    ds_read_b64_tr_b16 a[244:245], v217 offset:57344
    ds_read_b64_tr_b16 a[246:247], v217 offset:59392
    v_mfma_f32_16x16x32_bf16 v[12:15], a[192:195], a[172:175], v[12:15]
    buffer_load_dwordx4 a[148:151], v221, s[16:19], s23 offen offset:3072 sc1
    v_mfma_f32_16x16x32_bf16 v[76:79], a[200:203], a[172:175], v[76:79]
    ds_read_b64_tr_b16 a[248:249], v217 offset:53248
    ds_read_b64_tr_b16 a[250:251], v217 offset:55296
    v_mfma_f32_16x16x32_bf16 v[76:79], a[204:207], a[188:191], v[76:79]
    ds_read_b64_tr_b16 a[252:253], v217 offset:61440
    ds_read_b64_tr_b16 a[254:255], v217 offset:63488
    v_mfma_f32_16x16x32_bf16 v[72:75], a[204:207], a[184:187], v[72:75]
    v_fmac_f32 v48, v208, v176
    v_fmac_f32 v49, v208, v177
    v_mfma_f32_16x16x32_bf16 v[72:75], a[200:203], a[168:171], v[72:75]
    buffer_load_dwordx4 a[152:155], v222, s[16:19], s23 offen offset:3072 sc1
    v_mfma_f32_16x16x32_bf16 v[68:71], a[200:203], a[164:167], v[68:71]
    v_fmac_f32 v50, v208, v178
    v_fmac_f32 v51, v208, v179
    v_mfma_f32_16x16x32_bf16 v[68:71], a[204:207], a[180:183], v[68:71]
    v_fmac_f32 v48, v212, v180
    v_fmac_f32 v49, v212, v181
    v_mfma_f32_16x16x32_bf16 v[64:67], a[204:207], a[176:179], v[64:67]
    v_fmac_f32 v50, v212, v182
    v_fmac_f32 v51, v212, v183
    v_mfma_f32_16x16x32_bf16 v[64:67], a[200:203], a[160:163], v[64:67]
    buffer_load_dwordx4 a[156:159], v223, s[16:19], s23 offen offset:3072 sc1
    v_mfma_f32_16x16x32_bf16 v[16:19], a[208:211], a[160:163], v[16:19]
    v_fmac_f32 v52, v209, v176
    v_fmac_f32 v53, v209, v177
    v_mfma_f32_16x16x32_bf16 v[16:19], a[212:215], a[176:179], v[16:19]
    v_fmac_f32 v54, v209, v178
    v_fmac_f32 v55, v209, v179
    v_mfma_f32_16x16x32_bf16 v[20:23], a[212:215], a[180:183], v[20:23]
    s_lshr_b32 s3, s37, 2
    v_fmac_f32 v52, v213, v180
    v_fmac_f32 v53, v213, v181
    v_mfma_f32_16x16x32_bf16 v[20:23], a[208:211], a[164:167], v[20:23]
    s_add_u32 m0, s3, 102400
    v_fmac_f32 v54, v213, v182
    v_fmac_f32 v55, v213, v183
    v_mfma_f32_16x16x32_bf16 v[24:27], a[208:211], a[168:171], v[24:27]
    buffer_load_dwordx4 v251, s[16:19], 0 offen sc1 lds
    v_mfma_f32_16x16x32_bf16 v[24:27], a[212:215], a[184:187], v[24:27]
    v_fmac_f32 v56, v210, v176
    v_fmac_f32 v57, v210, v177
    v_mfma_f32_16x16x32_bf16 v[28:31], a[212:215], a[188:191], v[28:31]
    v_fmac_f32 v58, v210, v178
    v_fmac_f32 v59, v210, v179
    v_mfma_f32_16x16x32_bf16 v[28:31], a[208:211], a[172:175], v[28:31]
    v_fmac_f32 v56, v214, v180
    v_fmac_f32 v57, v214, v181
    v_mfma_f32_16x16x32_bf16 v[92:95], a[216:219], a[172:175], v[92:95]
    buffer_load_dwordx4 v[152:155], v249, s[16:19], s81 offen offset:1024 sc1
    v_mfma_f32_16x16x32_bf16 v[92:95], a[220:223], a[188:191], v[92:95]
    v_fmac_f32 v58, v214, v182
    v_fmac_f32 v59, v214, v183
    v_mfma_f32_16x16x32_bf16 v[88:91], a[220:223], a[184:187], v[88:91]
    v_fmac_f32 v60, v211, v176
    v_fmac_f32 v61, v211, v177
    v_mfma_f32_16x16x32_bf16 v[88:91], a[216:219], a[168:171], v[88:91]
    v_fmac_f32 v62, v211, v178
    v_fmac_f32 v63, v211, v179
    v_mfma_f32_16x16x32_bf16 v[84:87], a[216:219], a[164:167], v[84:87]
    buffer_load_dwordx4 v[156:159], v249, s[16:19], s81 offen offset:2048 sc1
    v_mfma_f32_16x16x32_bf16 v[84:87], a[220:223], a[180:183], v[84:87]
    v_fmac_f32 v60, v215, v180
    v_fmac_f32 v61, v215, v181
    v_mfma_f32_16x16x32_bf16 v[80:83], a[220:223], a[176:179], v[80:83]
    v_fmac_f32 v62, v215, v182
    v_fmac_f32 v63, v215, v183
    v_mfma_f32_16x16x32_bf16 v[80:83], a[216:219], a[160:163], v[80:83]
    s_waitcnt vmcnt(29) lgkmcnt(0)
    v_add_u32 v216, 0x10000, v216
    v_add_u32 v217, 0x10000, v217
    v_mfma_f32_16x16x32_bf16 v[0:3], a[224:227], a[64:67], v[0:3]
    ds_read_b64_tr_b16 a[192:193], v216 offset:0
    ds_read_b64_tr_b16 a[194:195], v216 offset:2048
    v_mfma_f32_16x16x32_bf16 v[0:3], a[228:231], a[80:83], v[0:3]
    ds_read_b64_tr_b16 a[196:197], v216 offset:8192
    ds_read_b64_tr_b16 a[198:199], v216 offset:10240
    v_mfma_f32_16x16x32_bf16 v[4:7], a[228:231], a[84:87], v[4:7]
    ds_read_b64_tr_b16 a[200:201], v216 offset:4096
    ds_read_b64_tr_b16 a[202:203], v216 offset:6144
    v_mfma_f32_16x16x32_bf16 v[4:7], a[224:227], a[68:71], v[4:7]
    buffer_load_dwordx4 v[160:163], v249, s[16:19], s81 offen offset:3072 sc1
    v_mfma_f32_16x16x32_bf16 v[8:11], a[224:227], a[72:75], v[8:11]
    ds_read_b64_tr_b16 a[204:205], v216 offset:12288
    ds_read_b64_tr_b16 a[206:207], v216 offset:14336
    v_mfma_f32_16x16x32_bf16 v[8:11], a[228:231], a[88:91], v[8:11]
    ds_read_b64_tr_b16 a[208:209], v217 offset:0
    ds_read_b64_tr_b16 a[210:211], v217 offset:2048
    v_mfma_f32_16x16x32_bf16 v[12:15], a[228:231], a[92:95], v[12:15]
    s_add_u32 s81, s81, s79
    ds_read_b64_tr_b16 a[212:213], v217 offset:8192
    ds_read_b64_tr_b16 a[214:215], v217 offset:10240
    v_mfma_f32_16x16x32_bf16 v[12:15], a[224:227], a[76:79], v[12:15]
    buffer_load_dwordx4 v[164:167], v249, s[16:19], s81 offen offset:0 sc1
    v_mfma_f32_16x16x32_bf16 v[76:79], a[232:235], a[76:79], v[76:79]
    ds_read_b64_tr_b16 a[216:217], v217 offset:4096
    ds_read_b64_tr_b16 a[218:219], v217 offset:6144
    v_mfma_f32_16x16x32_bf16 v[76:79], a[236:239], a[92:95], v[76:79]
    s_add_u32 s81, s51, 1351680
    ds_read_b64_tr_b16 a[220:221], v217 offset:12288
    ds_read_b64_tr_b16 a[222:223], v217 offset:14336
    v_mfma_f32_16x16x32_bf16 v[72:75], a[236:239], a[88:91], v[72:75]
    s_add_u32 m0, s28, 0
    v_fmac_f32 v112, v208, v184
    v_fmac_f32 v113, v208, v185
    v_mfma_f32_16x16x32_bf16 v[72:75], a[232:235], a[72:75], v[72:75]
    buffer_load_dwordx4 v249, s[16:19], s81 offen offset:0 sc1 lds
    v_mfma_f32_16x16x32_bf16 v[68:71], a[232:235], a[68:71], v[68:71]
    v_fmac_f32 v114, v208, v186
    v_fmac_f32 v115, v208, v187
    v_mfma_f32_16x16x32_bf16 v[68:71], a[236:239], a[84:87], v[68:71]
    v_fmac_f32 v112, v212, v188
    v_fmac_f32 v113, v212, v189
    v_mfma_f32_16x16x32_bf16 v[64:67], a[236:239], a[80:83], v[64:67]
    s_add_u32 m0, s28, 0
    v_fmac_f32 v114, v212, v190
    v_fmac_f32 v115, v212, v191
    v_mfma_f32_16x16x32_bf16 v[64:67], a[232:235], a[64:67], v[64:67]
    buffer_load_dwordx4 v249, s[16:19], s81 offen offset:1024 sc1 lds
    v_mfma_f32_16x16x32_bf16 v[16:19], a[240:243], a[64:67], v[16:19]
    v_fmac_f32 v116, v209, v184
    v_fmac_f32 v117, v209, v185
    v_mfma_f32_16x16x32_bf16 v[16:19], a[244:247], a[80:83], v[16:19]
    v_fmac_f32 v118, v209, v186
    v_fmac_f32 v119, v209, v187
    v_mfma_f32_16x16x32_bf16 v[20:23], a[244:247], a[84:87], v[20:23]
    v_fmac_f32 v116, v213, v188
    v_fmac_f32 v117, v213, v189
    v_mfma_f32_16x16x32_bf16 v[20:23], a[240:243], a[68:71], v[20:23]
    s_add_u32 m0, s28, 0
    v_fmac_f32 v118, v213, v190
    v_fmac_f32 v119, v213, v191
    v_mfma_f32_16x16x32_bf16 v[24:27], a[240:243], a[72:75], v[24:27]
    buffer_load_dwordx4 v249, s[16:19], s81 offen offset:2048 sc1 lds
    v_mfma_f32_16x16x32_bf16 v[24:27], a[244:247], a[88:91], v[24:27]
    v_fmac_f32 v120, v210, v184
    v_fmac_f32 v121, v210, v185
    v_mfma_f32_16x16x32_bf16 v[28:31], a[244:247], a[92:95], v[28:31]
    v_fmac_f32 v122, v210, v186
    v_fmac_f32 v123, v210, v187
    v_mfma_f32_16x16x32_bf16 v[28:31], a[240:243], a[76:79], v[28:31]
    s_add_u32 m0, s28, 0
    v_fmac_f32 v120, v214, v188
    v_fmac_f32 v121, v214, v189
    v_mfma_f32_16x16x32_bf16 v[92:95], a[248:251], a[76:79], v[92:95]
    buffer_load_dwordx4 v249, s[16:19], s81 offen offset:3072 sc1 lds
    v_mfma_f32_16x16x32_bf16 v[92:95], a[252:255], a[92:95], v[92:95]
    v_fmac_f32 v122, v214, v190
    v_fmac_f32 v123, v214, v191
    v_mfma_f32_16x16x32_bf16 v[88:91], a[252:255], a[88:91], v[88:91]
    s_add_u32 s81, s81, s79
    v_fmac_f32 v124, v211, v184
    v_fmac_f32 v125, v211, v185
    v_mfma_f32_16x16x32_bf16 v[88:91], a[248:251], a[72:75], v[88:91]
    s_add_u32 m0, s28, 4096
    v_fmac_f32 v126, v211, v186
    v_fmac_f32 v127, v211, v187
    v_mfma_f32_16x16x32_bf16 v[84:87], a[248:251], a[68:71], v[84:87]
    buffer_load_dwordx4 v249, s[16:19], s81 offen offset:0 sc1 lds
    v_mfma_f32_16x16x32_bf16 v[84:87], a[252:255], a[84:87], v[84:87]
    v_fmac_f32 v124, v215, v188
    v_fmac_f32 v125, v215, v189
    v_mfma_f32_16x16x32_bf16 v[80:83], a[252:255], a[80:83], v[80:83]
    v_fmac_f32 v126, v215, v190
    v_fmac_f32 v127, v215, v191
    v_mfma_f32_16x16x32_bf16 v[80:83], a[248:251], a[64:67], v[80:83]
    s_waitcnt vmcnt(24) lgkmcnt(0)
    v_mfma_f32_16x16x32_bf16 v[0:3], a[192:195], a[96:99], v[0:3]
    ds_read_b64_tr_b16 a[224:225], v216 offset:16384
    v_mov_b32 v208, 0
    v_mfma_f32_16x16x32_bf16 v[0:3], a[196:199], a[112:115], v[0:3]
    ds_read_b64_tr_b16 a[226:227], v216 offset:18432
    v_mov_b32 v209, s55
    v_mfma_f32_16x16x32_bf16 v[4:7], a[196:199], a[116:119], v[4:7]
    s_add_u32 s81, s51, 1310720
    ds_read_b64_tr_b16 a[228:229], v216 offset:24576
    v_mfma_f32_16x16x32_bf16 v[4:7], a[192:195], a[100:103], v[4:7]
    buffer_load_dwordx4 v[168:171], v249, s[16:19], s81 offen offset:0 sc1
    v_mfma_f32_16x16x32_bf16 v[8:11], a[192:195], a[104:107], v[8:11]
    ds_read_b64_tr_b16 a[230:231], v216 offset:26624
    v_mfma_f32_16x16x32_bf16 v[8:11], a[196:199], a[120:123], v[8:11]
    ds_read_b64_tr_b16 a[232:233], v216 offset:20480
    v_mfma_f32_16x16x32_bf16 v[12:15], a[196:199], a[124:127], v[12:15]
    ds_read_b64_tr_b16 a[234:235], v216 offset:22528
    v_mfma_f32_16x16x32_bf16 v[12:15], a[192:195], a[108:111], v[12:15]
    buffer_load_dwordx4 v[172:175], v249, s[16:19], s81 offen offset:1024 sc1
    v_mfma_f32_16x16x32_bf16 v[76:79], a[200:203], a[108:111], v[76:79]
    ds_read_b64_tr_b16 a[236:237], v216 offset:28672
    v_mfma_f32_16x16x32_bf16 v[76:79], a[204:207], a[124:127], v[76:79]
    ds_read_b64_tr_b16 a[238:239], v216 offset:30720
    v_mfma_f32_16x16x32_bf16 v[72:75], a[204:207], a[120:123], v[72:75]
    ds_read_b64_tr_b16 a[240:241], v217 offset:16384
    v_mfma_f32_16x16x32_bf16 v[72:75], a[200:203], a[104:107], v[72:75]
    buffer_load_dwordx4 v[176:179], v249, s[16:19], s81 offen offset:2048 sc1
    v_mfma_f32_16x16x32_bf16 v[68:71], a[200:203], a[100:103], v[68:71]
    ds_read_b64_tr_b16 a[242:243], v217 offset:18432
    v_mfma_f32_16x16x32_bf16 v[68:71], a[204:207], a[116:119], v[68:71]
    ds_read_b64_tr_b16 a[244:245], v217 offset:24576
    v_mfma_f32_16x16x32_bf16 v[64:67], a[204:207], a[112:115], v[64:67]
    ds_read_b64_tr_b16 a[246:247], v217 offset:26624
    v_mfma_f32_16x16x32_bf16 v[64:67], a[200:203], a[96:99], v[64:67]
    buffer_load_dwordx4 v[180:183], v249, s[16:19], s81 offen offset:3072 sc1
    v_mfma_f32_16x16x32_bf16 v[16:19], a[208:211], a[96:99], v[16:19]
    ds_read_b64_tr_b16 a[248:249], v217 offset:20480
    v_mfma_f32_16x16x32_bf16 v[16:19], a[212:215], a[112:115], v[16:19]
    ds_read_b64_tr_b16 a[250:251], v217 offset:22528
    v_mfma_f32_16x16x32_bf16 v[20:23], a[212:215], a[116:119], v[20:23]
    ds_read_b64_tr_b16 a[252:253], v217 offset:28672
    v_mfma_f32_16x16x32_bf16 v[20:23], a[208:211], a[100:103], v[20:23]
    s_add_u32 s81, s81, s79
    ds_read_b64_tr_b16 a[254:255], v217 offset:30720
    v_mfma_f32_16x16x32_bf16 v[24:27], a[208:211], a[104:107], v[24:27]
    buffer_load_dwordx4 v[184:187], v249, s[16:19], s81 offen offset:0 sc1
    v_mfma_f32_16x16x32_bf16 v[24:27], a[212:215], a[120:123], v[24:27]
    v_mfma_f32_16x16x32_bf16 v[28:31], a[212:215], a[124:127], v[28:31]
    v_mfma_f32_16x16x32_bf16 v[28:31], a[208:211], a[108:111], v[28:31]
    s_add_u32 s81, s51, 1638400
    v_mfma_f32_16x16x32_bf16 v[92:95], a[216:219], a[108:111], v[92:95]
    buffer_load_dwordx4 v[188:191], v249, s[16:19], s81 offen offset:0 sc1
    v_mfma_f32_16x16x32_bf16 v[92:95], a[220:223], a[124:127], v[92:95]
    v_mfma_f32_16x16x32_bf16 v[88:91], a[220:223], a[120:123], v[88:91]
    v_mfma_f32_16x16x32_bf16 v[88:91], a[216:219], a[104:107], v[88:91]
    v_mfma_f32_16x16x32_bf16 v[84:87], a[216:219], a[100:103], v[84:87]
    buffer_load_dwordx4 v[192:195], v249, s[16:19], s81 offen offset:1024 sc1
    v_mfma_f32_16x16x32_bf16 v[84:87], a[220:223], a[116:119], v[84:87]
    v_mfma_f32_16x16x32_bf16 v[80:83], a[220:223], a[112:115], v[80:83]
    v_mfma_f32_16x16x32_bf16 v[80:83], a[216:219], a[96:99], v[80:83]
    s_waitcnt vmcnt(17) lgkmcnt(0)
    v_mfma_f32_16x16x32_bf16 v[0:3], a[224:227], a[128:131], v[0:3]
    ds_read_b64_tr_b16 a[192:193], v218 offset:32768
    ds_read_b64_tr_b16 a[194:195], v218 offset:34816
    v_mfma_f32_16x16x32_bf16 v[0:3], a[228:231], a[144:147], v[0:3]
    ds_read_b64_tr_b16 a[196:197], v218 offset:40960
    ds_read_b64_tr_b16 a[198:199], v218 offset:43008
    v_mfma_f32_16x16x32_bf16 v[64:67], a[236:239], a[144:147], v[64:67]
    ds_read_b64_tr_b16 a[200:201], v218 offset:36864
    ds_read_b64_tr_b16 a[202:203], v218 offset:38912
    v_mfma_f32_16x16x32_bf16 v[64:67], a[232:235], a[128:131], v[64:67]
    buffer_load_dwordx4 v[196:199], v249, s[16:19], s81 offen offset:2048 sc1
    v_mfma_f32_16x16x32_bf16 v[16:19], a[240:243], a[128:131], v[16:19]
    ds_read_b64_tr_b16 a[204:205], v218 offset:45056
    ds_read_b64_tr_b16 a[206:207], v218 offset:47104
    v_mfma_f32_16x16x32_bf16 v[16:19], a[244:247], a[144:147], v[16:19]
    ds_read_b64_tr_b16 a[208:209], v219 offset:32768
    ds_read_b64_tr_b16 a[210:211], v219 offset:34816
    v_mfma_f32_16x16x32_bf16 v[80:83], a[252:255], a[144:147], v[80:83]
    ds_read_b64_tr_b16 a[212:213], v219 offset:40960
    ds_read_b64_tr_b16 a[214:215], v219 offset:43008
    v_mfma_f32_16x16x32_bf16 v[80:83], a[248:251], a[128:131], v[80:83]
    buffer_load_dwordx4 v[200:203], v249, s[16:19], s81 offen offset:3072 sc1
    v_mfma_f32_16x16x32_bf16 v[84:87], a[248:251], a[132:135], v[84:87]
    ds_read_b64_tr_b16 a[216:217], v219 offset:36864
    ds_read_b64_tr_b16 a[218:219], v219 offset:38912
    v_mfma_f32_16x16x32_bf16 v[84:87], a[252:255], a[148:151], v[84:87]
    ds_read_b64_tr_b16 a[220:221], v219 offset:45056
    ds_read_b64_tr_b16 a[222:223], v219 offset:47104
    v_mfma_f32_16x16x32_bf16 v[20:23], a[244:247], a[148:151], v[20:23]
    s_add_u32 s81, s81, s79
    v_mfma_f32_16x16x32_bf16 v[20:23], a[240:243], a[132:135], v[20:23]
    buffer_load_dwordx4 v[204:207], v249, s[16:19], s81 offen offset:0 sc1
    v_mfma_f32_16x16x32_bf16 v[68:71], a[232:235], a[132:135], v[68:71]
    s_add_u32 s81, s51, 1679360
    v_mfma_f32_16x16x32_bf16 v[68:71], a[236:239], a[148:151], v[68:71]
    s_add_u32 m0, s28, 5120
    v_mfma_f32_16x16x32_bf16 v[4:7], a[228:231], a[148:151], v[4:7]
    buffer_load_dwordx4 v249, s[16:19], s81 offen offset:0 sc1 lds
    v_mfma_f32_16x16x32_bf16 v[4:7], a[224:227], a[132:135], v[4:7]
    v_max_f32 v0, 0, v0
    v_max_f32 v1, 0, v1
    v_mfma_f32_16x16x32_bf16 v[8:11], a[224:227], a[136:139], v[8:11]
    v_max_f32 v2, 0, v2
    v_max_f32 v3, 0, v3
    v_mfma_f32_16x16x32_bf16 v[8:11], a[228:231], a[152:155], v[8:11]
    v_mul_f32 v0, v0, v64
    v_mul_f32 v1, v1, v65
    v_mfma_f32_16x16x32_bf16 v[72:75], a[236:239], a[152:155], v[72:75]
    v_mul_f32 v2, v2, v66
    v_mul_f32 v3, v3, v67
    v_mfma_f32_16x16x32_bf16 v[72:75], a[232:235], a[136:139], v[72:75]
    v_cvt_pk_bf16_f32 v232, v0, v1
    v_cvt_pk_bf16_f32 v233, v2, v3
    v_mfma_f32_16x16x32_bf16 v[24:27], a[240:243], a[136:139], v[24:27]
    v_max_f32 v16, 0, v16
    v_max_f32 v17, 0, v17
    v_mfma_f32_16x16x32_bf16 v[24:27], a[244:247], a[152:155], v[24:27]
    s_add_u32 m0, s28, 5120
    v_max_f32 v18, 0, v18
    v_max_f32 v19, 0, v19
    v_mfma_f32_16x16x32_bf16 v[88:91], a[252:255], a[152:155], v[88:91]
HOP1_5:
    s_cbranch_execz HOPRET1
    buffer_load_dwordx4 v249, s[16:19], s81 offen offset:1024 sc1 lds
    v_mfma_f32_16x16x32_bf16 v[88:91], a[248:251], a[136:139], v[88:91]
    v_mul_f32 v16, v16, v80
    v_mul_f32 v17, v17, v81
    v_mfma_f32_16x16x32_bf16 v[92:95], a[248:251], a[140:143], v[92:95]
    v_mul_f32 v18, v18, v82
    v_mul_f32 v19, v19, v83
    v_mfma_f32_16x16x32_bf16 v[92:95], a[252:255], a[156:159], v[92:95]
    v_cvt_pk_bf16_f32 v234, v16, v17
    v_cvt_pk_bf16_f32 v235, v18, v19
    v_mfma_f32_16x16x32_bf16 v[28:31], a[244:247], a[156:159], v[28:31]
    buffer_store_dwordx4 v[232:235], v249, s[16:19], s30 offen offset:0 sc1
    v_mfma_f32_16x16x32_bf16 v[28:31], a[240:243], a[140:143], v[28:31]
    v_max_f32 v4, 0, v4
    v_max_f32 v5, 0, v5
    v_mfma_f32_16x16x32_bf16 v[76:79], a[232:235], a[140:143], v[76:79]
    v_max_f32 v6, 0, v6
    v_max_f32 v7, 0, v7
    v_mfma_f32_16x16x32_bf16 v[76:79], a[236:239], a[156:159], v[76:79]
    v_mul_f32 v4, v4, v68
    v_mul_f32 v5, v5, v69
    v_mfma_f32_16x16x32_bf16 v[12:15], a[228:231], a[156:159], v[12:15]
    v_mul_f32 v6, v6, v70
    v_mul_f32 v7, v7, v71
    v_mfma_f32_16x16x32_bf16 v[12:15], a[224:227], a[140:143], v[12:15]
    s_waitcnt lgkmcnt(0)
    v_cvt_pk_bf16_f32 v236, v4, v5
    v_cvt_pk_bf16_f32 v237, v6, v7
    v_mfma_f32_16x16x32_bf16 v[32:35], a[192:195], a[160:163], v[32:35]
    ds_read_b64_tr_b16 a[224:225], v218 offset:49152
    ds_read_b64_tr_b16 a[226:227], v218 offset:51200
    v_mfma_f32_16x16x32_bf16 v[32:35], a[196:199], a[176:179], v[32:35]
    ds_read_b64_tr_b16 a[228:229], v218 offset:57344
    ds_read_b64_tr_b16 a[230:231], v218 offset:59392
    v_mfma_f32_16x16x32_bf16 v[36:39], a[196:199], a[180:183], v[36:39]
    s_add_u32 m0, s28, 5120
    ds_read_b64_tr_b16 a[232:233], v218 offset:53248
    ds_read_b64_tr_b16 a[234:235], v218 offset:55296
    v_mfma_f32_16x16x32_bf16 v[36:39], a[192:195], a[164:167], v[36:39]
    buffer_load_dwordx4 v249, s[16:19], s81 offen offset:2048 sc1 lds
    v_mfma_f32_16x16x32_bf16 v[40:43], a[192:195], a[168:171], v[40:43]
    ds_read_b64_tr_b16 a[236:237], v218 offset:61440
    ds_read_b64_tr_b16 a[238:239], v218 offset:63488
    v_mfma_f32_16x16x32_bf16 v[40:43], a[196:199], a[184:187], v[40:43]
    ds_read_b64_tr_b16 a[240:241], v219 offset:49152
    ds_read_b64_tr_b16 a[242:243], v219 offset:51200
    v_mfma_f32_16x16x32_bf16 v[44:47], a[196:199], a[188:191], v[44:47]
    s_add_u32 m0, s29, -3072
    ds_read_b64_tr_b16 a[244:245], v219 offset:57344
    ds_read_b64_tr_b16 a[246:247], v219 offset:59392
    v_mfma_f32_16x16x32_bf16 v[44:47], a[192:195], a[172:175], v[44:47]
    buffer_load_dwordx4 v249, s[16:19], s81 offen offset:3072 sc1 lds
    v_mfma_f32_16x16x32_bf16 v[108:111], a[200:203], a[172:175], v[108:111]
    ds_read_b64_tr_b16 a[248:249], v219 offset:53248
    ds_read_b64_tr_b16 a[250:251], v219 offset:55296
    v_mfma_f32_16x16x32_bf16 v[108:111], a[204:207], a[188:191], v[108:111]
    s_add_u32 s81, s81, s79
    ds_read_b64_tr_b16 a[252:253], v219 offset:61440
    ds_read_b64_tr_b16 a[254:255], v219 offset:63488
    v_mfma_f32_16x16x32_bf16 v[104:107], a[204:207], a[184:187], v[104:107]
    s_add_u32 m0, s29, 1024
    v_max_f32 v20, 0, v20
    v_max_f32 v21, 0, v21
    v_mfma_f32_16x16x32_bf16 v[104:107], a[200:203], a[168:171], v[104:107]
    buffer_load_dwordx4 v249, s[16:19], s81 offen offset:0 sc1 lds
    v_mfma_f32_16x16x32_bf16 v[100:103], a[200:203], a[164:167], v[100:103]
    v_add_u32 v218, 0x10000, v218
    v_add_u32 v219, 0x10000, v219
    v_mfma_f32_16x16x32_bf16 v[100:103], a[204:207], a[180:183], v[100:103]
    v_max_f32 v22, 0, v22
    v_max_f32 v23, 0, v23
    v_mfma_f32_16x16x32_bf16 v[96:99], a[204:207], a[176:179], v[96:99]
    v_mul_f32 v20, v20, v84
    v_mul_f32 v21, v21, v85
    v_mfma_f32_16x16x32_bf16 v[96:99], a[200:203], a[160:163], v[96:99]
    s_add_u32 s81, s51, 2007040
    s_cmp_lt_u32 s22, 3
    s_cselect_b32 s81, s81, 0x7f000000
    v_mul_f32 v22, v22, v86
    v_mul_f32 v23, v23, v87
    v_mfma_f32_16x16x32_bf16 v[48:51], a[208:211], a[160:163], v[48:51]
    s_add_u32 m0, s29, 2048
    v_cvt_pk_bf16_f32 v238, v20, v21
    v_cvt_pk_bf16_f32 v239, v22, v23
    v_mfma_f32_16x16x32_bf16 v[48:51], a[212:215], a[176:179], v[48:51]
    buffer_load_dwordx4 v249, s[16:19], s81 offen offset:0 sc1 lds
    v_mfma_f32_16x16x32_bf16 v[52:55], a[212:215], a[180:183], v[52:55]
    buffer_store_dwordx4 v[236:239], v249, s[16:19], s31 offen offset:0 sc1
    v_mfma_f32_16x16x32_bf16 v[52:55], a[208:211], a[164:167], v[52:55]
    v_max_f32 v8, 0, v8
    v_max_f32 v9, 0, v9
    v_mfma_f32_16x16x32_bf16 v[56:59], a[208:211], a[168:171], v[56:59]
    v_max_f32 v10, 0, v10
    v_max_f32 v11, 0, v11
    v_mfma_f32_16x16x32_bf16 v[56:59], a[212:215], a[184:187], v[56:59]
    v_mul_f32 v8, v8, v72
    v_mul_f32 v9, v9, v73
    v_mfma_f32_16x16x32_bf16 v[60:63], a[212:215], a[188:191], v[60:63]
    v_mul_f32 v10, v10, v74
    v_mul_f32 v11, v11, v75
    v_mfma_f32_16x16x32_bf16 v[60:63], a[208:211], a[172:175], v[60:63]
    s_add_u32 m0, s29, 2048
    v_cvt_pk_bf16_f32 v240, v8, v9
    v_cvt_pk_bf16_f32 v241, v10, v11
    v_mfma_f32_16x16x32_bf16 v[124:127], a[216:219], a[172:175], v[124:127]
    buffer_load_dwordx4 v249, s[16:19], s81 offen offset:1024 sc1 lds
    v_mfma_f32_16x16x32_bf16 v[124:127], a[220:223], a[188:191], v[124:127]
    v_max_f32 v24, 0, v24
    v_max_f32 v25, 0, v25
    v_mfma_f32_16x16x32_bf16 v[120:123], a[220:223], a[184:187], v[120:123]
    v_max_f32 v26, 0, v26
    v_max_f32 v27, 0, v27
    v_mfma_f32_16x16x32_bf16 v[120:123], a[216:219], a[168:171], v[120:123]
    v_mul_f32 v24, v24, v88
    v_mul_f32 v25, v25, v89
    v_mfma_f32_16x16x32_bf16 v[116:119], a[216:219], a[164:167], v[116:119]
    v_mul_f32 v26, v26, v90
    v_mul_f32 v27, v27, v91
    v_mfma_f32_16x16x32_bf16 v[116:119], a[220:223], a[180:183], v[116:119]
    v_cvt_pk_bf16_f32 v242, v24, v25
    v_cvt_pk_bf16_f32 v243, v26, v27
    v_mfma_f32_16x16x32_bf16 v[112:115], a[220:223], a[176:179], v[112:115]
    buffer_store_dwordx4 v[240:243], v249, s[16:19], s32 offen offset:0 sc1
    v_mfma_f32_16x16x32_bf16 v[112:115], a[216:219], a[160:163], v[112:115]
    s_waitcnt lgkmcnt(0)
    v_max_f32 v12, 0, v12
    v_max_f32 v13, 0, v13
    v_max_f32 v14, 0, v14
    v_max_f32 v15, 0, v15
    v_mul_f32 v12, v12, v76
    v_mul_f32 v13, v13, v77
    v_mul_f32 v14, v14, v78
    v_mul_f32 v15, v15, v79
    v_cvt_pk_bf16_f32 v244, v12, v13
    v_cvt_pk_bf16_f32 v245, v14, v15
    v_max_f32 v28, 0, v28
    v_max_f32 v29, 0, v29
    v_max_f32 v30, 0, v30
    v_max_f32 v31, 0, v31
    v_mul_f32 v28, v28, v92
    v_mul_f32 v29, v29, v93
    v_mul_f32 v30, v30, v94
    v_mul_f32 v31, v31, v95
    v_cvt_pk_bf16_f32 v246, v28, v29
    v_cvt_pk_bf16_f32 v247, v30, v31
    buffer_store_dwordx4 v[244:247], v249, s[16:19], s33 offen offset:0 sc1
    v_mfma_f32_16x16x32_bf16 v[32:35], a[224:227], a[64:67], v[32:35]
    ds_read_b64_tr_b16 a[192:193], v218 offset:0
    v_mfma_f32_16x16x32_bf16 v[32:35], a[228:231], a[80:83], v[32:35]
    ds_read_b64_tr_b16 a[194:195], v218 offset:2048
    v_mfma_f32_16x16x32_bf16 v[36:39], a[228:231], a[84:87], v[36:39]
    s_add_u32 m0, s29, 2048
    ds_read_b64_tr_b16 a[196:197], v218 offset:8192
    v_mfma_f32_16x16x32_bf16 v[36:39], a[224:227], a[68:71], v[36:39]
    buffer_load_dwordx4 v249, s[16:19], s81 offen offset:2048 sc1 lds
    v_mfma_f32_16x16x32_bf16 v[40:43], a[224:227], a[72:75], v[40:43]
    ds_read_b64_tr_b16 a[198:199], v218 offset:10240
    v_mfma_f32_16x16x32_bf16 v[40:43], a[228:231], a[88:91], v[40:43]
    ds_read_b64_tr_b16 a[200:201], v218 offset:4096
    v_mfma_f32_16x16x32_bf16 v[44:47], a[228:231], a[92:95], v[44:47]
    s_add_u32 m0, s29, 2048
    ds_read_b64_tr_b16 a[202:203], v218 offset:6144
    v_mfma_f32_16x16x32_bf16 v[44:47], a[224:227], a[76:79], v[44:47]
    buffer_load_dwordx4 v249, s[16:19], s81 offen offset:3072 sc1 lds
    v_mfma_f32_16x16x32_bf16 v[108:111], a[232:235], a[76:79], v[108:111]
    ds_read_b64_tr_b16 a[204:205], v218 offset:12288
    v_mfma_f32_16x16x32_bf16 v[108:111], a[236:239], a[92:95], v[108:111]
    s_add_u32 s81, s81, s79
    ds_read_b64_tr_b16 a[206:207], v218 offset:14336
    v_mfma_f32_16x16x32_bf16 v[104:107], a[236:239], a[88:91], v[104:107]
    s_add_u32 m0, s29, 6144
    ds_read_b64_tr_b16 a[208:209], v219 offset:0
    v_mfma_f32_16x16x32_bf16 v[104:107], a[232:235], a[72:75], v[104:107]
    buffer_load_dwordx4 v249, s[16:19], s81 offen offset:0 sc1 lds
    v_mfma_f32_16x16x32_bf16 v[100:103], a[232:235], a[68:71], v[100:103]
    ds_read_b64_tr_b16 a[210:211], v219 offset:2048
    v_mfma_f32_16x16x32_bf16 v[100:103], a[236:239], a[84:87], v[100:103]
    s_add_u32 s81, s51, 1966080
    s_cmp_lt_u32 s22, 3
    ds_read_b64_tr_b16 a[212:213], v219 offset:8192
    v_mfma_f32_16x16x32_bf16 v[96:99], a[236:239], a[80:83], v[96:99]
    s_cselect_b32 s81, s81, 0x7f000000
    ds_read_b64_tr_b16 a[214:215], v219 offset:10240
    v_mfma_f32_16x16x32_bf16 v[96:99], a[232:235], a[64:67], v[96:99]
    buffer_load_dwordx4 a[168:171], v249, s[16:19], s81 offen offset:0 sc1
    v_mfma_f32_16x16x32_bf16 v[48:51], a[240:243], a[64:67], v[48:51]
    ds_read_b64_tr_b16 a[216:217], v219 offset:4096
    v_mfma_f32_16x16x32_bf16 v[48:51], a[244:247], a[80:83], v[48:51]
    ds_read_b64_tr_b16 a[218:219], v219 offset:6144
    v_mfma_f32_16x16x32_bf16 v[52:55], a[244:247], a[84:87], v[52:55]
    ds_read_b64_tr_b16 a[220:221], v219 offset:12288
    v_mfma_f32_16x16x32_bf16 v[52:55], a[240:243], a[68:71], v[52:55]
    ds_read_b64_tr_b16 a[222:223], v219 offset:14336
    v_mfma_f32_16x16x32_bf16 v[56:59], a[240:243], a[72:75], v[56:59]
    buffer_load_dwordx4 a[172:175], v249, s[16:19], s81 offen offset:1024 sc1
    v_mfma_f32_16x16x32_bf16 v[56:59], a[244:247], a[88:91], v[56:59]
    v_mfma_f32_16x16x32_bf16 v[60:63], a[244:247], a[92:95], v[60:63]
    v_mfma_f32_16x16x32_bf16 v[60:63], a[240:243], a[76:79], v[60:63]
    v_mfma_f32_16x16x32_bf16 v[124:127], a[248:251], a[76:79], v[124:127]
    buffer_load_dwordx4 a[176:179], v249, s[16:19], s81 offen offset:2048 sc1
    v_mfma_f32_16x16x32_bf16 v[124:127], a[252:255], a[92:95], v[124:127]
    v_mfma_f32_16x16x32_bf16 v[120:123], a[252:255], a[88:91], v[120:123]
    v_mfma_f32_16x16x32_bf16 v[120:123], a[248:251], a[72:75], v[120:123]
    v_mfma_f32_16x16x32_bf16 v[116:119], a[248:251], a[68:71], v[116:119]
    buffer_load_dwordx4 a[180:183], v249, s[16:19], s81 offen offset:3072 sc1
    v_mfma_f32_16x16x32_bf16 v[116:119], a[252:255], a[84:87], v[116:119]
    v_mfma_f32_16x16x32_bf16 v[112:115], a[252:255], a[80:83], v[112:115]
    v_mfma_f32_16x16x32_bf16 v[112:115], a[248:251], a[64:67], v[112:115]
    s_waitcnt lgkmcnt(0)
    v_mfma_f32_16x16x32_bf16 v[32:35], a[192:195], a[96:99], v[32:35]
    ds_read_b64_tr_b16 a[224:225], v218 offset:16384
    v_mfma_f32_16x16x32_bf16 v[32:35], a[196:199], a[112:115], v[32:35]
    ds_read_b64_tr_b16 a[226:227], v218 offset:18432
    v_mfma_f32_16x16x32_bf16 v[36:39], a[196:199], a[116:119], v[36:39]
    s_add_u32 s81, s81, s79
    ds_read_b64_tr_b16 a[228:229], v218 offset:24576
    v_mfma_f32_16x16x32_bf16 v[36:39], a[192:195], a[100:103], v[36:39]
    buffer_load_dwordx4 a[184:187], v249, s[16:19], s81 offen offset:0 sc1
    v_mfma_f32_16x16x32_bf16 v[40:43], a[192:195], a[104:107], v[40:43]
    ds_read_b64_tr_b16 a[230:231], v218 offset:26624
    v_mfma_f32_16x16x32_bf16 v[40:43], a[196:199], a[120:123], v[40:43]
    ds_read_b64_tr_b16 a[232:233], v218 offset:20480
    v_mfma_f32_16x16x32_bf16 v[44:47], a[196:199], a[124:127], v[44:47]
    s_add_u32 s81, s51, 40960
    ds_read_b64_tr_b16 a[234:235], v218 offset:22528
    v_mfma_f32_16x16x32_bf16 v[44:47], a[192:195], a[108:111], v[44:47]
    buffer_load_dwordx4 a[60:63], v249, s[16:19], s81 offen offset:0 sc1
    v_mfma_f32_16x16x32_bf16 v[108:111], a[200:203], a[108:111], v[108:111]
    ds_read_b64_tr_b16 a[236:237], v218 offset:28672
    v_mfma_f32_16x16x32_bf16 v[108:111], a[204:207], a[124:127], v[108:111]
    ds_read_b64_tr_b16 a[238:239], v218 offset:30720
    v_mfma_f32_16x16x32_bf16 v[104:107], a[204:207], a[120:123], v[104:107]
    ds_read_b64_tr_b16 a[240:241], v219 offset:16384
    v_mfma_f32_16x16x32_bf16 v[104:107], a[200:203], a[104:107], v[104:107]
    buffer_load_dwordx4 a[64:67], v249, s[16:19], s81 offen offset:1024 sc1
    v_mfma_f32_16x16x32_bf16 v[100:103], a[200:203], a[100:103], v[100:103]
    ds_read_b64_tr_b16 a[242:243], v219 offset:18432
    v_mfma_f32_16x16x32_bf16 v[100:103], a[204:207], a[116:119], v[100:103]
    s_waitcnt vmcnt(10)
    s_mov_b64 exec, 1
    buffer_store_dword v209, v208, s[16:19], s24 offen sc1
    s_mov_b64 exec, -1
    ds_read_b64_tr_b16 a[244:245], v219 offset:24576
    v_mfma_f32_16x16x32_bf16 v[96:99], a[204:207], a[112:115], v[96:99]
    ds_read_b64_tr_b16 a[246:247], v219 offset:26624
    v_mfma_f32_16x16x32_bf16 v[96:99], a[200:203], a[96:99], v[96:99]
    buffer_load_dwordx4 a[68:71], v249, s[16:19], s81 offen offset:2048 sc1
    v_mfma_f32_16x16x32_bf16 v[48:51], a[208:211], a[96:99], v[48:51]
    ds_read_b64_tr_b16 a[248:249], v219 offset:20480
    v_mfma_f32_16x16x32_bf16 v[48:51], a[212:215], a[112:115], v[48:51]
    ds_read_b64_tr_b16 a[250:251], v219 offset:22528
    v_mfma_f32_16x16x32_bf16 v[52:55], a[212:215], a[116:119], v[52:55]
    ds_read_b64_tr_b16 a[252:253], v219 offset:28672
    v_mfma_f32_16x16x32_bf16 v[52:55], a[208:211], a[100:103], v[52:55]
    ds_read_b64_tr_b16 a[254:255], v219 offset:30720
    v_mfma_f32_16x16x32_bf16 v[56:59], a[208:211], a[104:107], v[56:59]
    buffer_load_dwordx4 a[72:75], v249, s[16:19], s81 offen offset:3072 sc1
    v_mfma_f32_16x16x32_bf16 v[56:59], a[212:215], a[120:123], v[56:59]
    v_mfma_f32_16x16x32_bf16 v[60:63], a[212:215], a[124:127], v[60:63]
    v_mfma_f32_16x16x32_bf16 v[60:63], a[208:211], a[108:111], v[60:63]
    s_add_u32 s81, s81, s79
    v_mfma_f32_16x16x32_bf16 v[124:127], a[216:219], a[108:111], v[124:127]
    buffer_load_dwordx4 a[76:79], v249, s[16:19], s81 offen offset:0 sc1
    v_mfma_f32_16x16x32_bf16 v[124:127], a[220:223], a[124:127], v[124:127]
    v_mfma_f32_16x16x32_bf16 v[120:123], a[220:223], a[120:123], v[120:123]
    v_mfma_f32_16x16x32_bf16 v[120:123], a[216:219], a[104:107], v[120:123]
    v_mfma_f32_16x16x32_bf16 v[116:119], a[216:219], a[100:103], v[116:119]
    v_mfma_f32_16x16x32_bf16 v[116:119], a[220:223], a[116:119], v[116:119]
    v_mfma_f32_16x16x32_bf16 v[112:115], a[220:223], a[112:115], v[112:115]
    v_mfma_f32_16x16x32_bf16 v[112:115], a[216:219], a[96:99], v[112:115]
    s_waitcnt lgkmcnt(0)
    v_mfma_f32_16x16x32_bf16 v[32:35], a[224:227], a[128:131], v[32:35]
    s_add_u32 s81, s51, 368640
    v_mfma_f32_16x16x32_bf16 v[32:35], a[228:231], a[144:147], v[32:35]
    buffer_load_dwordx4 a[96:99], v249, s[16:19], s81 offen offset:0 sc1
    v_mfma_f32_16x16x32_bf16 v[96:99], a[236:239], a[144:147], v[96:99]
    v_mfma_f32_16x16x32_bf16 v[96:99], a[232:235], a[128:131], v[96:99]
    buffer_load_dwordx4 a[100:103], v249, s[16:19], s81 offen offset:1024 sc1
    v_mfma_f32_16x16x32_bf16 v[48:51], a[240:243], a[128:131], v[48:51]
    v_mfma_f32_16x16x32_bf16 v[48:51], a[244:247], a[144:147], v[48:51]
    buffer_load_dwordx4 a[104:107], v249, s[16:19], s81 offen offset:2048 sc1
    v_mfma_f32_16x16x32_bf16 v[112:115], a[252:255], a[144:147], v[112:115]
    v_mfma_f32_16x16x32_bf16 v[112:115], a[248:251], a[128:131], v[112:115]
    buffer_load_dwordx4 a[108:111], v249, s[16:19], s81 offen offset:3072 sc1
    v_mfma_f32_16x16x32_bf16 v[116:119], a[248:251], a[132:135], v[116:119]
    s_add_u32 s81, s81, s79
    v_mfma_f32_16x16x32_bf16 v[116:119], a[252:255], a[148:151], v[116:119]
    buffer_load_dwordx4 a[112:115], v249, s[16:19], s81 offen offset:0 sc1
    v_mfma_f32_16x16x32_bf16 v[52:55], a[244:247], a[148:151], v[52:55]
    v_mfma_f32_16x16x32_bf16 v[52:55], a[240:243], a[132:135], v[52:55]
    v_mfma_f32_16x16x32_bf16 v[100:103], a[232:235], a[132:135], v[100:103]
    v_mfma_f32_16x16x32_bf16 v[100:103], a[236:239], a[148:151], v[100:103]
    v_mfma_f32_16x16x32_bf16 v[36:39], a[228:231], a[148:151], v[36:39]
    v_mfma_f32_16x16x32_bf16 v[36:39], a[224:227], a[132:135], v[36:39]
    v_max_f32 v32, 0, v32
    v_max_f32 v33, 0, v33
    v_mfma_f32_16x16x32_bf16 v[40:43], a[224:227], a[136:139], v[40:43]
    v_max_f32 v34, 0, v34
    v_max_f32 v35, 0, v35
    v_mfma_f32_16x16x32_bf16 v[40:43], a[228:231], a[152:155], v[40:43]
    v_mul_f32 v32, v32, v96
    v_mul_f32 v33, v33, v97
    v_mfma_f32_16x16x32_bf16 v[104:107], a[236:239], a[152:155], v[104:107]
    v_mul_f32 v34, v34, v98
    v_mul_f32 v35, v35, v99
    v_mfma_f32_16x16x32_bf16 v[104:107], a[232:235], a[136:139], v[104:107]
    v_cvt_pk_bf16_f32 v232, v32, v33
    v_cvt_pk_bf16_f32 v233, v34, v35
    v_mfma_f32_16x16x32_bf16 v[56:59], a[240:243], a[136:139], v[56:59]
    v_max_f32 v48, 0, v48
    v_max_f32 v49, 0, v49
    v_mfma_f32_16x16x32_bf16 v[56:59], a[244:247], a[152:155], v[56:59]
    v_max_f32 v50, 0, v50
    v_max_f32 v51, 0, v51
    v_mfma_f32_16x16x32_bf16 v[120:123], a[252:255], a[152:155], v[120:123]
    v_mul_f32 v48, v48, v112
    v_mul_f32 v49, v49, v113
    v_mfma_f32_16x16x32_bf16 v[120:123], a[248:251], a[136:139], v[120:123]
    v_mul_f32 v50, v50, v114
    v_mul_f32 v51, v51, v115
    v_mfma_f32_16x16x32_bf16 v[124:127], a[248:251], a[140:143], v[124:127]
    v_cvt_pk_bf16_f32 v234, v48, v49
    v_cvt_pk_bf16_f32 v235, v50, v51
    v_mfma_f32_16x16x32_bf16 v[124:127], a[252:255], a[156:159], v[124:127]
    buffer_store_dwordx4 v[232:235], v249, s[16:19], s30 offen offset:1024 sc1
    v_mfma_f32_16x16x32_bf16 v[60:63], a[244:247], a[156:159], v[60:63]
    v_max_f32 v36, 0, v36
    v_max_f32 v37, 0, v37
    v_mfma_f32_16x16x32_bf16 v[60:63], a[240:243], a[140:143], v[60:63]
    v_max_f32 v38, 0, v38
    v_max_f32 v39, 0, v39
    v_mfma_f32_16x16x32_bf16 v[108:111], a[232:235], a[140:143], v[108:111]
    v_mul_f32 v36, v36, v100
    v_mul_f32 v37, v37, v101
    v_mfma_f32_16x16x32_bf16 v[108:111], a[236:239], a[156:159], v[108:111]
    v_mul_f32 v38, v38, v102
    v_mul_f32 v39, v39, v103
    v_mfma_f32_16x16x32_bf16 v[44:47], a[228:231], a[156:159], v[44:47]
    v_cvt_pk_bf16_f32 v236, v36, v37
    v_cvt_pk_bf16_f32 v237, v38, v39
    v_mfma_f32_16x16x32_bf16 v[44:47], a[224:227], a[140:143], v[44:47]
    v_max_f32 v52, 0, v52
    v_max_f32 v53, 0, v53
    v_max_f32 v54, 0, v54
    v_max_f32 v55, 0, v55
    v_mul_f32 v52, v52, v116
    v_mul_f32 v53, v53, v117
    v_mul_f32 v54, v54, v118
    v_mul_f32 v55, v55, v119
    v_cvt_pk_bf16_f32 v238, v52, v53
    v_cvt_pk_bf16_f32 v239, v54, v55
    buffer_store_dwordx4 v[236:239], v249, s[16:19], s31 offen offset:1024 sc1
    v_max_f32 v40, 0, v40
    v_max_f32 v41, 0, v41
    v_max_f32 v42, 0, v42
    v_max_f32 v43, 0, v43
    v_pk_mul_f32 v[40:41], v[40:41], v[104:105]
    v_pk_mul_f32 v[42:43], v[42:43], v[106:107]
    v_cvt_pk_bf16_f32 v240, v40, v41
    v_cvt_pk_bf16_f32 v241, v42, v43
    v_max_f32 v56, 0, v56
    v_max_f32 v57, 0, v57
    v_max_f32 v58, 0, v58
    v_max_f32 v59, 0, v59
    v_pk_mul_f32 v[56:57], v[56:57], v[120:121]
    v_pk_mul_f32 v[58:59], v[58:59], v[122:123]
    v_cvt_pk_bf16_f32 v242, v56, v57
    v_cvt_pk_bf16_f32 v243, v58, v59
    buffer_store_dwordx4 v[240:243], v249, s[16:19], s32 offen offset:1024 sc1
    v_max_f32 v44, 0, v44
    v_max_f32 v45, 0, v45
    v_max_f32 v46, 0, v46
    v_max_f32 v47, 0, v47
    v_pk_mul_f32 v[44:45], v[44:45], v[108:109]
    v_pk_mul_f32 v[46:47], v[46:47], v[110:111]
    v_cvt_pk_bf16_f32 v244, v44, v45
    v_cvt_pk_bf16_f32 v245, v46, v47
    v_max_f32 v60, 0, v60
    v_max_f32 v61, 0, v61
    v_max_f32 v62, 0, v62
    v_max_f32 v63, 0, v63
    v_pk_mul_f32 v[60:61], v[60:61], v[124:125]
    v_pk_mul_f32 v[62:63], v[62:63], v[126:127]
    v_cvt_pk_bf16_f32 v246, v60, v61
    v_cvt_pk_bf16_f32 v247, v62, v63
    buffer_store_dwordx4 v[244:247], v249, s[16:19], s33 offen offset:1024 sc1
    s_add_u32 s24, s24, 0x4000
G3_start:
    s_waitcnt vmcnt(20)
    v_add_u32 v126, s28, v249
    v_add_u32 v127, s29, v249
    s_add_u32 s81, s51, 696320
    buffer_load_dwordx4 a[128:131], v249, s[16:19], s81 offen offset:0 sc1
    buffer_load_dwordx4 a[132:135], v249, s[16:19], s81 offen offset:1024 sc1
    buffer_load_dwordx4 a[136:139], v249, s[16:19], s81 offen offset:2048 sc1
    buffer_load_dwordx4 a[140:143], v249, s[16:19], s81 offen offset:3072 sc1
    s_add_u32 s81, s81, s79
    buffer_load_dwordx4 a[144:147], v249, s[16:19], s81 offen offset:0 sc1
    ds_read_b128 a[192:195], v126 offset:0
    ds_read_b128 a[196:199], v126 offset:1024
    ds_read_b128 a[200:203], v126 offset:2048
    ds_read_b128 a[204:207], v126 offset:3072
    ds_read_b128 a[208:211], v126 offset:4096
    ds_read_b128 a[212:215], v126 offset:5120
    ds_read_b128 a[216:219], v126 offset:6144
    ds_read_b128 a[220:223], v126 offset:7168
    ds_read_b128 a[224:227], v127 offset:0
    ds_read_b128 a[228:231], v127 offset:1024
    ds_read_b128 a[232:235], v127 offset:2048
    ds_read_b128 a[236:239], v127 offset:3072
    ds_read_b128 a[240:243], v127 offset:4096
    ds_read_b128 a[244:247], v127 offset:5120
    ds_read_b128 a[248:251], v127 offset:6144
    v_accvgpr_read_b32 v80, a0
    v_accvgpr_read_b32 v81, a1
    v_accvgpr_read_b32 v82, a2
    v_accvgpr_read_b32 v83, a3
    v_accvgpr_read_b32 v84, a4
    v_accvgpr_read_b32 v85, a5
    v_accvgpr_read_b32 v86, a6
    v_accvgpr_read_b32 v87, a7
    v_accvgpr_read_b32 v88, a8
    v_accvgpr_read_b32 v89, a9
    v_accvgpr_read_b32 v90, a10
    v_accvgpr_read_b32 v91, a11
    v_accvgpr_read_b32 v92, a12
    v_accvgpr_read_b32 v93, a13
    v_accvgpr_read_b32 v94, a14
    v_accvgpr_read_b32 v95, a15
    v_accvgpr_read_b32 v96, a16
    v_accvgpr_read_b32 v97, a17
    v_accvgpr_read_b32 v98, a18
    v_accvgpr_read_b32 v99, a19
    s_lshr_b32 s3, s37, 2
    s_add_u32 s3, s3, 102400
    v_add_u32 v252, s3, v229
    v_min_u32 v126, 0x1a0, v249
    s_lshl_b32 s3, s76, 7
    s_add_u32 s3, s3, 2936832
    s_add_u32 s25, s3, 0x4000
    s_cmp_eq_u32 s22, 0
    s_cselect_b32 s3, s3, 0x7f000000
    buffer_load_dword v127, v126, s[16:19], s3 offen sc1
    s_waitcnt vmcnt(6)
    s_mov_b64 exec, 1
    buffer_store_dword v209, v208, s[16:19], s24 offen sc1
    s_mov_b64 exec, -1
    s_add_u32 s81, s51, 1024000
    buffer_load_dwordx4 a[148:151], v249, s[16:19], s81 offen offset:0 sc1
    buffer_load_dwordx4 a[152:155], v249, s[16:19], s81 offen offset:1024 sc1
    buffer_load_dwordx4 a[156:159], v249, s[16:19], s81 offen offset:2048 sc1
    buffer_load_dwordx4 a[160:163], v249, s[16:19], s81 offen offset:3072 sc1
    s_add_u32 s81, s81, s79
    buffer_load_dwordx4 a[164:167], v249, s[16:19], s81 offen offset:0 sc1
    s_waitcnt lgkmcnt(0)
    s_cmp_lg_u32 s22, 0
    s_waitcnt vmcnt(6)
    s_cbranch_scc1 S3_ok
    v_cmp_ne_u32 vcc, s55, v127
    s_cbranch_vccz S3_ok
S3_spin:
    s_mov_b32 s98, 262144
S3_loop:
    buffer_load_dword v127, v126, s[16:19], s3 offen sc1
    s_sub_u32 s98, s98, 1
    s_waitcnt vmcnt(0)
    s_cbranch_scc1 S3_ok
    v_cmp_ne_u32 vcc, s55, v127
    s_cbranch_vccz S3_ok
    s_sleep 6
    s_branch S3_loop
S3_ok:
    s_barrier
    s_add_u32 s82, s80, 0
    buffer_load_dwordx4 a[84:87], v225, s[16:19], s82 offen sc1
    buffer_load_dwordx4 a[88:91], v226, s[16:19], s82 offen sc1
    buffer_load_dwordx4 a[92:95], v227, s[16:19], s82 offen sc1
    buffer_load_dwordx4 a[80:83], v224, s[16:19], s82 offen sc1
    s_add_u32 s82, s80, 8192
    buffer_load_dwordx4 a[4:7], v225, s[16:19], s82 offen sc1
    buffer_load_dwordx4 a[8:11], v226, s[16:19], s82 offen sc1
    buffer_load_dwordx4 a[12:15], v227, s[16:19], s82 offen sc1
    buffer_load_dwordx4 a[0:3], v224, s[16:19], s82 offen sc1
    s_add_u32 s82, s80, 16384
    buffer_load_dwordx4 v[212:215], v225, s[16:19], s82 offen sc1
    buffer_load_dwordx4 v[216:219], v226, s[16:19], s82 offen sc1
    buffer_load_dwordx4 v[220:223], v227, s[16:19], s82 offen sc1
    buffer_load_dwordx4 v[208:211], v224, s[16:19], s82 offen sc1
    s_add_u32 s82, s80, 24576
    buffer_load_dwordx4 v[236:239], v225, s[16:19], s82 offen sc1
    buffer_load_dwordx4 v[240:243], v226, s[16:19], s82 offen sc1
    buffer_load_dwordx4 v[244:247], v227, s[16:19], s82 offen sc1
    buffer_load_dwordx4 v[232:235], v224, s[16:19], s82 offen sc1
    s_lshl_b32 s3, s83, 10
    s_add_u32 s3, s3, 2686976
    buffer_load_dwordx4 v[120:123], v249, s[16:19], s3 offen sc1
    s_mul_i32 s3, s22, 15360
    s_add_u32 s3, s3, 32768
    v_and_b32 v248, 0xf0, v249
    v_lshl_add_u32 v248, v248, 3, v229
    v_lshrrev_b32 v248, 1, v248
    v_add_u32 v248, s3, v248
    s_waitcnt vmcnt(13)
    v_mfma_f32_16x16x32_bf16 v[0:3], a[20:23], a[80:83], 0
    s_add_u32 s82, s80, 32768
    v_mfma_f32_16x16x32_bf16 v[20:23], a[20:23], a[84:87], 0
    buffer_load_dwordx4 a[120:123], v225, s[16:19], s82 offen sc1
    v_mfma_f32_16x16x32_bf16 v[40:43], a[20:23], a[88:91], 0
    v_mfma_f32_16x16x32_bf16 v[60:63], a[20:23], a[92:95], 0
    v_mfma_f32_16x16x32_bf16 v[64:67], a[24:27], a[92:95], 0
    v_mfma_f32_16x16x32_bf16 v[44:47], a[24:27], a[88:91], 0
    buffer_load_dwordx4 a[124:127], v226, s[16:19], s82 offen sc1
    v_mfma_f32_16x16x32_bf16 v[24:27], a[24:27], a[84:87], 0
    v_mfma_f32_16x16x32_bf16 v[4:7], a[24:27], a[80:83], 0
    v_mfma_f32_16x16x32_bf16 v[8:11], a[28:31], a[80:83], 0
    v_mfma_f32_16x16x32_bf16 v[28:31], a[28:31], a[84:87], 0
    v_mfma_f32_16x16x32_bf16 v[48:51], a[28:31], a[88:91], 0
    buffer_load_dwordx4 a[188:191], v227, s[16:19], s82 offen sc1
    v_mfma_f32_16x16x32_bf16 v[68:71], a[28:31], a[92:95], 0
    v_mfma_f32_16x16x32_bf16 v[72:75], a[32:35], a[92:95], 0
    v_mfma_f32_16x16x32_bf16 v[52:55], a[32:35], a[88:91], 0
    v_mfma_f32_16x16x32_bf16 v[32:35], a[32:35], a[84:87], 0
    v_mfma_f32_16x16x32_bf16 v[12:15], a[32:35], a[80:83], 0
    buffer_load_dwordx4 a[116:119], v224, s[16:19], s82 offen sc1
    v_mfma_f32_16x16x32_bf16 v[16:19], a[36:39], a[80:83], 0
    v_mfma_f32_16x16x32_bf16 v[36:39], a[36:39], a[84:87], 0
    v_mfma_f32_16x16x32_bf16 v[56:59], a[36:39], a[88:91], 0
    v_mfma_f32_16x16x32_bf16 v[76:79], a[36:39], a[92:95], 0
    s_waitcnt vmcnt(13)
    v_mfma_f32_16x16x32_bf16 v[0:3], a[40:43], a[0:3], v[0:3]
    v_mfma_f32_16x16x32_bf16 v[20:23], a[40:43], a[4:7], v[20:23]
    buffer_load_dword v127, v126, s[16:19], s25 offen sc1
    v_mfma_f32_16x16x32_bf16 v[40:43], a[40:43], a[8:11], v[40:43]
    v_mfma_f32_16x16x32_bf16 v[60:63], a[40:43], a[12:15], v[60:63]
    s_add_u32 s82, s80, 40960
    v_mfma_f32_16x16x32_bf16 v[64:67], a[44:47], a[12:15], v[64:67]
    buffer_load_dwordx4 a[84:87], v225, s[16:19], s82 offen sc1
    v_mfma_f32_16x16x32_bf16 v[44:47], a[44:47], a[8:11], v[44:47]
    v_mfma_f32_16x16x32_bf16 v[24:27], a[44:47], a[4:7], v[24:27]
    v_mfma_f32_16x16x32_bf16 v[4:7], a[44:47], a[0:3], v[4:7]
    v_mfma_f32_16x16x32_bf16 v[8:11], a[48:51], a[0:3], v[8:11]
    buffer_load_dwordx4 a[88:91], v226, s[16:19], s82 offen sc1
    v_mfma_f32_16x16x32_bf16 v[28:31], a[48:51], a[4:7], v[28:31]
    v_mfma_f32_16x16x32_bf16 v[48:51], a[48:51], a[8:11], v[48:51]
    v_mfma_f32_16x16x32_bf16 v[68:71], a[48:51], a[12:15], v[68:71]
    v_mfma_f32_16x16x32_bf16 v[72:75], a[52:55], a[12:15], v[72:75]
    buffer_load_dwordx4 a[92:95], v227, s[16:19], s82 offen sc1
    v_mfma_f32_16x16x32_bf16 v[52:55], a[52:55], a[8:11], v[52:55]
    v_mfma_f32_16x16x32_bf16 v[32:35], a[52:55], a[4:7], v[32:35]
    v_mfma_f32_16x16x32_bf16 v[12:15], a[52:55], a[0:3], v[12:15]
    v_mfma_f32_16x16x32_bf16 v[16:19], a[56:59], a[0:3], v[16:19]
    buffer_load_dwordx4 a[80:83], v224, s[16:19], s82 offen sc1
    v_mfma_f32_16x16x32_bf16 v[36:39], a[56:59], a[4:7], v[36:39]
    v_mfma_f32_16x16x32_bf16 v[56:59], a[56:59], a[8:11], v[56:59]
    v_mfma_f32_16x16x32_bf16 v[76:79], a[56:59], a[12:15], v[76:79]
    s_waitcnt vmcnt(14)
    v_mfma_f32_16x16x32_bf16 v[0:3], v[128:131], v[208:211], v[0:3]
    s_add_u32 s82, s80, 49152
    s_cmp_lt_u32 s22, 3
    s_cselect_b32 s82, s82, 0x7f000000
    v_mfma_f32_16x16x32_bf16 v[20:23], v[128:131], v[212:215], v[20:23]
    buffer_load_dwordx4 a[4:7], v225, s[16:19], s82 offen sc1
    v_mfma_f32_16x16x32_bf16 v[40:43], v[128:131], v[216:219], v[40:43]
    v_mfma_f32_16x16x32_bf16 v[60:63], v[128:131], v[220:223], v[60:63]
    v_mfma_f32_16x16x32_bf16 v[64:67], v[132:135], v[220:223], v[64:67]
    v_mfma_f32_16x16x32_bf16 v[44:47], v[132:135], v[216:219], v[44:47]
    buffer_load_dwordx4 a[8:11], v226, s[16:19], s82 offen sc1
    v_mfma_f32_16x16x32_bf16 v[24:27], v[132:135], v[212:215], v[24:27]
    v_mfma_f32_16x16x32_bf16 v[4:7], v[132:135], v[208:211], v[4:7]
    v_mfma_f32_16x16x32_bf16 v[8:11], v[136:139], v[208:211], v[8:11]
    v_mfma_f32_16x16x32_bf16 v[28:31], v[136:139], v[212:215], v[28:31]
    v_mfma_f32_16x16x32_bf16 v[48:51], v[136:139], v[216:219], v[48:51]
    buffer_load_dwordx4 a[12:15], v227, s[16:19], s82 offen sc1
    v_mfma_f32_16x16x32_bf16 v[68:71], v[136:139], v[220:223], v[68:71]
    v_mfma_f32_16x16x32_bf16 v[72:75], v[140:143], v[220:223], v[72:75]
    v_mfma_f32_16x16x32_bf16 v[52:55], v[140:143], v[216:219], v[52:55]
    v_mfma_f32_16x16x32_bf16 v[32:35], v[140:143], v[212:215], v[32:35]
    v_mfma_f32_16x16x32_bf16 v[12:15], v[140:143], v[208:211], v[12:15]
    buffer_load_dwordx4 a[0:3], v224, s[16:19], s82 offen sc1
    v_mfma_f32_16x16x32_bf16 v[16:19], v[144:147], v[208:211], v[16:19]
    v_mfma_f32_16x16x32_bf16 v[36:39], v[144:147], v[212:215], v[36:39]
    v_mfma_f32_16x16x32_bf16 v[56:59], v[144:147], v[216:219], v[56:59]
    v_mfma_f32_16x16x32_bf16 v[76:79], v[144:147], v[220:223], v[76:79]
    s_waitcnt vmcnt(14)
    s_waitcnt vmcnt(8)
    v_cmp_ne_u32 vcc, s55, v127
    s_cbranch_vccnz S3b_spin
S3b_ok:
    v_mfma_f32_16x16x32_bf16 v[0:3], v[148:151], v[232:235], v[0:3]
    s_add_u32 s82, s80, 1024
    v_mfma_f32_16x16x32_bf16 v[20:23], v[148:151], v[236:239], v[20:23]
HOP1_6:
    s_cbranch_execz HOPRET1
    buffer_load_dwordx4 v[212:215], v225, s[16:19], s82 offen sc1
    v_mfma_f32_16x16x32_bf16 v[40:43], v[148:151], v[240:243], v[40:43]
    v_mfma_f32_16x16x32_bf16 v[60:63], v[148:151], v[244:247], v[60:63]
    v_mfma_f32_16x16x32_bf16 v[64:67], v[152:155], v[244:247], v[64:67]
    v_mfma_f32_16x16x32_bf16 v[44:47], v[152:155], v[240:243], v[44:47]
    buffer_load_dwordx4 v[216:219], v226, s[16:19], s82 offen sc1
    v_mfma_f32_16x16x32_bf16 v[24:27], v[152:155], v[236:239], v[24:27]
    v_mfma_f32_16x16x32_bf16 v[4:7], v[152:155], v[232:235], v[4:7]
    v_mfma_f32_16x16x32_bf16 v[8:11], v[156:159], v[232:235], v[8:11]
    v_mfma_f32_16x16x32_bf16 v[28:31], v[156:159], v[236:239], v[28:31]
    v_mfma_f32_16x16x32_bf16 v[48:51], v[156:159], v[240:243], v[48:51]
    buffer_load_dwordx4 v[220:223], v227, s[16:19], s82 offen sc1
    v_mfma_f32_16x16x32_bf16 v[68:71], v[156:159], v[244:247], v[68:71]
    v_mfma_f32_16x16x32_bf16 v[72:75], v[160:163], v[244:247], v[72:75]
    v_mfma_f32_16x16x32_bf16 v[52:55], v[160:163], v[240:243], v[52:55]
    v_mfma_f32_16x16x32_bf16 v[32:35], v[160:163], v[236:239], v[32:35]
    v_mfma_f32_16x16x32_bf16 v[12:15], v[160:163], v[232:235], v[12:15]
    buffer_load_dwordx4 v[208:211], v224, s[16:19], s82 offen sc1
    v_mfma_f32_16x16x32_bf16 v[16:19], v[164:167], v[232:235], v[16:19]
    v_mfma_f32_16x16x32_bf16 v[36:39], v[164:167], v[236:239], v[36:39]
    v_mfma_f32_16x16x32_bf16 v[56:59], v[164:167], v[240:243], v[56:59]
    v_mfma_f32_16x16x32_bf16 v[76:79], v[164:167], v[244:247], v[76:79]
    v_mfma_f32_16x16x32_bf16 v[0:3], v[168:171], a[116:119], v[0:3]
    s_add_u32 s82, s80, 9216
    v_mfma_f32_16x16x32_bf16 v[20:23], v[168:171], a[120:123], v[20:23]
    buffer_load_dwordx4 v[236:239], v225, s[16:19], s82 offen sc1
    v_mfma_f32_16x16x32_bf16 v[40:43], v[168:171], a[124:127], v[40:43]
    v_mfma_f32_16x16x32_bf16 v[60:63], v[168:171], a[188:191], v[60:63]
    v_mfma_f32_16x16x32_bf16 v[64:67], v[172:175], a[188:191], v[64:67]
    v_mfma_f32_16x16x32_bf16 v[44:47], v[172:175], a[124:127], v[44:47]
    buffer_load_dwordx4 v[240:243], v226, s[16:19], s82 offen sc1
    v_mfma_f32_16x16x32_bf16 v[24:27], v[172:175], a[120:123], v[24:27]
    v_mfma_f32_16x16x32_bf16 v[4:7], v[172:175], a[116:119], v[4:7]
    v_mfma_f32_16x16x32_bf16 v[8:11], v[176:179], a[116:119], v[8:11]
    v_mfma_f32_16x16x32_bf16 v[28:31], v[176:179], a[120:123], v[28:31]
    v_mfma_f32_16x16x32_bf16 v[48:51], v[176:179], a[124:127], v[48:51]
    buffer_load_dwordx4 v[244:247], v227, s[16:19], s82 offen sc1
    v_mfma_f32_16x16x32_bf16 v[68:71], v[176:179], a[188:191], v[68:71]
    v_mfma_f32_16x16x32_bf16 v[72:75], v[180:183], a[188:191], v[72:75]
    v_mfma_f32_16x16x32_bf16 v[52:55], v[180:183], a[124:127], v[52:55]
    v_mfma_f32_16x16x32_bf16 v[32:35], v[180:183], a[120:123], v[32:35]
    v_mfma_f32_16x16x32_bf16 v[12:15], v[180:183], a[116:119], v[12:15]
    buffer_load_dwordx4 v[232:235], v224, s[16:19], s82 offen sc1
    v_mfma_f32_16x16x32_bf16 v[16:19], v[184:187], a[116:119], v[16:19]
    v_mfma_f32_16x16x32_bf16 v[36:39], v[184:187], a[120:123], v[36:39]
    v_mfma_f32_16x16x32_bf16 v[56:59], v[184:187], a[124:127], v[56:59]
    v_mfma_f32_16x16x32_bf16 v[76:79], v[184:187], a[188:191], v[76:79]
    s_waitcnt vmcnt(12)
    v_mfma_f32_16x16x32_bf16 v[0:3], v[188:191], a[80:83], v[0:3]
    s_add_u32 s82, s80, 17408
    ds_read_b128 v[100:103], v252 offset:0
    v_mfma_f32_16x16x32_bf16 v[20:23], v[188:191], a[84:87], v[20:23]
    buffer_load_dwordx4 a[120:123], v225, s[16:19], s82 offen sc1
    v_mfma_f32_16x16x32_bf16 v[40:43], v[188:191], a[88:91], v[40:43]
    ds_read_b128 v[104:107], v252 offset:64
    v_mfma_f32_16x16x32_bf16 v[60:63], v[188:191], a[92:95], v[60:63]
    ds_read_b128 v[108:111], v252 offset:128
    v_mfma_f32_16x16x32_bf16 v[64:67], v[192:195], a[92:95], v[64:67]
    ds_read_b128 v[112:115], v252 offset:192
    v_mfma_f32_16x16x32_bf16 v[44:47], v[192:195], a[88:91], v[44:47]
    buffer_load_dwordx4 a[124:127], v226, s[16:19], s82 offen sc1
    v_mfma_f32_16x16x32_bf16 v[24:27], v[192:195], a[84:87], v[24:27]
    ds_read_b128 v[116:119], v252 offset:256
    v_mfma_f32_16x16x32_bf16 v[4:7], v[192:195], a[80:83], v[4:7]
    v_mfma_f32_16x16x32_bf16 v[8:11], v[196:199], a[80:83], v[8:11]
    v_mfma_f32_16x16x32_bf16 v[28:31], v[196:199], a[84:87], v[28:31]
    v_mfma_f32_16x16x32_bf16 v[48:51], v[196:199], a[88:91], v[48:51]
    buffer_load_dwordx4 a[188:191], v227, s[16:19], s82 offen sc1
    v_mfma_f32_16x16x32_bf16 v[68:71], v[196:199], a[92:95], v[68:71]
    v_mfma_f32_16x16x32_bf16 v[72:75], v[200:203], a[92:95], v[72:75]
    v_mfma_f32_16x16x32_bf16 v[52:55], v[200:203], a[88:91], v[52:55]
    v_mfma_f32_16x16x32_bf16 v[32:35], v[200:203], a[84:87], v[32:35]
    v_mfma_f32_16x16x32_bf16 v[12:15], v[200:203], a[80:83], v[12:15]
    buffer_load_dwordx4 a[116:119], v224, s[16:19], s82 offen sc1
    v_mfma_f32_16x16x32_bf16 v[16:19], v[204:207], a[80:83], v[16:19]
    v_mfma_f32_16x16x32_bf16 v[36:39], v[204:207], a[84:87], v[36:39]
    v_mfma_f32_16x16x32_bf16 v[56:59], v[204:207], a[88:91], v[56:59]
    v_mfma_f32_16x16x32_bf16 v[76:79], v[204:207], a[92:95], v[76:79]
    s_waitcnt vmcnt(12) lgkmcnt(0)
    v_mfma_f32_16x16x32_bf16 v[0:3], a[168:171], a[0:3], v[0:3]
    s_add_u32 s82, s80, 25600
    v_and_b32 v126, 0xf0, v249
    v_add_u32 v248, v248, v126
    v_mfma_f32_16x16x32_bf16 v[20:23], a[168:171], a[4:7], v[20:23]
    buffer_load_dwordx4 a[84:87], v225, s[16:19], s82 offen sc1
    v_mfma_f32_16x16x32_bf16 v[40:43], a[168:171], a[8:11], v[40:43]
    v_lshrrev_b32 v126, 6, v249
    v_lshl_add_u32 v126, v126, 4, v230
    v_mfma_f32_16x16x32_bf16 v[60:63], a[168:171], a[12:15], v[60:63]
    v_mfma_f32_16x16x32_bf16 v[64:67], a[172:175], a[12:15], v[64:67]
    v_mfma_f32_16x16x32_bf16 v[44:47], a[172:175], a[8:11], v[44:47]
    buffer_load_dwordx4 a[88:91], v226, s[16:19], s82 offen sc1
    v_mfma_f32_16x16x32_bf16 v[24:27], a[172:175], a[4:7], v[24:27]
    v_mfma_f32_16x16x32_bf16 v[4:7], a[172:175], a[0:3], v[4:7]
    v_mfma_f32_16x16x32_bf16 v[8:11], a[176:179], a[0:3], v[8:11]
    v_mfma_f32_16x16x32_bf16 v[28:31], a[176:179], a[4:7], v[28:31]
    v_mfma_f32_16x16x32_bf16 v[48:51], a[176:179], a[8:11], v[48:51]
    buffer_load_dwordx4 a[92:95], v227, s[16:19], s82 offen sc1
    v_mfma_f32_16x16x32_bf16 v[68:71], a[176:179], a[12:15], v[68:71]
    v_mfma_f32_16x16x32_bf16 v[72:75], a[180:183], a[12:15], v[72:75]
    v_mfma_f32_16x16x32_bf16 v[52:55], a[180:183], a[8:11], v[52:55]
    v_mfma_f32_16x16x32_bf16 v[32:35], a[180:183], a[4:7], v[32:35]
    v_mfma_f32_16x16x32_bf16 v[12:15], a[180:183], a[0:3], v[12:15]
    buffer_load_dwordx4 a[80:83], v224, s[16:19], s82 offen sc1
    v_mfma_f32_16x16x32_bf16 v[16:19], a[184:187], a[0:3], v[16:19]
    v_mfma_f32_16x16x32_bf16 v[36:39], a[184:187], a[4:7], v[36:39]
    v_mfma_f32_16x16x32_bf16 v[56:59], a[184:187], a[8:11], v[56:59]
    v_mfma_f32_16x16x32_bf16 v[76:79], a[184:187], a[12:15], v[76:79]
    s_waitcnt vmcnt(12)
    v_mfma_f32_16x16x32_bf16 v[0:3], a[60:63], v[208:211], v[0:3]
    s_add_u32 s82, s80, 33792
    v_mfma_f32_16x16x32_bf16 v[20:23], a[60:63], v[212:215], v[20:23]
    buffer_load_dwordx4 a[4:7], v225, s[16:19], s82 offen sc1
    v_mfma_f32_16x16x32_bf16 v[40:43], a[60:63], v[216:219], v[40:43]
    v_mfma_f32_16x16x32_bf16 v[60:63], a[60:63], v[220:223], v[60:63]
    v_mfma_f32_16x16x32_bf16 v[64:67], a[64:67], v[220:223], v[64:67]
    v_mfma_f32_16x16x32_bf16 v[44:47], a[64:67], v[216:219], v[44:47]
    buffer_load_dwordx4 a[8:11], v226, s[16:19], s82 offen sc1
    v_mfma_f32_16x16x32_bf16 v[24:27], a[64:67], v[212:215], v[24:27]
    v_mfma_f32_16x16x32_bf16 v[4:7], a[64:67], v[208:211], v[4:7]
    v_mfma_f32_16x16x32_bf16 v[8:11], a[68:71], v[208:211], v[8:11]
    v_mfma_f32_16x16x32_bf16 v[28:31], a[68:71], v[212:215], v[28:31]
    v_mfma_f32_16x16x32_bf16 v[48:51], a[68:71], v[216:219], v[48:51]
    buffer_load_dwordx4 a[12:15], v227, s[16:19], s82 offen sc1
    v_mfma_f32_16x16x32_bf16 v[68:71], a[68:71], v[220:223], v[68:71]
    v_mfma_f32_16x16x32_bf16 v[72:75], a[72:75], v[220:223], v[72:75]
    v_mfma_f32_16x16x32_bf16 v[52:55], a[72:75], v[216:219], v[52:55]
    v_mfma_f32_16x16x32_bf16 v[32:35], a[72:75], v[212:215], v[32:35]
    v_mfma_f32_16x16x32_bf16 v[12:15], a[72:75], v[208:211], v[12:15]
    buffer_load_dwordx4 a[0:3], v224, s[16:19], s82 offen sc1
    v_mfma_f32_16x16x32_bf16 v[16:19], a[76:79], v[208:211], v[16:19]
    v_mfma_f32_16x16x32_bf16 v[36:39], a[76:79], v[212:215], v[36:39]
    v_mfma_f32_16x16x32_bf16 v[56:59], a[76:79], v[216:219], v[56:59]
    v_mfma_f32_16x16x32_bf16 v[76:79], a[76:79], v[220:223], v[76:79]
    s_waitcnt vmcnt(12)
    v_mfma_f32_16x16x32_bf16 v[0:3], a[96:99], v[232:235], v[0:3]
    s_add_u32 s82, s80, 41984
    v_add_f32 v120, v120, v122
    v_add_f32 v121, v121, v123
    v_mfma_f32_16x16x32_bf16 v[20:23], a[96:99], v[236:239], v[20:23]
    buffer_load_dwordx4 v[212:215], v225, s[16:19], s82 offen sc1
    v_mfma_f32_16x16x32_bf16 v[40:43], a[96:99], v[240:243], v[40:43]
    v_mov_b32 v122, v120
    v_mov_b32 v123, v121
    v_mfma_f32_16x16x32_bf16 v[60:63], a[96:99], v[244:247], v[60:63]
    s_nop 0
    v_permlane32_swap_b32 v122, v120
    v_mfma_f32_16x16x32_bf16 v[64:67], a[100:103], v[244:247], v[64:67]
    v_permlane32_swap_b32 v123, v121
    v_add_f32 v120, v120, v122
    v_mfma_f32_16x16x32_bf16 v[44:47], a[100:103], v[240:243], v[44:47]
    buffer_load_dwordx4 v[216:219], v226, s[16:19], s82 offen sc1
    v_mfma_f32_16x16x32_bf16 v[24:27], a[100:103], v[236:239], v[24:27]
    v_add_f32 v121, v121, v123
    v_mov_b32 v122, v120
    v_mfma_f32_16x16x32_bf16 v[4:7], a[100:103], v[232:235], v[4:7]
    v_mov_b32 v123, v121
    s_nop 0
    v_mfma_f32_16x16x32_bf16 v[8:11], a[104:107], v[232:235], v[8:11]
    v_permlane16_swap_b32 v122, v120
    v_permlane16_swap_b32 v123, v121
    v_mfma_f32_16x16x32_bf16 v[28:31], a[104:107], v[236:239], v[28:31]
    v_add_f32 v120, v120, v122
    v_add_f32 v121, v121, v123
    v_mfma_f32_16x16x32_bf16 v[48:51], a[104:107], v[240:243], v[48:51]
    buffer_load_dwordx4 v[220:223], v227, s[16:19], s82 offen sc1
    v_mfma_f32_16x16x32_bf16 v[68:71], a[104:107], v[244:247], v[68:71]
    v_mul_f32 v124, 0xbacccccd, v120
    v_mul_f32 v121, 0x3acccccd, v121
    v_mfma_f32_16x16x32_bf16 v[72:75], a[108:111], v[244:247], v[72:75]
    v_mul_f32 v122, 0x33800000, v124
    v_fma_f32 v121, -v124, v124, v121
    v_mfma_f32_16x16x32_bf16 v[52:55], a[108:111], v[240:243], v[52:55]
    v_mul_f32 v122, v122, v124
    v_max_f32 v121, v122, v121
    v_mfma_f32_16x16x32_bf16 v[32:35], a[108:111], v[236:239], v[32:35]
    v_add_f32 v121, 0x3727c5ac, v121
    v_rcp_f32 v125, v121
    v_mfma_f32_16x16x32_bf16 v[12:15], a[108:111], v[232:235], v[12:15]
    buffer_load_dwordx4 v[208:211], v224, s[16:19], s82 offen sc1
    v_mfma_f32_16x16x32_bf16 v[16:19], a[112:115], v[232:235], v[16:19]
    v_mfma_f32_16x16x32_bf16 v[36:39], a[112:115], v[236:239], v[36:39]
    v_mfma_f32_16x16x32_bf16 v[56:59], a[112:115], v[240:243], v[56:59]
    v_mfma_f32_16x16x32_bf16 v[76:79], a[112:115], v[244:247], v[76:79]
    s_waitcnt vmcnt(12)
    v_mfma_f32_16x16x32_bf16 v[0:3], a[128:131], a[116:119], v[0:3]
    s_add_u32 s82, s80, 50176
    s_cmp_lt_u32 s22, 3
    s_cselect_b32 s82, s82, 0x7f000000
    v_mul_f32 v100, v100, v125
    v_mul_f32 v101, v101, v125
    v_mfma_f32_16x16x32_bf16 v[20:23], a[128:131], a[120:123], v[20:23]
    buffer_load_dwordx4 v[236:239], v225, s[16:19], s82 offen sc1
    v_mfma_f32_16x16x32_bf16 v[40:43], a[128:131], a[124:127], v[40:43]
    v_mul_f32 v102, v102, v125
    v_mul_f32 v103, v103, v125
    v_mfma_f32_16x16x32_bf16 v[60:63], a[128:131], a[188:191], v[60:63]
    v_mul_f32 v104, v104, v125
    v_mul_f32 v105, v105, v125
    v_mfma_f32_16x16x32_bf16 v[64:67], a[132:135], a[188:191], v[64:67]
    v_mul_f32 v106, v106, v125
    v_mul_f32 v107, v107, v125
    v_mfma_f32_16x16x32_bf16 v[44:47], a[132:135], a[124:127], v[44:47]
    buffer_load_dwordx4 v[240:243], v226, s[16:19], s82 offen sc1
    v_mfma_f32_16x16x32_bf16 v[24:27], a[132:135], a[120:123], v[24:27]
    v_mul_f32 v108, v108, v125
    v_mul_f32 v109, v109, v125
    v_mfma_f32_16x16x32_bf16 v[4:7], a[132:135], a[116:119], v[4:7]
    v_mul_f32 v110, v110, v125
    v_mul_f32 v111, v111, v125
    v_mfma_f32_16x16x32_bf16 v[8:11], a[136:139], a[116:119], v[8:11]
    v_mul_f32 v112, v112, v125
    v_mul_f32 v113, v113, v125
    v_mfma_f32_16x16x32_bf16 v[28:31], a[136:139], a[120:123], v[28:31]
    v_mul_f32 v114, v114, v125
    v_mul_f32 v115, v115, v125
    v_mfma_f32_16x16x32_bf16 v[48:51], a[136:139], a[124:127], v[48:51]
    buffer_load_dwordx4 v[244:247], v227, s[16:19], s82 offen sc1
    v_mfma_f32_16x16x32_bf16 v[68:71], a[136:139], a[188:191], v[68:71]
    v_mul_f32 v116, v116, v125
    v_mul_f32 v117, v117, v125
    v_mfma_f32_16x16x32_bf16 v[72:75], a[140:143], a[188:191], v[72:75]
    v_mul_f32 v118, v118, v125
    v_mul_f32 v119, v119, v125
    v_mfma_f32_16x16x32_bf16 v[52:55], a[140:143], a[124:127], v[52:55]
    v_mfma_f32_16x16x32_bf16 v[32:35], a[140:143], a[120:123], v[32:35]
    v_mfma_f32_16x16x32_bf16 v[12:15], a[140:143], a[116:119], v[12:15]
    buffer_load_dwordx4 v[232:235], v224, s[16:19], s82 offen sc1
    v_mfma_f32_16x16x32_bf16 v[16:19], a[144:147], a[116:119], v[16:19]
    v_mfma_f32_16x16x32_bf16 v[36:39], a[144:147], a[120:123], v[36:39]
    v_mfma_f32_16x16x32_bf16 v[56:59], a[144:147], a[124:127], v[56:59]
    v_mfma_f32_16x16x32_bf16 v[76:79], a[144:147], a[188:191], v[76:79]
    s_waitcnt vmcnt(3)
    v_mfma_f32_16x16x32_bf16 v[20:23], a[148:151], a[84:87], v[20:23]
    v_mfma_f32_16x16x32_bf16 v[20:23], a[192:195], a[4:7], v[20:23]
    v_mfma_f32_16x16x32_bf16 v[20:23], a[212:215], v[212:215], v[20:23]
    v_mfma_f32_16x16x32_bf16 v[20:23], a[232:235], v[236:239], v[20:23]
    v_mfma_f32_16x16x32_bf16 v[24:27], a[236:239], v[236:239], v[24:27]
    v_mfma_f32_16x16x32_bf16 v[24:27], a[216:219], v[212:215], v[24:27]
    v_mfma_f32_16x16x32_bf16 v[24:27], a[196:199], a[4:7], v[24:27]
    v_mfma_f32_16x16x32_bf16 v[24:27], a[152:155], a[84:87], v[24:27]
    v_mfma_f32_16x16x32_bf16 v[28:31], a[156:159], a[84:87], v[28:31]
    v_mfma_f32_16x16x32_bf16 v[28:31], a[200:203], a[4:7], v[28:31]
    v_mfma_f32_16x16x32_bf16 v[28:31], a[220:223], v[212:215], v[28:31]
    v_mfma_f32_16x16x32_bf16 v[28:31], a[240:243], v[236:239], v[28:31]
    ds_write_b128 v231, v[20:23] offset:0
    v_mfma_f32_16x16x32_bf16 v[32:35], a[244:247], v[236:239], v[32:35]
    v_mfma_f32_16x16x32_bf16 v[32:35], a[224:227], v[212:215], v[32:35]
    v_mfma_f32_16x16x32_bf16 v[32:35], a[204:207], a[4:7], v[32:35]
    v_mfma_f32_16x16x32_bf16 v[32:35], a[160:163], a[84:87], v[32:35]
    ds_write_b128 v231, v[24:27] offset:1024
    v_mfma_f32_16x16x32_bf16 v[36:39], a[164:167], a[84:87], v[36:39]
    v_mfma_f32_16x16x32_bf16 v[36:39], a[208:211], a[4:7], v[36:39]
    v_mfma_f32_16x16x32_bf16 v[36:39], a[228:231], v[212:215], v[36:39]
    v_mfma_f32_16x16x32_bf16 v[36:39], a[248:251], v[236:239], v[36:39]
    s_waitcnt vmcnt(2)
    ds_write_b128 v231, v[28:31] offset:2048
    v_mfma_f32_16x16x32_bf16 v[40:43], a[148:151], a[88:91], v[40:43]
    v_mfma_f32_16x16x32_bf16 v[40:43], a[192:195], a[8:11], v[40:43]
    v_mfma_f32_16x16x32_bf16 v[40:43], a[212:215], v[216:219], v[40:43]
    v_mfma_f32_16x16x32_bf16 v[40:43], a[232:235], v[240:243], v[40:43]
    ds_write_b128 v231, v[32:35] offset:3072
    v_mfma_f32_16x16x32_bf16 v[44:47], a[236:239], v[240:243], v[44:47]
    v_mfma_f32_16x16x32_bf16 v[44:47], a[216:219], v[216:219], v[44:47]
    v_mfma_f32_16x16x32_bf16 v[44:47], a[196:199], a[8:11], v[44:47]
    v_mfma_f32_16x16x32_bf16 v[44:47], a[152:155], a[88:91], v[44:47]
    ds_write_b128 v231, v[36:39] offset:4096
    v_mfma_f32_16x16x32_bf16 v[48:51], a[156:159], a[88:91], v[48:51]
    v_mfma_f32_16x16x32_bf16 v[48:51], a[200:203], a[8:11], v[48:51]
    v_mfma_f32_16x16x32_bf16 v[48:51], a[220:223], v[216:219], v[48:51]
    v_mfma_f32_16x16x32_bf16 v[48:51], a[240:243], v[240:243], v[48:51]
    ds_write_b128 v253, v[40:43] offset:0
    v_mfma_f32_16x16x32_bf16 v[52:55], a[244:247], v[240:243], v[52:55]
    v_mfma_f32_16x16x32_bf16 v[52:55], a[224:227], v[216:219], v[52:55]
    v_mfma_f32_16x16x32_bf16 v[52:55], a[204:207], a[8:11], v[52:55]
    v_mfma_f32_16x16x32_bf16 v[52:55], a[160:163], a[88:91], v[52:55]
    ds_write_b128 v253, v[44:47] offset:1024
    v_mfma_f32_16x16x32_bf16 v[56:59], a[164:167], a[88:91], v[56:59]
    v_mfma_f32_16x16x32_bf16 v[56:59], a[208:211], a[8:11], v[56:59]
    v_mfma_f32_16x16x32_bf16 v[56:59], a[228:231], v[216:219], v[56:59]
    v_mfma_f32_16x16x32_bf16 v[56:59], a[248:251], v[240:243], v[56:59]
    s_waitcnt vmcnt(1)
    ds_write_b128 v253, v[48:51] offset:2048
    v_mfma_f32_16x16x32_bf16 v[60:63], a[148:151], a[92:95], v[60:63]
    v_mfma_f32_16x16x32_bf16 v[60:63], a[192:195], a[12:15], v[60:63]
    v_mfma_f32_16x16x32_bf16 v[60:63], a[212:215], v[220:223], v[60:63]
    v_mfma_f32_16x16x32_bf16 v[60:63], a[232:235], v[244:247], v[60:63]
    ds_write_b128 v253, v[52:55] offset:3072
    v_mfma_f32_16x16x32_bf16 v[64:67], a[236:239], v[244:247], v[64:67]
    v_mfma_f32_16x16x32_bf16 v[64:67], a[216:219], v[220:223], v[64:67]
    v_mfma_f32_16x16x32_bf16 v[64:67], a[196:199], a[12:15], v[64:67]
    v_mfma_f32_16x16x32_bf16 v[64:67], a[152:155], a[92:95], v[64:67]
    ds_write_b128 v253, v[56:59] offset:4096
    v_mfma_f32_16x16x32_bf16 v[68:71], a[156:159], a[92:95], v[68:71]
    v_mfma_f32_16x16x32_bf16 v[68:71], a[200:203], a[12:15], v[68:71]
    v_mfma_f32_16x16x32_bf16 v[68:71], a[220:223], v[220:223], v[68:71]
    v_mfma_f32_16x16x32_bf16 v[68:71], a[240:243], v[244:247], v[68:71]
    ds_write_b128 v254, v[60:63] offset:0
    v_mfma_f32_16x16x32_bf16 v[72:75], a[244:247], v[244:247], v[72:75]
    v_mfma_f32_16x16x32_bf16 v[72:75], a[224:227], v[220:223], v[72:75]
    v_mfma_f32_16x16x32_bf16 v[72:75], a[204:207], a[12:15], v[72:75]
    v_mfma_f32_16x16x32_bf16 v[72:75], a[160:163], a[92:95], v[72:75]
    ds_write_b128 v254, v[64:67] offset:1024
    v_mfma_f32_16x16x32_bf16 v[76:79], a[164:167], a[92:95], v[76:79]
    v_mfma_f32_16x16x32_bf16 v[76:79], a[208:211], a[12:15], v[76:79]
    v_mfma_f32_16x16x32_bf16 v[76:79], a[228:231], v[220:223], v[76:79]
    v_mfma_f32_16x16x32_bf16 v[76:79], a[248:251], v[244:247], v[76:79]
    s_waitcnt vmcnt(0)
    ds_write_b128 v254, v[68:71] offset:2048
    v_mfma_f32_16x16x32_bf16 v[0:3], a[148:151], a[80:83], v[0:3]
    v_mfma_f32_16x16x32_bf16 v[0:3], a[192:195], a[0:3], v[0:3]
    v_mfma_f32_16x16x32_bf16 v[0:3], a[212:215], v[208:211], v[0:3]
    v_mfma_f32_16x16x32_bf16 v[0:3], a[232:235], v[232:235], v[0:3]
    ds_write_b128 v254, v[72:75] offset:3072
    v_mfma_f32_16x16x32_bf16 v[4:7], a[236:239], v[232:235], v[4:7]
    v_mfma_f32_16x16x32_bf16 v[4:7], a[216:219], v[208:211], v[4:7]
    v_mfma_f32_16x16x32_bf16 v[4:7], a[196:199], a[0:3], v[4:7]
    v_mfma_f32_16x16x32_bf16 v[4:7], a[152:155], a[80:83], v[4:7]
    ds_write_b128 v254, v[76:79] offset:4096
    v_mfma_f32_16x16x32_bf16 v[8:11], a[156:159], a[80:83], v[8:11]
    v_mfma_f32_16x16x32_bf16 v[8:11], a[200:203], a[0:3], v[8:11]
    v_mfma_f32_16x16x32_bf16 v[8:11], a[220:223], v[208:211], v[8:11]
    v_mfma_f32_16x16x32_bf16 v[8:11], a[240:243], v[232:235], v[8:11]
    s_waitcnt lgkmcnt(0)
    v_mfma_f32_16x16x32_bf16 v[12:15], a[244:247], v[232:235], v[12:15]
    s_barrier
    ds_read_b128 v[20:23], v230 offset:0
    ds_read_b128 v[40:43], v230 offset:5120
    v_mfma_f32_16x16x32_bf16 v[12:15], a[224:227], v[208:211], v[12:15]
    ds_read_b128 v[60:63], v230 offset:10240
    ds_read_b128 v[24:27], v230 offset:1024
    v_mfma_f32_16x16x32_bf16 v[12:15], a[204:207], a[0:3], v[12:15]
    ds_read_b128 v[44:47], v230 offset:6144
    ds_read_b128 v[64:67], v230 offset:11264
    v_mfma_f32_16x16x32_bf16 v[12:15], a[160:163], a[80:83], v[12:15]
    ds_read_b128 v[28:31], v230 offset:2048
    ds_read_b128 v[48:51], v230 offset:7168
    v_mfma_f32_16x16x32_bf16 v[16:19], a[164:167], a[80:83], v[16:19]
    ds_read_b128 v[68:71], v230 offset:12288
    ds_read_b128 v[32:35], v230 offset:3072
    v_mfma_f32_16x16x32_bf16 v[16:19], a[208:211], a[0:3], v[16:19]
    ds_read_b128 v[52:55], v230 offset:8192
    ds_read_b128 v[72:75], v230 offset:13312
    v_mfma_f32_16x16x32_bf16 v[16:19], a[228:231], v[208:211], v[16:19]
    ds_read_b128 v[36:39], v230 offset:4096
    ds_read_b128 v[56:59], v230 offset:9216
    v_mfma_f32_16x16x32_bf16 v[16:19], a[248:251], v[232:235], v[16:19]
    ds_read_b128 v[76:79], v230 offset:14336
    s_waitcnt lgkmcnt(12)
    v_pk_add_f32 v[0:1], v[0:1], v[20:21]
    v_pk_add_f32 v[40:41], v[40:41], v[60:61]
    v_pk_add_f32 v[2:3], v[2:3], v[22:23]
    v_pk_add_f32 v[42:43], v[42:43], v[62:63]
    v_pk_add_f32 v[0:1], v[0:1], v[40:41]
    v_pk_add_f32 v[2:3], v[2:3], v[42:43]
    v_pk_fma_f32 v[80:81], v[100:101], v[0:1], v[80:81]
    v_pk_fma_f32 v[82:83], v[102:103], v[2:3], v[82:83]
    v_cvt_pk_bf16_f32 v160, v80, v81
    v_cvt_pk_bf16_f32 v161, v82, v83
    ds_write_b64 v248, v[160:161] offset:0
    s_waitcnt lgkmcnt(10)
    v_pk_add_f32 v[4:5], v[4:5], v[24:25]
    v_pk_add_f32 v[44:45], v[44:45], v[64:65]
    v_pk_add_f32 v[6:7], v[6:7], v[26:27]
    v_pk_add_f32 v[46:47], v[46:47], v[66:67]
    v_pk_add_f32 v[4:5], v[4:5], v[44:45]
    v_pk_add_f32 v[6:7], v[6:7], v[46:47]
    v_pk_fma_f32 v[84:85], v[104:105], v[4:5], v[84:85]
    v_pk_fma_f32 v[86:87], v[106:107], v[6:7], v[86:87]
    v_cvt_pk_bf16_f32 v162, v84, v85
    v_cvt_pk_bf16_f32 v163, v86, v87
    ds_write_b64 v248, v[162:163] offset:32
    ds_read_b128 v[172:175], v126 offset:0
    s_waitcnt lgkmcnt(9)
    v_pk_add_f32 v[8:9], v[8:9], v[28:29]
    v_pk_add_f32 v[48:49], v[48:49], v[68:69]
    v_pk_add_f32 v[10:11], v[10:11], v[30:31]
    v_pk_add_f32 v[50:51], v[50:51], v[70:71]
    v_pk_add_f32 v[8:9], v[8:9], v[48:49]
    v_pk_add_f32 v[10:11], v[10:11], v[50:51]
    v_pk_fma_f32 v[88:89], v[108:109], v[8:9], v[88:89]
    v_pk_fma_f32 v[90:91], v[110:111], v[10:11], v[90:91]
    v_cvt_pk_bf16_f32 v164, v88, v89
    v_cvt_pk_bf16_f32 v165, v90, v91
    ds_write_b64 v248, v[164:165] offset:1280
    s_waitcnt lgkmcnt(7)
    v_pk_add_f32 v[12:13], v[12:13], v[32:33]
    v_pk_add_f32 v[52:53], v[52:53], v[72:73]
    v_pk_add_f32 v[14:15], v[14:15], v[34:35]
    v_pk_add_f32 v[54:55], v[54:55], v[74:75]
    v_pk_add_f32 v[12:13], v[12:13], v[52:53]
    v_pk_add_f32 v[14:15], v[14:15], v[54:55]
    v_pk_fma_f32 v[92:93], v[112:113], v[12:13], v[92:93]
    v_pk_fma_f32 v[94:95], v[114:115], v[14:15], v[94:95]
    v_cvt_pk_bf16_f32 v166, v92, v93
    v_cvt_pk_bf16_f32 v167, v94, v95
    ds_write_b64 v248, v[166:167] offset:1312
    ds_read_b128 v[176:179], v126 offset:1280
    s_waitcnt lgkmcnt(3)
    buffer_store_dwordx4 v[172:175], v228, s[72:75], s84 offen offset:0
    s_waitcnt lgkmcnt(6)
    v_pk_add_f32 v[16:17], v[16:17], v[36:37]
    v_pk_add_f32 v[56:57], v[56:57], v[76:77]
    v_pk_add_f32 v[18:19], v[18:19], v[38:39]
    v_pk_add_f32 v[58:59], v[58:59], v[78:79]
    v_pk_add_f32 v[16:17], v[16:17], v[56:57]
    v_pk_add_f32 v[18:19], v[18:19], v[58:59]
    v_pk_fma_f32 v[96:97], v[116:117], v[16:17], v[96:97]
    v_pk_fma_f32 v[98:99], v[118:119], v[18:19], v[98:99]
    v_cvt_pk_bf16_f32 v168, v96, v97
    v_cvt_pk_bf16_f32 v169, v98, v99
    ds_write_b64 v248, v[168:169] offset:2560
    ds_read_b128 v[180:183], v126 offset:2560
    s_waitcnt lgkmcnt(2)
    buffer_store_dwordx4 v[176:179], v228, s[72:75], s84 offen offset:64
    s_mov_b32 exec_lo, 0x33333333
    s_mov_b32 exec_hi, 0x33333333
    s_waitcnt lgkmcnt(0)
    buffer_store_dwordx4 v[180:183], v228, s[72:75], s85 offen
    s_mov_b64 exec, -1
PK_end:
    s_endpgm
S0_spin:
    s_mov_b32 s98, 262144
S0_loop:
    buffer_load_dword v236, v240, s[16:19], s27 offen sc1
    s_sub_u32 s98, s98, 1
    s_waitcnt vmcnt(0)
    s_cbranch_scc1 S0_ok
    v_cmp_ne_u32 vcc, s55, v236
    s_cbranch_vccz S0_ok
    s_sleep 2
    s_branch S0_loop
K1_pg0:
    ds_read_b32 v223, v222
    s_waitcnt lgkmcnt(0)
    v_cmp_gt_u32 vcc, v220, v223
    s_cbranch_vccnz K1_pg0
    s_branch K1_pg0_ok
K1_pg1:
    ds_read_b32 v223, v222
    s_waitcnt lgkmcnt(0)
    v_cmp_gt_u32 vcc, v220, v223
    s_cbranch_vccnz K1_pg1
    s_branch K1_pg1_ok
SP_spin:
    s_mov_b32 s98, 262144
SP_loop:
    buffer_load_dword v238, v236, s[16:19], s24 offen sc1
    s_sub_u32 s98, s98, 1
    s_waitcnt vmcnt(0)
    s_cbranch_scc1 SP_ok
    v_cmp_ne_u32 vcc, s55, v238
    s_cbranch_vccz SP_ok
    s_sleep 6
    s_branch SP_loop
S2b_spin:
    s_mov_b32 s98, 262144
S2b_loop:
    buffer_load_dword v237, v236, s[16:19], s27 offen sc1
    s_sub_u32 s98, s98, 1
    s_waitcnt vmcnt(0)
    s_cbranch_scc1 S2b_ok
    v_cmp_ne_u32 vcc, s55, v237
    s_cbranch_vccz S2b_ok
    s_sleep 6
    s_branch S2b_loop
G2_idle:
    s_mov_b32 s3, 2883584
    s_mov_b64 exec, 1
    buffer_store_dword v97, v96, s[16:19], s3 offen
    s_mov_b64 exec, -1
    s_waitcnt lgkmcnt(0)
    s_mov_b32 s24, 0x7f000000
    v_mov_b32 v208, 0
    v_add_u32 v251, s86, v249
    v_add_u32 v252, s87, v249
    v_cmp_gt_u32 vcc, 0x100, v249
    v_subrev_u32 v252, 0x100, v252
    s_nop 0
    v_cndmask_b32 v251, v252, v251, vcc
    s_lshr_b32 s3, s37, 2
    s_add_u32 m0, s3, 102400
    s_barrier
    buffer_load_dwordx4 v251, s[16:19], 0 offen sc1 lds
    s_add_u32 s81, s51, 1351680
    s_add_u32 m0, s28, 0
    s_nop 0
    buffer_load_dwordx4 v249, s[16:19], s81 offen offset:0 sc1 lds
    s_add_u32 m0, s28, 0
    s_nop 0
    buffer_load_dwordx4 v249, s[16:19], s81 offen offset:1024 sc1 lds
    s_add_u32 m0, s28, 0
    s_nop 0
    buffer_load_dwordx4 v249, s[16:19], s81 offen offset:2048 sc1 lds
    s_add_u32 m0, s28, 0
    s_nop 0
    buffer_load_dwordx4 v249, s[16:19], s81 offen offset:3072 sc1 lds
    s_add_u32 s81, s81, s79
    s_add_u32 m0, s28, 4096
    s_nop 0
    buffer_load_dwordx4 v249, s[16:19], s81 offen offset:0 sc1 lds
    s_add_u32 s81, s51, 1679360
    s_add_u32 m0, s28, 5120
    s_nop 0
    buffer_load_dwordx4 v249, s[16:19], s81 offen offset:0 sc1 lds
    s_add_u32 m0, s28, 5120
    s_nop 0
    buffer_load_dwordx4 v249, s[16:19], s81 offen offset:1024 sc1 lds
    s_add_u32 m0, s28, 5120
    s_nop 0
    buffer_load_dwordx4 v249, s[16:19], s81 offen offset:2048 sc1 lds
    s_add_u32 m0, s29, -3072
    s_nop 0
    buffer_load_dwordx4 v249, s[16:19], s81 offen offset:3072 sc1 lds
    s_add_u32 s81, s81, s79
    s_add_u32 m0, s29, 1024
    s_nop 0
    buffer_load_dwordx4 v249, s[16:19], s81 offen offset:0 sc1 lds
    s_add_u32 s81, s51, 2007040
    s_cmp_lt_u32 s22, 3
    s_cselect_b32 s81, s81, 0x7f000000
    s_add_u32 m0, s29, 2048
    s_nop 0
    buffer_load_dwordx4 v249, s[16:19], s81 offen offset:0 sc1 lds
    s_add_u32 m0, s29, 2048
    s_nop 0
    buffer_load_dwordx4 v249, s[16:19], s81 offen offset:1024 sc1 lds
    s_add_u32 m0, s29, 2048
    s_nop 0
    buffer_load_dwordx4 v249, s[16:19], s81 offen offset:2048 sc1 lds
    s_add_u32 m0, s29, 2048
    s_nop 0
    buffer_load_dwordx4 v249, s[16:19], s81 offen offset:3072 sc1 lds
    s_add_u32 s81, s81, s79
    s_add_u32 m0, s29, 6144
    s_nop 0
    buffer_load_dwordx4 v249, s[16:19], s81 offen offset:0 sc1 lds
    s_add_u32 s81, s51, 0
    buffer_load_dwordx4 a[20:23], v249, s[16:19], s81 offen offset:0 sc1
    buffer_load_dwordx4 a[24:27], v249, s[16:19], s81 offen offset:1024 sc1
    buffer_load_dwordx4 a[28:31], v249, s[16:19], s81 offen offset:2048 sc1
    buffer_load_dwordx4 a[32:35], v249, s[16:19], s81 offen offset:3072 sc1
    s_add_u32 s81, s81, s79
    buffer_load_dwordx4 a[36:39], v249, s[16:19], s81 offen offset:0 sc1
    s_add_u32 s81, s51, 327680
    buffer_load_dwordx4 a[40:43], v249, s[16:19], s81 offen offset:0 sc1
    buffer_load_dwordx4 a[44:47], v249, s[16:19], s81 offen offset:1024 sc1
    buffer_load_dwordx4 a[48:51], v249, s[16:19], s81 offen offset:2048 sc1
    buffer_load_dwordx4 a[52:55], v249, s[16:19], s81 offen offset:3072 sc1
    s_add_u32 s81, s81, s79
    buffer_load_dwordx4 a[56:59], v249, s[16:19], s81 offen offset:0 sc1
    s_add_u32 s81, s51, 655360
    buffer_load_dwordx4 v[128:131], v249, s[16:19], s81 offen offset:0 sc1
    buffer_load_dwordx4 v[132:135], v249, s[16:19], s81 offen offset:1024 sc1
    buffer_load_dwordx4 v[136:139], v249, s[16:19], s81 offen offset:2048 sc1
    buffer_load_dwordx4 v[140:143], v249, s[16:19], s81 offen offset:3072 sc1
    s_add_u32 s81, s81, s79
    buffer_load_dwordx4 v[144:147], v249, s[16:19], s81 offen offset:0 sc1
    s_add_u32 s81, s51, 983040
    buffer_load_dwordx4 v[148:151], v249, s[16:19], s81 offen offset:0 sc1
    buffer_load_dwordx4 v[152:155], v249, s[16:19], s81 offen offset:1024 sc1
    buffer_load_dwordx4 v[156:159], v249, s[16:19], s81 offen offset:2048 sc1
    buffer_load_dwordx4 v[160:163], v249, s[16:19], s81 offen offset:3072 sc1
    s_add_u32 s81, s81, s79
    buffer_load_dwordx4 v[164:167], v249, s[16:19], s81 offen offset:0 sc1
    s_add_u32 s81, s51, 1310720
    buffer_load_dwordx4 v[168:171], v249, s[16:19], s81 offen offset:0 sc1
    buffer_load_dwordx4 v[172:175], v249, s[16:19], s81 offen offset:1024 sc1
    buffer_load_dwordx4 v[176:179], v249, s[16:19], s81 offen offset:2048 sc1
    buffer_load_dwordx4 v[180:183], v249, s[16:19], s81 offen offset:3072 sc1
    s_add_u32 s81, s81, s79
    buffer_load_dwordx4 v[184:187], v249, s[16:19], s81 offen offset:0 sc1
    s_add_u32 s81, s51, 1638400
    buffer_load_dwordx4 v[188:191], v249, s[16:19], s81 offen offset:0 sc1
    buffer_load_dwordx4 v[192:195], v249, s[16:19], s81 offen offset:1024 sc1
    buffer_load_dwordx4 v[196:199], v249, s[16:19], s81 offen offset:2048 sc1
    buffer_load_dwordx4 v[200:203], v249, s[16:19], s81 offen offset:3072 sc1
    s_add_u32 s81, s81, s79
    buffer_load_dwordx4 v[204:207], v249, s[16:19], s81 offen offset:0 sc1
    s_add_u32 s81, s51, 1966080
    s_cmp_lt_u32 s22, 3
    s_cselect_b32 s81, s81, 0x7f000000
    buffer_load_dwordx4 a[168:171], v249, s[16:19], s81 offen offset:0 sc1
    buffer_load_dwordx4 a[172:175], v249, s[16:19], s81 offen offset:1024 sc1
    buffer_load_dwordx4 a[176:179], v249, s[16:19], s81 offen offset:2048 sc1
    buffer_load_dwordx4 a[180:183], v249, s[16:19], s81 offen offset:3072 sc1
    s_add_u32 s81, s81, s79
    buffer_load_dwordx4 a[184:187], v249, s[16:19], s81 offen offset:0 sc1
    s_add_u32 s81, s51, 40960
    buffer_load_dwordx4 a[60:63], v249, s[16:19], s81 offen offset:0 sc1
    buffer_load_dwordx4 a[64:67], v249, s[16:19], s81 offen offset:1024 sc1
    buffer_load_dwordx4 a[68:71], v249, s[16:19], s81 offen offset:2048 sc1
    buffer_load_dwordx4 a[72:75], v249, s[16:19], s81 offen offset:3072 sc1
    s_add_u32 s81, s81, s79
    buffer_load_dwordx4 a[76:79], v249, s[16:19], s81 offen offset:0 sc1
    s_add_u32 s81, s51, 368640
    buffer_load_dwordx4 a[96:99], v249, s[16:19], s81 offen offset:0 sc1
    buffer_load_dwordx4 a[100:103], v249, s[16:19], s81 offen offset:1024 sc1
    buffer_load_dwordx4 a[104:107], v249, s[16:19], s81 offen offset:2048 sc1
    buffer_load_dwordx4 a[108:111], v249, s[16:19], s81 offen offset:3072 sc1
    s_add_u32 s81, s81, s79
    buffer_load_dwordx4 a[112:115], v249, s[16:19], s81 offen offset:0 sc1
    s_waitcnt vmcnt(0)
    s_branch G3_start
S3b_spin:
    s_mov_b32 s98, 262144
S3b_loop:
    buffer_load_dword v127, v126, s[16:19], s25 offen sc1
    s_sub_u32 s98, s98, 1
    s_waitcnt vmcnt(0)
    s_cbranch_scc1 S3b_ok
    v_cmp_ne_u32 vcc, s55, v127
    s_cbranch_vccz S3b_ok
    s_sleep 6
    s_branch S3b_loop
K1_dosig:
    s_cmp_eq_u32 s27, 3
    s_cbranch_scc1 K1_pull0
    s_cmp_eq_u32 s27, 2
    s_cbranch_scc1 K1_pull1
    s_cmp_eq_u32 s27, 1
    s_cbranch_scc1 K1_pull2
    s_mov_b32 s39, 3
    v_mov_b32 v240, 0
    v_mov_b32 v241, s55
    s_lshl_b32 s3, s2, 2
    s_add_u32 s3, s3, 2985984
    s_mov_b64 exec, 1
    buffer_store_dword v241, v240, s[16:19], s3 offen sc1
    s_mov_b64 exec, -1
    s_branch K1_sigret
K1_pull0:
    v_and_b32 v240, 16, v249
    v_lshlrev_b32 v240, 3, v240
    s_lshl_b32 s3, s2, 2
    s_add_u32 s3, s3, s22
    s_lshl_b32 s3, s3, 8
    s_add_u32 s3, s3, 2887680
    buffer_load_dword a255, v240, s[16:19], s3 offen sc1
    buffer_load_dword a255, v249, s[16:19], s89 offen sc1
    s_lshl_b32 s3, s83, 2
    s_lshr_b32 s98, s77, 1
    s_add_u32 s3, s3, s98
    s_lshl_b32 s3, s3, 8
    s_add_u32 s3, s3, 2686976
    v_and_b32 v240, 0xf0, v249
    buffer_load_dword a255, v240, s[16:19], s3 offen sc1
    s_mov_b32 s3, 2985984
    buffer_load_dwordx4 v[236:239], v249, s[16:19], s3 offen sc1
    s_branch K1_sigret
K1_pull1:
    v_xor_b32 v236, s55, v236
    v_xor_b32 v237, s55, v237
    v_xor_b32 v238, s55, v238
    v_xor_b32 v239, s55, v239
    v_or3_b32 v236, v236, v237, v238
    v_or_b32 v236, v236, v239
    v_cmp_ne_u32 vcc, 0, v236
    s_lshr_b32 s3, s2, 3
    s_lshl_b32 s3, s3, 2
    s_add_u32 s3, s3, s22
    s_mul_i32 s3, s3, 10240
    s_and_b32 s98, s2, 1
    s_mul_i32 s98, s98, 2621440
    s_add_u32 s3, s3, s98
    s_add_u32 s3, s3, 37748736
    s_cmp_eq_u64 vcc, 0
    s_cselect_b32 s48, s3, 0x7f000000
K1_pull2:
K1_pull3:
    v_lshlrev_b32 v240, 3, v249
    buffer_load_dword a255, v240, s[16:19], s48 offen sc1
    v_and_b32 v240, 0x780, v240
    s_add_u32 s3, s48, 8192
    buffer_load_dword a255, v240, s[16:19], s3 offen sc1
    s_add_u32 s48, s48, 1310720
    s_branch K1_sigret
R_fin:
    s_sub_u32 s3, s99, 3407872
    s_lshr_b32 s3, s3, 1
    s_add_u32 s3, s3, 2629632
    v_lshrrev_b32 v5, 1, v249
    buffer_store_dwordx2 v[16:17], v5, s[16:19], s3 offen sc1
    v_lshrrev_b32 v5, 1, v7
    buffer_store_dwordx2 v[20:21], v5, s[16:19], s3 offen sc1
    v_lshrrev_b32 v5, 1, v8
    buffer_store_dwordx2 v[24:25], v5, s[16:19], s3 offen sc1
    s_and_b32 s98, s2, 3
    s_mul_i32 s98, s98, 320
    s_bitcmp1_b32 s2, 2
    s_cselect_b32 s3, 0, 1280
    s_cselect_b64 vcc, -1, 0
    s_add_u32 s3, s3, s98
    s_add_u32 s3, s3, 2646016
    v_cndmask_b32 v19, v23, v19, vcc
    v_and_b32 v5, 0xfffffff1, v2
    v_bfe_u32 v6, v2, 1, 2
    v_lshl_add_u32 v5, v6, 2, v5
    v_bfe_u32 v6, v2, 3, 1
    v_lshl_add_u32 v5, v6, 1, v5
    v_lshlrev_b32 v5, 2, v5
    buffer_store_dword v19, v5, s[16:19], s3 offen sc1
    v_and_b32 v5, 63, v5
    s_bitcmp1_b32 s2, 2
    s_cselect_b32 s98, 0, 16
    s_lshl_b32 exec_lo, 0xffff, s98
    s_mov_b32 exec_hi, 0
    buffer_store_dword v27, v5, s[16:19], s3 offen offset:256 sc1
    s_mov_b64 exec, -1
    s_branch R_finret
K1_shwait:
    s_mov_b32 s49, 2985984
    s_mov_b32 s98, 262144
K1_shloop:
    buffer_load_dwordx4 v[244:247], v249, s[16:19], s49 offen sc1
    s_sub_u32 s98, s98, 1
    s_waitcnt vmcnt(0)
    s_cbranch_scc1 K1_shp_ret
    v_xor_b32 v244, s55, v244
    v_xor_b32 v245, s55, v245
    v_xor_b32 v246, s55, v246
    v_xor_b32 v247, s55, v247
    v_or3_b32 v244, v244, v245, v246
    v_or_b32 v244, v244, v247
    v_cmp_ne_u32 vcc, 0, v244
    s_cbranch_vccz K1_shp_ret
    s_sleep 8
    s_branch K1_shloop
K1_retry:
    s_cmp_lg_u32 s29, 0
    s_cbranch_scc1 K1_noretry
    v_mov_b32 v220, 0xff800000
    v_mov_b32 v221, 0xff800000
    v_mov_b32 v222, 0xff800000
    v_mov_b32 v223, 0xff800000
    s_mov_b32 s23, s35
    s_mov_b32 s27, 32
    s_mov_b32 m0, s37
    s_waitcnt vmcnt(0)
K1_maxloop:
    s_barrier
    buffer_load_dwordx4 v251, s[4:7], s23 offen offset:0  lds
    buffer_load_dwordx4 v252, s[4:7], s23 offen offset:1024  lds
    buffer_load_dwordx4 v251, s[4:7], s23 offen offset:2048  lds
    buffer_load_dwordx4 v252, s[4:7], s23 offen offset:3072  lds
    s_add_u32 s23, s23, 0x4000
    s_waitcnt vmcnt(0)
    s_barrier
    ds_read_b128 a[128:131], v208 offset:0
    ds_read_b128 a[132:135], v209 offset:0
    ds_read_b128 a[136:139], v210 offset:0
    ds_read_b128 a[140:143], v211 offset:0
    ds_read_b128 a[144:147], v208 offset:4096
    ds_read_b128 a[148:151], v209 offset:4096
    ds_read_b128 a[152:155], v210 offset:4096
    ds_read_b128 a[156:159], v211 offset:4096
    s_waitcnt lgkmcnt(0)
    v_mfma_f32_16x16x32_bf16 v[4:7], a[128:131], v[0:3], 0
    v_mfma_f32_16x16x32_bf16 v[4:7], a[132:135], v[8:11], v[4:7]
    v_mfma_f32_16x16x32_bf16 v[4:7], a[136:139], v[16:19], v[4:7]
    v_mfma_f32_16x16x32_bf16 v[4:7], a[140:143], v[24:27], v[4:7]
    v_mfma_f32_16x16x32_bf16 v[36:39], a[140:143], v[56:59], 0
    v_mfma_f32_16x16x32_bf16 v[36:39], a[136:139], v[48:51], v[36:39]
    v_mfma_f32_16x16x32_bf16 v[36:39], a[132:135], v[40:43], v[36:39]
    v_mfma_f32_16x16x32_bf16 v[36:39], a[128:131], v[32:35], v[36:39]
    v_mfma_f32_16x16x32_bf16 v[68:71], a[128:131], v[64:67], 0
    v_mfma_f32_16x16x32_bf16 v[68:71], a[132:135], v[72:75], v[68:71]
    v_mfma_f32_16x16x32_bf16 v[68:71], a[136:139], v[80:83], v[68:71]
    v_mfma_f32_16x16x32_bf16 v[68:71], a[140:143], v[88:91], v[68:71]
    v_mfma_f32_16x16x32_bf16 v[100:103], a[140:143], v[120:123], 0
    v_mfma_f32_16x16x32_bf16 v[100:103], a[136:139], v[112:115], v[100:103]
    v_mfma_f32_16x16x32_bf16 v[100:103], a[132:135], v[104:107], v[100:103]
    v_mfma_f32_16x16x32_bf16 v[100:103], a[128:131], v[96:99], v[100:103]
    v_mfma_f32_16x16x32_bf16 v[12:15], a[144:147], v[0:3], 0
    v_mfma_f32_16x16x32_bf16 v[12:15], a[148:151], v[8:11], v[12:15]
    v_mfma_f32_16x16x32_bf16 v[12:15], a[152:155], v[16:19], v[12:15]
    v_mfma_f32_16x16x32_bf16 v[12:15], a[156:159], v[24:27], v[12:15]
    v_mfma_f32_16x16x32_bf16 v[44:47], a[156:159], v[56:59], 0
    v_mfma_f32_16x16x32_bf16 v[44:47], a[152:155], v[48:51], v[44:47]
    v_mfma_f32_16x16x32_bf16 v[44:47], a[148:151], v[40:43], v[44:47]
    v_mfma_f32_16x16x32_bf16 v[44:47], a[144:147], v[32:35], v[44:47]
    v_mfma_f32_16x16x32_bf16 v[76:79], a[144:147], v[64:67], 0
    v_mfma_f32_16x16x32_bf16 v[76:79], a[148:151], v[72:75], v[76:79]
    v_mfma_f32_16x16x32_bf16 v[76:79], a[152:155], v[80:83], v[76:79]
    v_mfma_f32_16x16x32_bf16 v[76:79], a[156:159], v[88:91], v[76:79]
    v_mfma_f32_16x16x32_bf16 v[108:111], a[156:159], v[120:123], 0
    v_mfma_f32_16x16x32_bf16 v[108:111], a[152:155], v[112:115], v[108:111]
    v_mfma_f32_16x16x32_bf16 v[108:111], a[148:151], v[104:107], v[108:111]
    v_mfma_f32_16x16x32_bf16 v[108:111], a[144:147], v[96:99], v[108:111]
    s_nop 7
    v_max3_f32 v220, v220, v4, v5
    v_max3_f32 v220, v220, v6, v7
    v_max3_f32 v220, v220, v12, v13
    v_max3_f32 v220, v220, v14, v15
    v_max3_f32 v221, v221, v36, v37
    v_max3_f32 v221, v221, v38, v39
    v_max3_f32 v221, v221, v44, v45
    v_max3_f32 v221, v221, v46, v47
    v_max3_f32 v222, v222, v68, v69
    v_max3_f32 v222, v222, v70, v71
    v_max3_f32 v222, v222, v76, v77
    v_max3_f32 v222, v222, v78, v79
    v_max3_f32 v223, v223, v100, v101
    v_max3_f32 v223, v223, v102, v103
    v_max3_f32 v223, v223, v108, v109
    v_max3_f32 v223, v223, v110, v111
    ds_read_b128 a[128:131], v208 offset:8192
    ds_read_b128 a[132:135], v209 offset:8192
    ds_read_b128 a[136:139], v210 offset:8192
    ds_read_b128 a[140:143], v211 offset:8192
    ds_read_b128 a[144:147], v208 offset:12288
    ds_read_b128 a[148:151], v209 offset:12288
    ds_read_b128 a[152:155], v210 offset:12288
    ds_read_b128 a[156:159], v211 offset:12288
    s_waitcnt lgkmcnt(0)
    v_mfma_f32_16x16x32_bf16 v[4:7], a[128:131], v[0:3], 0
    v_mfma_f32_16x16x32_bf16 v[4:7], a[132:135], v[8:11], v[4:7]
    v_mfma_f32_16x16x32_bf16 v[4:7], a[136:139], v[16:19], v[4:7]
    v_mfma_f32_16x16x32_bf16 v[4:7], a[140:143], v[24:27], v[4:7]
    v_mfma_f32_16x16x32_bf16 v[36:39], a[140:143], v[56:59], 0
    v_mfma_f32_16x16x32_bf16 v[36:39], a[136:139], v[48:51], v[36:39]
    v_mfma_f32_16x16x32_bf16 v[36:39], a[132:135], v[40:43], v[36:39]
    v_mfma_f32_16x16x32_bf16 v[36:39], a[128:131], v[32:35], v[36:39]
    v_mfma_f32_16x16x32_bf16 v[68:71], a[128:131], v[64:67], 0
    v_mfma_f32_16x16x32_bf16 v[68:71], a[132:135], v[72:75], v[68:71]
    v_mfma_f32_16x16x32_bf16 v[68:71], a[136:139], v[80:83], v[68:71]
    v_mfma_f32_16x16x32_bf16 v[68:71], a[140:143], v[88:91], v[68:71]
    v_mfma_f32_16x16x32_bf16 v[100:103], a[140:143], v[120:123], 0
    v_mfma_f32_16x16x32_bf16 v[100:103], a[136:139], v[112:115], v[100:103]
    v_mfma_f32_16x16x32_bf16 v[100:103], a[132:135], v[104:107], v[100:103]
    v_mfma_f32_16x16x32_bf16 v[100:103], a[128:131], v[96:99], v[100:103]
    v_mfma_f32_16x16x32_bf16 v[12:15], a[144:147], v[0:3], 0
    v_mfma_f32_16x16x32_bf16 v[12:15], a[148:151], v[8:11], v[12:15]
    v_mfma_f32_16x16x32_bf16 v[12:15], a[152:155], v[16:19], v[12:15]
    v_mfma_f32_16x16x32_bf16 v[12:15], a[156:159], v[24:27], v[12:15]
    v_mfma_f32_16x16x32_bf16 v[44:47], a[156:159], v[56:59], 0
    v_mfma_f32_16x16x32_bf16 v[44:47], a[152:155], v[48:51], v[44:47]
    v_mfma_f32_16x16x32_bf16 v[44:47], a[148:151], v[40:43], v[44:47]
    v_mfma_f32_16x16x32_bf16 v[44:47], a[144:147], v[32:35], v[44:47]
    v_mfma_f32_16x16x32_bf16 v[76:79], a[144:147], v[64:67], 0
    v_mfma_f32_16x16x32_bf16 v[76:79], a[148:151], v[72:75], v[76:79]
    v_mfma_f32_16x16x32_bf16 v[76:79], a[152:155], v[80:83], v[76:79]
    v_mfma_f32_16x16x32_bf16 v[76:79], a[156:159], v[88:91], v[76:79]
    v_mfma_f32_16x16x32_bf16 v[108:111], a[156:159], v[120:123], 0
    v_mfma_f32_16x16x32_bf16 v[108:111], a[152:155], v[112:115], v[108:111]
    v_mfma_f32_16x16x32_bf16 v[108:111], a[148:151], v[104:107], v[108:111]
    v_mfma_f32_16x16x32_bf16 v[108:111], a[144:147], v[96:99], v[108:111]
    s_nop 7
    v_max3_f32 v220, v220, v4, v5
    v_max3_f32 v220, v220, v6, v7
    v_max3_f32 v220, v220, v12, v13
    v_max3_f32 v220, v220, v14, v15
    v_max3_f32 v221, v221, v36, v37
    v_max3_f32 v221, v221, v38, v39
    v_max3_f32 v221, v221, v44, v45
    v_max3_f32 v221, v221, v46, v47
    v_max3_f32 v222, v222, v68, v69
    v_max3_f32 v222, v222, v70, v71
    v_max3_f32 v222, v222, v76, v77
    v_max3_f32 v222, v222, v78, v79
    v_max3_f32 v223, v223, v100, v101
    v_max3_f32 v223, v223, v102, v103
    v_max3_f32 v223, v223, v108, v109
    v_max3_f32 v223, v223, v110, v111
    s_sub_u32 s27, s27, 1
    s_cmp_lg_u32 s27, 0
    s_cbranch_scc1 K1_maxloop
    v_accvgpr_write_b32 a224, v220
    v_accvgpr_write_b32 a225, v221
    v_accvgpr_write_b32 a226, v222
    v_accvgpr_write_b32 a227, v223
    s_mov_b32 s23, s35
    s_mov_b32 s24, s35
    s_add_u32 m0, s37, 32768
    s_nop 0
    buffer_load_dwordx4 v251, s[4:7], s23 offen offset:0  lds
    buffer_load_dwordx4 v252, s[4:7], s23 offen offset:1024  lds
    buffer_load_dwordx4 v251, s[4:7], s23 offen offset:2048  lds
    buffer_load_dwordx4 v252, s[4:7], s23 offen offset:3072  lds
    s_add_u32 s23, s23, 0x4000
    s_add_u32 m0, s37, 65536
    s_nop 0
    buffer_load_dwordx4 v251, s[4:7], s23 offen offset:0  lds
    buffer_load_dwordx4 v252, s[4:7], s23 offen offset:1024  lds
    buffer_load_dwordx4 v251, s[4:7], s23 offen offset:2048  lds
    buffer_load_dwordx4 v252, s[4:7], s23 offen offset:3072  lds
    s_add_u32 s23, s23, 0x4000
    s_add_u32 m0, s37, 98304
    s_nop 0
    buffer_load_dwordx4 v251, s[4:7], s23 offen offset:0  lds
    buffer_load_dwordx4 v252, s[4:7], s23 offen offset:1024  lds
    buffer_load_dwordx4 v251, s[4:7], s23 offen offset:2048  lds
    buffer_load_dwordx4 v252, s[4:7], s23 offen offset:3072  lds
    s_add_u32 s23, s23, 0x4000
    s_add_u32 m0, s37, 114688
    s_nop 0
    buffer_load_dwordx4 v251, s[8:11], s24 offen offset:0  lds
    buffer_load_dwordx4 v252, s[8:11], s24 offen offset:1024  lds
    buffer_load_dwordx4 v251, s[8:11], s24 offen offset:2048  lds
    buffer_load_dwordx4 v252, s[8:11], s24 offen offset:3072  lds
    s_add_u32 s24, s24, 0x4000
    s_mov_b32 s28, 0
    s_mov_b32 s29, 1
    s_mov_b32 s39, 0
    s_mov_b32 s101, 0x7f000000
    s_mov_b32 s48, 0x7f000000
    s_waitcnt vmcnt(0)
    s_barrier
    ds_read_b128 a[160:163], v208 offset:32768
    ds_read_b128 a[164:167], v209 offset:32768
    ds_read_b128 a[168:171], v210 offset:32768
    ds_read_b128 a[172:175], v211 offset:32768
    ds_read_b128 a[176:179], v208 offset:36864
    ds_read_b128 a[180:183], v209 offset:36864
    ds_read_b128 a[184:187], v210 offset:36864
    ds_read_b128 a[188:191], v211 offset:36864
PK_last:
    s_branch K1_att0
    .fill 256, 4, 0xBF800000

.section .rodata,"a"
.p2align 6
.amdhsa_kernel adaLN_cond__mha_block_cached__glu_gated_reglu__prompt_kernel
  .amdhsa_next_free_vgpr 512
  .amdhsa_next_free_sgpr 102
  .amdhsa_accum_offset 256
  .amdhsa_group_segment_fixed_size 0
  .amdhsa_kernarg_size 112
  .amdhsa_user_sgpr_count 2
  .amdhsa_user_sgpr_kernarg_segment_ptr 1
  .amdhsa_system_sgpr_workgroup_id_x 1
  .amdhsa_float_denorm_mode_32 3
.end_amdhsa_kernel
```
